```python
import torch

def _softmax(x, axis=-1):
    return torch.softmax(x, dim=axis)
def _gelu(x):
    return torch.nn.functional.gelu(x, approximate="tanh")
def _silu(x):
    return torch.nn.functional.silu(x)
def _sigmoid(x):
    return torch.sigmoid(x)
def _layernorm(x, axis=-1, eps=1e-5):
    m = x.mean(dim=axis, keepdim=True)
    v = x.var(dim=axis, keepdim=True, unbiased=False)
    return (x - m) / torch.sqrt(v + eps)
def _scatter_add(tgt, idx, src, axis=0):
    return tgt.clone().index_add_(axis, idx, src)
def _segment_sum(src, seg, n):
    out = torch.zeros((n,) + src.shape[1:], dtype=src.dtype)
    return out.index_add_(0, seg, src)
def _pad(x, pw):
    flat = tuple(v for pair in reversed(pw) for v in pair)
    return torch.nn.functional.pad(x, flat)

kernel_name = 'interleave_layers__ssm_conv_s4__geglu_ffn__prompt'

def setup_inputs():

    _w = (lambda a: (lambda t: t.to(torch.bfloat16) if t.is_floating_point() else t)(torch.as_tensor(a)))
    def _A_setup():
        B, L, D, N = 1, 2048, 512, 128
        A_re = -(lambda _x: torch.exp(torch.as_tensor(_x)))((lambda *s: torch.randn(*s, dtype=torch.bfloat16) * 1.6)(D, N))
        A_im = torch.pi * (lambda *s: torch.randn(*s, dtype=torch.bfloat16) * 0.2)(D, N)
        B_re = (lambda *s: torch.randn(*s, dtype=torch.bfloat16) * 0.2)(D, N)
        B_im = (lambda *s: torch.randn(*s, dtype=torch.bfloat16) * 0.2)(D, N)
        C_re = (lambda *s: torch.randn(*s, dtype=torch.bfloat16) * 0.2)(D, N)
        C_im = (lambda *s: torch.randn(*s, dtype=torch.bfloat16) * 0.2)(D, N)
        log_dt = (lambda *s: torch.randn(*s, dtype=torch.bfloat16) * 0.2)(D) * 0.5 - 4.0
        Dskip = (lambda *s: torch.randn(*s, dtype=torch.bfloat16) * 0.2)(D)
        return {
            "u": _w((lambda *s: torch.randn(*s, dtype=torch.bfloat16) * 0.05)(B, L, D)),
            "A_re": _w(A_re),
            "A_im": _w(A_im),
            "B_re": _w(B_re),
            "B_im": _w(B_im),
            "C_re": _w(C_re),
            "C_im": _w(C_im),
            "log_dt": _w(log_dt),
            "Dskip": _w(Dskip),
        }
    _A_in = _A_setup()

    def _B_setup():
        B, S, D, F = 1, 2048, 512, 1792
        return {
            "x": _w((lambda *s: torch.randn(*s, dtype=torch.bfloat16) * 0.05)(B, S, D)),
            "w_gate": _w((lambda *s: torch.randn(*s, dtype=torch.bfloat16) * 0.05)(D, F)),
            "w_up": _w((lambda *s: torch.randn(*s, dtype=torch.bfloat16) * 0.05)(D, F)),
            "w_down": _w((lambda *s: torch.randn(*s, dtype=torch.bfloat16) * 0.05)(F, D)),
        }
    _B_in = _B_setup()

    return {
        "A_u": _A_in["u"],
        "A_A_re": _A_in["A_re"],
        "A_A_im": _A_in["A_im"],
        "A_B_re": _A_in["B_re"],
        "A_B_im": _A_in["B_im"],
        "A_C_re": _A_in["C_re"],
        "A_C_im": _A_in["C_im"],
        "A_log_dt": _A_in["log_dt"],
        "A_Dskip": _A_in["Dskip"],
        "B_x": _B_in["x"],
        "B_w_gate": _B_in["w_gate"],
        "B_w_up": _B_in["w_up"],
        "B_w_down": _B_in["w_down"],
    }

def reference(A_u, A_A_re, A_A_im, A_B_re, A_B_im, A_C_re, A_C_im, A_log_dt, A_Dskip, B_x, B_w_gate, B_w_up, B_w_down):
    def _A_ref(u, A_re, A_im, B_re, B_im, C_re, C_im, log_dt, Dskip):
        Bsz, L, D = u.shape
        dt = torch.exp(log_dt)[:, None]
        A = A_re + 1j * A_im
        Bc = B_re + 1j * B_im
        Cc = C_re + 1j * C_im
        logdA = dt * A
        dB = dt * Bc
        l = (lambda x, dt: x.to(dt))(torch.arange(L), A_re.dtype)
        P = torch.exp(logdA[:, :, None] * l[None, None, :])
        K = torch.einsum("dn,dnl,dn->dl", Cc, P, dB).real
        L2 = 2 * L
        Kp = _pad(K, ((0, 0), (0, L)))
        up = (lambda x, *d: x.permute(*d))(u, 0, 2, 1)
        up = _pad(up, ((0, 0), (0, 0), (0, L)))
        Kf = (lambda x, axes=(-2,-1): torch.fft.rfft2(x.float(), dim=axes))(Kp[:, None, :], axes=(-2, -1))
        Uf = (lambda x, axes=(-2,-1): torch.fft.rfft2(x.float(), dim=axes))(up[:, :, None, :], axes=(-2, -1))
        Yf = Uf * Kf[None, :, :, :]
        y = (lambda x, s, axes=(-2,-1): torch.fft.irfft2(x, s=s, dim=axes).to(torch.bfloat16))(Yf, (1, L2), axes=(-2, -1))[:, :, 0, :L]
        y = (lambda x, *d: x.permute(*d))(y, 0, 2, 1) + u * Dskip[None, None, :]
        return y

    def _B_ref(x, w_gate, w_up, w_down):
        return (_gelu(x @ w_gate) * (x @ w_up)) @ w_down

    x = A_u
    x = x + _A_ref(_layernorm(x, axis=-1), A_A_re, A_A_im, A_B_re, A_B_im, A_C_re, A_C_im, A_log_dt, A_Dskip)
    x = x + _B_ref(_layernorm(x, axis=-1), B_w_gate, B_w_up, B_w_down)
    x = x + _A_ref(_layernorm(x, axis=-1), A_A_re, A_A_im, A_B_re, A_B_im, A_C_re, A_C_im, A_log_dt, A_Dskip)
    x = x + _B_ref(_layernorm(x, axis=-1), B_w_gate, B_w_up, B_w_down)
    return x
```

```asm
; @launch kernel=prep_kernel grid=(861,1,1) block=(256,1,1) lds=137216
; @launch kernel=conv1_kernel grid=(256,1,1) block=(256,1,1) lds=42432
; @launch kernel=g1a_kernel grid=(224,1,1) block=(256,1,1) lds=147456
; @launch kernel=g2a_kernel grid=(256,1,1) block=(256,1,1) lds=65536
; @launch kernel=conv2_kernel grid=(256,1,1) block=(256,1,1) lds=42432
; @launch kernel=g1b_kernel grid=(224,1,1) block=(256,1,1) lds=147456
; @launch kernel=g2b_kernel grid=(256,1,1) block=(256,1,1) lds=65536
.amdgcn_target "amdgcn-amd-amdhsa--gfx950"
.text
.globl prep_kernel
.p2align 8
.type prep_kernel,@function
prep_kernel:
    s_cmp_ge_u32 s2, 861
    s_cbranch_scc1 prep_exit
    s_load_dwordx2 s[6:7], s[0:1], 120
    s_cmp_ge_u32 s2, 349
    s_cbranch_scc1 prep_kgen
    s_cmp_ge_u32 s2, 348
    s_cbranch_scc1 prep_zero
    s_cmp_ge_u32 s2, 320
    s_cbranch_scc1 prep_colsum
    s_cmp_ge_u32 s2, 256
    s_cbranch_scc1 prep_stats
    s_load_dwordx2 s[4:5], s[0:1], 0
    s_waitcnt lgkmcnt(0)
    s_add_u32 s8, s4, 0x0
    s_addc_u32 s9, s5, 0
    s_and_b32 s9, s9, 0xffff
    s_mov_b32 s10, 0x200000
    s_mov_b32 s11, 0x00020000
    s_add_u32 s12, s6, 0x0
    s_addc_u32 s13, s7, 0
    s_and_b32 s13, s13, 0xffff
    s_mov_b32 s14, 0x200000
    s_mov_b32 s15, 0x00020000
    s_lshr_b32 s16, s2, 3
    s_lshl_b32 s16, s16, 6
    s_and_b32 s17, s2, 7
    s_lshl_b32 s17, s17, 6
    v_and_b32 v1, 63, v0
    v_lshrrev_b32 v2, 6, v0
    v_lshlrev_b32 v3, 4, v2
    v_add_u32 v3, s16, v3
    v_add_u32 v4, s17, v1
    v_lshlrev_b32 v5, 10, v3
    v_lshl_add_u32 v5, v4, 1, v5
    s_movk_i32 s18, 0x1000
    s_movk_i32 s19, 0x2000
    s_movk_i32 s20, 0x3000
    buffer_load_ushort v10, v5, s[8:11], 0 offen offset:0
    buffer_load_ushort v11, v5, s[8:11], 0 offen offset:1024
    buffer_load_ushort v12, v5, s[8:11], 0 offen offset:2048
    buffer_load_ushort v13, v5, s[8:11], 0 offen offset:3072
    buffer_load_ushort v14, v5, s[8:11], s18 offen offset:0
    buffer_load_ushort v15, v5, s[8:11], s18 offen offset:1024
    buffer_load_ushort v16, v5, s[8:11], s18 offen offset:2048
    buffer_load_ushort v17, v5, s[8:11], s18 offen offset:3072
    buffer_load_ushort v18, v5, s[8:11], s19 offen offset:0
    buffer_load_ushort v19, v5, s[8:11], s19 offen offset:1024
    buffer_load_ushort v20, v5, s[8:11], s19 offen offset:2048
    buffer_load_ushort v21, v5, s[8:11], s19 offen offset:3072
    buffer_load_ushort v22, v5, s[8:11], s20 offen offset:0
    buffer_load_ushort v23, v5, s[8:11], s20 offen offset:1024
    buffer_load_ushort v24, v5, s[8:11], s20 offen offset:2048
    buffer_load_ushort v25, v5, s[8:11], s20 offen offset:3072
    v_lshlrev_b32 v6, 12, v4
    v_lshl_add_u32 v6, v3, 1, v6
    s_waitcnt vmcnt(0)
    v_lshl_or_b32 v30, v11, 16, v10
    v_lshl_or_b32 v31, v13, 16, v12
    v_lshl_or_b32 v32, v15, 16, v14
    v_lshl_or_b32 v33, v17, 16, v16
    v_lshl_or_b32 v34, v19, 16, v18
    v_lshl_or_b32 v35, v21, 16, v20
    v_lshl_or_b32 v36, v23, 16, v22
    v_lshl_or_b32 v37, v25, 16, v24
    buffer_store_dwordx4 v[30:33], v6, s[12:15], 0 offen
    buffer_store_dwordx4 v[34:37], v6, s[12:15], 0 offen offset:16
    s_endpgm
prep_stats:
    s_load_dwordx2 s[4:5], s[0:1], 0
    s_waitcnt lgkmcnt(0)
    s_add_u32 s8, s4, 0x0
    s_addc_u32 s9, s5, 0
    s_and_b32 s9, s9, 0xffff
    s_mov_b32 s10, 0x200000
    s_mov_b32 s11, 0x00020000
    s_add_u32 s12, s6, 0x1400000
    s_addc_u32 s13, s7, 0
    s_and_b32 s13, s13, 0xffff
    s_mov_b32 s14, 0x4000
    s_mov_b32 s15, 0x00020000
    s_sub_u32 s16, s2, 256
    s_lshl_b32 s16, s16, 5
    v_lshrrev_b32 v1, 6, v0
    v_lshlrev_b32 v1, 3, v1
    v_add_u32 v1, s16, v1
    v_and_b32 v2, 63, v0
    v_lshlrev_b32 v3, 10, v1
    v_lshl_add_u32 v3, v2, 4, v3
    s_movk_i32 s18, 0x1000
    buffer_load_dwordx4 v[8:11], v3, s[8:11], 0 offen offset:0
    buffer_load_dwordx4 v[12:15], v3, s[8:11], 0 offen offset:1024
    buffer_load_dwordx4 v[16:19], v3, s[8:11], 0 offen offset:2048
    buffer_load_dwordx4 v[20:23], v3, s[8:11], 0 offen offset:3072
    buffer_load_dwordx4 v[24:27], v3, s[8:11], s18 offen offset:0
    buffer_load_dwordx4 v[28:31], v3, s[8:11], s18 offen offset:1024
    buffer_load_dwordx4 v[32:35], v3, s[8:11], s18 offen offset:2048
    buffer_load_dwordx4 v[36:39], v3, s[8:11], s18 offen offset:3072
    v_mov_b32 v4, 0x3f803f80
    v_mov_b32 v40, 0
    v_mov_b32 v48, 0
    v_mov_b32 v41, 0
    v_mov_b32 v49, 0
    v_mov_b32 v42, 0
    v_mov_b32 v50, 0
    v_mov_b32 v43, 0
    v_mov_b32 v51, 0
    v_mov_b32 v44, 0
    v_mov_b32 v52, 0
    v_mov_b32 v45, 0
    v_mov_b32 v53, 0
    v_mov_b32 v46, 0
    v_mov_b32 v54, 0
    v_mov_b32 v47, 0
    v_mov_b32 v55, 0
    s_waitcnt vmcnt(7)
    v_dot2_f32_bf16 v40, v8, v4, v40
    v_dot2_f32_bf16 v40, v9, v4, v40
    v_dot2_f32_bf16 v40, v10, v4, v40
    v_dot2_f32_bf16 v40, v11, v4, v40
    v_dot2_f32_bf16 v48, v8, v8, v48
    v_dot2_f32_bf16 v48, v9, v9, v48
    v_dot2_f32_bf16 v48, v10, v10, v48
    v_dot2_f32_bf16 v48, v11, v11, v48
    s_waitcnt vmcnt(6)
    v_dot2_f32_bf16 v41, v12, v4, v41
    v_dot2_f32_bf16 v41, v13, v4, v41
    v_dot2_f32_bf16 v41, v14, v4, v41
    v_dot2_f32_bf16 v41, v15, v4, v41
    v_dot2_f32_bf16 v49, v12, v12, v49
    v_dot2_f32_bf16 v49, v13, v13, v49
    v_dot2_f32_bf16 v49, v14, v14, v49
    v_dot2_f32_bf16 v49, v15, v15, v49
    s_waitcnt vmcnt(5)
    v_dot2_f32_bf16 v42, v16, v4, v42
    v_dot2_f32_bf16 v42, v17, v4, v42
    v_dot2_f32_bf16 v42, v18, v4, v42
    v_dot2_f32_bf16 v42, v19, v4, v42
    v_dot2_f32_bf16 v50, v16, v16, v50
    v_dot2_f32_bf16 v50, v17, v17, v50
    v_dot2_f32_bf16 v50, v18, v18, v50
    v_dot2_f32_bf16 v50, v19, v19, v50
    s_waitcnt vmcnt(4)
    v_dot2_f32_bf16 v43, v20, v4, v43
    v_dot2_f32_bf16 v43, v21, v4, v43
    v_dot2_f32_bf16 v43, v22, v4, v43
    v_dot2_f32_bf16 v43, v23, v4, v43
    v_dot2_f32_bf16 v51, v20, v20, v51
    v_dot2_f32_bf16 v51, v21, v21, v51
    v_dot2_f32_bf16 v51, v22, v22, v51
    v_dot2_f32_bf16 v51, v23, v23, v51
    s_waitcnt vmcnt(3)
    v_dot2_f32_bf16 v44, v24, v4, v44
    v_dot2_f32_bf16 v44, v25, v4, v44
    v_dot2_f32_bf16 v44, v26, v4, v44
    v_dot2_f32_bf16 v44, v27, v4, v44
    v_dot2_f32_bf16 v52, v24, v24, v52
    v_dot2_f32_bf16 v52, v25, v25, v52
    v_dot2_f32_bf16 v52, v26, v26, v52
    v_dot2_f32_bf16 v52, v27, v27, v52
    s_waitcnt vmcnt(2)
    v_dot2_f32_bf16 v45, v28, v4, v45
    v_dot2_f32_bf16 v45, v29, v4, v45
    v_dot2_f32_bf16 v45, v30, v4, v45
    v_dot2_f32_bf16 v45, v31, v4, v45
    v_dot2_f32_bf16 v53, v28, v28, v53
    v_dot2_f32_bf16 v53, v29, v29, v53
    v_dot2_f32_bf16 v53, v30, v30, v53
    v_dot2_f32_bf16 v53, v31, v31, v53
    s_waitcnt vmcnt(1)
    v_dot2_f32_bf16 v46, v32, v4, v46
    v_dot2_f32_bf16 v46, v33, v4, v46
    v_dot2_f32_bf16 v46, v34, v4, v46
    v_dot2_f32_bf16 v46, v35, v4, v46
    v_dot2_f32_bf16 v54, v32, v32, v54
    v_dot2_f32_bf16 v54, v33, v33, v54
    v_dot2_f32_bf16 v54, v34, v34, v54
    v_dot2_f32_bf16 v54, v35, v35, v54
    s_waitcnt vmcnt(0)
    v_dot2_f32_bf16 v47, v36, v4, v47
    v_dot2_f32_bf16 v47, v37, v4, v47
    v_dot2_f32_bf16 v47, v38, v4, v47
    v_dot2_f32_bf16 v47, v39, v4, v47
    v_dot2_f32_bf16 v55, v36, v36, v55
    v_dot2_f32_bf16 v55, v37, v37, v55
    v_dot2_f32_bf16 v55, v38, v38, v55
    v_dot2_f32_bf16 v55, v39, v39, v55
    s_nop 3
    s_nop 1
    v_add_f32_dpp v40, v40, v40 row_shr:1 row_mask:0xf bank_mask:0xf bound_ctrl:0
    s_nop 1
    v_add_f32_dpp v40, v40, v40 row_shr:2 row_mask:0xf bank_mask:0xf bound_ctrl:0
    s_nop 1
    v_add_f32_dpp v40, v40, v40 row_shr:4 row_mask:0xf bank_mask:0xf bound_ctrl:0
    s_nop 1
    v_add_f32_dpp v40, v40, v40 row_shr:8 row_mask:0xf bank_mask:0xf bound_ctrl:0
    s_nop 1
    v_add_f32_dpp v40, v40, v40 row_bcast:15 row_mask:0xa bank_mask:0xf
    s_nop 1
    v_add_f32_dpp v40, v40, v40 row_bcast:31 row_mask:0xc bank_mask:0xf
    s_nop 1
    v_add_f32_dpp v48, v48, v48 row_shr:1 row_mask:0xf bank_mask:0xf bound_ctrl:0
    s_nop 1
    v_add_f32_dpp v48, v48, v48 row_shr:2 row_mask:0xf bank_mask:0xf bound_ctrl:0
    s_nop 1
    v_add_f32_dpp v48, v48, v48 row_shr:4 row_mask:0xf bank_mask:0xf bound_ctrl:0
    s_nop 1
    v_add_f32_dpp v48, v48, v48 row_shr:8 row_mask:0xf bank_mask:0xf bound_ctrl:0
    s_nop 1
    v_add_f32_dpp v48, v48, v48 row_bcast:15 row_mask:0xa bank_mask:0xf
    s_nop 1
    v_add_f32_dpp v48, v48, v48 row_bcast:31 row_mask:0xc bank_mask:0xf
    s_nop 1
    v_add_f32_dpp v41, v41, v41 row_shr:1 row_mask:0xf bank_mask:0xf bound_ctrl:0
    s_nop 1
    v_add_f32_dpp v41, v41, v41 row_shr:2 row_mask:0xf bank_mask:0xf bound_ctrl:0
    s_nop 1
    v_add_f32_dpp v41, v41, v41 row_shr:4 row_mask:0xf bank_mask:0xf bound_ctrl:0
    s_nop 1
    v_add_f32_dpp v41, v41, v41 row_shr:8 row_mask:0xf bank_mask:0xf bound_ctrl:0
    s_nop 1
    v_add_f32_dpp v41, v41, v41 row_bcast:15 row_mask:0xa bank_mask:0xf
    s_nop 1
    v_add_f32_dpp v41, v41, v41 row_bcast:31 row_mask:0xc bank_mask:0xf
    s_nop 1
    v_add_f32_dpp v49, v49, v49 row_shr:1 row_mask:0xf bank_mask:0xf bound_ctrl:0
    s_nop 1
    v_add_f32_dpp v49, v49, v49 row_shr:2 row_mask:0xf bank_mask:0xf bound_ctrl:0
    s_nop 1
    v_add_f32_dpp v49, v49, v49 row_shr:4 row_mask:0xf bank_mask:0xf bound_ctrl:0
    s_nop 1
    v_add_f32_dpp v49, v49, v49 row_shr:8 row_mask:0xf bank_mask:0xf bound_ctrl:0
    s_nop 1
    v_add_f32_dpp v49, v49, v49 row_bcast:15 row_mask:0xa bank_mask:0xf
    s_nop 1
    v_add_f32_dpp v49, v49, v49 row_bcast:31 row_mask:0xc bank_mask:0xf
    s_nop 1
    v_add_f32_dpp v42, v42, v42 row_shr:1 row_mask:0xf bank_mask:0xf bound_ctrl:0
    s_nop 1
    v_add_f32_dpp v42, v42, v42 row_shr:2 row_mask:0xf bank_mask:0xf bound_ctrl:0
    s_nop 1
    v_add_f32_dpp v42, v42, v42 row_shr:4 row_mask:0xf bank_mask:0xf bound_ctrl:0
    s_nop 1
    v_add_f32_dpp v42, v42, v42 row_shr:8 row_mask:0xf bank_mask:0xf bound_ctrl:0
    s_nop 1
    v_add_f32_dpp v42, v42, v42 row_bcast:15 row_mask:0xa bank_mask:0xf
    s_nop 1
    v_add_f32_dpp v42, v42, v42 row_bcast:31 row_mask:0xc bank_mask:0xf
    s_nop 1
    v_add_f32_dpp v50, v50, v50 row_shr:1 row_mask:0xf bank_mask:0xf bound_ctrl:0
    s_nop 1
    v_add_f32_dpp v50, v50, v50 row_shr:2 row_mask:0xf bank_mask:0xf bound_ctrl:0
    s_nop 1
    v_add_f32_dpp v50, v50, v50 row_shr:4 row_mask:0xf bank_mask:0xf bound_ctrl:0
    s_nop 1
    v_add_f32_dpp v50, v50, v50 row_shr:8 row_mask:0xf bank_mask:0xf bound_ctrl:0
    s_nop 1
    v_add_f32_dpp v50, v50, v50 row_bcast:15 row_mask:0xa bank_mask:0xf
    s_nop 1
    v_add_f32_dpp v50, v50, v50 row_bcast:31 row_mask:0xc bank_mask:0xf
    s_nop 1
    v_add_f32_dpp v43, v43, v43 row_shr:1 row_mask:0xf bank_mask:0xf bound_ctrl:0
    s_nop 1
    v_add_f32_dpp v43, v43, v43 row_shr:2 row_mask:0xf bank_mask:0xf bound_ctrl:0
    s_nop 1
    v_add_f32_dpp v43, v43, v43 row_shr:4 row_mask:0xf bank_mask:0xf bound_ctrl:0
    s_nop 1
    v_add_f32_dpp v43, v43, v43 row_shr:8 row_mask:0xf bank_mask:0xf bound_ctrl:0
    s_nop 1
    v_add_f32_dpp v43, v43, v43 row_bcast:15 row_mask:0xa bank_mask:0xf
    s_nop 1
    v_add_f32_dpp v43, v43, v43 row_bcast:31 row_mask:0xc bank_mask:0xf
    s_nop 1
    v_add_f32_dpp v51, v51, v51 row_shr:1 row_mask:0xf bank_mask:0xf bound_ctrl:0
    s_nop 1
    v_add_f32_dpp v51, v51, v51 row_shr:2 row_mask:0xf bank_mask:0xf bound_ctrl:0
    s_nop 1
    v_add_f32_dpp v51, v51, v51 row_shr:4 row_mask:0xf bank_mask:0xf bound_ctrl:0
    s_nop 1
    v_add_f32_dpp v51, v51, v51 row_shr:8 row_mask:0xf bank_mask:0xf bound_ctrl:0
    s_nop 1
    v_add_f32_dpp v51, v51, v51 row_bcast:15 row_mask:0xa bank_mask:0xf
    s_nop 1
    v_add_f32_dpp v51, v51, v51 row_bcast:31 row_mask:0xc bank_mask:0xf
    s_nop 1
    v_add_f32_dpp v44, v44, v44 row_shr:1 row_mask:0xf bank_mask:0xf bound_ctrl:0
    s_nop 1
    v_add_f32_dpp v44, v44, v44 row_shr:2 row_mask:0xf bank_mask:0xf bound_ctrl:0
    s_nop 1
    v_add_f32_dpp v44, v44, v44 row_shr:4 row_mask:0xf bank_mask:0xf bound_ctrl:0
    s_nop 1
    v_add_f32_dpp v44, v44, v44 row_shr:8 row_mask:0xf bank_mask:0xf bound_ctrl:0
    s_nop 1
    v_add_f32_dpp v44, v44, v44 row_bcast:15 row_mask:0xa bank_mask:0xf
    s_nop 1
    v_add_f32_dpp v44, v44, v44 row_bcast:31 row_mask:0xc bank_mask:0xf
    s_nop 1
    v_add_f32_dpp v52, v52, v52 row_shr:1 row_mask:0xf bank_mask:0xf bound_ctrl:0
    s_nop 1
    v_add_f32_dpp v52, v52, v52 row_shr:2 row_mask:0xf bank_mask:0xf bound_ctrl:0
    s_nop 1
    v_add_f32_dpp v52, v52, v52 row_shr:4 row_mask:0xf bank_mask:0xf bound_ctrl:0
    s_nop 1
    v_add_f32_dpp v52, v52, v52 row_shr:8 row_mask:0xf bank_mask:0xf bound_ctrl:0
    s_nop 1
    v_add_f32_dpp v52, v52, v52 row_bcast:15 row_mask:0xa bank_mask:0xf
    s_nop 1
    v_add_f32_dpp v52, v52, v52 row_bcast:31 row_mask:0xc bank_mask:0xf
    s_nop 1
    v_add_f32_dpp v45, v45, v45 row_shr:1 row_mask:0xf bank_mask:0xf bound_ctrl:0
    s_nop 1
    v_add_f32_dpp v45, v45, v45 row_shr:2 row_mask:0xf bank_mask:0xf bound_ctrl:0
    s_nop 1
    v_add_f32_dpp v45, v45, v45 row_shr:4 row_mask:0xf bank_mask:0xf bound_ctrl:0
    s_nop 1
    v_add_f32_dpp v45, v45, v45 row_shr:8 row_mask:0xf bank_mask:0xf bound_ctrl:0
    s_nop 1
    v_add_f32_dpp v45, v45, v45 row_bcast:15 row_mask:0xa bank_mask:0xf
    s_nop 1
    v_add_f32_dpp v45, v45, v45 row_bcast:31 row_mask:0xc bank_mask:0xf
    s_nop 1
    v_add_f32_dpp v53, v53, v53 row_shr:1 row_mask:0xf bank_mask:0xf bound_ctrl:0
    s_nop 1
    v_add_f32_dpp v53, v53, v53 row_shr:2 row_mask:0xf bank_mask:0xf bound_ctrl:0
    s_nop 1
    v_add_f32_dpp v53, v53, v53 row_shr:4 row_mask:0xf bank_mask:0xf bound_ctrl:0
    s_nop 1
    v_add_f32_dpp v53, v53, v53 row_shr:8 row_mask:0xf bank_mask:0xf bound_ctrl:0
    s_nop 1
    v_add_f32_dpp v53, v53, v53 row_bcast:15 row_mask:0xa bank_mask:0xf
    s_nop 1
    v_add_f32_dpp v53, v53, v53 row_bcast:31 row_mask:0xc bank_mask:0xf
    s_nop 1
    v_add_f32_dpp v46, v46, v46 row_shr:1 row_mask:0xf bank_mask:0xf bound_ctrl:0
    s_nop 1
    v_add_f32_dpp v46, v46, v46 row_shr:2 row_mask:0xf bank_mask:0xf bound_ctrl:0
    s_nop 1
    v_add_f32_dpp v46, v46, v46 row_shr:4 row_mask:0xf bank_mask:0xf bound_ctrl:0
    s_nop 1
    v_add_f32_dpp v46, v46, v46 row_shr:8 row_mask:0xf bank_mask:0xf bound_ctrl:0
    s_nop 1
    v_add_f32_dpp v46, v46, v46 row_bcast:15 row_mask:0xa bank_mask:0xf
    s_nop 1
    v_add_f32_dpp v46, v46, v46 row_bcast:31 row_mask:0xc bank_mask:0xf
    s_nop 1
    v_add_f32_dpp v54, v54, v54 row_shr:1 row_mask:0xf bank_mask:0xf bound_ctrl:0
    s_nop 1
    v_add_f32_dpp v54, v54, v54 row_shr:2 row_mask:0xf bank_mask:0xf bound_ctrl:0
    s_nop 1
    v_add_f32_dpp v54, v54, v54 row_shr:4 row_mask:0xf bank_mask:0xf bound_ctrl:0
    s_nop 1
    v_add_f32_dpp v54, v54, v54 row_shr:8 row_mask:0xf bank_mask:0xf bound_ctrl:0
    s_nop 1
    v_add_f32_dpp v54, v54, v54 row_bcast:15 row_mask:0xa bank_mask:0xf
    s_nop 1
    v_add_f32_dpp v54, v54, v54 row_bcast:31 row_mask:0xc bank_mask:0xf
    s_nop 1
    v_add_f32_dpp v47, v47, v47 row_shr:1 row_mask:0xf bank_mask:0xf bound_ctrl:0
    s_nop 1
    v_add_f32_dpp v47, v47, v47 row_shr:2 row_mask:0xf bank_mask:0xf bound_ctrl:0
    s_nop 1
    v_add_f32_dpp v47, v47, v47 row_shr:4 row_mask:0xf bank_mask:0xf bound_ctrl:0
    s_nop 1
    v_add_f32_dpp v47, v47, v47 row_shr:8 row_mask:0xf bank_mask:0xf bound_ctrl:0
    s_nop 1
    v_add_f32_dpp v47, v47, v47 row_bcast:15 row_mask:0xa bank_mask:0xf
    s_nop 1
    v_add_f32_dpp v47, v47, v47 row_bcast:31 row_mask:0xc bank_mask:0xf
    s_nop 1
    v_add_f32_dpp v55, v55, v55 row_shr:1 row_mask:0xf bank_mask:0xf bound_ctrl:0
    s_nop 1
    v_add_f32_dpp v55, v55, v55 row_shr:2 row_mask:0xf bank_mask:0xf bound_ctrl:0
    s_nop 1
    v_add_f32_dpp v55, v55, v55 row_shr:4 row_mask:0xf bank_mask:0xf bound_ctrl:0
    s_nop 1
    v_add_f32_dpp v55, v55, v55 row_shr:8 row_mask:0xf bank_mask:0xf bound_ctrl:0
    s_nop 1
    v_add_f32_dpp v55, v55, v55 row_bcast:15 row_mask:0xa bank_mask:0xf
    s_nop 1
    v_add_f32_dpp v55, v55, v55 row_bcast:31 row_mask:0xc bank_mask:0xf
    v_lshlrev_b32 v5, 3, v1
    v_cmp_eq_u32 vcc, 63, v2
    s_and_saveexec_b64 s[20:21], vcc
    v_mov_b32 v6, v40
    v_mov_b32 v7, v48
    buffer_store_dwordx2 v[6:7], v5, s[12:15], 0 offen offset:0
    s_nop 0
    v_mov_b32 v6, v41
    v_mov_b32 v7, v49
    buffer_store_dwordx2 v[6:7], v5, s[12:15], 0 offen offset:8
    s_nop 0
    v_mov_b32 v6, v42
    v_mov_b32 v7, v50
    buffer_store_dwordx2 v[6:7], v5, s[12:15], 0 offen offset:16
    s_nop 0
    v_mov_b32 v6, v43
    v_mov_b32 v7, v51
    buffer_store_dwordx2 v[6:7], v5, s[12:15], 0 offen offset:24
    s_nop 0
    v_mov_b32 v6, v44
    v_mov_b32 v7, v52
    buffer_store_dwordx2 v[6:7], v5, s[12:15], 0 offen offset:32
    s_nop 0
    v_mov_b32 v6, v45
    v_mov_b32 v7, v53
    buffer_store_dwordx2 v[6:7], v5, s[12:15], 0 offen offset:40
    s_nop 0
    v_mov_b32 v6, v46
    v_mov_b32 v7, v54
    buffer_store_dwordx2 v[6:7], v5, s[12:15], 0 offen offset:48
    s_nop 0
    v_mov_b32 v6, v47
    v_mov_b32 v7, v55
    buffer_store_dwordx2 v[6:7], v5, s[12:15], 0 offen offset:56
    s_nop 0
    s_endpgm
prep_colsum:
    s_sub_u32 s16, s2, 320
    s_cmp_ge_u32 s16, 14
    s_movk_i32 s17, 80
    s_cselect_b32 s17, 88, s17
    s_cselect_b32 s22, 14, 0
    s_sub_u32 s16, s16, s22
    s_load_dwordx2 s[4:5], s[0:1], s17
    s_waitcnt lgkmcnt(0)
    s_add_u32 s8, s4, 0x0
    s_addc_u32 s9, s5, 0
    s_and_b32 s9, s9, 0xffff
    s_mov_b32 s10, 0x1c0000
    s_mov_b32 s11, 0x00020000
    s_lshl_b32 s23, s22, 9
    s_add_u32 s23, s23, 21102592
    s_add_u32 s12, s6, s23
    s_addc_u32 s13, s7, 0
    s_and_b32 s13, s13, 0xffff
    s_mov_b32 s14, 7168
    s_mov_b32 s15, 0x00020000
    v_and_b32 v1, 15, v0
    v_lshrrev_b32 v2, 4, v0
    s_lshl_b32 s18, s16, 8
    v_lshlrev_b32 v3, 4, v1
    v_add_u32 v3, s18, v3
    s_mov_b32 s19, 114688
    v_mul_lo_u32 v4, v2, s19
    v_add_u32 v3, v3, v4
    v_mov_b32 v100, 0
    v_mov_b32 v101, 0
    v_mov_b32 v102, 0
    v_mov_b32 v103, 0
    v_mov_b32 v104, 0
    v_mov_b32 v105, 0
    v_mov_b32 v106, 0
    v_mov_b32 v107, 0
    s_mov_b32 s24, 0
    s_mov_b32 s25, 3584
    s_mov_b32 s26, 7168
    s_mov_b32 s27, 10752
    s_mov_b32 s28, 14336
    s_mov_b32 s29, 17920
    s_mov_b32 s30, 21504
    s_mov_b32 s31, 25088
    s_mov_b32 s32, 28672
    s_mov_b32 s33, 32256
    s_mov_b32 s34, 35840
    s_mov_b32 s35, 39424
    s_mov_b32 s36, 43008
    s_mov_b32 s37, 46592
    s_mov_b32 s38, 50176
    s_mov_b32 s39, 53760
    buffer_load_dwordx4 v[8:11], v3, s[8:11], s24 offen
    buffer_load_dwordx4 v[12:15], v3, s[8:11], s25 offen
    buffer_load_dwordx4 v[16:19], v3, s[8:11], s26 offen
    buffer_load_dwordx4 v[20:23], v3, s[8:11], s27 offen
    buffer_load_dwordx4 v[24:27], v3, s[8:11], s28 offen
    buffer_load_dwordx4 v[28:31], v3, s[8:11], s29 offen
    buffer_load_dwordx4 v[32:35], v3, s[8:11], s30 offen
    buffer_load_dwordx4 v[36:39], v3, s[8:11], s31 offen
    buffer_load_dwordx4 v[40:43], v3, s[8:11], s32 offen
    buffer_load_dwordx4 v[44:47], v3, s[8:11], s33 offen
    buffer_load_dwordx4 v[48:51], v3, s[8:11], s34 offen
    buffer_load_dwordx4 v[52:55], v3, s[8:11], s35 offen
    buffer_load_dwordx4 v[56:59], v3, s[8:11], s36 offen
    buffer_load_dwordx4 v[60:63], v3, s[8:11], s37 offen
    buffer_load_dwordx4 v[64:67], v3, s[8:11], s38 offen
    buffer_load_dwordx4 v[68:71], v3, s[8:11], s39 offen
    s_waitcnt vmcnt(15)
    v_lshlrev_b32 v5, 16, v8
    v_and_b32 v6, 0xffff0000, v8
    v_add_f32 v100, v100, v5
    v_add_f32 v101, v101, v6
    v_lshlrev_b32 v5, 16, v9
    v_and_b32 v6, 0xffff0000, v9
    v_add_f32 v102, v102, v5
    v_add_f32 v103, v103, v6
    v_lshlrev_b32 v5, 16, v10
    v_and_b32 v6, 0xffff0000, v10
    v_add_f32 v104, v104, v5
    v_add_f32 v105, v105, v6
    v_lshlrev_b32 v5, 16, v11
    v_and_b32 v6, 0xffff0000, v11
    v_add_f32 v106, v106, v5
    v_add_f32 v107, v107, v6
    s_waitcnt vmcnt(14)
    v_lshlrev_b32 v5, 16, v12
    v_and_b32 v6, 0xffff0000, v12
    v_add_f32 v100, v100, v5
    v_add_f32 v101, v101, v6
    v_lshlrev_b32 v5, 16, v13
    v_and_b32 v6, 0xffff0000, v13
    v_add_f32 v102, v102, v5
    v_add_f32 v103, v103, v6
    v_lshlrev_b32 v5, 16, v14
    v_and_b32 v6, 0xffff0000, v14
    v_add_f32 v104, v104, v5
    v_add_f32 v105, v105, v6
    v_lshlrev_b32 v5, 16, v15
    v_and_b32 v6, 0xffff0000, v15
    v_add_f32 v106, v106, v5
    v_add_f32 v107, v107, v6
    s_waitcnt vmcnt(13)
    v_lshlrev_b32 v5, 16, v16
    v_and_b32 v6, 0xffff0000, v16
    v_add_f32 v100, v100, v5
    v_add_f32 v101, v101, v6
    v_lshlrev_b32 v5, 16, v17
    v_and_b32 v6, 0xffff0000, v17
    v_add_f32 v102, v102, v5
    v_add_f32 v103, v103, v6
    v_lshlrev_b32 v5, 16, v18
    v_and_b32 v6, 0xffff0000, v18
    v_add_f32 v104, v104, v5
    v_add_f32 v105, v105, v6
    v_lshlrev_b32 v5, 16, v19
    v_and_b32 v6, 0xffff0000, v19
    v_add_f32 v106, v106, v5
    v_add_f32 v107, v107, v6
    s_waitcnt vmcnt(12)
    v_lshlrev_b32 v5, 16, v20
    v_and_b32 v6, 0xffff0000, v20
    v_add_f32 v100, v100, v5
    v_add_f32 v101, v101, v6
    v_lshlrev_b32 v5, 16, v21
    v_and_b32 v6, 0xffff0000, v21
    v_add_f32 v102, v102, v5
    v_add_f32 v103, v103, v6
    v_lshlrev_b32 v5, 16, v22
    v_and_b32 v6, 0xffff0000, v22
    v_add_f32 v104, v104, v5
    v_add_f32 v105, v105, v6
    v_lshlrev_b32 v5, 16, v23
    v_and_b32 v6, 0xffff0000, v23
    v_add_f32 v106, v106, v5
    v_add_f32 v107, v107, v6
    s_waitcnt vmcnt(11)
    v_lshlrev_b32 v5, 16, v24
    v_and_b32 v6, 0xffff0000, v24
    v_add_f32 v100, v100, v5
    v_add_f32 v101, v101, v6
    v_lshlrev_b32 v5, 16, v25
    v_and_b32 v6, 0xffff0000, v25
    v_add_f32 v102, v102, v5
    v_add_f32 v103, v103, v6
    v_lshlrev_b32 v5, 16, v26
    v_and_b32 v6, 0xffff0000, v26
    v_add_f32 v104, v104, v5
    v_add_f32 v105, v105, v6
    v_lshlrev_b32 v5, 16, v27
    v_and_b32 v6, 0xffff0000, v27
    v_add_f32 v106, v106, v5
    v_add_f32 v107, v107, v6
    s_waitcnt vmcnt(10)
    v_lshlrev_b32 v5, 16, v28
    v_and_b32 v6, 0xffff0000, v28
    v_add_f32 v100, v100, v5
    v_add_f32 v101, v101, v6
    v_lshlrev_b32 v5, 16, v29
    v_and_b32 v6, 0xffff0000, v29
    v_add_f32 v102, v102, v5
    v_add_f32 v103, v103, v6
    v_lshlrev_b32 v5, 16, v30
    v_and_b32 v6, 0xffff0000, v30
    v_add_f32 v104, v104, v5
    v_add_f32 v105, v105, v6
    v_lshlrev_b32 v5, 16, v31
    v_and_b32 v6, 0xffff0000, v31
    v_add_f32 v106, v106, v5
    v_add_f32 v107, v107, v6
    s_waitcnt vmcnt(9)
    v_lshlrev_b32 v5, 16, v32
    v_and_b32 v6, 0xffff0000, v32
    v_add_f32 v100, v100, v5
    v_add_f32 v101, v101, v6
    v_lshlrev_b32 v5, 16, v33
    v_and_b32 v6, 0xffff0000, v33
    v_add_f32 v102, v102, v5
    v_add_f32 v103, v103, v6
    v_lshlrev_b32 v5, 16, v34
    v_and_b32 v6, 0xffff0000, v34
    v_add_f32 v104, v104, v5
    v_add_f32 v105, v105, v6
    v_lshlrev_b32 v5, 16, v35
    v_and_b32 v6, 0xffff0000, v35
    v_add_f32 v106, v106, v5
    v_add_f32 v107, v107, v6
    s_waitcnt vmcnt(8)
    v_lshlrev_b32 v5, 16, v36
    v_and_b32 v6, 0xffff0000, v36
    v_add_f32 v100, v100, v5
    v_add_f32 v101, v101, v6
    v_lshlrev_b32 v5, 16, v37
    v_and_b32 v6, 0xffff0000, v37
    v_add_f32 v102, v102, v5
    v_add_f32 v103, v103, v6
    v_lshlrev_b32 v5, 16, v38
    v_and_b32 v6, 0xffff0000, v38
    v_add_f32 v104, v104, v5
    v_add_f32 v105, v105, v6
    v_lshlrev_b32 v5, 16, v39
    v_and_b32 v6, 0xffff0000, v39
    v_add_f32 v106, v106, v5
    v_add_f32 v107, v107, v6
    s_waitcnt vmcnt(7)
    v_lshlrev_b32 v5, 16, v40
    v_and_b32 v6, 0xffff0000, v40
    v_add_f32 v100, v100, v5
    v_add_f32 v101, v101, v6
    v_lshlrev_b32 v5, 16, v41
    v_and_b32 v6, 0xffff0000, v41
    v_add_f32 v102, v102, v5
    v_add_f32 v103, v103, v6
    v_lshlrev_b32 v5, 16, v42
    v_and_b32 v6, 0xffff0000, v42
    v_add_f32 v104, v104, v5
    v_add_f32 v105, v105, v6
    v_lshlrev_b32 v5, 16, v43
    v_and_b32 v6, 0xffff0000, v43
    v_add_f32 v106, v106, v5
    v_add_f32 v107, v107, v6
    s_waitcnt vmcnt(6)
    v_lshlrev_b32 v5, 16, v44
    v_and_b32 v6, 0xffff0000, v44
    v_add_f32 v100, v100, v5
    v_add_f32 v101, v101, v6
    v_lshlrev_b32 v5, 16, v45
    v_and_b32 v6, 0xffff0000, v45
    v_add_f32 v102, v102, v5
    v_add_f32 v103, v103, v6
    v_lshlrev_b32 v5, 16, v46
    v_and_b32 v6, 0xffff0000, v46
    v_add_f32 v104, v104, v5
    v_add_f32 v105, v105, v6
    v_lshlrev_b32 v5, 16, v47
    v_and_b32 v6, 0xffff0000, v47
    v_add_f32 v106, v106, v5
    v_add_f32 v107, v107, v6
    s_waitcnt vmcnt(5)
    v_lshlrev_b32 v5, 16, v48
    v_and_b32 v6, 0xffff0000, v48
    v_add_f32 v100, v100, v5
    v_add_f32 v101, v101, v6
    v_lshlrev_b32 v5, 16, v49
    v_and_b32 v6, 0xffff0000, v49
    v_add_f32 v102, v102, v5
    v_add_f32 v103, v103, v6
    v_lshlrev_b32 v5, 16, v50
    v_and_b32 v6, 0xffff0000, v50
    v_add_f32 v104, v104, v5
    v_add_f32 v105, v105, v6
    v_lshlrev_b32 v5, 16, v51
    v_and_b32 v6, 0xffff0000, v51
    v_add_f32 v106, v106, v5
    v_add_f32 v107, v107, v6
    s_waitcnt vmcnt(4)
    v_lshlrev_b32 v5, 16, v52
    v_and_b32 v6, 0xffff0000, v52
    v_add_f32 v100, v100, v5
    v_add_f32 v101, v101, v6
    v_lshlrev_b32 v5, 16, v53
    v_and_b32 v6, 0xffff0000, v53
    v_add_f32 v102, v102, v5
    v_add_f32 v103, v103, v6
    v_lshlrev_b32 v5, 16, v54
    v_and_b32 v6, 0xffff0000, v54
    v_add_f32 v104, v104, v5
    v_add_f32 v105, v105, v6
    v_lshlrev_b32 v5, 16, v55
    v_and_b32 v6, 0xffff0000, v55
    v_add_f32 v106, v106, v5
    v_add_f32 v107, v107, v6
    s_waitcnt vmcnt(3)
    v_lshlrev_b32 v5, 16, v56
    v_and_b32 v6, 0xffff0000, v56
    v_add_f32 v100, v100, v5
    v_add_f32 v101, v101, v6
    v_lshlrev_b32 v5, 16, v57
    v_and_b32 v6, 0xffff0000, v57
    v_add_f32 v102, v102, v5
    v_add_f32 v103, v103, v6
    v_lshlrev_b32 v5, 16, v58
    v_and_b32 v6, 0xffff0000, v58
    v_add_f32 v104, v104, v5
    v_add_f32 v105, v105, v6
    v_lshlrev_b32 v5, 16, v59
    v_and_b32 v6, 0xffff0000, v59
    v_add_f32 v106, v106, v5
    v_add_f32 v107, v107, v6
    s_waitcnt vmcnt(2)
    v_lshlrev_b32 v5, 16, v60
    v_and_b32 v6, 0xffff0000, v60
    v_add_f32 v100, v100, v5
    v_add_f32 v101, v101, v6
    v_lshlrev_b32 v5, 16, v61
    v_and_b32 v6, 0xffff0000, v61
    v_add_f32 v102, v102, v5
    v_add_f32 v103, v103, v6
    v_lshlrev_b32 v5, 16, v62
    v_and_b32 v6, 0xffff0000, v62
    v_add_f32 v104, v104, v5
    v_add_f32 v105, v105, v6
    v_lshlrev_b32 v5, 16, v63
    v_and_b32 v6, 0xffff0000, v63
    v_add_f32 v106, v106, v5
    v_add_f32 v107, v107, v6
    s_waitcnt vmcnt(1)
    v_lshlrev_b32 v5, 16, v64
    v_and_b32 v6, 0xffff0000, v64
    v_add_f32 v100, v100, v5
    v_add_f32 v101, v101, v6
    v_lshlrev_b32 v5, 16, v65
    v_and_b32 v6, 0xffff0000, v65
    v_add_f32 v102, v102, v5
    v_add_f32 v103, v103, v6
    v_lshlrev_b32 v5, 16, v66
    v_and_b32 v6, 0xffff0000, v66
    v_add_f32 v104, v104, v5
    v_add_f32 v105, v105, v6
    v_lshlrev_b32 v5, 16, v67
    v_and_b32 v6, 0xffff0000, v67
    v_add_f32 v106, v106, v5
    v_add_f32 v107, v107, v6
    s_waitcnt vmcnt(0)
    v_lshlrev_b32 v5, 16, v68
    v_and_b32 v6, 0xffff0000, v68
    v_add_f32 v100, v100, v5
    v_add_f32 v101, v101, v6
    v_lshlrev_b32 v5, 16, v69
    v_and_b32 v6, 0xffff0000, v69
    v_add_f32 v102, v102, v5
    v_add_f32 v103, v103, v6
    v_lshlrev_b32 v5, 16, v70
    v_and_b32 v6, 0xffff0000, v70
    v_add_f32 v104, v104, v5
    v_add_f32 v105, v105, v6
    v_lshlrev_b32 v5, 16, v71
    v_and_b32 v6, 0xffff0000, v71
    v_add_f32 v106, v106, v5
    v_add_f32 v107, v107, v6
    s_mov_b32 s24, 57344
    s_mov_b32 s25, 60928
    s_mov_b32 s26, 64512
    s_mov_b32 s27, 68096
    s_mov_b32 s28, 71680
    s_mov_b32 s29, 75264
    s_mov_b32 s30, 78848
    s_mov_b32 s31, 82432
    s_mov_b32 s32, 86016
    s_mov_b32 s33, 89600
    s_mov_b32 s34, 93184
    s_mov_b32 s35, 96768
    s_mov_b32 s36, 100352
    s_mov_b32 s37, 103936
    s_mov_b32 s38, 107520
    s_mov_b32 s39, 111104
    buffer_load_dwordx4 v[8:11], v3, s[8:11], s24 offen
    buffer_load_dwordx4 v[12:15], v3, s[8:11], s25 offen
    buffer_load_dwordx4 v[16:19], v3, s[8:11], s26 offen
    buffer_load_dwordx4 v[20:23], v3, s[8:11], s27 offen
    buffer_load_dwordx4 v[24:27], v3, s[8:11], s28 offen
    buffer_load_dwordx4 v[28:31], v3, s[8:11], s29 offen
    buffer_load_dwordx4 v[32:35], v3, s[8:11], s30 offen
    buffer_load_dwordx4 v[36:39], v3, s[8:11], s31 offen
    buffer_load_dwordx4 v[40:43], v3, s[8:11], s32 offen
    buffer_load_dwordx4 v[44:47], v3, s[8:11], s33 offen
    buffer_load_dwordx4 v[48:51], v3, s[8:11], s34 offen
    buffer_load_dwordx4 v[52:55], v3, s[8:11], s35 offen
    buffer_load_dwordx4 v[56:59], v3, s[8:11], s36 offen
    buffer_load_dwordx4 v[60:63], v3, s[8:11], s37 offen
    buffer_load_dwordx4 v[64:67], v3, s[8:11], s38 offen
    buffer_load_dwordx4 v[68:71], v3, s[8:11], s39 offen
    s_waitcnt vmcnt(15)
    v_lshlrev_b32 v5, 16, v8
    v_and_b32 v6, 0xffff0000, v8
    v_add_f32 v100, v100, v5
    v_add_f32 v101, v101, v6
    v_lshlrev_b32 v5, 16, v9
    v_and_b32 v6, 0xffff0000, v9
    v_add_f32 v102, v102, v5
    v_add_f32 v103, v103, v6
    v_lshlrev_b32 v5, 16, v10
    v_and_b32 v6, 0xffff0000, v10
    v_add_f32 v104, v104, v5
    v_add_f32 v105, v105, v6
    v_lshlrev_b32 v5, 16, v11
    v_and_b32 v6, 0xffff0000, v11
    v_add_f32 v106, v106, v5
    v_add_f32 v107, v107, v6
    s_waitcnt vmcnt(14)
    v_lshlrev_b32 v5, 16, v12
    v_and_b32 v6, 0xffff0000, v12
    v_add_f32 v100, v100, v5
    v_add_f32 v101, v101, v6
    v_lshlrev_b32 v5, 16, v13
    v_and_b32 v6, 0xffff0000, v13
    v_add_f32 v102, v102, v5
    v_add_f32 v103, v103, v6
    v_lshlrev_b32 v5, 16, v14
    v_and_b32 v6, 0xffff0000, v14
    v_add_f32 v104, v104, v5
    v_add_f32 v105, v105, v6
    v_lshlrev_b32 v5, 16, v15
    v_and_b32 v6, 0xffff0000, v15
    v_add_f32 v106, v106, v5
    v_add_f32 v107, v107, v6
    s_waitcnt vmcnt(13)
    v_lshlrev_b32 v5, 16, v16
    v_and_b32 v6, 0xffff0000, v16
    v_add_f32 v100, v100, v5
    v_add_f32 v101, v101, v6
    v_lshlrev_b32 v5, 16, v17
    v_and_b32 v6, 0xffff0000, v17
    v_add_f32 v102, v102, v5
    v_add_f32 v103, v103, v6
    v_lshlrev_b32 v5, 16, v18
    v_and_b32 v6, 0xffff0000, v18
    v_add_f32 v104, v104, v5
    v_add_f32 v105, v105, v6
    v_lshlrev_b32 v5, 16, v19
    v_and_b32 v6, 0xffff0000, v19
    v_add_f32 v106, v106, v5
    v_add_f32 v107, v107, v6
    s_waitcnt vmcnt(12)
    v_lshlrev_b32 v5, 16, v20
    v_and_b32 v6, 0xffff0000, v20
    v_add_f32 v100, v100, v5
    v_add_f32 v101, v101, v6
    v_lshlrev_b32 v5, 16, v21
    v_and_b32 v6, 0xffff0000, v21
    v_add_f32 v102, v102, v5
    v_add_f32 v103, v103, v6
    v_lshlrev_b32 v5, 16, v22
    v_and_b32 v6, 0xffff0000, v22
    v_add_f32 v104, v104, v5
    v_add_f32 v105, v105, v6
    v_lshlrev_b32 v5, 16, v23
    v_and_b32 v6, 0xffff0000, v23
    v_add_f32 v106, v106, v5
    v_add_f32 v107, v107, v6
    s_waitcnt vmcnt(11)
    v_lshlrev_b32 v5, 16, v24
    v_and_b32 v6, 0xffff0000, v24
    v_add_f32 v100, v100, v5
    v_add_f32 v101, v101, v6
    v_lshlrev_b32 v5, 16, v25
    v_and_b32 v6, 0xffff0000, v25
    v_add_f32 v102, v102, v5
    v_add_f32 v103, v103, v6
    v_lshlrev_b32 v5, 16, v26
    v_and_b32 v6, 0xffff0000, v26
    v_add_f32 v104, v104, v5
    v_add_f32 v105, v105, v6
    v_lshlrev_b32 v5, 16, v27
    v_and_b32 v6, 0xffff0000, v27
    v_add_f32 v106, v106, v5
    v_add_f32 v107, v107, v6
    s_waitcnt vmcnt(10)
    v_lshlrev_b32 v5, 16, v28
    v_and_b32 v6, 0xffff0000, v28
    v_add_f32 v100, v100, v5
    v_add_f32 v101, v101, v6
    v_lshlrev_b32 v5, 16, v29
    v_and_b32 v6, 0xffff0000, v29
    v_add_f32 v102, v102, v5
    v_add_f32 v103, v103, v6
    v_lshlrev_b32 v5, 16, v30
    v_and_b32 v6, 0xffff0000, v30
    v_add_f32 v104, v104, v5
    v_add_f32 v105, v105, v6
    v_lshlrev_b32 v5, 16, v31
    v_and_b32 v6, 0xffff0000, v31
    v_add_f32 v106, v106, v5
    v_add_f32 v107, v107, v6
    s_waitcnt vmcnt(9)
    v_lshlrev_b32 v5, 16, v32
    v_and_b32 v6, 0xffff0000, v32
    v_add_f32 v100, v100, v5
    v_add_f32 v101, v101, v6
    v_lshlrev_b32 v5, 16, v33
    v_and_b32 v6, 0xffff0000, v33
    v_add_f32 v102, v102, v5
    v_add_f32 v103, v103, v6
    v_lshlrev_b32 v5, 16, v34
    v_and_b32 v6, 0xffff0000, v34
    v_add_f32 v104, v104, v5
    v_add_f32 v105, v105, v6
    v_lshlrev_b32 v5, 16, v35
    v_and_b32 v6, 0xffff0000, v35
    v_add_f32 v106, v106, v5
    v_add_f32 v107, v107, v6
    s_waitcnt vmcnt(8)
    v_lshlrev_b32 v5, 16, v36
    v_and_b32 v6, 0xffff0000, v36
    v_add_f32 v100, v100, v5
    v_add_f32 v101, v101, v6
    v_lshlrev_b32 v5, 16, v37
    v_and_b32 v6, 0xffff0000, v37
    v_add_f32 v102, v102, v5
    v_add_f32 v103, v103, v6
    v_lshlrev_b32 v5, 16, v38
    v_and_b32 v6, 0xffff0000, v38
    v_add_f32 v104, v104, v5
    v_add_f32 v105, v105, v6
    v_lshlrev_b32 v5, 16, v39
    v_and_b32 v6, 0xffff0000, v39
    v_add_f32 v106, v106, v5
    v_add_f32 v107, v107, v6
    s_waitcnt vmcnt(7)
    v_lshlrev_b32 v5, 16, v40
    v_and_b32 v6, 0xffff0000, v40
    v_add_f32 v100, v100, v5
    v_add_f32 v101, v101, v6
    v_lshlrev_b32 v5, 16, v41
    v_and_b32 v6, 0xffff0000, v41
    v_add_f32 v102, v102, v5
    v_add_f32 v103, v103, v6
    v_lshlrev_b32 v5, 16, v42
    v_and_b32 v6, 0xffff0000, v42
    v_add_f32 v104, v104, v5
    v_add_f32 v105, v105, v6
    v_lshlrev_b32 v5, 16, v43
    v_and_b32 v6, 0xffff0000, v43
    v_add_f32 v106, v106, v5
    v_add_f32 v107, v107, v6
    s_waitcnt vmcnt(6)
    v_lshlrev_b32 v5, 16, v44
    v_and_b32 v6, 0xffff0000, v44
    v_add_f32 v100, v100, v5
    v_add_f32 v101, v101, v6
    v_lshlrev_b32 v5, 16, v45
    v_and_b32 v6, 0xffff0000, v45
    v_add_f32 v102, v102, v5
    v_add_f32 v103, v103, v6
    v_lshlrev_b32 v5, 16, v46
    v_and_b32 v6, 0xffff0000, v46
    v_add_f32 v104, v104, v5
    v_add_f32 v105, v105, v6
    v_lshlrev_b32 v5, 16, v47
    v_and_b32 v6, 0xffff0000, v47
    v_add_f32 v106, v106, v5
    v_add_f32 v107, v107, v6
    s_waitcnt vmcnt(5)
    v_lshlrev_b32 v5, 16, v48
    v_and_b32 v6, 0xffff0000, v48
    v_add_f32 v100, v100, v5
    v_add_f32 v101, v101, v6
    v_lshlrev_b32 v5, 16, v49
    v_and_b32 v6, 0xffff0000, v49
    v_add_f32 v102, v102, v5
    v_add_f32 v103, v103, v6
    v_lshlrev_b32 v5, 16, v50
    v_and_b32 v6, 0xffff0000, v50
    v_add_f32 v104, v104, v5
    v_add_f32 v105, v105, v6
    v_lshlrev_b32 v5, 16, v51
    v_and_b32 v6, 0xffff0000, v51
    v_add_f32 v106, v106, v5
    v_add_f32 v107, v107, v6
    s_waitcnt vmcnt(4)
    v_lshlrev_b32 v5, 16, v52
    v_and_b32 v6, 0xffff0000, v52
    v_add_f32 v100, v100, v5
    v_add_f32 v101, v101, v6
    v_lshlrev_b32 v5, 16, v53
    v_and_b32 v6, 0xffff0000, v53
    v_add_f32 v102, v102, v5
    v_add_f32 v103, v103, v6
    v_lshlrev_b32 v5, 16, v54
    v_and_b32 v6, 0xffff0000, v54
    v_add_f32 v104, v104, v5
    v_add_f32 v105, v105, v6
    v_lshlrev_b32 v5, 16, v55
    v_and_b32 v6, 0xffff0000, v55
    v_add_f32 v106, v106, v5
    v_add_f32 v107, v107, v6
    s_waitcnt vmcnt(3)
    v_lshlrev_b32 v5, 16, v56
    v_and_b32 v6, 0xffff0000, v56
    v_add_f32 v100, v100, v5
    v_add_f32 v101, v101, v6
    v_lshlrev_b32 v5, 16, v57
    v_and_b32 v6, 0xffff0000, v57
    v_add_f32 v102, v102, v5
    v_add_f32 v103, v103, v6
    v_lshlrev_b32 v5, 16, v58
    v_and_b32 v6, 0xffff0000, v58
    v_add_f32 v104, v104, v5
    v_add_f32 v105, v105, v6
    v_lshlrev_b32 v5, 16, v59
    v_and_b32 v6, 0xffff0000, v59
    v_add_f32 v106, v106, v5
    v_add_f32 v107, v107, v6
    s_waitcnt vmcnt(2)
    v_lshlrev_b32 v5, 16, v60
    v_and_b32 v6, 0xffff0000, v60
    v_add_f32 v100, v100, v5
    v_add_f32 v101, v101, v6
    v_lshlrev_b32 v5, 16, v61
    v_and_b32 v6, 0xffff0000, v61
    v_add_f32 v102, v102, v5
    v_add_f32 v103, v103, v6
    v_lshlrev_b32 v5, 16, v62
    v_and_b32 v6, 0xffff0000, v62
    v_add_f32 v104, v104, v5
    v_add_f32 v105, v105, v6
    v_lshlrev_b32 v5, 16, v63
    v_and_b32 v6, 0xffff0000, v63
    v_add_f32 v106, v106, v5
    v_add_f32 v107, v107, v6
    s_waitcnt vmcnt(1)
    v_lshlrev_b32 v5, 16, v64
    v_and_b32 v6, 0xffff0000, v64
    v_add_f32 v100, v100, v5
    v_add_f32 v101, v101, v6
    v_lshlrev_b32 v5, 16, v65
    v_and_b32 v6, 0xffff0000, v65
    v_add_f32 v102, v102, v5
    v_add_f32 v103, v103, v6
    v_lshlrev_b32 v5, 16, v66
    v_and_b32 v6, 0xffff0000, v66
    v_add_f32 v104, v104, v5
    v_add_f32 v105, v105, v6
    v_lshlrev_b32 v5, 16, v67
    v_and_b32 v6, 0xffff0000, v67
    v_add_f32 v106, v106, v5
    v_add_f32 v107, v107, v6
    s_waitcnt vmcnt(0)
    v_lshlrev_b32 v5, 16, v68
    v_and_b32 v6, 0xffff0000, v68
    v_add_f32 v100, v100, v5
    v_add_f32 v101, v101, v6
    v_lshlrev_b32 v5, 16, v69
    v_and_b32 v6, 0xffff0000, v69
    v_add_f32 v102, v102, v5
    v_add_f32 v103, v103, v6
    v_lshlrev_b32 v5, 16, v70
    v_and_b32 v6, 0xffff0000, v70
    v_add_f32 v104, v104, v5
    v_add_f32 v105, v105, v6
    v_lshlrev_b32 v5, 16, v71
    v_and_b32 v6, 0xffff0000, v71
    v_add_f32 v106, v106, v5
    v_add_f32 v107, v107, v6
    v_lshlrev_b32 v7, 9, v2
    v_lshl_add_u32 v7, v1, 5, v7
    ds_write_b128 v7, v[100:103]
    ds_write_b128 v7, v[104:107] offset:16
    s_waitcnt lgkmcnt(0)
    s_barrier
    v_cmp_gt_u32 vcc, 128, v0
    s_and_saveexec_b64 s[20:21], vcc
    s_cbranch_execz prep_exit
    v_lshlrev_b32 v7, 2, v0
    ds_read_b32 v8, v7 offset:0
    ds_read_b32 v9, v7 offset:512
    ds_read_b32 v10, v7 offset:1024
    ds_read_b32 v11, v7 offset:1536
    ds_read_b32 v12, v7 offset:2048
    ds_read_b32 v13, v7 offset:2560
    ds_read_b32 v14, v7 offset:3072
    ds_read_b32 v15, v7 offset:3584
    ds_read_b32 v16, v7 offset:4096
    ds_read_b32 v17, v7 offset:4608
    ds_read_b32 v18, v7 offset:5120
    ds_read_b32 v19, v7 offset:5632
    ds_read_b32 v20, v7 offset:6144
    ds_read_b32 v21, v7 offset:6656
    ds_read_b32 v22, v7 offset:7168
    ds_read_b32 v23, v7 offset:7680
    s_waitcnt lgkmcnt(0)
    v_add_f32 v8, v8, v9
    v_add_f32 v8, v8, v10
    v_add_f32 v8, v8, v11
    v_add_f32 v8, v8, v12
    v_add_f32 v8, v8, v13
    v_add_f32 v8, v8, v14
    v_add_f32 v8, v8, v15
    v_add_f32 v8, v8, v16
    v_add_f32 v8, v8, v17
    v_add_f32 v8, v8, v18
    v_add_f32 v8, v8, v19
    v_add_f32 v8, v8, v20
    v_add_f32 v8, v8, v21
    v_add_f32 v8, v8, v22
    v_add_f32 v8, v8, v23
    s_lshl_b32 s18, s16, 9
    v_add_u32 v7, s18, v7
    buffer_store_dword v8, v7, s[12:15], 0 offen
    s_endpgm
prep_zero:
    s_waitcnt lgkmcnt(0)
    s_add_u32 s12, s6, 0x1410000
    s_addc_u32 s13, s7, 0
    s_and_b32 s13, s13, 0xffff
    s_mov_b32 s14, 0x4000
    s_mov_b32 s15, 0x00020000
    v_lshlrev_b32 v1, 6, v0
    v_mov_b32 v4, 0
    v_mov_b32 v5, 0
    v_mov_b32 v6, 0
    v_mov_b32 v7, 0
    buffer_store_dwordx4 v[4:7], v1, s[12:15], 0 offen offset:0
    buffer_store_dwordx4 v[4:7], v1, s[12:15], 0 offen offset:16
    buffer_store_dwordx4 v[4:7], v1, s[12:15], 0 offen offset:32
    buffer_store_dwordx4 v[4:7], v1, s[12:15], 0 offen offset:48
    s_endpgm
prep_kgen:
    s_sub_u32 s16, s2, 349
    s_load_dwordx2 s[24:25], s[0:1], 8
    s_load_dwordx2 s[26:27], s[0:1], 16
    s_load_dwordx2 s[28:29], s[0:1], 24
    s_load_dwordx2 s[30:31], s[0:1], 32
    s_load_dwordx2 s[32:33], s[0:1], 40
    s_load_dwordx2 s[34:35], s[0:1], 48
    s_load_dwordx2 s[36:37], s[0:1], 56
    s_waitcnt lgkmcnt(0)
    s_add_u32 s40, s24, 0x0
    s_addc_u32 s41, s25, 0
    s_and_b32 s41, s41, 0xffff
    s_mov_b32 s42, 0x20000
    s_mov_b32 s43, 0x00020000
    s_add_u32 s44, s26, 0x0
    s_addc_u32 s45, s27, 0
    s_and_b32 s45, s45, 0xffff
    s_mov_b32 s46, 0x20000
    s_mov_b32 s47, 0x00020000
    s_add_u32 s48, s28, 0x0
    s_addc_u32 s49, s29, 0
    s_and_b32 s49, s49, 0xffff
    s_mov_b32 s50, 0x20000
    s_mov_b32 s51, 0x00020000
    s_add_u32 s52, s30, 0x0
    s_addc_u32 s53, s31, 0
    s_and_b32 s53, s53, 0xffff
    s_mov_b32 s54, 0x20000
    s_mov_b32 s55, 0x00020000
    s_add_u32 s56, s32, 0x0
    s_addc_u32 s57, s33, 0
    s_and_b32 s57, s57, 0xffff
    s_mov_b32 s58, 0x20000
    s_mov_b32 s59, 0x00020000
    s_add_u32 s60, s34, 0x0
    s_addc_u32 s61, s35, 0
    s_and_b32 s61, s61, 0xffff
    s_mov_b32 s62, 0x20000
    s_mov_b32 s63, 0x00020000
    s_add_u32 s64, s36, 0x0
    s_addc_u32 s65, s37, 0
    s_and_b32 s65, s65, 0xffff
    s_mov_b32 s66, 0x400
    s_mov_b32 s67, 0x00020000
    s_add_u32 s68, s6, 0x1000000
    s_addc_u32 s69, s7, 0
    s_and_b32 s69, s69, 0xffff
    s_mov_b32 s70, 0x208000
    s_mov_b32 s71, 0x00020000
    v_and_b32 v1, 127, v0
    v_lshrrev_b32 v2, 7, v0
    s_lshl_b32 s17, s16, 8
    v_lshl_add_u32 v3, v1, 1, s17
    buffer_load_ushort v10, v3, s[40:43], 0 offen
    buffer_load_ushort v11, v3, s[44:47], 0 offen
    buffer_load_ushort v12, v3, s[48:51], 0 offen
    buffer_load_ushort v13, v3, s[52:55], 0 offen
    buffer_load_ushort v14, v3, s[56:59], 0 offen
    buffer_load_ushort v15, v3, s[60:63], 0 offen
    s_lshl_b32 s18, s16, 1
    v_mov_b32 v4, s18
    buffer_load_ushort v16, v4, s[64:67], 0 offen
    s_waitcnt vmcnt(0)
    v_lshlrev_b32 v10, 16, v10
    v_lshlrev_b32 v11, 16, v11
    v_lshlrev_b32 v12, 16, v12
    v_lshlrev_b32 v13, 16, v13
    v_lshlrev_b32 v14, 16, v14
    v_lshlrev_b32 v15, 16, v15
    v_lshlrev_b32 v16, 16, v16
    v_mul_f32 v17, 0x3fb8aa3b, v16
    v_exp_f32 v17, v17
    s_nop 0
    v_cvt_pk_bf16_f32 v17, v17, v17
    s_nop 0
    v_lshlrev_b32 v17, 16, v17
    v_mul_f32 v18, v17, v10
    v_mul_f32 v19, v17, v11
    v_mul_f32 v20, v17, v12
    v_mul_f32 v21, v17, v13
    v_mul_f32 v22, v14, v20
    v_fma_f32 v22, -v15, v21, v22
    v_mul_f32 v23, v14, v21
    v_fma_f32 v23, v15, v20, v23
    v_mul_f32 v24, 0x3fb8aa3b, v18
    v_mul_f32 v25, 0x3e22f983, v19
    v_lshlrev_b32 v5, 3, v1
    v_cmp_eq_u32 vcc, 0, v2
    s_cbranch_vccz kgen_beta
    v_mul_f32 v26, 0x00000000, v24
    v_exp_f32 v26, v26
    v_mul_f32 v27, 0x00000000, v25
    v_fract_f32 v27, v27
    v_cos_f32 v30, v27
    v_sin_f32 v31, v27
    s_nop 0
    v_mul_f32 v30, v26, v30
    v_mul_f32 v31, v26, v31
    v_mul_f32 v28, v30, v22
    v_fma_f32 v28, -v31, v23, v28
    v_mul_f32 v31, v31, v22
    v_fma_f32 v31, v30, v23, v31
    v_mov_b32 v30, v28
    v_mul_f32 v26, 0x41800000, v24
    v_exp_f32 v26, v26
    v_mul_f32 v27, 0x41800000, v25
    v_fract_f32 v27, v27
    v_cos_f32 v32, v27
    v_sin_f32 v33, v27
    s_nop 0
    v_mul_f32 v32, v26, v32
    v_mul_f32 v33, v26, v33
    v_mov_b32 v34, v30
    v_sub_f32 v35, 0, v31
    ds_write_b64 v5, v[34:35] offset:0
    v_mul_f32 v28, v30, v32
    v_fma_f32 v28, -v31, v33, v28
    v_mul_f32 v31, v31, v32
    v_fma_f32 v31, v30, v33, v31
    v_mov_b32 v30, v28
    v_mov_b32 v34, v30
    v_sub_f32 v35, 0, v31
    ds_write_b64 v5, v[34:35] offset:1040
    v_mul_f32 v28, v30, v32
    v_fma_f32 v28, -v31, v33, v28
    v_mul_f32 v31, v31, v32
    v_fma_f32 v31, v30, v33, v31
    v_mov_b32 v30, v28
    v_mov_b32 v34, v30
    v_sub_f32 v35, 0, v31
    ds_write_b64 v5, v[34:35] offset:2080
    v_mul_f32 v28, v30, v32
    v_fma_f32 v28, -v31, v33, v28
    v_mul_f32 v31, v31, v32
    v_fma_f32 v31, v30, v33, v31
    v_mov_b32 v30, v28
    v_mov_b32 v34, v30
    v_sub_f32 v35, 0, v31
    ds_write_b64 v5, v[34:35] offset:3120
    v_mul_f32 v28, v30, v32
    v_fma_f32 v28, -v31, v33, v28
    v_mul_f32 v31, v31, v32
    v_fma_f32 v31, v30, v33, v31
    v_mov_b32 v30, v28
    v_mov_b32 v34, v30
    v_sub_f32 v35, 0, v31
    ds_write_b64 v5, v[34:35] offset:4160
    v_mul_f32 v28, v30, v32
    v_fma_f32 v28, -v31, v33, v28
    v_mul_f32 v31, v31, v32
    v_fma_f32 v31, v30, v33, v31
    v_mov_b32 v30, v28
    v_mov_b32 v34, v30
    v_sub_f32 v35, 0, v31
    ds_write_b64 v5, v[34:35] offset:5200
    v_mul_f32 v28, v30, v32
    v_fma_f32 v28, -v31, v33, v28
    v_mul_f32 v31, v31, v32
    v_fma_f32 v31, v30, v33, v31
    v_mov_b32 v30, v28
    v_mov_b32 v34, v30
    v_sub_f32 v35, 0, v31
    ds_write_b64 v5, v[34:35] offset:6240
    v_mul_f32 v28, v30, v32
    v_fma_f32 v28, -v31, v33, v28
    v_mul_f32 v31, v31, v32
    v_fma_f32 v31, v30, v33, v31
    v_mov_b32 v30, v28
    v_mov_b32 v34, v30
    v_sub_f32 v35, 0, v31
    ds_write_b64 v5, v[34:35] offset:7280
    v_mul_f32 v28, v30, v32
    v_fma_f32 v28, -v31, v33, v28
    v_mul_f32 v31, v31, v32
    v_fma_f32 v31, v30, v33, v31
    v_mov_b32 v30, v28
    v_mov_b32 v34, v30
    v_sub_f32 v35, 0, v31
    ds_write_b64 v5, v[34:35] offset:8320
    v_mul_f32 v28, v30, v32
    v_fma_f32 v28, -v31, v33, v28
    v_mul_f32 v31, v31, v32
    v_fma_f32 v31, v30, v33, v31
    v_mov_b32 v30, v28
    v_mov_b32 v34, v30
    v_sub_f32 v35, 0, v31
    ds_write_b64 v5, v[34:35] offset:9360
    v_mul_f32 v28, v30, v32
    v_fma_f32 v28, -v31, v33, v28
    v_mul_f32 v31, v31, v32
    v_fma_f32 v31, v30, v33, v31
    v_mov_b32 v30, v28
    v_mov_b32 v34, v30
    v_sub_f32 v35, 0, v31
    ds_write_b64 v5, v[34:35] offset:10400
    v_mul_f32 v28, v30, v32
    v_fma_f32 v28, -v31, v33, v28
    v_mul_f32 v31, v31, v32
    v_fma_f32 v31, v30, v33, v31
    v_mov_b32 v30, v28
    v_mov_b32 v34, v30
    v_sub_f32 v35, 0, v31
    ds_write_b64 v5, v[34:35] offset:11440
    v_mul_f32 v28, v30, v32
    v_fma_f32 v28, -v31, v33, v28
    v_mul_f32 v31, v31, v32
    v_fma_f32 v31, v30, v33, v31
    v_mov_b32 v30, v28
    v_mov_b32 v34, v30
    v_sub_f32 v35, 0, v31
    ds_write_b64 v5, v[34:35] offset:12480
    v_mul_f32 v28, v30, v32
    v_fma_f32 v28, -v31, v33, v28
    v_mul_f32 v31, v31, v32
    v_fma_f32 v31, v30, v33, v31
    v_mov_b32 v30, v28
    v_mov_b32 v34, v30
    v_sub_f32 v35, 0, v31
    ds_write_b64 v5, v[34:35] offset:13520
    v_mul_f32 v28, v30, v32
    v_fma_f32 v28, -v31, v33, v28
    v_mul_f32 v31, v31, v32
    v_fma_f32 v31, v30, v33, v31
    v_mov_b32 v30, v28
    v_mov_b32 v34, v30
    v_sub_f32 v35, 0, v31
    ds_write_b64 v5, v[34:35] offset:14560
    v_mul_f32 v28, v30, v32
    v_fma_f32 v28, -v31, v33, v28
    v_mul_f32 v31, v31, v32
    v_fma_f32 v31, v30, v33, v31
    v_mov_b32 v30, v28
    v_mov_b32 v34, v30
    v_sub_f32 v35, 0, v31
    ds_write_b64 v5, v[34:35] offset:15600
    v_add_u32 v5, 33280, v5
    v_mul_f32 v26, 0x43800000, v24
    v_exp_f32 v26, v26
    v_mul_f32 v27, 0x43800000, v25
    v_fract_f32 v27, v27
    v_cos_f32 v30, v27
    v_sin_f32 v31, v27
    s_nop 0
    v_mul_f32 v30, v26, v30
    v_mul_f32 v31, v26, v31
    v_mul_f32 v28, v30, v22
    v_fma_f32 v28, -v31, v23, v28
    v_mul_f32 v31, v31, v22
    v_fma_f32 v31, v30, v23, v31
    v_mov_b32 v30, v28
    v_mul_f32 v26, 0x42000000, v24
    v_exp_f32 v26, v26
    v_mul_f32 v27, 0x42000000, v25
    v_fract_f32 v27, v27
    v_cos_f32 v32, v27
    v_sin_f32 v33, v27
    s_nop 0
    v_mul_f32 v32, v26, v32
    v_mul_f32 v33, v26, v33
    v_mov_b32 v34, v30
    v_sub_f32 v35, 0, v31
    ds_write_b64 v5, v[34:35] offset:0
    v_mul_f32 v28, v30, v32
    v_fma_f32 v28, -v31, v33, v28
    v_mul_f32 v31, v31, v32
    v_fma_f32 v31, v30, v33, v31
    v_mov_b32 v30, v28
    v_mov_b32 v34, v30
    v_sub_f32 v35, 0, v31
    ds_write_b64 v5, v[34:35] offset:1040
    v_mul_f32 v28, v30, v32
    v_fma_f32 v28, -v31, v33, v28
    v_mul_f32 v31, v31, v32
    v_fma_f32 v31, v30, v33, v31
    v_mov_b32 v30, v28
    v_mov_b32 v34, v30
    v_sub_f32 v35, 0, v31
    ds_write_b64 v5, v[34:35] offset:2080
    v_mul_f32 v28, v30, v32
    v_fma_f32 v28, -v31, v33, v28
    v_mul_f32 v31, v31, v32
    v_fma_f32 v31, v30, v33, v31
    v_mov_b32 v30, v28
    v_mov_b32 v34, v30
    v_sub_f32 v35, 0, v31
    ds_write_b64 v5, v[34:35] offset:3120
    v_mul_f32 v28, v30, v32
    v_fma_f32 v28, -v31, v33, v28
    v_mul_f32 v31, v31, v32
    v_fma_f32 v31, v30, v33, v31
    v_mov_b32 v30, v28
    v_mov_b32 v34, v30
    v_sub_f32 v35, 0, v31
    ds_write_b64 v5, v[34:35] offset:4160
    v_mul_f32 v28, v30, v32
    v_fma_f32 v28, -v31, v33, v28
    v_mul_f32 v31, v31, v32
    v_fma_f32 v31, v30, v33, v31
    v_mov_b32 v30, v28
    v_mov_b32 v34, v30
    v_sub_f32 v35, 0, v31
    ds_write_b64 v5, v[34:35] offset:5200
    v_mul_f32 v28, v30, v32
    v_fma_f32 v28, -v31, v33, v28
    v_mul_f32 v31, v31, v32
    v_fma_f32 v31, v30, v33, v31
    v_mov_b32 v30, v28
    v_mov_b32 v34, v30
    v_sub_f32 v35, 0, v31
    ds_write_b64 v5, v[34:35] offset:6240
    v_mul_f32 v28, v30, v32
    v_fma_f32 v28, -v31, v33, v28
    v_mul_f32 v31, v31, v32
    v_fma_f32 v31, v30, v33, v31
    v_mov_b32 v30, v28
    v_mov_b32 v34, v30
    v_sub_f32 v35, 0, v31
    ds_write_b64 v5, v[34:35] offset:7280
    v_add_u32 v5, 33280, v5
    v_mul_f32 v26, 0x44000000, v24
    v_exp_f32 v26, v26
    v_mul_f32 v27, 0x44000000, v25
    v_fract_f32 v27, v27
    v_cos_f32 v30, v27
    v_sin_f32 v31, v27
    s_nop 0
    v_mul_f32 v30, v26, v30
    v_mul_f32 v31, v26, v31
    v_mul_f32 v28, v30, v22
    v_fma_f32 v28, -v31, v23, v28
    v_mul_f32 v31, v31, v22
    v_fma_f32 v31, v30, v23, v31
    v_mov_b32 v30, v28
    v_mul_f32 v26, 0x42800000, v24
    v_exp_f32 v26, v26
    v_mul_f32 v27, 0x42800000, v25
    v_fract_f32 v27, v27
    v_cos_f32 v32, v27
    v_sin_f32 v33, v27
    s_nop 0
    v_mul_f32 v32, v26, v32
    v_mul_f32 v33, v26, v33
    v_mov_b32 v34, v30
    v_sub_f32 v35, 0, v31
    ds_write_b64 v5, v[34:35] offset:0
    v_mul_f32 v28, v30, v32
    v_fma_f32 v28, -v31, v33, v28
    v_mul_f32 v31, v31, v32
    v_fma_f32 v31, v30, v33, v31
    v_mov_b32 v30, v28
    v_mov_b32 v34, v30
    v_sub_f32 v35, 0, v31
    ds_write_b64 v5, v[34:35] offset:1040
    v_mul_f32 v28, v30, v32
    v_fma_f32 v28, -v31, v33, v28
    v_mul_f32 v31, v31, v32
    v_fma_f32 v31, v30, v33, v31
    v_mov_b32 v30, v28
    v_mov_b32 v34, v30
    v_sub_f32 v35, 0, v31
    ds_write_b64 v5, v[34:35] offset:2080
    v_mul_f32 v28, v30, v32
    v_fma_f32 v28, -v31, v33, v28
    v_mul_f32 v31, v31, v32
    v_fma_f32 v31, v30, v33, v31
    v_mov_b32 v30, v28
    v_mov_b32 v34, v30
    v_sub_f32 v35, 0, v31
    ds_write_b64 v5, v[34:35] offset:3120
    v_mul_f32 v28, v30, v32
    v_fma_f32 v28, -v31, v33, v28
    v_mul_f32 v31, v31, v32
    v_fma_f32 v31, v30, v33, v31
    v_mov_b32 v30, v28
    v_mov_b32 v34, v30
    v_sub_f32 v35, 0, v31
    ds_write_b64 v5, v[34:35] offset:4160
    v_mul_f32 v28, v30, v32
    v_fma_f32 v28, -v31, v33, v28
    v_mul_f32 v31, v31, v32
    v_fma_f32 v31, v30, v33, v31
    v_mov_b32 v30, v28
    v_mov_b32 v34, v30
    v_sub_f32 v35, 0, v31
    ds_write_b64 v5, v[34:35] offset:5200
    v_mul_f32 v28, v30, v32
    v_fma_f32 v28, -v31, v33, v28
    v_mul_f32 v31, v31, v32
    v_fma_f32 v31, v30, v33, v31
    v_mov_b32 v30, v28
    v_mov_b32 v34, v30
    v_sub_f32 v35, 0, v31
    ds_write_b64 v5, v[34:35] offset:6240
    v_mul_f32 v28, v30, v32
    v_fma_f32 v28, -v31, v33, v28
    v_mul_f32 v31, v31, v32
    v_fma_f32 v31, v30, v33, v31
    v_mov_b32 v30, v28
    v_mov_b32 v34, v30
    v_sub_f32 v35, 0, v31
    ds_write_b64 v5, v[34:35] offset:7280
    v_add_u32 v5, 33280, v5
    v_mul_f32 v26, 0x44800000, v24
    v_exp_f32 v26, v26
    v_mul_f32 v27, 0x44800000, v25
    v_fract_f32 v27, v27
    v_cos_f32 v30, v27
    v_sin_f32 v31, v27
    s_nop 0
    v_mul_f32 v30, v26, v30
    v_mul_f32 v31, v26, v31
    v_mul_f32 v28, v30, v22
    v_fma_f32 v28, -v31, v23, v28
    v_mul_f32 v31, v31, v22
    v_fma_f32 v31, v30, v23, v31
    v_mov_b32 v30, v28
    v_mul_f32 v26, 0x43000000, v24
    v_exp_f32 v26, v26
    v_mul_f32 v27, 0x43000000, v25
    v_fract_f32 v27, v27
    v_cos_f32 v32, v27
    v_sin_f32 v33, v27
    s_nop 0
    v_mul_f32 v32, v26, v32
    v_mul_f32 v33, v26, v33
    v_mov_b32 v34, v30
    v_sub_f32 v35, 0, v31
    ds_write_b64 v5, v[34:35] offset:0
    v_mul_f32 v28, v30, v32
    v_fma_f32 v28, -v31, v33, v28
    v_mul_f32 v31, v31, v32
    v_fma_f32 v31, v30, v33, v31
    v_mov_b32 v30, v28
    v_mov_b32 v34, v30
    v_sub_f32 v35, 0, v31
    ds_write_b64 v5, v[34:35] offset:1040
    v_mul_f32 v28, v30, v32
    v_fma_f32 v28, -v31, v33, v28
    v_mul_f32 v31, v31, v32
    v_fma_f32 v31, v30, v33, v31
    v_mov_b32 v30, v28
    v_mov_b32 v34, v30
    v_sub_f32 v35, 0, v31
    ds_write_b64 v5, v[34:35] offset:2080
    v_mul_f32 v28, v30, v32
    v_fma_f32 v28, -v31, v33, v28
    v_mul_f32 v31, v31, v32
    v_fma_f32 v31, v30, v33, v31
    v_mov_b32 v30, v28
    v_mov_b32 v34, v30
    v_sub_f32 v35, 0, v31
    ds_write_b64 v5, v[34:35] offset:3120
    v_mul_f32 v28, v30, v32
    v_fma_f32 v28, -v31, v33, v28
    v_mul_f32 v31, v31, v32
    v_fma_f32 v31, v30, v33, v31
    v_mov_b32 v30, v28
    v_mov_b32 v34, v30
    v_sub_f32 v35, 0, v31
    ds_write_b64 v5, v[34:35] offset:4160
    v_mul_f32 v28, v30, v32
    v_fma_f32 v28, -v31, v33, v28
    v_mul_f32 v31, v31, v32
    v_fma_f32 v31, v30, v33, v31
    v_mov_b32 v30, v28
    v_mov_b32 v34, v30
    v_sub_f32 v35, 0, v31
    ds_write_b64 v5, v[34:35] offset:5200
    v_mul_f32 v28, v30, v32
    v_fma_f32 v28, -v31, v33, v28
    v_mul_f32 v31, v31, v32
    v_fma_f32 v31, v30, v33, v31
    v_mov_b32 v30, v28
    v_mov_b32 v34, v30
    v_sub_f32 v35, 0, v31
    ds_write_b64 v5, v[34:35] offset:6240
    v_mul_f32 v28, v30, v32
    v_fma_f32 v28, -v31, v33, v28
    v_mul_f32 v31, v31, v32
    v_fma_f32 v31, v30, v33, v31
    v_mov_b32 v30, v28
    v_mov_b32 v34, v30
    v_sub_f32 v35, 0, v31
    ds_write_b64 v5, v[34:35] offset:7280
    v_mul_f32 v28, v30, v32
    v_fma_f32 v28, -v31, v33, v28
    v_mul_f32 v31, v31, v32
    v_fma_f32 v31, v30, v33, v31
    v_mov_b32 v30, v28
    v_mov_b32 v34, v30
    v_sub_f32 v35, 0, v31
    ds_write_b64 v5, v[34:35] offset:8320
    v_add_u32 v5, 33280, v5
    s_branch kgen_p2
kgen_beta:
    v_mul_f32 v26, 0x3f800000, v24
    v_exp_f32 v26, v26
    v_mul_f32 v27, 0x3f800000, v25
    v_fract_f32 v27, v27
    v_cos_f32 v32, v27
    v_sin_f32 v33, v27
    s_nop 0
    v_mul_f32 v32, v26, v32
    v_mul_f32 v33, v26, v33
    v_mov_b32 v30, 1.0
    v_mov_b32 v31, 0
    v_mov_b32 v34, v30
    v_mov_b32 v35, v31
    ds_write_b64 v5, v[34:35] offset:16640
    v_mul_f32 v28, v30, v32
    v_fma_f32 v28, -v31, v33, v28
    v_mul_f32 v31, v31, v32
    v_fma_f32 v31, v30, v33, v31
    v_mov_b32 v30, v28
    v_mov_b32 v34, v30
    v_mov_b32 v35, v31
    ds_write_b64 v5, v[34:35] offset:17680
    v_mul_f32 v28, v30, v32
    v_fma_f32 v28, -v31, v33, v28
    v_mul_f32 v31, v31, v32
    v_fma_f32 v31, v30, v33, v31
    v_mov_b32 v30, v28
    v_mov_b32 v34, v30
    v_mov_b32 v35, v31
    ds_write_b64 v5, v[34:35] offset:18720
    v_mul_f32 v28, v30, v32
    v_fma_f32 v28, -v31, v33, v28
    v_mul_f32 v31, v31, v32
    v_fma_f32 v31, v30, v33, v31
    v_mov_b32 v30, v28
    v_mov_b32 v34, v30
    v_mov_b32 v35, v31
    ds_write_b64 v5, v[34:35] offset:19760
    v_mul_f32 v28, v30, v32
    v_fma_f32 v28, -v31, v33, v28
    v_mul_f32 v31, v31, v32
    v_fma_f32 v31, v30, v33, v31
    v_mov_b32 v30, v28
    v_mov_b32 v34, v30
    v_mov_b32 v35, v31
    ds_write_b64 v5, v[34:35] offset:20800
    v_mul_f32 v28, v30, v32
    v_fma_f32 v28, -v31, v33, v28
    v_mul_f32 v31, v31, v32
    v_fma_f32 v31, v30, v33, v31
    v_mov_b32 v30, v28
    v_mov_b32 v34, v30
    v_mov_b32 v35, v31
    ds_write_b64 v5, v[34:35] offset:21840
    v_mul_f32 v28, v30, v32
    v_fma_f32 v28, -v31, v33, v28
    v_mul_f32 v31, v31, v32
    v_fma_f32 v31, v30, v33, v31
    v_mov_b32 v30, v28
    v_mov_b32 v34, v30
    v_mov_b32 v35, v31
    ds_write_b64 v5, v[34:35] offset:22880
    v_mul_f32 v28, v30, v32
    v_fma_f32 v28, -v31, v33, v28
    v_mul_f32 v31, v31, v32
    v_fma_f32 v31, v30, v33, v31
    v_mov_b32 v30, v28
    v_mov_b32 v34, v30
    v_mov_b32 v35, v31
    ds_write_b64 v5, v[34:35] offset:23920
    v_mul_f32 v28, v30, v32
    v_fma_f32 v28, -v31, v33, v28
    v_mul_f32 v31, v31, v32
    v_fma_f32 v31, v30, v33, v31
    v_mov_b32 v30, v28
    v_mov_b32 v34, v30
    v_mov_b32 v35, v31
    ds_write_b64 v5, v[34:35] offset:24960
    v_mul_f32 v28, v30, v32
    v_fma_f32 v28, -v31, v33, v28
    v_mul_f32 v31, v31, v32
    v_fma_f32 v31, v30, v33, v31
    v_mov_b32 v30, v28
    v_mov_b32 v34, v30
    v_mov_b32 v35, v31
    ds_write_b64 v5, v[34:35] offset:26000
    v_mul_f32 v28, v30, v32
    v_fma_f32 v28, -v31, v33, v28
    v_mul_f32 v31, v31, v32
    v_fma_f32 v31, v30, v33, v31
    v_mov_b32 v30, v28
    v_mov_b32 v34, v30
    v_mov_b32 v35, v31
    ds_write_b64 v5, v[34:35] offset:27040
    v_mul_f32 v28, v30, v32
    v_fma_f32 v28, -v31, v33, v28
    v_mul_f32 v31, v31, v32
    v_fma_f32 v31, v30, v33, v31
    v_mov_b32 v30, v28
    v_mov_b32 v34, v30
    v_mov_b32 v35, v31
    ds_write_b64 v5, v[34:35] offset:28080
    v_mul_f32 v28, v30, v32
    v_fma_f32 v28, -v31, v33, v28
    v_mul_f32 v31, v31, v32
    v_fma_f32 v31, v30, v33, v31
    v_mov_b32 v30, v28
    v_mov_b32 v34, v30
    v_mov_b32 v35, v31
    ds_write_b64 v5, v[34:35] offset:29120
    v_mul_f32 v28, v30, v32
    v_fma_f32 v28, -v31, v33, v28
    v_mul_f32 v31, v31, v32
    v_fma_f32 v31, v30, v33, v31
    v_mov_b32 v30, v28
    v_mov_b32 v34, v30
    v_mov_b32 v35, v31
    ds_write_b64 v5, v[34:35] offset:30160
    v_mul_f32 v28, v30, v32
    v_fma_f32 v28, -v31, v33, v28
    v_mul_f32 v31, v31, v32
    v_fma_f32 v31, v30, v33, v31
    v_mov_b32 v30, v28
    v_mov_b32 v34, v30
    v_mov_b32 v35, v31
    ds_write_b64 v5, v[34:35] offset:31200
    v_mul_f32 v28, v30, v32
    v_fma_f32 v28, -v31, v33, v28
    v_mul_f32 v31, v31, v32
    v_fma_f32 v31, v30, v33, v31
    v_mov_b32 v30, v28
    v_mov_b32 v34, v30
    v_mov_b32 v35, v31
    ds_write_b64 v5, v[34:35] offset:32240
    v_add_u32 v5, 33280, v5
    v_mul_f32 v26, 0x40000000, v24
    v_exp_f32 v26, v26
    v_mul_f32 v27, 0x40000000, v25
    v_fract_f32 v27, v27
    v_cos_f32 v32, v27
    v_sin_f32 v33, v27
    s_nop 0
    v_mul_f32 v32, v26, v32
    v_mul_f32 v33, v26, v33
    v_mov_b32 v30, 1.0
    v_mov_b32 v31, 0
    v_mov_b32 v34, v30
    v_mov_b32 v35, v31
    ds_write_b64 v5, v[34:35] offset:16640
    v_mul_f32 v28, v30, v32
    v_fma_f32 v28, -v31, v33, v28
    v_mul_f32 v31, v31, v32
    v_fma_f32 v31, v30, v33, v31
    v_mov_b32 v30, v28
    v_mov_b32 v34, v30
    v_mov_b32 v35, v31
    ds_write_b64 v5, v[34:35] offset:17680
    v_mul_f32 v28, v30, v32
    v_fma_f32 v28, -v31, v33, v28
    v_mul_f32 v31, v31, v32
    v_fma_f32 v31, v30, v33, v31
    v_mov_b32 v30, v28
    v_mov_b32 v34, v30
    v_mov_b32 v35, v31
    ds_write_b64 v5, v[34:35] offset:18720
    v_mul_f32 v28, v30, v32
    v_fma_f32 v28, -v31, v33, v28
    v_mul_f32 v31, v31, v32
    v_fma_f32 v31, v30, v33, v31
    v_mov_b32 v30, v28
    v_mov_b32 v34, v30
    v_mov_b32 v35, v31
    ds_write_b64 v5, v[34:35] offset:19760
    v_mul_f32 v28, v30, v32
    v_fma_f32 v28, -v31, v33, v28
    v_mul_f32 v31, v31, v32
    v_fma_f32 v31, v30, v33, v31
    v_mov_b32 v30, v28
    v_mov_b32 v34, v30
    v_mov_b32 v35, v31
    ds_write_b64 v5, v[34:35] offset:20800
    v_mul_f32 v28, v30, v32
    v_fma_f32 v28, -v31, v33, v28
    v_mul_f32 v31, v31, v32
    v_fma_f32 v31, v30, v33, v31
    v_mov_b32 v30, v28
    v_mov_b32 v34, v30
    v_mov_b32 v35, v31
    ds_write_b64 v5, v[34:35] offset:21840
    v_mul_f32 v28, v30, v32
    v_fma_f32 v28, -v31, v33, v28
    v_mul_f32 v31, v31, v32
    v_fma_f32 v31, v30, v33, v31
    v_mov_b32 v30, v28
    v_mov_b32 v34, v30
    v_mov_b32 v35, v31
    ds_write_b64 v5, v[34:35] offset:22880
    v_mul_f32 v28, v30, v32
    v_fma_f32 v28, -v31, v33, v28
    v_mul_f32 v31, v31, v32
    v_fma_f32 v31, v30, v33, v31
    v_mov_b32 v30, v28
    v_mov_b32 v34, v30
    v_mov_b32 v35, v31
    ds_write_b64 v5, v[34:35] offset:23920
    v_mul_f32 v28, v30, v32
    v_fma_f32 v28, -v31, v33, v28
    v_mul_f32 v31, v31, v32
    v_fma_f32 v31, v30, v33, v31
    v_mov_b32 v30, v28
    v_mov_b32 v34, v30
    v_mov_b32 v35, v31
    ds_write_b64 v5, v[34:35] offset:24960
    v_mul_f32 v28, v30, v32
    v_fma_f32 v28, -v31, v33, v28
    v_mul_f32 v31, v31, v32
    v_fma_f32 v31, v30, v33, v31
    v_mov_b32 v30, v28
    v_mov_b32 v34, v30
    v_mov_b32 v35, v31
    ds_write_b64 v5, v[34:35] offset:26000
    v_mul_f32 v28, v30, v32
    v_fma_f32 v28, -v31, v33, v28
    v_mul_f32 v31, v31, v32
    v_fma_f32 v31, v30, v33, v31
    v_mov_b32 v30, v28
    v_mov_b32 v34, v30
    v_mov_b32 v35, v31
    ds_write_b64 v5, v[34:35] offset:27040
    v_mul_f32 v28, v30, v32
    v_fma_f32 v28, -v31, v33, v28
    v_mul_f32 v31, v31, v32
    v_fma_f32 v31, v30, v33, v31
    v_mov_b32 v30, v28
    v_mov_b32 v34, v30
    v_mov_b32 v35, v31
    ds_write_b64 v5, v[34:35] offset:28080
    v_mul_f32 v28, v30, v32
    v_fma_f32 v28, -v31, v33, v28
    v_mul_f32 v31, v31, v32
    v_fma_f32 v31, v30, v33, v31
    v_mov_b32 v30, v28
    v_mov_b32 v34, v30
    v_mov_b32 v35, v31
    ds_write_b64 v5, v[34:35] offset:29120
    v_mul_f32 v28, v30, v32
    v_fma_f32 v28, -v31, v33, v28
    v_mul_f32 v31, v31, v32
    v_fma_f32 v31, v30, v33, v31
    v_mov_b32 v30, v28
    v_mov_b32 v34, v30
    v_mov_b32 v35, v31
    ds_write_b64 v5, v[34:35] offset:30160
    v_mul_f32 v28, v30, v32
    v_fma_f32 v28, -v31, v33, v28
    v_mul_f32 v31, v31, v32
    v_fma_f32 v31, v30, v33, v31
    v_mov_b32 v30, v28
    v_mov_b32 v34, v30
    v_mov_b32 v35, v31
    ds_write_b64 v5, v[34:35] offset:31200
    v_mul_f32 v28, v30, v32
    v_fma_f32 v28, -v31, v33, v28
    v_mul_f32 v31, v31, v32
    v_fma_f32 v31, v30, v33, v31
    v_mov_b32 v30, v28
    v_mov_b32 v34, v30
    v_mov_b32 v35, v31
    ds_write_b64 v5, v[34:35] offset:32240
    v_add_u32 v5, 33280, v5
    v_mul_f32 v26, 0x40800000, v24
    v_exp_f32 v26, v26
    v_mul_f32 v27, 0x40800000, v25
    v_fract_f32 v27, v27
    v_cos_f32 v32, v27
    v_sin_f32 v33, v27
    s_nop 0
    v_mul_f32 v32, v26, v32
    v_mul_f32 v33, v26, v33
    v_mov_b32 v30, 1.0
    v_mov_b32 v31, 0
    v_mov_b32 v34, v30
    v_mov_b32 v35, v31
    ds_write_b64 v5, v[34:35] offset:16640
    v_mul_f32 v28, v30, v32
    v_fma_f32 v28, -v31, v33, v28
    v_mul_f32 v31, v31, v32
    v_fma_f32 v31, v30, v33, v31
    v_mov_b32 v30, v28
    v_mov_b32 v34, v30
    v_mov_b32 v35, v31
    ds_write_b64 v5, v[34:35] offset:17680
    v_mul_f32 v28, v30, v32
    v_fma_f32 v28, -v31, v33, v28
    v_mul_f32 v31, v31, v32
    v_fma_f32 v31, v30, v33, v31
    v_mov_b32 v30, v28
    v_mov_b32 v34, v30
    v_mov_b32 v35, v31
    ds_write_b64 v5, v[34:35] offset:18720
    v_mul_f32 v28, v30, v32
    v_fma_f32 v28, -v31, v33, v28
    v_mul_f32 v31, v31, v32
    v_fma_f32 v31, v30, v33, v31
    v_mov_b32 v30, v28
    v_mov_b32 v34, v30
    v_mov_b32 v35, v31
    ds_write_b64 v5, v[34:35] offset:19760
    v_mul_f32 v28, v30, v32
    v_fma_f32 v28, -v31, v33, v28
    v_mul_f32 v31, v31, v32
    v_fma_f32 v31, v30, v33, v31
    v_mov_b32 v30, v28
    v_mov_b32 v34, v30
    v_mov_b32 v35, v31
    ds_write_b64 v5, v[34:35] offset:20800
    v_mul_f32 v28, v30, v32
    v_fma_f32 v28, -v31, v33, v28
    v_mul_f32 v31, v31, v32
    v_fma_f32 v31, v30, v33, v31
    v_mov_b32 v30, v28
    v_mov_b32 v34, v30
    v_mov_b32 v35, v31
    ds_write_b64 v5, v[34:35] offset:21840
    v_mul_f32 v28, v30, v32
    v_fma_f32 v28, -v31, v33, v28
    v_mul_f32 v31, v31, v32
    v_fma_f32 v31, v30, v33, v31
    v_mov_b32 v30, v28
    v_mov_b32 v34, v30
    v_mov_b32 v35, v31
    ds_write_b64 v5, v[34:35] offset:22880
    v_mul_f32 v28, v30, v32
    v_fma_f32 v28, -v31, v33, v28
    v_mul_f32 v31, v31, v32
    v_fma_f32 v31, v30, v33, v31
    v_mov_b32 v30, v28
    v_mov_b32 v34, v30
    v_mov_b32 v35, v31
    ds_write_b64 v5, v[34:35] offset:23920
    v_mul_f32 v28, v30, v32
    v_fma_f32 v28, -v31, v33, v28
    v_mul_f32 v31, v31, v32
    v_fma_f32 v31, v30, v33, v31
    v_mov_b32 v30, v28
    v_mov_b32 v34, v30
    v_mov_b32 v35, v31
    ds_write_b64 v5, v[34:35] offset:24960
    v_mul_f32 v28, v30, v32
    v_fma_f32 v28, -v31, v33, v28
    v_mul_f32 v31, v31, v32
    v_fma_f32 v31, v30, v33, v31
    v_mov_b32 v30, v28
    v_mov_b32 v34, v30
    v_mov_b32 v35, v31
    ds_write_b64 v5, v[34:35] offset:26000
    v_mul_f32 v28, v30, v32
    v_fma_f32 v28, -v31, v33, v28
    v_mul_f32 v31, v31, v32
    v_fma_f32 v31, v30, v33, v31
    v_mov_b32 v30, v28
    v_mov_b32 v34, v30
    v_mov_b32 v35, v31
    ds_write_b64 v5, v[34:35] offset:27040
    v_mul_f32 v28, v30, v32
    v_fma_f32 v28, -v31, v33, v28
    v_mul_f32 v31, v31, v32
    v_fma_f32 v31, v30, v33, v31
    v_mov_b32 v30, v28
    v_mov_b32 v34, v30
    v_mov_b32 v35, v31
    ds_write_b64 v5, v[34:35] offset:28080
    v_mul_f32 v28, v30, v32
    v_fma_f32 v28, -v31, v33, v28
    v_mul_f32 v31, v31, v32
    v_fma_f32 v31, v30, v33, v31
    v_mov_b32 v30, v28
    v_mov_b32 v34, v30
    v_mov_b32 v35, v31
    ds_write_b64 v5, v[34:35] offset:29120
    v_mul_f32 v28, v30, v32
    v_fma_f32 v28, -v31, v33, v28
    v_mul_f32 v31, v31, v32
    v_fma_f32 v31, v30, v33, v31
    v_mov_b32 v30, v28
    v_mov_b32 v34, v30
    v_mov_b32 v35, v31
    ds_write_b64 v5, v[34:35] offset:30160
    v_mul_f32 v28, v30, v32
    v_fma_f32 v28, -v31, v33, v28
    v_mul_f32 v31, v31, v32
    v_fma_f32 v31, v30, v33, v31
    v_mov_b32 v30, v28
    v_mov_b32 v34, v30
    v_mov_b32 v35, v31
    ds_write_b64 v5, v[34:35] offset:31200
    v_mul_f32 v28, v30, v32
    v_fma_f32 v28, -v31, v33, v28
    v_mul_f32 v31, v31, v32
    v_fma_f32 v31, v30, v33, v31
    v_mov_b32 v30, v28
    v_mov_b32 v34, v30
    v_mov_b32 v35, v31
    ds_write_b64 v5, v[34:35] offset:32240
    v_add_u32 v5, 33280, v5
    v_mul_f32 v26, 0x41000000, v24
    v_exp_f32 v26, v26
    v_mul_f32 v27, 0x41000000, v25
    v_fract_f32 v27, v27
    v_cos_f32 v32, v27
    v_sin_f32 v33, v27
    s_nop 0
    v_mul_f32 v32, v26, v32
    v_mul_f32 v33, v26, v33
    v_mov_b32 v30, 1.0
    v_mov_b32 v31, 0
    v_mov_b32 v34, v30
    v_mov_b32 v35, v31
    ds_write_b64 v5, v[34:35] offset:16640
    v_mul_f32 v28, v30, v32
    v_fma_f32 v28, -v31, v33, v28
    v_mul_f32 v31, v31, v32
    v_fma_f32 v31, v30, v33, v31
    v_mov_b32 v30, v28
    v_mov_b32 v34, v30
    v_mov_b32 v35, v31
    ds_write_b64 v5, v[34:35] offset:17680
    v_mul_f32 v28, v30, v32
    v_fma_f32 v28, -v31, v33, v28
    v_mul_f32 v31, v31, v32
    v_fma_f32 v31, v30, v33, v31
    v_mov_b32 v30, v28
    v_mov_b32 v34, v30
    v_mov_b32 v35, v31
    ds_write_b64 v5, v[34:35] offset:18720
    v_mul_f32 v28, v30, v32
    v_fma_f32 v28, -v31, v33, v28
    v_mul_f32 v31, v31, v32
    v_fma_f32 v31, v30, v33, v31
    v_mov_b32 v30, v28
    v_mov_b32 v34, v30
    v_mov_b32 v35, v31
    ds_write_b64 v5, v[34:35] offset:19760
    v_mul_f32 v28, v30, v32
    v_fma_f32 v28, -v31, v33, v28
    v_mul_f32 v31, v31, v32
    v_fma_f32 v31, v30, v33, v31
    v_mov_b32 v30, v28
    v_mov_b32 v34, v30
    v_mov_b32 v35, v31
    ds_write_b64 v5, v[34:35] offset:20800
    v_mul_f32 v28, v30, v32
    v_fma_f32 v28, -v31, v33, v28
    v_mul_f32 v31, v31, v32
    v_fma_f32 v31, v30, v33, v31
    v_mov_b32 v30, v28
    v_mov_b32 v34, v30
    v_mov_b32 v35, v31
    ds_write_b64 v5, v[34:35] offset:21840
    v_mul_f32 v28, v30, v32
    v_fma_f32 v28, -v31, v33, v28
    v_mul_f32 v31, v31, v32
    v_fma_f32 v31, v30, v33, v31
    v_mov_b32 v30, v28
    v_mov_b32 v34, v30
    v_mov_b32 v35, v31
    ds_write_b64 v5, v[34:35] offset:22880
    v_mul_f32 v28, v30, v32
    v_fma_f32 v28, -v31, v33, v28
    v_mul_f32 v31, v31, v32
    v_fma_f32 v31, v30, v33, v31
    v_mov_b32 v30, v28
    v_mov_b32 v34, v30
    v_mov_b32 v35, v31
    ds_write_b64 v5, v[34:35] offset:23920
    v_mul_f32 v28, v30, v32
    v_fma_f32 v28, -v31, v33, v28
    v_mul_f32 v31, v31, v32
    v_fma_f32 v31, v30, v33, v31
    v_mov_b32 v30, v28
    v_mov_b32 v34, v30
    v_mov_b32 v35, v31
    ds_write_b64 v5, v[34:35] offset:24960
    v_mul_f32 v28, v30, v32
    v_fma_f32 v28, -v31, v33, v28
    v_mul_f32 v31, v31, v32
    v_fma_f32 v31, v30, v33, v31
    v_mov_b32 v30, v28
    v_mov_b32 v34, v30
    v_mov_b32 v35, v31
    ds_write_b64 v5, v[34:35] offset:26000
    v_mul_f32 v28, v30, v32
    v_fma_f32 v28, -v31, v33, v28
    v_mul_f32 v31, v31, v32
    v_fma_f32 v31, v30, v33, v31
    v_mov_b32 v30, v28
    v_mov_b32 v34, v30
    v_mov_b32 v35, v31
    ds_write_b64 v5, v[34:35] offset:27040
    v_mul_f32 v28, v30, v32
    v_fma_f32 v28, -v31, v33, v28
    v_mul_f32 v31, v31, v32
    v_fma_f32 v31, v30, v33, v31
    v_mov_b32 v30, v28
    v_mov_b32 v34, v30
    v_mov_b32 v35, v31
    ds_write_b64 v5, v[34:35] offset:28080
    v_mul_f32 v28, v30, v32
    v_fma_f32 v28, -v31, v33, v28
    v_mul_f32 v31, v31, v32
    v_fma_f32 v31, v30, v33, v31
    v_mov_b32 v30, v28
    v_mov_b32 v34, v30
    v_mov_b32 v35, v31
    ds_write_b64 v5, v[34:35] offset:29120
    v_mul_f32 v28, v30, v32
    v_fma_f32 v28, -v31, v33, v28
    v_mul_f32 v31, v31, v32
    v_fma_f32 v31, v30, v33, v31
    v_mov_b32 v30, v28
    v_mov_b32 v34, v30
    v_mov_b32 v35, v31
    ds_write_b64 v5, v[34:35] offset:30160
    v_mul_f32 v28, v30, v32
    v_fma_f32 v28, -v31, v33, v28
    v_mul_f32 v31, v31, v32
    v_fma_f32 v31, v30, v33, v31
    v_mov_b32 v30, v28
    v_mov_b32 v34, v30
    v_mov_b32 v35, v31
    ds_write_b64 v5, v[34:35] offset:31200
    v_mul_f32 v28, v30, v32
    v_fma_f32 v28, -v31, v33, v28
    v_mul_f32 v31, v31, v32
    v_fma_f32 v31, v30, v33, v31
    v_mov_b32 v30, v28
    v_mov_b32 v34, v30
    v_mov_b32 v35, v31
    ds_write_b64 v5, v[34:35] offset:32240
    v_add_u32 v5, 33280, v5
kgen_p2:
    s_waitcnt lgkmcnt(0)
    s_barrier
    v_lshrrev_b32 v6, 6, v0
    v_and_b32 v7, 63, v0
    v_and_b32 v8, 15, v7
    v_lshrrev_b32 v9, 4, v7
    s_mov_b32 s19, 33280
    v_mul_lo_u32 v36, v6, s19
    s_movk_i32 s20, 1040
    v_mul_lo_u32 v37, v8, s20
    v_add_u32 v36, v36, v37
    v_lshl_add_u32 v36, v9, 2, v36
    v_add_u32 v37, 16640, v36
    v_mov_b32 v40, 0
    v_mov_b32 v41, 0
    v_mov_b32 v42, 0
    v_mov_b32 v43, 0
    ds_read_b32 v50, v36 offset:0
    ds_read_b32 v70, v37 offset:0
    ds_read_b32 v51, v36 offset:16
    ds_read_b32 v71, v37 offset:16
    ds_read_b32 v52, v36 offset:32
    ds_read_b32 v72, v37 offset:32
    ds_read_b32 v53, v36 offset:48
    ds_read_b32 v73, v37 offset:48
    ds_read_b32 v54, v36 offset:64
    ds_read_b32 v74, v37 offset:64
    ds_read_b32 v55, v36 offset:80
    ds_read_b32 v75, v37 offset:80
    ds_read_b32 v56, v36 offset:96
    ds_read_b32 v76, v37 offset:96
    ds_read_b32 v57, v36 offset:112
    ds_read_b32 v77, v37 offset:112
    ds_read_b32 v58, v36 offset:128
    ds_read_b32 v78, v37 offset:128
    ds_read_b32 v59, v36 offset:144
    ds_read_b32 v79, v37 offset:144
    ds_read_b32 v60, v36 offset:160
    ds_read_b32 v80, v37 offset:160
    ds_read_b32 v61, v36 offset:176
    ds_read_b32 v81, v37 offset:176
    s_waitcnt lgkmcnt(15)
    v_mfma_f32_16x16x4_f32 v[40:43], v50, v70, v[40:43]
    v_mfma_f32_16x16x4_f32 v[40:43], v51, v71, v[40:43]
    v_mfma_f32_16x16x4_f32 v[40:43], v52, v72, v[40:43]
    v_mfma_f32_16x16x4_f32 v[40:43], v53, v73, v[40:43]
    ds_read_b32 v62, v36 offset:192
    ds_read_b32 v82, v37 offset:192
    ds_read_b32 v63, v36 offset:208
    ds_read_b32 v83, v37 offset:208
    ds_read_b32 v64, v36 offset:224
    ds_read_b32 v84, v37 offset:224
    ds_read_b32 v65, v36 offset:240
    ds_read_b32 v85, v37 offset:240
    s_waitcnt lgkmcnt(15)
    v_mfma_f32_16x16x4_f32 v[40:43], v54, v74, v[40:43]
    v_mfma_f32_16x16x4_f32 v[40:43], v55, v75, v[40:43]
    v_mfma_f32_16x16x4_f32 v[40:43], v56, v76, v[40:43]
    v_mfma_f32_16x16x4_f32 v[40:43], v57, v77, v[40:43]
    ds_read_b32 v50, v36 offset:256
    ds_read_b32 v70, v37 offset:256
    ds_read_b32 v51, v36 offset:272
    ds_read_b32 v71, v37 offset:272
    ds_read_b32 v52, v36 offset:288
    ds_read_b32 v72, v37 offset:288
    ds_read_b32 v53, v36 offset:304
    ds_read_b32 v73, v37 offset:304
    s_waitcnt lgkmcnt(15)
    v_mfma_f32_16x16x4_f32 v[40:43], v58, v78, v[40:43]
    v_mfma_f32_16x16x4_f32 v[40:43], v59, v79, v[40:43]
    v_mfma_f32_16x16x4_f32 v[40:43], v60, v80, v[40:43]
    v_mfma_f32_16x16x4_f32 v[40:43], v61, v81, v[40:43]
    ds_read_b32 v54, v36 offset:320
    ds_read_b32 v74, v37 offset:320
    ds_read_b32 v55, v36 offset:336
    ds_read_b32 v75, v37 offset:336
    ds_read_b32 v56, v36 offset:352
    ds_read_b32 v76, v37 offset:352
    ds_read_b32 v57, v36 offset:368
    ds_read_b32 v77, v37 offset:368
    s_waitcnt lgkmcnt(15)
    v_mfma_f32_16x16x4_f32 v[40:43], v62, v82, v[40:43]
    v_mfma_f32_16x16x4_f32 v[40:43], v63, v83, v[40:43]
    v_mfma_f32_16x16x4_f32 v[40:43], v64, v84, v[40:43]
    v_mfma_f32_16x16x4_f32 v[40:43], v65, v85, v[40:43]
    ds_read_b32 v58, v36 offset:384
    ds_read_b32 v78, v37 offset:384
    ds_read_b32 v59, v36 offset:400
    ds_read_b32 v79, v37 offset:400
    ds_read_b32 v60, v36 offset:416
    ds_read_b32 v80, v37 offset:416
    ds_read_b32 v61, v36 offset:432
    ds_read_b32 v81, v37 offset:432
    s_waitcnt lgkmcnt(15)
    v_mfma_f32_16x16x4_f32 v[40:43], v50, v70, v[40:43]
    v_mfma_f32_16x16x4_f32 v[40:43], v51, v71, v[40:43]
    v_mfma_f32_16x16x4_f32 v[40:43], v52, v72, v[40:43]
    v_mfma_f32_16x16x4_f32 v[40:43], v53, v73, v[40:43]
    ds_read_b32 v62, v36 offset:448
    ds_read_b32 v82, v37 offset:448
    ds_read_b32 v63, v36 offset:464
    ds_read_b32 v83, v37 offset:464
    ds_read_b32 v64, v36 offset:480
    ds_read_b32 v84, v37 offset:480
    ds_read_b32 v65, v36 offset:496
    ds_read_b32 v85, v37 offset:496
    s_waitcnt lgkmcnt(15)
    v_mfma_f32_16x16x4_f32 v[40:43], v54, v74, v[40:43]
    v_mfma_f32_16x16x4_f32 v[40:43], v55, v75, v[40:43]
    v_mfma_f32_16x16x4_f32 v[40:43], v56, v76, v[40:43]
    v_mfma_f32_16x16x4_f32 v[40:43], v57, v77, v[40:43]
    ds_read_b32 v50, v36 offset:512
    ds_read_b32 v70, v37 offset:512
    ds_read_b32 v51, v36 offset:528
    ds_read_b32 v71, v37 offset:528
    ds_read_b32 v52, v36 offset:544
    ds_read_b32 v72, v37 offset:544
    ds_read_b32 v53, v36 offset:560
    ds_read_b32 v73, v37 offset:560
    s_waitcnt lgkmcnt(15)
    v_mfma_f32_16x16x4_f32 v[40:43], v58, v78, v[40:43]
    v_mfma_f32_16x16x4_f32 v[40:43], v59, v79, v[40:43]
    v_mfma_f32_16x16x4_f32 v[40:43], v60, v80, v[40:43]
    v_mfma_f32_16x16x4_f32 v[40:43], v61, v81, v[40:43]
    ds_read_b32 v54, v36 offset:576
    ds_read_b32 v74, v37 offset:576
    ds_read_b32 v55, v36 offset:592
    ds_read_b32 v75, v37 offset:592
    ds_read_b32 v56, v36 offset:608
    ds_read_b32 v76, v37 offset:608
    ds_read_b32 v57, v36 offset:624
    ds_read_b32 v77, v37 offset:624
    s_waitcnt lgkmcnt(15)
    v_mfma_f32_16x16x4_f32 v[40:43], v62, v82, v[40:43]
    v_mfma_f32_16x16x4_f32 v[40:43], v63, v83, v[40:43]
    v_mfma_f32_16x16x4_f32 v[40:43], v64, v84, v[40:43]
    v_mfma_f32_16x16x4_f32 v[40:43], v65, v85, v[40:43]
    ds_read_b32 v58, v36 offset:640
    ds_read_b32 v78, v37 offset:640
    ds_read_b32 v59, v36 offset:656
    ds_read_b32 v79, v37 offset:656
    ds_read_b32 v60, v36 offset:672
    ds_read_b32 v80, v37 offset:672
    ds_read_b32 v61, v36 offset:688
    ds_read_b32 v81, v37 offset:688
    s_waitcnt lgkmcnt(15)
    v_mfma_f32_16x16x4_f32 v[40:43], v50, v70, v[40:43]
    v_mfma_f32_16x16x4_f32 v[40:43], v51, v71, v[40:43]
    v_mfma_f32_16x16x4_f32 v[40:43], v52, v72, v[40:43]
    v_mfma_f32_16x16x4_f32 v[40:43], v53, v73, v[40:43]
    ds_read_b32 v62, v36 offset:704
    ds_read_b32 v82, v37 offset:704
    ds_read_b32 v63, v36 offset:720
    ds_read_b32 v83, v37 offset:720
    ds_read_b32 v64, v36 offset:736
    ds_read_b32 v84, v37 offset:736
    ds_read_b32 v65, v36 offset:752
    ds_read_b32 v85, v37 offset:752
    s_waitcnt lgkmcnt(15)
    v_mfma_f32_16x16x4_f32 v[40:43], v54, v74, v[40:43]
    v_mfma_f32_16x16x4_f32 v[40:43], v55, v75, v[40:43]
    v_mfma_f32_16x16x4_f32 v[40:43], v56, v76, v[40:43]
    v_mfma_f32_16x16x4_f32 v[40:43], v57, v77, v[40:43]
    ds_read_b32 v50, v36 offset:768
    ds_read_b32 v70, v37 offset:768
    ds_read_b32 v51, v36 offset:784
    ds_read_b32 v71, v37 offset:784
    ds_read_b32 v52, v36 offset:800
    ds_read_b32 v72, v37 offset:800
    ds_read_b32 v53, v36 offset:816
    ds_read_b32 v73, v37 offset:816
    s_waitcnt lgkmcnt(15)
    v_mfma_f32_16x16x4_f32 v[40:43], v58, v78, v[40:43]
    v_mfma_f32_16x16x4_f32 v[40:43], v59, v79, v[40:43]
    v_mfma_f32_16x16x4_f32 v[40:43], v60, v80, v[40:43]
    v_mfma_f32_16x16x4_f32 v[40:43], v61, v81, v[40:43]
    ds_read_b32 v54, v36 offset:832
    ds_read_b32 v74, v37 offset:832
    ds_read_b32 v55, v36 offset:848
    ds_read_b32 v75, v37 offset:848
    ds_read_b32 v56, v36 offset:864
    ds_read_b32 v76, v37 offset:864
    ds_read_b32 v57, v36 offset:880
    ds_read_b32 v77, v37 offset:880
    s_waitcnt lgkmcnt(15)
    v_mfma_f32_16x16x4_f32 v[40:43], v62, v82, v[40:43]
    v_mfma_f32_16x16x4_f32 v[40:43], v63, v83, v[40:43]
    v_mfma_f32_16x16x4_f32 v[40:43], v64, v84, v[40:43]
    v_mfma_f32_16x16x4_f32 v[40:43], v65, v85, v[40:43]
    ds_read_b32 v58, v36 offset:896
    ds_read_b32 v78, v37 offset:896
    ds_read_b32 v59, v36 offset:912
    ds_read_b32 v79, v37 offset:912
    ds_read_b32 v60, v36 offset:928
    ds_read_b32 v80, v37 offset:928
    ds_read_b32 v61, v36 offset:944
    ds_read_b32 v81, v37 offset:944
    s_waitcnt lgkmcnt(15)
    v_mfma_f32_16x16x4_f32 v[40:43], v50, v70, v[40:43]
    v_mfma_f32_16x16x4_f32 v[40:43], v51, v71, v[40:43]
    v_mfma_f32_16x16x4_f32 v[40:43], v52, v72, v[40:43]
    v_mfma_f32_16x16x4_f32 v[40:43], v53, v73, v[40:43]
    ds_read_b32 v62, v36 offset:960
    ds_read_b32 v82, v37 offset:960
    ds_read_b32 v63, v36 offset:976
    ds_read_b32 v83, v37 offset:976
    ds_read_b32 v64, v36 offset:992
    ds_read_b32 v84, v37 offset:992
    ds_read_b32 v65, v36 offset:1008
    ds_read_b32 v85, v37 offset:1008
    s_waitcnt lgkmcnt(15)
    v_mfma_f32_16x16x4_f32 v[40:43], v54, v74, v[40:43]
    v_mfma_f32_16x16x4_f32 v[40:43], v55, v75, v[40:43]
    v_mfma_f32_16x16x4_f32 v[40:43], v56, v76, v[40:43]
    v_mfma_f32_16x16x4_f32 v[40:43], v57, v77, v[40:43]
    s_waitcnt lgkmcnt(8)
    v_mfma_f32_16x16x4_f32 v[40:43], v58, v78, v[40:43]
    v_mfma_f32_16x16x4_f32 v[40:43], v59, v79, v[40:43]
    v_mfma_f32_16x16x4_f32 v[40:43], v60, v80, v[40:43]
    v_mfma_f32_16x16x4_f32 v[40:43], v61, v81, v[40:43]
    s_waitcnt lgkmcnt(0)
    v_mfma_f32_16x16x4_f32 v[40:43], v62, v82, v[40:43]
    v_mfma_f32_16x16x4_f32 v[40:43], v63, v83, v[40:43]
    v_mfma_f32_16x16x4_f32 v[40:43], v64, v84, v[40:43]
    v_mfma_f32_16x16x4_f32 v[40:43], v65, v85, v[40:43]
    s_nop 11
    v_lshlrev_b32 v38, 10, v6
    v_lshl_add_u32 v38, v9, 8, v38
    v_lshl_add_u32 v38, v8, 2, v38
    v_add_u32 v38, 133120, v38
    ds_write_b32 v38, v40 offset:0
    ds_write_b32 v38, v41 offset:64
    ds_write_b32 v38, v42 offset:128
    ds_write_b32 v38, v43 offset:192
    s_waitcnt lgkmcnt(0)
    s_barrier
    v_lshlrev_b32 v6, 3, v0
    v_add_u32 v7, 0, v6
    v_cvt_f32_u32 v7, v7
    s_nop 0
    v_cvt_pk_bf16_f32 v7, v7, v7
    s_nop 0
    v_lshlrev_b32 v7, 16, v7
    v_lshrrev_b32 v8, 23, v7
    v_subrev_u32 v8, 134, v8
    v_max_i32 v8, 0, v8
    v_min_i32 v8, 3, v8
    v_cvt_u32_f32 v9, v7
    s_nop 0
    v_lshrrev_b32 v9, v8, v9
    v_lshl_add_u32 v9, v8, 8, v9
    v_min_i32 v8, 1, v8
    v_lshlrev_b32 v8, 7, v8
    v_sub_u32 v9, v9, v8
    v_lshlrev_b32 v9, 2, v9
    v_add_u32 v9, 133120, v9
    ds_read_b32 v40, v9
    v_add_u32 v7, 1, v6
    v_cvt_f32_u32 v7, v7
    s_nop 0
    v_cvt_pk_bf16_f32 v7, v7, v7
    s_nop 0
    v_lshlrev_b32 v7, 16, v7
    v_lshrrev_b32 v8, 23, v7
    v_subrev_u32 v8, 134, v8
    v_max_i32 v8, 0, v8
    v_min_i32 v8, 3, v8
    v_cvt_u32_f32 v9, v7
    s_nop 0
    v_lshrrev_b32 v9, v8, v9
    v_lshl_add_u32 v9, v8, 8, v9
    v_min_i32 v8, 1, v8
    v_lshlrev_b32 v8, 7, v8
    v_sub_u32 v9, v9, v8
    v_lshlrev_b32 v9, 2, v9
    v_add_u32 v9, 133120, v9
    ds_read_b32 v41, v9
    v_add_u32 v7, 2, v6
    v_cvt_f32_u32 v7, v7
    s_nop 0
    v_cvt_pk_bf16_f32 v7, v7, v7
    s_nop 0
    v_lshlrev_b32 v7, 16, v7
    v_lshrrev_b32 v8, 23, v7
    v_subrev_u32 v8, 134, v8
    v_max_i32 v8, 0, v8
    v_min_i32 v8, 3, v8
    v_cvt_u32_f32 v9, v7
    s_nop 0
    v_lshrrev_b32 v9, v8, v9
    v_lshl_add_u32 v9, v8, 8, v9
    v_min_i32 v8, 1, v8
    v_lshlrev_b32 v8, 7, v8
    v_sub_u32 v9, v9, v8
    v_lshlrev_b32 v9, 2, v9
    v_add_u32 v9, 133120, v9
    ds_read_b32 v42, v9
    v_add_u32 v7, 3, v6
    v_cvt_f32_u32 v7, v7
    s_nop 0
    v_cvt_pk_bf16_f32 v7, v7, v7
    s_nop 0
    v_lshlrev_b32 v7, 16, v7
    v_lshrrev_b32 v8, 23, v7
    v_subrev_u32 v8, 134, v8
    v_max_i32 v8, 0, v8
    v_min_i32 v8, 3, v8
    v_cvt_u32_f32 v9, v7
    s_nop 0
    v_lshrrev_b32 v9, v8, v9
    v_lshl_add_u32 v9, v8, 8, v9
    v_min_i32 v8, 1, v8
    v_lshlrev_b32 v8, 7, v8
    v_sub_u32 v9, v9, v8
    v_lshlrev_b32 v9, 2, v9
    v_add_u32 v9, 133120, v9
    ds_read_b32 v43, v9
    v_add_u32 v7, 4, v6
    v_cvt_f32_u32 v7, v7
    s_nop 0
    v_cvt_pk_bf16_f32 v7, v7, v7
    s_nop 0
    v_lshlrev_b32 v7, 16, v7
    v_lshrrev_b32 v8, 23, v7
    v_subrev_u32 v8, 134, v8
    v_max_i32 v8, 0, v8
    v_min_i32 v8, 3, v8
    v_cvt_u32_f32 v9, v7
    s_nop 0
    v_lshrrev_b32 v9, v8, v9
    v_lshl_add_u32 v9, v8, 8, v9
    v_min_i32 v8, 1, v8
    v_lshlrev_b32 v8, 7, v8
    v_sub_u32 v9, v9, v8
    v_lshlrev_b32 v9, 2, v9
    v_add_u32 v9, 133120, v9
    ds_read_b32 v44, v9
    v_add_u32 v7, 5, v6
    v_cvt_f32_u32 v7, v7
    s_nop 0
    v_cvt_pk_bf16_f32 v7, v7, v7
    s_nop 0
    v_lshlrev_b32 v7, 16, v7
    v_lshrrev_b32 v8, 23, v7
    v_subrev_u32 v8, 134, v8
    v_max_i32 v8, 0, v8
    v_min_i32 v8, 3, v8
    v_cvt_u32_f32 v9, v7
    s_nop 0
    v_lshrrev_b32 v9, v8, v9
    v_lshl_add_u32 v9, v8, 8, v9
    v_min_i32 v8, 1, v8
    v_lshlrev_b32 v8, 7, v8
    v_sub_u32 v9, v9, v8
    v_lshlrev_b32 v9, 2, v9
    v_add_u32 v9, 133120, v9
    ds_read_b32 v45, v9
    v_add_u32 v7, 6, v6
    v_cvt_f32_u32 v7, v7
    s_nop 0
    v_cvt_pk_bf16_f32 v7, v7, v7
    s_nop 0
    v_lshlrev_b32 v7, 16, v7
    v_lshrrev_b32 v8, 23, v7
    v_subrev_u32 v8, 134, v8
    v_max_i32 v8, 0, v8
    v_min_i32 v8, 3, v8
    v_cvt_u32_f32 v9, v7
    s_nop 0
    v_lshrrev_b32 v9, v8, v9
    v_lshl_add_u32 v9, v8, 8, v9
    v_min_i32 v8, 1, v8
    v_lshlrev_b32 v8, 7, v8
    v_sub_u32 v9, v9, v8
    v_lshlrev_b32 v9, 2, v9
    v_add_u32 v9, 133120, v9
    ds_read_b32 v46, v9
    v_add_u32 v7, 7, v6
    v_cvt_f32_u32 v7, v7
    s_nop 0
    v_cvt_pk_bf16_f32 v7, v7, v7
    s_nop 0
    v_lshlrev_b32 v7, 16, v7
    v_lshrrev_b32 v8, 23, v7
    v_subrev_u32 v8, 134, v8
    v_max_i32 v8, 0, v8
    v_min_i32 v8, 3, v8
    v_cvt_u32_f32 v9, v7
    s_nop 0
    v_lshrrev_b32 v9, v8, v9
    v_lshl_add_u32 v9, v8, 8, v9
    v_min_i32 v8, 1, v8
    v_lshlrev_b32 v8, 7, v8
    v_sub_u32 v9, v9, v8
    v_lshlrev_b32 v9, 2, v9
    v_add_u32 v9, 133120, v9
    ds_read_b32 v47, v9
    s_waitcnt lgkmcnt(0)
    v_cvt_pk_bf16_f32 v50, v40, v41
    v_cvt_pk_bf16_f32 v51, v42, v43
    v_cvt_pk_bf16_f32 v52, v44, v45
    v_cvt_pk_bf16_f32 v53, v46, v47
    s_mul_i32 s21, s16, 4160
    v_lshlrev_b32 v6, 4, v0
    v_add_u32 v6, s21, v6
    buffer_store_dwordx4 v[50:53], v6, s[68:71], 0 offen offset:64
    v_mov_b32 v54, 0
    v_mov_b32 v55, 0
    v_mov_b32 v56, 0
    v_mov_b32 v57, 0
    v_cmp_gt_u32 vcc, 4, v0
    s_and_saveexec_b64 s[22:23], vcc
    s_cbranch_execz prep_exit
    buffer_store_dwordx4 v[54:57], v6, s[68:71], 0 offen
    s_branch prep_exit
prep_exit:
    s_endpgm

.globl conv1_kernel
.p2align 8
.type conv1_kernel,@function
conv1_kernel:
    s_cmp_ge_u32 s2, 256
    s_cbranch_scc1 conv1_exit
    s_load_dwordx2 s[4:5], s[0:1], 120
    s_load_dwordx2 s[6:7], s[0:1], 64
    v_readfirstlane_b32 s30, v0
    s_lshr_b32 s30, s30, 6
    s_lshr_b32 s31, s30, 1
    s_and_b32 s32, s30, 1
    s_lshl_b32 s33, s2, 1
    s_add_u32 s34, s33, s31
    s_waitcnt lgkmcnt(0)
    s_add_u32 s8, s4, 0x0
    s_addc_u32 s9, s5, 0
    s_and_b32 s9, s9, 0xffff
    s_mov_b32 s10, 0x200000
    s_mov_b32 s11, 0x00020000
    s_add_u32 s12, s4, 0x1400000
    s_addc_u32 s13, s5, 0
    s_and_b32 s13, s13, 0xffff
    s_mov_b32 s14, 0x4000
    s_mov_b32 s15, 0x00020000
    s_add_u32 s16, s4, 0x1000000
    s_addc_u32 s17, s5, 0
    s_and_b32 s17, s17, 0xffff
    s_mov_b32 s18, 0x208000
    s_mov_b32 s19, 0x00020000
    s_add_u32 s20, s4, 0x200000
    s_addc_u32 s21, s5, 0
    s_and_b32 s21, s21, 0xffff
    s_mov_b32 s22, 0x200000
    s_mov_b32 s23, 0x00020000
    s_lshl_b32 s37, s34, 1
    s_and_b32 s38, s37, 0xfffffffc
    s_load_dword s39, s[6:7], s38
    v_and_b32 v1, 63, v0
    v_lshlrev_b32 v2, 4, v1
    s_mul_i32 s40, s34, 4160
    s_mul_i32 s41, s31, 21216
    s_lshl_b32 s42, s32, 1
    s_add_u32 s43, s42, 0
    s_mul_i32 s44, s43, 4160
    s_add_u32 s44, s44, s41
    s_lshl_b32 s45, s43, 1
    s_add_u32 s45, s45, 34
    s_add_u32 s45, s45, s40
    s_mov_b32 m0, s44
    s_nop 0
    buffer_load_dwordx4 v2, s[16:19], s45 offen offset:0 lds
    buffer_load_dwordx4 v2, s[16:19], s45 offen offset:1024 lds
    buffer_load_dwordx4 v2, s[16:19], s45 offen offset:2048 lds
    buffer_load_dwordx4 v2, s[16:19], s45 offen offset:3072 lds
    s_add_u32 s44, s44, 4096
    s_add_u32 s45, s45, 4096
    s_mov_b32 m0, s44
    s_mov_b64 exec, 3
    buffer_load_dwordx4 v2, s[16:19], s45 offen lds
    s_mov_b64 exec, -1
    s_add_u32 s43, s42, 1
    s_mul_i32 s44, s43, 4160
    s_add_u32 s44, s44, s41
    s_lshl_b32 s45, s43, 1
    s_add_u32 s45, s45, 34
    s_add_u32 s45, s45, s40
    s_mov_b32 m0, s44
    s_nop 0
    buffer_load_dwordx4 v2, s[16:19], s45 offen offset:0 lds
    buffer_load_dwordx4 v2, s[16:19], s45 offen offset:1024 lds
    buffer_load_dwordx4 v2, s[16:19], s45 offen offset:2048 lds
    buffer_load_dwordx4 v2, s[16:19], s45 offen offset:3072 lds
    s_add_u32 s44, s44, 4096
    s_add_u32 s45, s45, 4096
    s_mov_b32 m0, s44
    s_mov_b64 exec, 3
    buffer_load_dwordx4 v2, s[16:19], s45 offen lds
    s_mov_b64 exec, -1
    v_lshlrev_b32 v3, 4, v0
    s_lshl_b32 s35, s33, 12
    s_add_u32 s36, s35, 4096
    buffer_load_dwordx4 v[8:11], v3, s[8:11], s35 offen
    buffer_load_dwordx4 v[12:15], v3, s[8:11], s36 offen
    v_lshlrev_b32 v4, 6, v0
    buffer_load_dwordx4 v[16:19], v4, s[12:15], 0 offen offset:0
    buffer_load_dwordx4 v[20:23], v4, s[12:15], 0 offen offset:16
    buffer_load_dwordx4 v[24:27], v4, s[12:15], 0 offen offset:32
    buffer_load_dwordx4 v[28:31], v4, s[12:15], 0 offen offset:48
    v_and_b32 v5, 15, v1
    v_lshrrev_b32 v6, 4, v1
    v_lshlrev_b32 v7, 5, v5
    v_lshl_add_u32 v7, v6, 3, v7
    s_lshl_b32 s46, s34, 12
    buffer_load_dwordx2 v[32:33], v7, s[8:11], s46 offen offset:0
    buffer_load_dwordx2 v[34:35], v7, s[8:11], s46 offen offset:512
    buffer_load_dwordx2 v[36:37], v7, s[8:11], s46 offen offset:1024
    buffer_load_dwordx2 v[38:39], v7, s[8:11], s46 offen offset:1536
    buffer_load_dwordx2 v[40:41], v7, s[8:11], s46 offen offset:2048
    buffer_load_dwordx2 v[42:43], v7, s[8:11], s46 offen offset:2560
    buffer_load_dwordx2 v[44:45], v7, s[8:11], s46 offen offset:3072
    buffer_load_dwordx2 v[46:47], v7, s[8:11], s46 offen offset:3584
    s_waitcnt vmcnt(8)
    v_mul_f32 v64, 0x3b000000, v16
    v_mul_f32 v65, 0x3b000000, v17
    v_fma_f32 v65, -v64, v64, v65
    v_max_f32 v65, 0, v65
    v_cvt_pk_bf16_f32 v64, v64, v65
    s_nop 0
    v_lshlrev_b32 v48, 16, v64
    v_and_b32 v65, 0xffff0000, v64
    v_add_f32 v65, 0x3727c5ac, v65
    v_cvt_pk_bf16_f32 v65, v65, v65
    s_nop 0
    v_lshlrev_b32 v65, 16, v65
    v_sqrt_f32 v65, v65
    s_nop 0
    v_cvt_pk_bf16_f32 v65, v65, v65
    s_nop 0
    v_lshlrev_b32 v65, 16, v65
    v_rcp_f32 v56, v65
    s_nop 0
    v_mul_f32 v64, 0x3b000000, v18
    v_mul_f32 v65, 0x3b000000, v19
    v_fma_f32 v65, -v64, v64, v65
    v_max_f32 v65, 0, v65
    v_cvt_pk_bf16_f32 v64, v64, v65
    s_nop 0
    v_lshlrev_b32 v49, 16, v64
    v_and_b32 v65, 0xffff0000, v64
    v_add_f32 v65, 0x3727c5ac, v65
    v_cvt_pk_bf16_f32 v65, v65, v65
    s_nop 0
    v_lshlrev_b32 v65, 16, v65
    v_sqrt_f32 v65, v65
    s_nop 0
    v_cvt_pk_bf16_f32 v65, v65, v65
    s_nop 0
    v_lshlrev_b32 v65, 16, v65
    v_rcp_f32 v57, v65
    s_nop 0
    v_mul_f32 v64, 0x3b000000, v20
    v_mul_f32 v65, 0x3b000000, v21
    v_fma_f32 v65, -v64, v64, v65
    v_max_f32 v65, 0, v65
    v_cvt_pk_bf16_f32 v64, v64, v65
    s_nop 0
    v_lshlrev_b32 v50, 16, v64
    v_and_b32 v65, 0xffff0000, v64
    v_add_f32 v65, 0x3727c5ac, v65
    v_cvt_pk_bf16_f32 v65, v65, v65
    s_nop 0
    v_lshlrev_b32 v65, 16, v65
    v_sqrt_f32 v65, v65
    s_nop 0
    v_cvt_pk_bf16_f32 v65, v65, v65
    s_nop 0
    v_lshlrev_b32 v65, 16, v65
    v_rcp_f32 v58, v65
    s_nop 0
    v_mul_f32 v64, 0x3b000000, v22
    v_mul_f32 v65, 0x3b000000, v23
    v_fma_f32 v65, -v64, v64, v65
    v_max_f32 v65, 0, v65
    v_cvt_pk_bf16_f32 v64, v64, v65
    s_nop 0
    v_lshlrev_b32 v51, 16, v64
    v_and_b32 v65, 0xffff0000, v64
    v_add_f32 v65, 0x3727c5ac, v65
    v_cvt_pk_bf16_f32 v65, v65, v65
    s_nop 0
    v_lshlrev_b32 v65, 16, v65
    v_sqrt_f32 v65, v65
    s_nop 0
    v_cvt_pk_bf16_f32 v65, v65, v65
    s_nop 0
    v_lshlrev_b32 v65, 16, v65
    v_rcp_f32 v59, v65
    s_nop 0
    v_mul_f32 v64, 0x3b000000, v24
    v_mul_f32 v65, 0x3b000000, v25
    v_fma_f32 v65, -v64, v64, v65
    v_max_f32 v65, 0, v65
    v_cvt_pk_bf16_f32 v64, v64, v65
    s_nop 0
    v_lshlrev_b32 v52, 16, v64
    v_and_b32 v65, 0xffff0000, v64
    v_add_f32 v65, 0x3727c5ac, v65
    v_cvt_pk_bf16_f32 v65, v65, v65
    s_nop 0
    v_lshlrev_b32 v65, 16, v65
    v_sqrt_f32 v65, v65
    s_nop 0
    v_cvt_pk_bf16_f32 v65, v65, v65
    s_nop 0
    v_lshlrev_b32 v65, 16, v65
    v_rcp_f32 v60, v65
    s_nop 0
    v_mul_f32 v64, 0x3b000000, v26
    v_mul_f32 v65, 0x3b000000, v27
    v_fma_f32 v65, -v64, v64, v65
    v_max_f32 v65, 0, v65
    v_cvt_pk_bf16_f32 v64, v64, v65
    s_nop 0
    v_lshlrev_b32 v53, 16, v64
    v_and_b32 v65, 0xffff0000, v64
    v_add_f32 v65, 0x3727c5ac, v65
    v_cvt_pk_bf16_f32 v65, v65, v65
    s_nop 0
    v_lshlrev_b32 v65, 16, v65
    v_sqrt_f32 v65, v65
    s_nop 0
    v_cvt_pk_bf16_f32 v65, v65, v65
    s_nop 0
    v_lshlrev_b32 v65, 16, v65
    v_rcp_f32 v61, v65
    s_nop 0
    v_mul_f32 v64, 0x3b000000, v28
    v_mul_f32 v65, 0x3b000000, v29
    v_fma_f32 v65, -v64, v64, v65
    v_max_f32 v65, 0, v65
    v_cvt_pk_bf16_f32 v64, v64, v65
    s_nop 0
    v_lshlrev_b32 v54, 16, v64
    v_and_b32 v65, 0xffff0000, v64
    v_add_f32 v65, 0x3727c5ac, v65
    v_cvt_pk_bf16_f32 v65, v65, v65
    s_nop 0
    v_lshlrev_b32 v65, 16, v65
    v_sqrt_f32 v65, v65
    s_nop 0
    v_cvt_pk_bf16_f32 v65, v65, v65
    s_nop 0
    v_lshlrev_b32 v65, 16, v65
    v_rcp_f32 v62, v65
    s_nop 0
    v_mul_f32 v64, 0x3b000000, v30
    v_mul_f32 v65, 0x3b000000, v31
    v_fma_f32 v65, -v64, v64, v65
    v_max_f32 v65, 0, v65
    v_cvt_pk_bf16_f32 v64, v64, v65
    s_nop 0
    v_lshlrev_b32 v55, 16, v64
    v_and_b32 v65, 0xffff0000, v64
    v_add_f32 v65, 0x3727c5ac, v65
    v_cvt_pk_bf16_f32 v65, v65, v65
    s_nop 0
    v_lshlrev_b32 v65, 16, v65
    v_sqrt_f32 v65, v65
    s_nop 0
    v_cvt_pk_bf16_f32 v65, v65, v65
    s_nop 0
    v_lshlrev_b32 v65, 16, v65
    v_rcp_f32 v63, v65
    s_nop 0
    v_lshlrev_b32 v64, 16, v8
    v_sub_f32 v64, v64, v48
    v_cvt_pk_bf16_f32 v64, v64, v64
    s_nop 0
    v_lshlrev_b32 v64, 16, v64
    v_mul_f32 v66, v64, v56
    v_and_b32 v64, 0xffff0000, v8
    v_sub_f32 v64, v64, v49
    v_cvt_pk_bf16_f32 v64, v64, v64
    s_nop 0
    v_lshlrev_b32 v64, 16, v64
    v_mul_f32 v67, v64, v57
    v_lshlrev_b32 v64, 16, v9
    v_sub_f32 v64, v64, v50
    v_cvt_pk_bf16_f32 v64, v64, v64
    s_nop 0
    v_lshlrev_b32 v64, 16, v64
    v_mul_f32 v68, v64, v58
    v_and_b32 v64, 0xffff0000, v9
    v_sub_f32 v64, v64, v51
    v_cvt_pk_bf16_f32 v64, v64, v64
    s_nop 0
    v_lshlrev_b32 v64, 16, v64
    v_mul_f32 v69, v64, v59
    v_lshlrev_b32 v64, 16, v10
    v_sub_f32 v64, v64, v52
    v_cvt_pk_bf16_f32 v64, v64, v64
    s_nop 0
    v_lshlrev_b32 v64, 16, v64
    v_mul_f32 v70, v64, v60
    v_and_b32 v64, 0xffff0000, v10
    v_sub_f32 v64, v64, v53
    v_cvt_pk_bf16_f32 v64, v64, v64
    s_nop 0
    v_lshlrev_b32 v64, 16, v64
    v_mul_f32 v71, v64, v61
    v_lshlrev_b32 v64, 16, v11
    v_sub_f32 v64, v64, v54
    v_cvt_pk_bf16_f32 v64, v64, v64
    s_nop 0
    v_lshlrev_b32 v64, 16, v64
    v_mul_f32 v72, v64, v62
    v_and_b32 v64, 0xffff0000, v11
    v_sub_f32 v64, v64, v55
    v_cvt_pk_bf16_f32 v64, v64, v64
    s_nop 0
    v_lshlrev_b32 v64, 16, v64
    v_mul_f32 v73, v64, v63
    v_cvt_pk_bf16_f32 v74, v73, v72
    v_cvt_pk_bf16_f32 v75, v71, v70
    v_cvt_pk_bf16_f32 v76, v69, v68
    v_cvt_pk_bf16_f32 v77, v67, v66
    v_lshlrev_b32 v64, 4, v0
    v_sub_u32 v64, 20720, v64
    ds_write_b128 v64, v[74:77]
    v_lshlrev_b32 v64, 16, v12
    v_sub_f32 v64, v64, v48
    v_cvt_pk_bf16_f32 v64, v64, v64
    s_nop 0
    v_lshlrev_b32 v64, 16, v64
    v_mul_f32 v66, v64, v56
    v_and_b32 v64, 0xffff0000, v12
    v_sub_f32 v64, v64, v49
    v_cvt_pk_bf16_f32 v64, v64, v64
    s_nop 0
    v_lshlrev_b32 v64, 16, v64
    v_mul_f32 v67, v64, v57
    v_lshlrev_b32 v64, 16, v13
    v_sub_f32 v64, v64, v50
    v_cvt_pk_bf16_f32 v64, v64, v64
    s_nop 0
    v_lshlrev_b32 v64, 16, v64
    v_mul_f32 v68, v64, v58
    v_and_b32 v64, 0xffff0000, v13
    v_sub_f32 v64, v64, v51
    v_cvt_pk_bf16_f32 v64, v64, v64
    s_nop 0
    v_lshlrev_b32 v64, 16, v64
    v_mul_f32 v69, v64, v59
    v_lshlrev_b32 v64, 16, v14
    v_sub_f32 v64, v64, v52
    v_cvt_pk_bf16_f32 v64, v64, v64
    s_nop 0
    v_lshlrev_b32 v64, 16, v64
    v_mul_f32 v70, v64, v60
    v_and_b32 v64, 0xffff0000, v14
    v_sub_f32 v64, v64, v53
    v_cvt_pk_bf16_f32 v64, v64, v64
    s_nop 0
    v_lshlrev_b32 v64, 16, v64
    v_mul_f32 v71, v64, v61
    v_lshlrev_b32 v64, 16, v15
    v_sub_f32 v64, v64, v54
    v_cvt_pk_bf16_f32 v64, v64, v64
    s_nop 0
    v_lshlrev_b32 v64, 16, v64
    v_mul_f32 v72, v64, v62
    v_and_b32 v64, 0xffff0000, v15
    v_sub_f32 v64, v64, v55
    v_cvt_pk_bf16_f32 v64, v64, v64
    s_nop 0
    v_lshlrev_b32 v64, 16, v64
    v_mul_f32 v73, v64, v63
    v_cvt_pk_bf16_f32 v74, v73, v72
    v_cvt_pk_bf16_f32 v75, v71, v70
    v_cvt_pk_bf16_f32 v76, v69, v68
    v_cvt_pk_bf16_f32 v77, v67, v66
    v_lshlrev_b32 v64, 4, v0
    v_sub_u32 v64, 41936, v64
    ds_write_b128 v64, v[74:77]
    v_mov_b32 v74, 0
    v_mov_b32 v75, 0
    v_mov_b32 v76, 0
    v_mov_b32 v77, 0
    v_lshlrev_b32 v64, 4, v0
    v_cmp_gt_u32 vcc, 30, v0
    s_and_saveexec_b64 s[48:49], vcc
    ds_write_b128 v64, v[74:77] offset:20736
    ds_write_b128 v64, v[74:77] offset:41952
    s_mov_b64 exec, s[48:49]
    s_waitcnt lgkmcnt(0)
    s_and_b32 s40, s34, 1
    s_lshl_b32 s40, s40, 4
    s_lshr_b32 s39, s39, s40
    s_lshl_b32 s39, s39, 16
    s_add_u32 s41, s41, 17120
    v_lshlrev_b32 v64, 5, v5
    v_sub_u32 v64, s41, v64
    v_lshl_add_u32 v64, v6, 4, v64
    s_mul_i32 s41, s31, 21216
    v_lshrrev_b32 v65, 2, v5
    s_movk_i32 s47, 4160
    v_mul_lo_u32 v65, v65, s47
    v_add_u32 v65, s41, v65
    v_lshl_add_u32 v65, v6, 4, v65
    v_and_b32 v66, 3, v5
    v_lshl_add_u32 v65, v66, 3, v65
    s_add_u32 s41, s41, 17144
    v_lshlrev_b32 v66, 5, v5
    v_sub_u32 v66, s41, v66
    v_lshlrev_b32 v67, 3, v6
    v_sub_u32 v66, v66, v67
    s_waitcnt vmcnt(0) lgkmcnt(0)
    s_barrier
    s_cmp_eq_u32 s32, 1
    s_cbranch_scc1 conv1_h1
    v_mov_b32 v196, 0
    v_mov_b32 v197, 0
    v_mov_b32 v198, 0
    v_mov_b32 v199, 0
    v_mov_b32 v200, 0
    v_mov_b32 v201, 0
    v_mov_b32 v202, 0
    v_mov_b32 v203, 0
    v_mov_b32 v204, 0
    v_mov_b32 v205, 0
    v_mov_b32 v206, 0
    v_mov_b32 v207, 0
    v_mov_b32 v208, 0
    v_mov_b32 v209, 0
    v_mov_b32 v210, 0
    v_mov_b32 v211, 0
    v_mov_b32 v212, 0
    v_mov_b32 v213, 0
    v_mov_b32 v214, 0
    v_mov_b32 v215, 0
    ds_read_b128 v[68:71], v64 offset:3584
    ds_read_b128 v[72:75], v64 offset:3072
    ds_read_b128 v[76:79], v64 offset:2560
    ds_read_b128 v[80:83], v64 offset:2048
    ds_read_b128 v[84:87], v64 offset:1536
    ds_read_b64_tr_b16 v[132:133], v65 offset:0
    ds_read_b64_tr_b16 v[134:135], v65 offset:8
    ds_read_b64_tr_b16 v[136:137], v65 offset:512
    ds_read_b64_tr_b16 v[138:139], v65 offset:520
    ds_read_b64_tr_b16 v[140:141], v65 offset:1024
    ds_read_b64_tr_b16 v[142:143], v65 offset:1032
    ds_read_b64_tr_b16 v[144:145], v65 offset:1536
    ds_read_b64_tr_b16 v[146:147], v65 offset:1544
    ds_read_b64_tr_b16 v[148:149], v65 offset:2048
    ds_read_b64_tr_b16 v[150:151], v65 offset:2056
    s_waitcnt lgkmcnt(0)
    ds_read_b128 v[100:103], v64 offset:3648
    ds_read_b128 v[104:107], v64 offset:3136
    ds_read_b128 v[108:111], v64 offset:2624
    ds_read_b128 v[112:115], v64 offset:2112
    ds_read_b128 v[116:119], v64 offset:1600
    ds_read_b64_tr_b16 v[164:165], v65 offset:64
    ds_read_b64_tr_b16 v[166:167], v65 offset:72
    ds_read_b64_tr_b16 v[168:169], v65 offset:576
    ds_read_b64_tr_b16 v[170:171], v65 offset:584
    ds_read_b64_tr_b16 v[172:173], v65 offset:1088
    ds_read_b64_tr_b16 v[174:175], v65 offset:1096
    ds_read_b64_tr_b16 v[176:177], v65 offset:1600
    ds_read_b64_tr_b16 v[178:179], v65 offset:1608
    ds_read_b64_tr_b16 v[180:181], v65 offset:2112
    ds_read_b64_tr_b16 v[182:183], v65 offset:2120
    v_mfma_f32_16x16x32_bf16 v[196:199], v[132:135], v[68:71], v[196:199]
    v_mfma_f32_16x16x32_bf16 v[200:203], v[132:135], v[72:75], v[200:203]
    v_mfma_f32_16x16x32_bf16 v[204:207], v[132:135], v[76:79], v[204:207]
    v_mfma_f32_16x16x32_bf16 v[208:211], v[132:135], v[80:83], v[208:211]
    v_mfma_f32_16x16x32_bf16 v[212:215], v[132:135], v[84:87], v[212:215]
    v_mfma_f32_16x16x32_bf16 v[200:203], v[136:139], v[68:71], v[200:203]
    v_mfma_f32_16x16x32_bf16 v[204:207], v[136:139], v[72:75], v[204:207]
    v_mfma_f32_16x16x32_bf16 v[208:211], v[136:139], v[76:79], v[208:211]
    v_mfma_f32_16x16x32_bf16 v[212:215], v[136:139], v[80:83], v[212:215]
    v_mfma_f32_16x16x32_bf16 v[204:207], v[140:143], v[68:71], v[204:207]
    v_mfma_f32_16x16x32_bf16 v[208:211], v[140:143], v[72:75], v[208:211]
    v_mfma_f32_16x16x32_bf16 v[212:215], v[140:143], v[76:79], v[212:215]
    v_mfma_f32_16x16x32_bf16 v[208:211], v[144:147], v[68:71], v[208:211]
    v_mfma_f32_16x16x32_bf16 v[212:215], v[144:147], v[72:75], v[212:215]
    v_mfma_f32_16x16x32_bf16 v[212:215], v[148:151], v[68:71], v[212:215]
    s_waitcnt lgkmcnt(0)
    ds_read_b128 v[68:71], v64 offset:3712
    ds_read_b128 v[72:75], v64 offset:3200
    ds_read_b128 v[76:79], v64 offset:2688
    ds_read_b128 v[80:83], v64 offset:2176
    ds_read_b128 v[84:87], v64 offset:1664
    ds_read_b64_tr_b16 v[132:133], v65 offset:128
    ds_read_b64_tr_b16 v[134:135], v65 offset:136
    ds_read_b64_tr_b16 v[136:137], v65 offset:640
    ds_read_b64_tr_b16 v[138:139], v65 offset:648
    ds_read_b64_tr_b16 v[140:141], v65 offset:1152
    ds_read_b64_tr_b16 v[142:143], v65 offset:1160
    ds_read_b64_tr_b16 v[144:145], v65 offset:1664
    ds_read_b64_tr_b16 v[146:147], v65 offset:1672
    ds_read_b64_tr_b16 v[148:149], v65 offset:2176
    ds_read_b64_tr_b16 v[150:151], v65 offset:2184
    v_mfma_f32_16x16x32_bf16 v[196:199], v[164:167], v[100:103], v[196:199]
    v_mfma_f32_16x16x32_bf16 v[200:203], v[164:167], v[104:107], v[200:203]
    v_mfma_f32_16x16x32_bf16 v[204:207], v[164:167], v[108:111], v[204:207]
    v_mfma_f32_16x16x32_bf16 v[208:211], v[164:167], v[112:115], v[208:211]
    v_mfma_f32_16x16x32_bf16 v[212:215], v[164:167], v[116:119], v[212:215]
    v_mfma_f32_16x16x32_bf16 v[200:203], v[168:171], v[100:103], v[200:203]
    v_mfma_f32_16x16x32_bf16 v[204:207], v[168:171], v[104:107], v[204:207]
    v_mfma_f32_16x16x32_bf16 v[208:211], v[168:171], v[108:111], v[208:211]
    v_mfma_f32_16x16x32_bf16 v[212:215], v[168:171], v[112:115], v[212:215]
    v_mfma_f32_16x16x32_bf16 v[204:207], v[172:175], v[100:103], v[204:207]
    v_mfma_f32_16x16x32_bf16 v[208:211], v[172:175], v[104:107], v[208:211]
    v_mfma_f32_16x16x32_bf16 v[212:215], v[172:175], v[108:111], v[212:215]
    v_mfma_f32_16x16x32_bf16 v[208:211], v[176:179], v[100:103], v[208:211]
    v_mfma_f32_16x16x32_bf16 v[212:215], v[176:179], v[104:107], v[212:215]
    v_mfma_f32_16x16x32_bf16 v[212:215], v[180:183], v[100:103], v[212:215]
    s_waitcnt lgkmcnt(0)
    ds_read_b128 v[100:103], v64 offset:3776
    ds_read_b128 v[104:107], v64 offset:3264
    ds_read_b128 v[108:111], v64 offset:2752
    ds_read_b128 v[112:115], v64 offset:2240
    ds_read_b128 v[116:119], v64 offset:1728
    ds_read_b64_tr_b16 v[164:165], v65 offset:192
    ds_read_b64_tr_b16 v[166:167], v65 offset:200
    ds_read_b64_tr_b16 v[168:169], v65 offset:704
    ds_read_b64_tr_b16 v[170:171], v65 offset:712
    ds_read_b64_tr_b16 v[172:173], v65 offset:1216
    ds_read_b64_tr_b16 v[174:175], v65 offset:1224
    ds_read_b64_tr_b16 v[176:177], v65 offset:1728
    ds_read_b64_tr_b16 v[178:179], v65 offset:1736
    ds_read_b64_tr_b16 v[180:181], v65 offset:2240
    ds_read_b64_tr_b16 v[182:183], v65 offset:2248
    v_mfma_f32_16x16x32_bf16 v[196:199], v[132:135], v[68:71], v[196:199]
    v_mfma_f32_16x16x32_bf16 v[200:203], v[132:135], v[72:75], v[200:203]
    v_mfma_f32_16x16x32_bf16 v[204:207], v[132:135], v[76:79], v[204:207]
    v_mfma_f32_16x16x32_bf16 v[208:211], v[132:135], v[80:83], v[208:211]
    v_mfma_f32_16x16x32_bf16 v[212:215], v[132:135], v[84:87], v[212:215]
    v_mfma_f32_16x16x32_bf16 v[200:203], v[136:139], v[68:71], v[200:203]
    v_mfma_f32_16x16x32_bf16 v[204:207], v[136:139], v[72:75], v[204:207]
    v_mfma_f32_16x16x32_bf16 v[208:211], v[136:139], v[76:79], v[208:211]
    v_mfma_f32_16x16x32_bf16 v[212:215], v[136:139], v[80:83], v[212:215]
    v_mfma_f32_16x16x32_bf16 v[204:207], v[140:143], v[68:71], v[204:207]
    v_mfma_f32_16x16x32_bf16 v[208:211], v[140:143], v[72:75], v[208:211]
    v_mfma_f32_16x16x32_bf16 v[212:215], v[140:143], v[76:79], v[212:215]
    v_mfma_f32_16x16x32_bf16 v[208:211], v[144:147], v[68:71], v[208:211]
    v_mfma_f32_16x16x32_bf16 v[212:215], v[144:147], v[72:75], v[212:215]
    v_mfma_f32_16x16x32_bf16 v[212:215], v[148:151], v[68:71], v[212:215]
    s_waitcnt lgkmcnt(0)
    ds_read_b128 v[68:71], v64 offset:3840
    ds_read_b128 v[72:75], v64 offset:3328
    ds_read_b128 v[76:79], v64 offset:2816
    ds_read_b128 v[80:83], v64 offset:2304
    ds_read_b128 v[84:87], v64 offset:1792
    ds_read_b64_tr_b16 v[132:133], v65 offset:256
    ds_read_b64_tr_b16 v[134:135], v65 offset:264
    ds_read_b64_tr_b16 v[136:137], v65 offset:768
    ds_read_b64_tr_b16 v[138:139], v65 offset:776
    ds_read_b64_tr_b16 v[140:141], v65 offset:1280
    ds_read_b64_tr_b16 v[142:143], v65 offset:1288
    ds_read_b64_tr_b16 v[144:145], v65 offset:1792
    ds_read_b64_tr_b16 v[146:147], v65 offset:1800
    ds_read_b64_tr_b16 v[148:149], v65 offset:2304
    ds_read_b64_tr_b16 v[150:151], v65 offset:2312
    v_mfma_f32_16x16x32_bf16 v[196:199], v[164:167], v[100:103], v[196:199]
    v_mfma_f32_16x16x32_bf16 v[200:203], v[164:167], v[104:107], v[200:203]
    v_mfma_f32_16x16x32_bf16 v[204:207], v[164:167], v[108:111], v[204:207]
    v_mfma_f32_16x16x32_bf16 v[208:211], v[164:167], v[112:115], v[208:211]
    v_mfma_f32_16x16x32_bf16 v[212:215], v[164:167], v[116:119], v[212:215]
    v_mfma_f32_16x16x32_bf16 v[200:203], v[168:171], v[100:103], v[200:203]
    v_mfma_f32_16x16x32_bf16 v[204:207], v[168:171], v[104:107], v[204:207]
    v_mfma_f32_16x16x32_bf16 v[208:211], v[168:171], v[108:111], v[208:211]
    v_mfma_f32_16x16x32_bf16 v[212:215], v[168:171], v[112:115], v[212:215]
    v_mfma_f32_16x16x32_bf16 v[204:207], v[172:175], v[100:103], v[204:207]
    v_mfma_f32_16x16x32_bf16 v[208:211], v[172:175], v[104:107], v[208:211]
    v_mfma_f32_16x16x32_bf16 v[212:215], v[172:175], v[108:111], v[212:215]
    v_mfma_f32_16x16x32_bf16 v[208:211], v[176:179], v[100:103], v[208:211]
    v_mfma_f32_16x16x32_bf16 v[212:215], v[176:179], v[104:107], v[212:215]
    v_mfma_f32_16x16x32_bf16 v[212:215], v[180:183], v[100:103], v[212:215]
    s_waitcnt lgkmcnt(0)
    ds_read_b128 v[100:103], v64 offset:3904
    ds_read_b128 v[104:107], v64 offset:3392
    ds_read_b128 v[108:111], v64 offset:2880
    ds_read_b128 v[112:115], v64 offset:2368
    ds_read_b128 v[116:119], v64 offset:1856
    ds_read_b64_tr_b16 v[164:165], v65 offset:320
    ds_read_b64_tr_b16 v[166:167], v65 offset:328
    ds_read_b64_tr_b16 v[168:169], v65 offset:832
    ds_read_b64_tr_b16 v[170:171], v65 offset:840
    ds_read_b64_tr_b16 v[172:173], v65 offset:1344
    ds_read_b64_tr_b16 v[174:175], v65 offset:1352
    ds_read_b64_tr_b16 v[176:177], v65 offset:1856
    ds_read_b64_tr_b16 v[178:179], v65 offset:1864
    ds_read_b64_tr_b16 v[180:181], v65 offset:2368
    ds_read_b64_tr_b16 v[182:183], v65 offset:2376
    v_mfma_f32_16x16x32_bf16 v[196:199], v[132:135], v[68:71], v[196:199]
    v_mfma_f32_16x16x32_bf16 v[200:203], v[132:135], v[72:75], v[200:203]
    v_mfma_f32_16x16x32_bf16 v[204:207], v[132:135], v[76:79], v[204:207]
    v_mfma_f32_16x16x32_bf16 v[208:211], v[132:135], v[80:83], v[208:211]
    v_mfma_f32_16x16x32_bf16 v[212:215], v[132:135], v[84:87], v[212:215]
    v_mfma_f32_16x16x32_bf16 v[200:203], v[136:139], v[68:71], v[200:203]
    v_mfma_f32_16x16x32_bf16 v[204:207], v[136:139], v[72:75], v[204:207]
    v_mfma_f32_16x16x32_bf16 v[208:211], v[136:139], v[76:79], v[208:211]
    v_mfma_f32_16x16x32_bf16 v[212:215], v[136:139], v[80:83], v[212:215]
    v_mfma_f32_16x16x32_bf16 v[204:207], v[140:143], v[68:71], v[204:207]
    v_mfma_f32_16x16x32_bf16 v[208:211], v[140:143], v[72:75], v[208:211]
    v_mfma_f32_16x16x32_bf16 v[212:215], v[140:143], v[76:79], v[212:215]
    v_mfma_f32_16x16x32_bf16 v[208:211], v[144:147], v[68:71], v[208:211]
    v_mfma_f32_16x16x32_bf16 v[212:215], v[144:147], v[72:75], v[212:215]
    v_mfma_f32_16x16x32_bf16 v[212:215], v[148:151], v[68:71], v[212:215]
    s_waitcnt lgkmcnt(0)
    ds_read_b128 v[68:71], v64 offset:3968
    ds_read_b128 v[72:75], v64 offset:3456
    ds_read_b128 v[76:79], v64 offset:2944
    ds_read_b128 v[80:83], v64 offset:2432
    ds_read_b128 v[84:87], v64 offset:1920
    ds_read_b64_tr_b16 v[132:133], v65 offset:384
    ds_read_b64_tr_b16 v[134:135], v65 offset:392
    ds_read_b64_tr_b16 v[136:137], v65 offset:896
    ds_read_b64_tr_b16 v[138:139], v65 offset:904
    ds_read_b64_tr_b16 v[140:141], v65 offset:1408
    ds_read_b64_tr_b16 v[142:143], v65 offset:1416
    ds_read_b64_tr_b16 v[144:145], v65 offset:1920
    ds_read_b64_tr_b16 v[146:147], v65 offset:1928
    ds_read_b64_tr_b16 v[148:149], v65 offset:2432
    ds_read_b64_tr_b16 v[150:151], v65 offset:2440
    v_mfma_f32_16x16x32_bf16 v[196:199], v[164:167], v[100:103], v[196:199]
    v_mfma_f32_16x16x32_bf16 v[200:203], v[164:167], v[104:107], v[200:203]
    v_mfma_f32_16x16x32_bf16 v[204:207], v[164:167], v[108:111], v[204:207]
    v_mfma_f32_16x16x32_bf16 v[208:211], v[164:167], v[112:115], v[208:211]
    v_mfma_f32_16x16x32_bf16 v[212:215], v[164:167], v[116:119], v[212:215]
    v_mfma_f32_16x16x32_bf16 v[200:203], v[168:171], v[100:103], v[200:203]
    v_mfma_f32_16x16x32_bf16 v[204:207], v[168:171], v[104:107], v[204:207]
    v_mfma_f32_16x16x32_bf16 v[208:211], v[168:171], v[108:111], v[208:211]
    v_mfma_f32_16x16x32_bf16 v[212:215], v[168:171], v[112:115], v[212:215]
    v_mfma_f32_16x16x32_bf16 v[204:207], v[172:175], v[100:103], v[204:207]
    v_mfma_f32_16x16x32_bf16 v[208:211], v[172:175], v[104:107], v[208:211]
    v_mfma_f32_16x16x32_bf16 v[212:215], v[172:175], v[108:111], v[212:215]
    v_mfma_f32_16x16x32_bf16 v[208:211], v[176:179], v[100:103], v[208:211]
    v_mfma_f32_16x16x32_bf16 v[212:215], v[176:179], v[104:107], v[212:215]
    v_mfma_f32_16x16x32_bf16 v[212:215], v[180:183], v[100:103], v[212:215]
    s_waitcnt lgkmcnt(0)
    ds_read_b128 v[100:103], v64 offset:4032
    ds_read_b128 v[104:107], v64 offset:3520
    ds_read_b128 v[108:111], v64 offset:3008
    ds_read_b128 v[112:115], v64 offset:2496
    ds_read_b128 v[116:119], v64 offset:1984
    ds_read_b64_tr_b16 v[164:165], v65 offset:448
    ds_read_b64_tr_b16 v[166:167], v65 offset:456
    ds_read_b64_tr_b16 v[168:169], v65 offset:960
    ds_read_b64_tr_b16 v[170:171], v65 offset:968
    ds_read_b64_tr_b16 v[172:173], v65 offset:1472
    ds_read_b64_tr_b16 v[174:175], v65 offset:1480
    ds_read_b64_tr_b16 v[176:177], v65 offset:1984
    ds_read_b64_tr_b16 v[178:179], v65 offset:1992
    ds_read_b64_tr_b16 v[180:181], v65 offset:2496
    ds_read_b64_tr_b16 v[182:183], v65 offset:2504
    v_mfma_f32_16x16x32_bf16 v[196:199], v[132:135], v[68:71], v[196:199]
    v_mfma_f32_16x16x32_bf16 v[200:203], v[132:135], v[72:75], v[200:203]
    v_mfma_f32_16x16x32_bf16 v[204:207], v[132:135], v[76:79], v[204:207]
    v_mfma_f32_16x16x32_bf16 v[208:211], v[132:135], v[80:83], v[208:211]
    v_mfma_f32_16x16x32_bf16 v[212:215], v[132:135], v[84:87], v[212:215]
    v_mfma_f32_16x16x32_bf16 v[200:203], v[136:139], v[68:71], v[200:203]
    v_mfma_f32_16x16x32_bf16 v[204:207], v[136:139], v[72:75], v[204:207]
    v_mfma_f32_16x16x32_bf16 v[208:211], v[136:139], v[76:79], v[208:211]
    v_mfma_f32_16x16x32_bf16 v[212:215], v[136:139], v[80:83], v[212:215]
    v_mfma_f32_16x16x32_bf16 v[204:207], v[140:143], v[68:71], v[204:207]
    v_mfma_f32_16x16x32_bf16 v[208:211], v[140:143], v[72:75], v[208:211]
    v_mfma_f32_16x16x32_bf16 v[212:215], v[140:143], v[76:79], v[212:215]
    v_mfma_f32_16x16x32_bf16 v[208:211], v[144:147], v[68:71], v[208:211]
    v_mfma_f32_16x16x32_bf16 v[212:215], v[144:147], v[72:75], v[212:215]
    v_mfma_f32_16x16x32_bf16 v[212:215], v[148:151], v[68:71], v[212:215]
    s_waitcnt lgkmcnt(0)
    v_mfma_f32_16x16x32_bf16 v[196:199], v[164:167], v[100:103], v[196:199]
    v_mfma_f32_16x16x32_bf16 v[200:203], v[164:167], v[104:107], v[200:203]
    v_mfma_f32_16x16x32_bf16 v[204:207], v[164:167], v[108:111], v[204:207]
    v_mfma_f32_16x16x32_bf16 v[208:211], v[164:167], v[112:115], v[208:211]
    v_mfma_f32_16x16x32_bf16 v[212:215], v[164:167], v[116:119], v[212:215]
    v_mfma_f32_16x16x32_bf16 v[200:203], v[168:171], v[100:103], v[200:203]
    v_mfma_f32_16x16x32_bf16 v[204:207], v[168:171], v[104:107], v[204:207]
    v_mfma_f32_16x16x32_bf16 v[208:211], v[168:171], v[108:111], v[208:211]
    v_mfma_f32_16x16x32_bf16 v[212:215], v[168:171], v[112:115], v[212:215]
    v_mfma_f32_16x16x32_bf16 v[204:207], v[172:175], v[100:103], v[204:207]
    v_mfma_f32_16x16x32_bf16 v[208:211], v[172:175], v[104:107], v[208:211]
    v_mfma_f32_16x16x32_bf16 v[212:215], v[172:175], v[108:111], v[212:215]
    v_mfma_f32_16x16x32_bf16 v[208:211], v[176:179], v[100:103], v[208:211]
    v_mfma_f32_16x16x32_bf16 v[212:215], v[176:179], v[104:107], v[212:215]
    v_mfma_f32_16x16x32_bf16 v[212:215], v[180:183], v[100:103], v[212:215]
    ds_read_b64 v[220:221], v66 offset:3584
    ds_read_b64 v[222:223], v66 offset:3072
    ds_read_b64 v[224:225], v66 offset:2560
    ds_read_b64 v[226:227], v66 offset:2048
    ds_read_b64 v[228:229], v66 offset:1536
    s_nop 7
    s_waitcnt lgkmcnt(0)
    v_cvt_pk_bf16_f32 v230, v196, v197
    v_cvt_pk_bf16_f32 v231, v198, v199
    v_and_b32 v232, 0xffff0000, v221
    v_lshlrev_b32 v233, 16, v221
    v_and_b32 v234, 0xffff0000, v220
    v_lshlrev_b32 v235, 16, v220
    v_mul_f32 v232, s39, v232
    v_mul_f32 v233, s39, v233
    v_mul_f32 v234, s39, v234
    v_mul_f32 v235, s39, v235
    v_cvt_pk_bf16_f32 v232, v232, v233
    v_cvt_pk_bf16_f32 v233, v234, v235
    s_nop 0
    v_lshlrev_b32 v234, 16, v230
    v_lshlrev_b32 v235, 16, v232
    v_add_f32 v234, v234, v235
    v_and_b32 v235, 0xffff0000, v230
    v_and_b32 v236, 0xffff0000, v232
    v_add_f32 v235, v235, v236
    v_cvt_pk_bf16_f32 v234, v234, v235
    s_nop 0
    v_lshlrev_b32 v235, 16, v234
    v_lshlrev_b32 v236, 16, v32
    v_add_f32 v235, v235, v236
    v_and_b32 v234, 0xffff0000, v234
    v_and_b32 v236, 0xffff0000, v32
    v_add_f32 v234, v234, v236
    v_cvt_pk_bf16_f32 v238, v235, v234
    v_lshlrev_b32 v234, 16, v231
    v_lshlrev_b32 v235, 16, v233
    v_add_f32 v234, v234, v235
    v_and_b32 v235, 0xffff0000, v231
    v_and_b32 v236, 0xffff0000, v233
    v_add_f32 v235, v235, v236
    v_cvt_pk_bf16_f32 v234, v234, v235
    s_nop 0
    v_lshlrev_b32 v235, 16, v234
    v_lshlrev_b32 v236, 16, v33
    v_add_f32 v235, v235, v236
    v_and_b32 v234, 0xffff0000, v234
    v_and_b32 v236, 0xffff0000, v33
    v_add_f32 v234, v234, v236
    v_cvt_pk_bf16_f32 v239, v235, v234
    s_nop 0
    buffer_store_dwordx2 v[238:239], v7, s[20:23], s46 offen offset:0
    s_nop 0
    v_cvt_pk_bf16_f32 v230, v200, v201
    v_cvt_pk_bf16_f32 v231, v202, v203
    v_and_b32 v232, 0xffff0000, v223
    v_lshlrev_b32 v233, 16, v223
    v_and_b32 v234, 0xffff0000, v222
    v_lshlrev_b32 v235, 16, v222
    v_mul_f32 v232, s39, v232
    v_mul_f32 v233, s39, v233
    v_mul_f32 v234, s39, v234
    v_mul_f32 v235, s39, v235
    v_cvt_pk_bf16_f32 v232, v232, v233
    v_cvt_pk_bf16_f32 v233, v234, v235
    s_nop 0
    v_lshlrev_b32 v234, 16, v230
    v_lshlrev_b32 v235, 16, v232
    v_add_f32 v234, v234, v235
    v_and_b32 v235, 0xffff0000, v230
    v_and_b32 v236, 0xffff0000, v232
    v_add_f32 v235, v235, v236
    v_cvt_pk_bf16_f32 v234, v234, v235
    s_nop 0
    v_lshlrev_b32 v235, 16, v234
    v_lshlrev_b32 v236, 16, v34
    v_add_f32 v235, v235, v236
    v_and_b32 v234, 0xffff0000, v234
    v_and_b32 v236, 0xffff0000, v34
    v_add_f32 v234, v234, v236
    v_cvt_pk_bf16_f32 v238, v235, v234
    v_lshlrev_b32 v234, 16, v231
    v_lshlrev_b32 v235, 16, v233
    v_add_f32 v234, v234, v235
    v_and_b32 v235, 0xffff0000, v231
    v_and_b32 v236, 0xffff0000, v233
    v_add_f32 v235, v235, v236
    v_cvt_pk_bf16_f32 v234, v234, v235
    s_nop 0
    v_lshlrev_b32 v235, 16, v234
    v_lshlrev_b32 v236, 16, v35
    v_add_f32 v235, v235, v236
    v_and_b32 v234, 0xffff0000, v234
    v_and_b32 v236, 0xffff0000, v35
    v_add_f32 v234, v234, v236
    v_cvt_pk_bf16_f32 v239, v235, v234
    s_nop 0
    buffer_store_dwordx2 v[238:239], v7, s[20:23], s46 offen offset:512
    s_nop 0
    v_cvt_pk_bf16_f32 v230, v204, v205
    v_cvt_pk_bf16_f32 v231, v206, v207
    v_and_b32 v232, 0xffff0000, v225
    v_lshlrev_b32 v233, 16, v225
    v_and_b32 v234, 0xffff0000, v224
    v_lshlrev_b32 v235, 16, v224
    v_mul_f32 v232, s39, v232
    v_mul_f32 v233, s39, v233
    v_mul_f32 v234, s39, v234
    v_mul_f32 v235, s39, v235
    v_cvt_pk_bf16_f32 v232, v232, v233
    v_cvt_pk_bf16_f32 v233, v234, v235
    s_nop 0
    v_lshlrev_b32 v234, 16, v230
    v_lshlrev_b32 v235, 16, v232
    v_add_f32 v234, v234, v235
    v_and_b32 v235, 0xffff0000, v230
    v_and_b32 v236, 0xffff0000, v232
    v_add_f32 v235, v235, v236
    v_cvt_pk_bf16_f32 v234, v234, v235
    s_nop 0
    v_lshlrev_b32 v235, 16, v234
    v_lshlrev_b32 v236, 16, v36
    v_add_f32 v235, v235, v236
    v_and_b32 v234, 0xffff0000, v234
    v_and_b32 v236, 0xffff0000, v36
    v_add_f32 v234, v234, v236
    v_cvt_pk_bf16_f32 v238, v235, v234
    v_lshlrev_b32 v234, 16, v231
    v_lshlrev_b32 v235, 16, v233
    v_add_f32 v234, v234, v235
    v_and_b32 v235, 0xffff0000, v231
    v_and_b32 v236, 0xffff0000, v233
    v_add_f32 v235, v235, v236
    v_cvt_pk_bf16_f32 v234, v234, v235
    s_nop 0
    v_lshlrev_b32 v235, 16, v234
    v_lshlrev_b32 v236, 16, v37
    v_add_f32 v235, v235, v236
    v_and_b32 v234, 0xffff0000, v234
    v_and_b32 v236, 0xffff0000, v37
    v_add_f32 v234, v234, v236
    v_cvt_pk_bf16_f32 v239, v235, v234
    s_nop 0
    buffer_store_dwordx2 v[238:239], v7, s[20:23], s46 offen offset:1024
    s_nop 0
    v_cvt_pk_bf16_f32 v230, v208, v209
    v_cvt_pk_bf16_f32 v231, v210, v211
    v_and_b32 v232, 0xffff0000, v227
    v_lshlrev_b32 v233, 16, v227
    v_and_b32 v234, 0xffff0000, v226
    v_lshlrev_b32 v235, 16, v226
    v_mul_f32 v232, s39, v232
    v_mul_f32 v233, s39, v233
    v_mul_f32 v234, s39, v234
    v_mul_f32 v235, s39, v235
    v_cvt_pk_bf16_f32 v232, v232, v233
    v_cvt_pk_bf16_f32 v233, v234, v235
    s_nop 0
    v_lshlrev_b32 v234, 16, v230
    v_lshlrev_b32 v235, 16, v232
    v_add_f32 v234, v234, v235
    v_and_b32 v235, 0xffff0000, v230
    v_and_b32 v236, 0xffff0000, v232
    v_add_f32 v235, v235, v236
    v_cvt_pk_bf16_f32 v234, v234, v235
    s_nop 0
    v_lshlrev_b32 v235, 16, v234
    v_lshlrev_b32 v236, 16, v38
    v_add_f32 v235, v235, v236
    v_and_b32 v234, 0xffff0000, v234
    v_and_b32 v236, 0xffff0000, v38
    v_add_f32 v234, v234, v236
    v_cvt_pk_bf16_f32 v238, v235, v234
    v_lshlrev_b32 v234, 16, v231
    v_lshlrev_b32 v235, 16, v233
    v_add_f32 v234, v234, v235
    v_and_b32 v235, 0xffff0000, v231
    v_and_b32 v236, 0xffff0000, v233
    v_add_f32 v235, v235, v236
    v_cvt_pk_bf16_f32 v234, v234, v235
    s_nop 0
    v_lshlrev_b32 v235, 16, v234
    v_lshlrev_b32 v236, 16, v39
    v_add_f32 v235, v235, v236
    v_and_b32 v234, 0xffff0000, v234
    v_and_b32 v236, 0xffff0000, v39
    v_add_f32 v234, v234, v236
    v_cvt_pk_bf16_f32 v239, v235, v234
    s_nop 0
    buffer_store_dwordx2 v[238:239], v7, s[20:23], s46 offen offset:1536
    s_nop 0
    v_cvt_pk_bf16_f32 v230, v212, v213
    v_cvt_pk_bf16_f32 v231, v214, v215
    v_and_b32 v232, 0xffff0000, v229
    v_lshlrev_b32 v233, 16, v229
    v_and_b32 v234, 0xffff0000, v228
    v_lshlrev_b32 v235, 16, v228
    v_mul_f32 v232, s39, v232
    v_mul_f32 v233, s39, v233
    v_mul_f32 v234, s39, v234
    v_mul_f32 v235, s39, v235
    v_cvt_pk_bf16_f32 v232, v232, v233
    v_cvt_pk_bf16_f32 v233, v234, v235
    s_nop 0
    v_lshlrev_b32 v234, 16, v230
    v_lshlrev_b32 v235, 16, v232
    v_add_f32 v234, v234, v235
    v_and_b32 v235, 0xffff0000, v230
    v_and_b32 v236, 0xffff0000, v232
    v_add_f32 v235, v235, v236
    v_cvt_pk_bf16_f32 v234, v234, v235
    s_nop 0
    v_lshlrev_b32 v235, 16, v234
    v_lshlrev_b32 v236, 16, v40
    v_add_f32 v235, v235, v236
    v_and_b32 v234, 0xffff0000, v234
    v_and_b32 v236, 0xffff0000, v40
    v_add_f32 v234, v234, v236
    v_cvt_pk_bf16_f32 v238, v235, v234
    v_lshlrev_b32 v234, 16, v231
    v_lshlrev_b32 v235, 16, v233
    v_add_f32 v234, v234, v235
    v_and_b32 v235, 0xffff0000, v231
    v_and_b32 v236, 0xffff0000, v233
    v_add_f32 v235, v235, v236
    v_cvt_pk_bf16_f32 v234, v234, v235
    s_nop 0
    v_lshlrev_b32 v235, 16, v234
    v_lshlrev_b32 v236, 16, v41
    v_add_f32 v235, v235, v236
    v_and_b32 v234, 0xffff0000, v234
    v_and_b32 v236, 0xffff0000, v41
    v_add_f32 v234, v234, v236
    v_cvt_pk_bf16_f32 v239, v235, v234
    s_nop 0
    buffer_store_dwordx2 v[238:239], v7, s[20:23], s46 offen offset:2048
    s_nop 0
    s_endpgm
conv1_h1:
    v_mov_b32 v196, 0
    v_mov_b32 v197, 0
    v_mov_b32 v198, 0
    v_mov_b32 v199, 0
    v_mov_b32 v200, 0
    v_mov_b32 v201, 0
    v_mov_b32 v202, 0
    v_mov_b32 v203, 0
    v_mov_b32 v204, 0
    v_mov_b32 v205, 0
    v_mov_b32 v206, 0
    v_mov_b32 v207, 0
    ds_read_b128 v[68:71], v64 offset:3584
    ds_read_b128 v[72:75], v64 offset:3072
    ds_read_b128 v[76:79], v64 offset:2560
    ds_read_b128 v[80:83], v64 offset:2048
    ds_read_b128 v[84:87], v64 offset:1536
    ds_read_b128 v[88:91], v64 offset:1024
    ds_read_b128 v[92:95], v64 offset:512
    ds_read_b128 v[96:99], v64 offset:0
    ds_read_b64_tr_b16 v[132:133], v65 offset:0
    ds_read_b64_tr_b16 v[134:135], v65 offset:8
    ds_read_b64_tr_b16 v[136:137], v65 offset:512
    ds_read_b64_tr_b16 v[138:139], v65 offset:520
    ds_read_b64_tr_b16 v[140:141], v65 offset:1024
    ds_read_b64_tr_b16 v[142:143], v65 offset:1032
    ds_read_b64_tr_b16 v[144:145], v65 offset:1536
    ds_read_b64_tr_b16 v[146:147], v65 offset:1544
    ds_read_b64_tr_b16 v[148:149], v65 offset:2048
    ds_read_b64_tr_b16 v[150:151], v65 offset:2056
    ds_read_b64_tr_b16 v[152:153], v65 offset:2560
    ds_read_b64_tr_b16 v[154:155], v65 offset:2568
    ds_read_b64_tr_b16 v[156:157], v65 offset:3072
    ds_read_b64_tr_b16 v[158:159], v65 offset:3080
    ds_read_b64_tr_b16 v[160:161], v65 offset:3584
    ds_read_b64_tr_b16 v[162:163], v65 offset:3592
    s_waitcnt lgkmcnt(0)
    ds_read_b128 v[100:103], v64 offset:3648
    ds_read_b128 v[104:107], v64 offset:3136
    ds_read_b128 v[108:111], v64 offset:2624
    ds_read_b128 v[112:115], v64 offset:2112
    ds_read_b128 v[116:119], v64 offset:1600
    ds_read_b128 v[120:123], v64 offset:1088
    ds_read_b128 v[124:127], v64 offset:576
    ds_read_b128 v[128:131], v64 offset:64
    ds_read_b64_tr_b16 v[164:165], v65 offset:64
    ds_read_b64_tr_b16 v[166:167], v65 offset:72
    ds_read_b64_tr_b16 v[168:169], v65 offset:576
    ds_read_b64_tr_b16 v[170:171], v65 offset:584
    ds_read_b64_tr_b16 v[172:173], v65 offset:1088
    ds_read_b64_tr_b16 v[174:175], v65 offset:1096
    ds_read_b64_tr_b16 v[176:177], v65 offset:1600
    ds_read_b64_tr_b16 v[178:179], v65 offset:1608
    ds_read_b64_tr_b16 v[180:181], v65 offset:2112
    ds_read_b64_tr_b16 v[182:183], v65 offset:2120
    ds_read_b64_tr_b16 v[184:185], v65 offset:2624
    ds_read_b64_tr_b16 v[186:187], v65 offset:2632
    ds_read_b64_tr_b16 v[188:189], v65 offset:3136
    ds_read_b64_tr_b16 v[190:191], v65 offset:3144
    ds_read_b64_tr_b16 v[192:193], v65 offset:3648
    ds_read_b64_tr_b16 v[194:195], v65 offset:3656
    v_mfma_f32_16x16x32_bf16 v[196:199], v[132:135], v[88:91], v[196:199]
    v_mfma_f32_16x16x32_bf16 v[200:203], v[132:135], v[92:95], v[200:203]
    v_mfma_f32_16x16x32_bf16 v[204:207], v[132:135], v[96:99], v[204:207]
    v_mfma_f32_16x16x32_bf16 v[196:199], v[136:139], v[84:87], v[196:199]
    v_mfma_f32_16x16x32_bf16 v[200:203], v[136:139], v[88:91], v[200:203]
    v_mfma_f32_16x16x32_bf16 v[204:207], v[136:139], v[92:95], v[204:207]
    v_mfma_f32_16x16x32_bf16 v[196:199], v[140:143], v[80:83], v[196:199]
    v_mfma_f32_16x16x32_bf16 v[200:203], v[140:143], v[84:87], v[200:203]
    v_mfma_f32_16x16x32_bf16 v[204:207], v[140:143], v[88:91], v[204:207]
    v_mfma_f32_16x16x32_bf16 v[196:199], v[144:147], v[76:79], v[196:199]
    v_mfma_f32_16x16x32_bf16 v[200:203], v[144:147], v[80:83], v[200:203]
    v_mfma_f32_16x16x32_bf16 v[204:207], v[144:147], v[84:87], v[204:207]
    v_mfma_f32_16x16x32_bf16 v[196:199], v[148:151], v[72:75], v[196:199]
    v_mfma_f32_16x16x32_bf16 v[200:203], v[148:151], v[76:79], v[200:203]
    v_mfma_f32_16x16x32_bf16 v[204:207], v[148:151], v[80:83], v[204:207]
    v_mfma_f32_16x16x32_bf16 v[196:199], v[152:155], v[68:71], v[196:199]
    v_mfma_f32_16x16x32_bf16 v[200:203], v[152:155], v[72:75], v[200:203]
    v_mfma_f32_16x16x32_bf16 v[204:207], v[152:155], v[76:79], v[204:207]
    v_mfma_f32_16x16x32_bf16 v[200:203], v[156:159], v[68:71], v[200:203]
    v_mfma_f32_16x16x32_bf16 v[204:207], v[156:159], v[72:75], v[204:207]
    v_mfma_f32_16x16x32_bf16 v[204:207], v[160:163], v[68:71], v[204:207]
    s_waitcnt lgkmcnt(0)
    ds_read_b128 v[68:71], v64 offset:3712
    ds_read_b128 v[72:75], v64 offset:3200
    ds_read_b128 v[76:79], v64 offset:2688
    ds_read_b128 v[80:83], v64 offset:2176
    ds_read_b128 v[84:87], v64 offset:1664
    ds_read_b128 v[88:91], v64 offset:1152
    ds_read_b128 v[92:95], v64 offset:640
    ds_read_b128 v[96:99], v64 offset:128
    ds_read_b64_tr_b16 v[132:133], v65 offset:128
    ds_read_b64_tr_b16 v[134:135], v65 offset:136
    ds_read_b64_tr_b16 v[136:137], v65 offset:640
    ds_read_b64_tr_b16 v[138:139], v65 offset:648
    ds_read_b64_tr_b16 v[140:141], v65 offset:1152
    ds_read_b64_tr_b16 v[142:143], v65 offset:1160
    ds_read_b64_tr_b16 v[144:145], v65 offset:1664
    ds_read_b64_tr_b16 v[146:147], v65 offset:1672
    ds_read_b64_tr_b16 v[148:149], v65 offset:2176
    ds_read_b64_tr_b16 v[150:151], v65 offset:2184
    ds_read_b64_tr_b16 v[152:153], v65 offset:2688
    ds_read_b64_tr_b16 v[154:155], v65 offset:2696
    ds_read_b64_tr_b16 v[156:157], v65 offset:3200
    ds_read_b64_tr_b16 v[158:159], v65 offset:3208
    ds_read_b64_tr_b16 v[160:161], v65 offset:3712
    ds_read_b64_tr_b16 v[162:163], v65 offset:3720
    v_mfma_f32_16x16x32_bf16 v[196:199], v[164:167], v[120:123], v[196:199]
    v_mfma_f32_16x16x32_bf16 v[200:203], v[164:167], v[124:127], v[200:203]
    v_mfma_f32_16x16x32_bf16 v[204:207], v[164:167], v[128:131], v[204:207]
    v_mfma_f32_16x16x32_bf16 v[196:199], v[168:171], v[116:119], v[196:199]
    v_mfma_f32_16x16x32_bf16 v[200:203], v[168:171], v[120:123], v[200:203]
    v_mfma_f32_16x16x32_bf16 v[204:207], v[168:171], v[124:127], v[204:207]
    v_mfma_f32_16x16x32_bf16 v[196:199], v[172:175], v[112:115], v[196:199]
    v_mfma_f32_16x16x32_bf16 v[200:203], v[172:175], v[116:119], v[200:203]
    v_mfma_f32_16x16x32_bf16 v[204:207], v[172:175], v[120:123], v[204:207]
    v_mfma_f32_16x16x32_bf16 v[196:199], v[176:179], v[108:111], v[196:199]
    v_mfma_f32_16x16x32_bf16 v[200:203], v[176:179], v[112:115], v[200:203]
    v_mfma_f32_16x16x32_bf16 v[204:207], v[176:179], v[116:119], v[204:207]
    v_mfma_f32_16x16x32_bf16 v[196:199], v[180:183], v[104:107], v[196:199]
    v_mfma_f32_16x16x32_bf16 v[200:203], v[180:183], v[108:111], v[200:203]
    v_mfma_f32_16x16x32_bf16 v[204:207], v[180:183], v[112:115], v[204:207]
    v_mfma_f32_16x16x32_bf16 v[196:199], v[184:187], v[100:103], v[196:199]
    v_mfma_f32_16x16x32_bf16 v[200:203], v[184:187], v[104:107], v[200:203]
    v_mfma_f32_16x16x32_bf16 v[204:207], v[184:187], v[108:111], v[204:207]
    v_mfma_f32_16x16x32_bf16 v[200:203], v[188:191], v[100:103], v[200:203]
    v_mfma_f32_16x16x32_bf16 v[204:207], v[188:191], v[104:107], v[204:207]
    v_mfma_f32_16x16x32_bf16 v[204:207], v[192:195], v[100:103], v[204:207]
    s_waitcnt lgkmcnt(0)
    ds_read_b128 v[100:103], v64 offset:3776
    ds_read_b128 v[104:107], v64 offset:3264
    ds_read_b128 v[108:111], v64 offset:2752
    ds_read_b128 v[112:115], v64 offset:2240
    ds_read_b128 v[116:119], v64 offset:1728
    ds_read_b128 v[120:123], v64 offset:1216
    ds_read_b128 v[124:127], v64 offset:704
    ds_read_b128 v[128:131], v64 offset:192
    ds_read_b64_tr_b16 v[164:165], v65 offset:192
    ds_read_b64_tr_b16 v[166:167], v65 offset:200
    ds_read_b64_tr_b16 v[168:169], v65 offset:704
    ds_read_b64_tr_b16 v[170:171], v65 offset:712
    ds_read_b64_tr_b16 v[172:173], v65 offset:1216
    ds_read_b64_tr_b16 v[174:175], v65 offset:1224
    ds_read_b64_tr_b16 v[176:177], v65 offset:1728
    ds_read_b64_tr_b16 v[178:179], v65 offset:1736
    ds_read_b64_tr_b16 v[180:181], v65 offset:2240
    ds_read_b64_tr_b16 v[182:183], v65 offset:2248
    ds_read_b64_tr_b16 v[184:185], v65 offset:2752
    ds_read_b64_tr_b16 v[186:187], v65 offset:2760
    ds_read_b64_tr_b16 v[188:189], v65 offset:3264
    ds_read_b64_tr_b16 v[190:191], v65 offset:3272
    ds_read_b64_tr_b16 v[192:193], v65 offset:3776
    ds_read_b64_tr_b16 v[194:195], v65 offset:3784
    v_mfma_f32_16x16x32_bf16 v[196:199], v[132:135], v[88:91], v[196:199]
    v_mfma_f32_16x16x32_bf16 v[200:203], v[132:135], v[92:95], v[200:203]
    v_mfma_f32_16x16x32_bf16 v[204:207], v[132:135], v[96:99], v[204:207]
    v_mfma_f32_16x16x32_bf16 v[196:199], v[136:139], v[84:87], v[196:199]
    v_mfma_f32_16x16x32_bf16 v[200:203], v[136:139], v[88:91], v[200:203]
    v_mfma_f32_16x16x32_bf16 v[204:207], v[136:139], v[92:95], v[204:207]
    v_mfma_f32_16x16x32_bf16 v[196:199], v[140:143], v[80:83], v[196:199]
    v_mfma_f32_16x16x32_bf16 v[200:203], v[140:143], v[84:87], v[200:203]
    v_mfma_f32_16x16x32_bf16 v[204:207], v[140:143], v[88:91], v[204:207]
    v_mfma_f32_16x16x32_bf16 v[196:199], v[144:147], v[76:79], v[196:199]
    v_mfma_f32_16x16x32_bf16 v[200:203], v[144:147], v[80:83], v[200:203]
    v_mfma_f32_16x16x32_bf16 v[204:207], v[144:147], v[84:87], v[204:207]
    v_mfma_f32_16x16x32_bf16 v[196:199], v[148:151], v[72:75], v[196:199]
    v_mfma_f32_16x16x32_bf16 v[200:203], v[148:151], v[76:79], v[200:203]
    v_mfma_f32_16x16x32_bf16 v[204:207], v[148:151], v[80:83], v[204:207]
    v_mfma_f32_16x16x32_bf16 v[196:199], v[152:155], v[68:71], v[196:199]
    v_mfma_f32_16x16x32_bf16 v[200:203], v[152:155], v[72:75], v[200:203]
    v_mfma_f32_16x16x32_bf16 v[204:207], v[152:155], v[76:79], v[204:207]
    v_mfma_f32_16x16x32_bf16 v[200:203], v[156:159], v[68:71], v[200:203]
    v_mfma_f32_16x16x32_bf16 v[204:207], v[156:159], v[72:75], v[204:207]
    v_mfma_f32_16x16x32_bf16 v[204:207], v[160:163], v[68:71], v[204:207]
    s_waitcnt lgkmcnt(0)
    ds_read_b128 v[68:71], v64 offset:3840
    ds_read_b128 v[72:75], v64 offset:3328
    ds_read_b128 v[76:79], v64 offset:2816
    ds_read_b128 v[80:83], v64 offset:2304
    ds_read_b128 v[84:87], v64 offset:1792
    ds_read_b128 v[88:91], v64 offset:1280
    ds_read_b128 v[92:95], v64 offset:768
    ds_read_b128 v[96:99], v64 offset:256
    ds_read_b64_tr_b16 v[132:133], v65 offset:256
    ds_read_b64_tr_b16 v[134:135], v65 offset:264
    ds_read_b64_tr_b16 v[136:137], v65 offset:768
    ds_read_b64_tr_b16 v[138:139], v65 offset:776
    ds_read_b64_tr_b16 v[140:141], v65 offset:1280
    ds_read_b64_tr_b16 v[142:143], v65 offset:1288
    ds_read_b64_tr_b16 v[144:145], v65 offset:1792
    ds_read_b64_tr_b16 v[146:147], v65 offset:1800
    ds_read_b64_tr_b16 v[148:149], v65 offset:2304
    ds_read_b64_tr_b16 v[150:151], v65 offset:2312
    ds_read_b64_tr_b16 v[152:153], v65 offset:2816
    ds_read_b64_tr_b16 v[154:155], v65 offset:2824
    ds_read_b64_tr_b16 v[156:157], v65 offset:3328
    ds_read_b64_tr_b16 v[158:159], v65 offset:3336
    ds_read_b64_tr_b16 v[160:161], v65 offset:3840
    ds_read_b64_tr_b16 v[162:163], v65 offset:3848
    v_mfma_f32_16x16x32_bf16 v[196:199], v[164:167], v[120:123], v[196:199]
    v_mfma_f32_16x16x32_bf16 v[200:203], v[164:167], v[124:127], v[200:203]
    v_mfma_f32_16x16x32_bf16 v[204:207], v[164:167], v[128:131], v[204:207]
    v_mfma_f32_16x16x32_bf16 v[196:199], v[168:171], v[116:119], v[196:199]
    v_mfma_f32_16x16x32_bf16 v[200:203], v[168:171], v[120:123], v[200:203]
    v_mfma_f32_16x16x32_bf16 v[204:207], v[168:171], v[124:127], v[204:207]
    v_mfma_f32_16x16x32_bf16 v[196:199], v[172:175], v[112:115], v[196:199]
    v_mfma_f32_16x16x32_bf16 v[200:203], v[172:175], v[116:119], v[200:203]
    v_mfma_f32_16x16x32_bf16 v[204:207], v[172:175], v[120:123], v[204:207]
    v_mfma_f32_16x16x32_bf16 v[196:199], v[176:179], v[108:111], v[196:199]
    v_mfma_f32_16x16x32_bf16 v[200:203], v[176:179], v[112:115], v[200:203]
    v_mfma_f32_16x16x32_bf16 v[204:207], v[176:179], v[116:119], v[204:207]
    v_mfma_f32_16x16x32_bf16 v[196:199], v[180:183], v[104:107], v[196:199]
    v_mfma_f32_16x16x32_bf16 v[200:203], v[180:183], v[108:111], v[200:203]
    v_mfma_f32_16x16x32_bf16 v[204:207], v[180:183], v[112:115], v[204:207]
    v_mfma_f32_16x16x32_bf16 v[196:199], v[184:187], v[100:103], v[196:199]
    v_mfma_f32_16x16x32_bf16 v[200:203], v[184:187], v[104:107], v[200:203]
    v_mfma_f32_16x16x32_bf16 v[204:207], v[184:187], v[108:111], v[204:207]
    v_mfma_f32_16x16x32_bf16 v[200:203], v[188:191], v[100:103], v[200:203]
    v_mfma_f32_16x16x32_bf16 v[204:207], v[188:191], v[104:107], v[204:207]
    v_mfma_f32_16x16x32_bf16 v[204:207], v[192:195], v[100:103], v[204:207]
    s_waitcnt lgkmcnt(0)
    ds_read_b128 v[100:103], v64 offset:3904
    ds_read_b128 v[104:107], v64 offset:3392
    ds_read_b128 v[108:111], v64 offset:2880
    ds_read_b128 v[112:115], v64 offset:2368
    ds_read_b128 v[116:119], v64 offset:1856
    ds_read_b128 v[120:123], v64 offset:1344
    ds_read_b128 v[124:127], v64 offset:832
    ds_read_b128 v[128:131], v64 offset:320
    ds_read_b64_tr_b16 v[164:165], v65 offset:320
    ds_read_b64_tr_b16 v[166:167], v65 offset:328
    ds_read_b64_tr_b16 v[168:169], v65 offset:832
    ds_read_b64_tr_b16 v[170:171], v65 offset:840
    ds_read_b64_tr_b16 v[172:173], v65 offset:1344
    ds_read_b64_tr_b16 v[174:175], v65 offset:1352
    ds_read_b64_tr_b16 v[176:177], v65 offset:1856
    ds_read_b64_tr_b16 v[178:179], v65 offset:1864
    ds_read_b64_tr_b16 v[180:181], v65 offset:2368
    ds_read_b64_tr_b16 v[182:183], v65 offset:2376
    ds_read_b64_tr_b16 v[184:185], v65 offset:2880
    ds_read_b64_tr_b16 v[186:187], v65 offset:2888
    ds_read_b64_tr_b16 v[188:189], v65 offset:3392
    ds_read_b64_tr_b16 v[190:191], v65 offset:3400
    ds_read_b64_tr_b16 v[192:193], v65 offset:3904
    ds_read_b64_tr_b16 v[194:195], v65 offset:3912
    v_mfma_f32_16x16x32_bf16 v[196:199], v[132:135], v[88:91], v[196:199]
    v_mfma_f32_16x16x32_bf16 v[200:203], v[132:135], v[92:95], v[200:203]
    v_mfma_f32_16x16x32_bf16 v[204:207], v[132:135], v[96:99], v[204:207]
    v_mfma_f32_16x16x32_bf16 v[196:199], v[136:139], v[84:87], v[196:199]
    v_mfma_f32_16x16x32_bf16 v[200:203], v[136:139], v[88:91], v[200:203]
    v_mfma_f32_16x16x32_bf16 v[204:207], v[136:139], v[92:95], v[204:207]
    v_mfma_f32_16x16x32_bf16 v[196:199], v[140:143], v[80:83], v[196:199]
    v_mfma_f32_16x16x32_bf16 v[200:203], v[140:143], v[84:87], v[200:203]
    v_mfma_f32_16x16x32_bf16 v[204:207], v[140:143], v[88:91], v[204:207]
    v_mfma_f32_16x16x32_bf16 v[196:199], v[144:147], v[76:79], v[196:199]
    v_mfma_f32_16x16x32_bf16 v[200:203], v[144:147], v[80:83], v[200:203]
    v_mfma_f32_16x16x32_bf16 v[204:207], v[144:147], v[84:87], v[204:207]
    v_mfma_f32_16x16x32_bf16 v[196:199], v[148:151], v[72:75], v[196:199]
    v_mfma_f32_16x16x32_bf16 v[200:203], v[148:151], v[76:79], v[200:203]
    v_mfma_f32_16x16x32_bf16 v[204:207], v[148:151], v[80:83], v[204:207]
    v_mfma_f32_16x16x32_bf16 v[196:199], v[152:155], v[68:71], v[196:199]
    v_mfma_f32_16x16x32_bf16 v[200:203], v[152:155], v[72:75], v[200:203]
    v_mfma_f32_16x16x32_bf16 v[204:207], v[152:155], v[76:79], v[204:207]
    v_mfma_f32_16x16x32_bf16 v[200:203], v[156:159], v[68:71], v[200:203]
    v_mfma_f32_16x16x32_bf16 v[204:207], v[156:159], v[72:75], v[204:207]
    v_mfma_f32_16x16x32_bf16 v[204:207], v[160:163], v[68:71], v[204:207]
    s_waitcnt lgkmcnt(0)
    ds_read_b128 v[68:71], v64 offset:3968
    ds_read_b128 v[72:75], v64 offset:3456
    ds_read_b128 v[76:79], v64 offset:2944
    ds_read_b128 v[80:83], v64 offset:2432
    ds_read_b128 v[84:87], v64 offset:1920
    ds_read_b128 v[88:91], v64 offset:1408
    ds_read_b128 v[92:95], v64 offset:896
    ds_read_b128 v[96:99], v64 offset:384
    ds_read_b64_tr_b16 v[132:133], v65 offset:384
    ds_read_b64_tr_b16 v[134:135], v65 offset:392
    ds_read_b64_tr_b16 v[136:137], v65 offset:896
    ds_read_b64_tr_b16 v[138:139], v65 offset:904
    ds_read_b64_tr_b16 v[140:141], v65 offset:1408
    ds_read_b64_tr_b16 v[142:143], v65 offset:1416
    ds_read_b64_tr_b16 v[144:145], v65 offset:1920
    ds_read_b64_tr_b16 v[146:147], v65 offset:1928
    ds_read_b64_tr_b16 v[148:149], v65 offset:2432
    ds_read_b64_tr_b16 v[150:151], v65 offset:2440
    ds_read_b64_tr_b16 v[152:153], v65 offset:2944
    ds_read_b64_tr_b16 v[154:155], v65 offset:2952
    ds_read_b64_tr_b16 v[156:157], v65 offset:3456
    ds_read_b64_tr_b16 v[158:159], v65 offset:3464
    ds_read_b64_tr_b16 v[160:161], v65 offset:3968
    ds_read_b64_tr_b16 v[162:163], v65 offset:3976
    v_mfma_f32_16x16x32_bf16 v[196:199], v[164:167], v[120:123], v[196:199]
    v_mfma_f32_16x16x32_bf16 v[200:203], v[164:167], v[124:127], v[200:203]
    v_mfma_f32_16x16x32_bf16 v[204:207], v[164:167], v[128:131], v[204:207]
    v_mfma_f32_16x16x32_bf16 v[196:199], v[168:171], v[116:119], v[196:199]
    v_mfma_f32_16x16x32_bf16 v[200:203], v[168:171], v[120:123], v[200:203]
    v_mfma_f32_16x16x32_bf16 v[204:207], v[168:171], v[124:127], v[204:207]
    v_mfma_f32_16x16x32_bf16 v[196:199], v[172:175], v[112:115], v[196:199]
    v_mfma_f32_16x16x32_bf16 v[200:203], v[172:175], v[116:119], v[200:203]
    v_mfma_f32_16x16x32_bf16 v[204:207], v[172:175], v[120:123], v[204:207]
    v_mfma_f32_16x16x32_bf16 v[196:199], v[176:179], v[108:111], v[196:199]
    v_mfma_f32_16x16x32_bf16 v[200:203], v[176:179], v[112:115], v[200:203]
    v_mfma_f32_16x16x32_bf16 v[204:207], v[176:179], v[116:119], v[204:207]
    v_mfma_f32_16x16x32_bf16 v[196:199], v[180:183], v[104:107], v[196:199]
    v_mfma_f32_16x16x32_bf16 v[200:203], v[180:183], v[108:111], v[200:203]
    v_mfma_f32_16x16x32_bf16 v[204:207], v[180:183], v[112:115], v[204:207]
    v_mfma_f32_16x16x32_bf16 v[196:199], v[184:187], v[100:103], v[196:199]
    v_mfma_f32_16x16x32_bf16 v[200:203], v[184:187], v[104:107], v[200:203]
    v_mfma_f32_16x16x32_bf16 v[204:207], v[184:187], v[108:111], v[204:207]
    v_mfma_f32_16x16x32_bf16 v[200:203], v[188:191], v[100:103], v[200:203]
    v_mfma_f32_16x16x32_bf16 v[204:207], v[188:191], v[104:107], v[204:207]
    v_mfma_f32_16x16x32_bf16 v[204:207], v[192:195], v[100:103], v[204:207]
    s_waitcnt lgkmcnt(0)
    ds_read_b128 v[100:103], v64 offset:4032
    ds_read_b128 v[104:107], v64 offset:3520
    ds_read_b128 v[108:111], v64 offset:3008
    ds_read_b128 v[112:115], v64 offset:2496
    ds_read_b128 v[116:119], v64 offset:1984
    ds_read_b128 v[120:123], v64 offset:1472
    ds_read_b128 v[124:127], v64 offset:960
    ds_read_b128 v[128:131], v64 offset:448
    ds_read_b64_tr_b16 v[164:165], v65 offset:448
    ds_read_b64_tr_b16 v[166:167], v65 offset:456
    ds_read_b64_tr_b16 v[168:169], v65 offset:960
    ds_read_b64_tr_b16 v[170:171], v65 offset:968
    ds_read_b64_tr_b16 v[172:173], v65 offset:1472
    ds_read_b64_tr_b16 v[174:175], v65 offset:1480
    ds_read_b64_tr_b16 v[176:177], v65 offset:1984
    ds_read_b64_tr_b16 v[178:179], v65 offset:1992
    ds_read_b64_tr_b16 v[180:181], v65 offset:2496
    ds_read_b64_tr_b16 v[182:183], v65 offset:2504
    ds_read_b64_tr_b16 v[184:185], v65 offset:3008
    ds_read_b64_tr_b16 v[186:187], v65 offset:3016
    ds_read_b64_tr_b16 v[188:189], v65 offset:3520
    ds_read_b64_tr_b16 v[190:191], v65 offset:3528
    ds_read_b64_tr_b16 v[192:193], v65 offset:4032
    ds_read_b64_tr_b16 v[194:195], v65 offset:4040
    v_mfma_f32_16x16x32_bf16 v[196:199], v[132:135], v[88:91], v[196:199]
    v_mfma_f32_16x16x32_bf16 v[200:203], v[132:135], v[92:95], v[200:203]
    v_mfma_f32_16x16x32_bf16 v[204:207], v[132:135], v[96:99], v[204:207]
    v_mfma_f32_16x16x32_bf16 v[196:199], v[136:139], v[84:87], v[196:199]
    v_mfma_f32_16x16x32_bf16 v[200:203], v[136:139], v[88:91], v[200:203]
    v_mfma_f32_16x16x32_bf16 v[204:207], v[136:139], v[92:95], v[204:207]
    v_mfma_f32_16x16x32_bf16 v[196:199], v[140:143], v[80:83], v[196:199]
    v_mfma_f32_16x16x32_bf16 v[200:203], v[140:143], v[84:87], v[200:203]
    v_mfma_f32_16x16x32_bf16 v[204:207], v[140:143], v[88:91], v[204:207]
    v_mfma_f32_16x16x32_bf16 v[196:199], v[144:147], v[76:79], v[196:199]
    v_mfma_f32_16x16x32_bf16 v[200:203], v[144:147], v[80:83], v[200:203]
    v_mfma_f32_16x16x32_bf16 v[204:207], v[144:147], v[84:87], v[204:207]
    v_mfma_f32_16x16x32_bf16 v[196:199], v[148:151], v[72:75], v[196:199]
    v_mfma_f32_16x16x32_bf16 v[200:203], v[148:151], v[76:79], v[200:203]
    v_mfma_f32_16x16x32_bf16 v[204:207], v[148:151], v[80:83], v[204:207]
    v_mfma_f32_16x16x32_bf16 v[196:199], v[152:155], v[68:71], v[196:199]
    v_mfma_f32_16x16x32_bf16 v[200:203], v[152:155], v[72:75], v[200:203]
    v_mfma_f32_16x16x32_bf16 v[204:207], v[152:155], v[76:79], v[204:207]
    v_mfma_f32_16x16x32_bf16 v[200:203], v[156:159], v[68:71], v[200:203]
    v_mfma_f32_16x16x32_bf16 v[204:207], v[156:159], v[72:75], v[204:207]
    v_mfma_f32_16x16x32_bf16 v[204:207], v[160:163], v[68:71], v[204:207]
    s_waitcnt lgkmcnt(0)
    v_mfma_f32_16x16x32_bf16 v[196:199], v[164:167], v[120:123], v[196:199]
    v_mfma_f32_16x16x32_bf16 v[200:203], v[164:167], v[124:127], v[200:203]
    v_mfma_f32_16x16x32_bf16 v[204:207], v[164:167], v[128:131], v[204:207]
    v_mfma_f32_16x16x32_bf16 v[196:199], v[168:171], v[116:119], v[196:199]
    v_mfma_f32_16x16x32_bf16 v[200:203], v[168:171], v[120:123], v[200:203]
    v_mfma_f32_16x16x32_bf16 v[204:207], v[168:171], v[124:127], v[204:207]
    v_mfma_f32_16x16x32_bf16 v[196:199], v[172:175], v[112:115], v[196:199]
    v_mfma_f32_16x16x32_bf16 v[200:203], v[172:175], v[116:119], v[200:203]
    v_mfma_f32_16x16x32_bf16 v[204:207], v[172:175], v[120:123], v[204:207]
    v_mfma_f32_16x16x32_bf16 v[196:199], v[176:179], v[108:111], v[196:199]
    v_mfma_f32_16x16x32_bf16 v[200:203], v[176:179], v[112:115], v[200:203]
    v_mfma_f32_16x16x32_bf16 v[204:207], v[176:179], v[116:119], v[204:207]
    v_mfma_f32_16x16x32_bf16 v[196:199], v[180:183], v[104:107], v[196:199]
    v_mfma_f32_16x16x32_bf16 v[200:203], v[180:183], v[108:111], v[200:203]
    v_mfma_f32_16x16x32_bf16 v[204:207], v[180:183], v[112:115], v[204:207]
    v_mfma_f32_16x16x32_bf16 v[196:199], v[184:187], v[100:103], v[196:199]
    v_mfma_f32_16x16x32_bf16 v[200:203], v[184:187], v[104:107], v[200:203]
    v_mfma_f32_16x16x32_bf16 v[204:207], v[184:187], v[108:111], v[204:207]
    v_mfma_f32_16x16x32_bf16 v[200:203], v[188:191], v[100:103], v[200:203]
    v_mfma_f32_16x16x32_bf16 v[204:207], v[188:191], v[104:107], v[204:207]
    v_mfma_f32_16x16x32_bf16 v[204:207], v[192:195], v[100:103], v[204:207]
    ds_read_b64 v[220:221], v66 offset:1024
    ds_read_b64 v[222:223], v66 offset:512
    ds_read_b64 v[224:225], v66 offset:0
    s_nop 7
    s_waitcnt lgkmcnt(0)
    v_cvt_pk_bf16_f32 v230, v196, v197
    v_cvt_pk_bf16_f32 v231, v198, v199
    v_and_b32 v232, 0xffff0000, v221
    v_lshlrev_b32 v233, 16, v221
    v_and_b32 v234, 0xffff0000, v220
    v_lshlrev_b32 v235, 16, v220
    v_mul_f32 v232, s39, v232
    v_mul_f32 v233, s39, v233
    v_mul_f32 v234, s39, v234
    v_mul_f32 v235, s39, v235
    v_cvt_pk_bf16_f32 v232, v232, v233
    v_cvt_pk_bf16_f32 v233, v234, v235
    s_nop 0
    v_lshlrev_b32 v234, 16, v230
    v_lshlrev_b32 v235, 16, v232
    v_add_f32 v234, v234, v235
    v_and_b32 v235, 0xffff0000, v230
    v_and_b32 v236, 0xffff0000, v232
    v_add_f32 v235, v235, v236
    v_cvt_pk_bf16_f32 v234, v234, v235
    s_nop 0
    v_lshlrev_b32 v235, 16, v234
    v_lshlrev_b32 v236, 16, v42
    v_add_f32 v235, v235, v236
    v_and_b32 v234, 0xffff0000, v234
    v_and_b32 v236, 0xffff0000, v42
    v_add_f32 v234, v234, v236
    v_cvt_pk_bf16_f32 v238, v235, v234
    v_lshlrev_b32 v234, 16, v231
    v_lshlrev_b32 v235, 16, v233
    v_add_f32 v234, v234, v235
    v_and_b32 v235, 0xffff0000, v231
    v_and_b32 v236, 0xffff0000, v233
    v_add_f32 v235, v235, v236
    v_cvt_pk_bf16_f32 v234, v234, v235
    s_nop 0
    v_lshlrev_b32 v235, 16, v234
    v_lshlrev_b32 v236, 16, v43
    v_add_f32 v235, v235, v236
    v_and_b32 v234, 0xffff0000, v234
    v_and_b32 v236, 0xffff0000, v43
    v_add_f32 v234, v234, v236
    v_cvt_pk_bf16_f32 v239, v235, v234
    s_nop 0
    buffer_store_dwordx2 v[238:239], v7, s[20:23], s46 offen offset:2560
    s_nop 0
    v_cvt_pk_bf16_f32 v230, v200, v201
    v_cvt_pk_bf16_f32 v231, v202, v203
    v_and_b32 v232, 0xffff0000, v223
    v_lshlrev_b32 v233, 16, v223
    v_and_b32 v234, 0xffff0000, v222
    v_lshlrev_b32 v235, 16, v222
    v_mul_f32 v232, s39, v232
    v_mul_f32 v233, s39, v233
    v_mul_f32 v234, s39, v234
    v_mul_f32 v235, s39, v235
    v_cvt_pk_bf16_f32 v232, v232, v233
    v_cvt_pk_bf16_f32 v233, v234, v235
    s_nop 0
    v_lshlrev_b32 v234, 16, v230
    v_lshlrev_b32 v235, 16, v232
    v_add_f32 v234, v234, v235
    v_and_b32 v235, 0xffff0000, v230
    v_and_b32 v236, 0xffff0000, v232
    v_add_f32 v235, v235, v236
    v_cvt_pk_bf16_f32 v234, v234, v235
    s_nop 0
    v_lshlrev_b32 v235, 16, v234
    v_lshlrev_b32 v236, 16, v44
    v_add_f32 v235, v235, v236
    v_and_b32 v234, 0xffff0000, v234
    v_and_b32 v236, 0xffff0000, v44
    v_add_f32 v234, v234, v236
    v_cvt_pk_bf16_f32 v238, v235, v234
    v_lshlrev_b32 v234, 16, v231
    v_lshlrev_b32 v235, 16, v233
    v_add_f32 v234, v234, v235
    v_and_b32 v235, 0xffff0000, v231
    v_and_b32 v236, 0xffff0000, v233
    v_add_f32 v235, v235, v236
    v_cvt_pk_bf16_f32 v234, v234, v235
    s_nop 0
    v_lshlrev_b32 v235, 16, v234
    v_lshlrev_b32 v236, 16, v45
    v_add_f32 v235, v235, v236
    v_and_b32 v234, 0xffff0000, v234
    v_and_b32 v236, 0xffff0000, v45
    v_add_f32 v234, v234, v236
    v_cvt_pk_bf16_f32 v239, v235, v234
    s_nop 0
    buffer_store_dwordx2 v[238:239], v7, s[20:23], s46 offen offset:3072
    s_nop 0
    v_cvt_pk_bf16_f32 v230, v204, v205
    v_cvt_pk_bf16_f32 v231, v206, v207
    v_and_b32 v232, 0xffff0000, v225
    v_lshlrev_b32 v233, 16, v225
    v_and_b32 v234, 0xffff0000, v224
    v_lshlrev_b32 v235, 16, v224
    v_mul_f32 v232, s39, v232
    v_mul_f32 v233, s39, v233
    v_mul_f32 v234, s39, v234
    v_mul_f32 v235, s39, v235
    v_cvt_pk_bf16_f32 v232, v232, v233
    v_cvt_pk_bf16_f32 v233, v234, v235
    s_nop 0
    v_lshlrev_b32 v234, 16, v230
    v_lshlrev_b32 v235, 16, v232
    v_add_f32 v234, v234, v235
    v_and_b32 v235, 0xffff0000, v230
    v_and_b32 v236, 0xffff0000, v232
    v_add_f32 v235, v235, v236
    v_cvt_pk_bf16_f32 v234, v234, v235
    s_nop 0
    v_lshlrev_b32 v235, 16, v234
    v_lshlrev_b32 v236, 16, v46
    v_add_f32 v235, v235, v236
    v_and_b32 v234, 0xffff0000, v234
    v_and_b32 v236, 0xffff0000, v46
    v_add_f32 v234, v234, v236
    v_cvt_pk_bf16_f32 v238, v235, v234
    v_lshlrev_b32 v234, 16, v231
    v_lshlrev_b32 v235, 16, v233
    v_add_f32 v234, v234, v235
    v_and_b32 v235, 0xffff0000, v231
    v_and_b32 v236, 0xffff0000, v233
    v_add_f32 v235, v235, v236
    v_cvt_pk_bf16_f32 v234, v234, v235
    s_nop 0
    v_lshlrev_b32 v235, 16, v234
    v_lshlrev_b32 v236, 16, v47
    v_add_f32 v235, v235, v236
    v_and_b32 v234, 0xffff0000, v234
    v_and_b32 v236, 0xffff0000, v47
    v_add_f32 v234, v234, v236
    v_cvt_pk_bf16_f32 v239, v235, v234
    s_nop 0
    buffer_store_dwordx2 v[238:239], v7, s[20:23], s46 offen offset:3584
    s_nop 0
    s_endpgm
conv1_exit:
    s_endpgm

.globl g1a_kernel
.p2align 8
.type g1a_kernel,@function
g1a_kernel:
    s_cmp_ge_u32 s2, 224
    s_cbranch_scc1 g1a_exit
    s_load_dwordx2 s[4:5], s[0:1], 120
    s_load_dwordx2 s[6:7], s[0:1], 80
    s_load_dwordx2 s[28:29], s[0:1], 88
    v_readfirstlane_b32 s30, v0
    s_lshr_b32 s30, s30, 6
    s_lshr_b32 s31, s30, 1
    s_and_b32 s32, s30, 1
    s_and_b32 s33, s2, 15
    s_lshl_b32 s33, s33, 7
    s_lshr_b32 s34, s2, 4
    s_lshl_b32 s34, s34, 7
    s_waitcnt lgkmcnt(0)
    s_add_u32 s8, s4, 0x200000
    s_addc_u32 s9, s5, 0
    s_and_b32 s9, s9, 0xffff
    s_mov_b32 s10, 0x200000
    s_mov_b32 s11, 0x00020000
    s_add_u32 s12, s6, 0x0
    s_addc_u32 s13, s7, 0
    s_and_b32 s13, s13, 0xffff
    s_mov_b32 s14, 0x1c0000
    s_mov_b32 s15, 0x00020000
    s_add_u32 s16, s28, 0x0
    s_addc_u32 s17, s29, 0
    s_and_b32 s17, s17, 0xffff
    s_mov_b32 s18, 0x1c0000
    s_mov_b32 s19, 0x00020000
    s_add_u32 s20, s4, 0x800000
    s_addc_u32 s21, s5, 0
    s_and_b32 s21, s21, 0xffff
    s_mov_b32 s22, 0x700000
    s_mov_b32 s23, 0x00020000
    s_add_u32 s24, s4, 0x1420000
    s_addc_u32 s25, s5, 0
    s_and_b32 s25, s25, 0xffff
    s_mov_b32 s26, 0x3800
    s_mov_b32 s27, 0x00020000
    v_and_b32 v25, 63, v0
    v_and_b32 v26, 15, v25
    v_lshrrev_b32 v27, 4, v25
    v_lshlrev_b32 v0, 1, v27
    v_xor_b32 v0, v0, v26
    v_lshlrev_b32 v0, 4, v0
    s_lshl_b32 s35, s30, 4
    s_add_u32 s35, s35, 0
    v_add_u32 v24, s35, v27
    v_lshl_add_u32 v9, v24, 12, v0
    s_lshl_b32 s36, s33, 1
    v_add_u32 v9, s36, v9
    s_movk_i32 s36, 3584
    v_mul_lo_u32 v24, v24, s36
    v_add_u32 v13, v24, v0
    s_lshl_b32 s36, s34, 1
    v_add_u32 v13, s36, v13
    v_lshlrev_b32 v0, 1, v27
    v_xor_b32 v0, v0, v26
    v_lshlrev_b32 v0, 4, v0
    s_lshl_b32 s35, s30, 4
    s_add_u32 s35, s35, 4
    v_add_u32 v24, s35, v27
    v_lshl_add_u32 v10, v24, 12, v0
    s_lshl_b32 s36, s33, 1
    v_add_u32 v10, s36, v10
    s_movk_i32 s36, 3584
    v_mul_lo_u32 v24, v24, s36
    v_add_u32 v14, v24, v0
    s_lshl_b32 s36, s34, 1
    v_add_u32 v14, s36, v14
    v_lshlrev_b32 v0, 1, v27
    v_xor_b32 v0, v0, v26
    v_xor_b32 v0, 8, v0
    v_lshlrev_b32 v0, 4, v0
    s_lshl_b32 s35, s30, 4
    s_add_u32 s35, s35, 8
    v_add_u32 v24, s35, v27
    v_lshl_add_u32 v11, v24, 12, v0
    s_lshl_b32 s36, s33, 1
    v_add_u32 v11, s36, v11
    s_movk_i32 s36, 3584
    v_mul_lo_u32 v24, v24, s36
    v_add_u32 v15, v24, v0
    s_lshl_b32 s36, s34, 1
    v_add_u32 v15, s36, v15
    v_lshlrev_b32 v0, 1, v27
    v_xor_b32 v0, v0, v26
    v_xor_b32 v0, 8, v0
    v_lshlrev_b32 v0, 4, v0
    s_lshl_b32 s35, s30, 4
    s_add_u32 s35, s35, 12
    v_add_u32 v24, s35, v27
    v_lshl_add_u32 v12, v24, 12, v0
    s_lshl_b32 s36, s33, 1
    v_add_u32 v12, s36, v12
    s_movk_i32 s36, 3584
    v_mul_lo_u32 v24, v24, s36
    v_add_u32 v16, v24, v0
    s_lshl_b32 s36, s34, 1
    v_add_u32 v16, s36, v16
    s_mov_b32 s40, 0
    s_mov_b32 s41, 0
    s_lshl_b32 s42, s30, 12
    s_add_u32 m0, s42, 0
    s_nop 0
    buffer_load_dwordx4 v9, s[8:11], s40 offen lds
    s_add_u32 m0, s42, 16384
    s_nop 0
    buffer_load_dwordx4 v13, s[12:15], s41 offen lds
    s_add_u32 m0, s42, 32768
    s_nop 0
    buffer_load_dwordx4 v13, s[16:19], s41 offen lds
    s_add_u32 m0, s42, 1024
    s_nop 0
    buffer_load_dwordx4 v10, s[8:11], s40 offen lds
    s_add_u32 m0, s42, 17408
    s_nop 0
    buffer_load_dwordx4 v14, s[12:15], s41 offen lds
    s_add_u32 m0, s42, 33792
    s_nop 0
    buffer_load_dwordx4 v14, s[16:19], s41 offen lds
    s_add_u32 m0, s42, 2048
    s_nop 0
    buffer_load_dwordx4 v11, s[8:11], s40 offen lds
    s_add_u32 m0, s42, 18432
    s_nop 0
    buffer_load_dwordx4 v15, s[12:15], s41 offen lds
    s_add_u32 m0, s42, 34816
    s_nop 0
    buffer_load_dwordx4 v15, s[16:19], s41 offen lds
    s_add_u32 m0, s42, 3072
    s_nop 0
    buffer_load_dwordx4 v12, s[8:11], s40 offen lds
    s_add_u32 m0, s42, 19456
    s_nop 0
    buffer_load_dwordx4 v16, s[12:15], s41 offen lds
    s_add_u32 m0, s42, 35840
    s_nop 0
    buffer_load_dwordx4 v16, s[16:19], s41 offen lds
    s_mov_b32 s40, 262144
    s_mov_b32 s41, 229376
    s_lshl_b32 s42, s30, 12
    s_add_u32 m0, s42, 49152
    s_nop 0
    buffer_load_dwordx4 v9, s[8:11], s40 offen lds
    s_add_u32 m0, s42, 65536
    s_nop 0
    buffer_load_dwordx4 v13, s[12:15], s41 offen lds
    s_add_u32 m0, s42, 81920
    s_nop 0
    buffer_load_dwordx4 v13, s[16:19], s41 offen lds
    s_add_u32 m0, s42, 50176
    s_nop 0
    buffer_load_dwordx4 v10, s[8:11], s40 offen lds
    s_add_u32 m0, s42, 66560
    s_nop 0
    buffer_load_dwordx4 v14, s[12:15], s41 offen lds
    s_add_u32 m0, s42, 82944
    s_nop 0
    buffer_load_dwordx4 v14, s[16:19], s41 offen lds
    s_add_u32 m0, s42, 51200
    s_nop 0
    buffer_load_dwordx4 v11, s[8:11], s40 offen lds
    s_add_u32 m0, s42, 67584
    s_nop 0
    buffer_load_dwordx4 v15, s[12:15], s41 offen lds
    s_add_u32 m0, s42, 83968
    s_nop 0
    buffer_load_dwordx4 v15, s[16:19], s41 offen lds
    s_add_u32 m0, s42, 52224
    s_nop 0
    buffer_load_dwordx4 v12, s[8:11], s40 offen lds
    s_add_u32 m0, s42, 68608
    s_nop 0
    buffer_load_dwordx4 v16, s[12:15], s41 offen lds
    s_add_u32 m0, s42, 84992
    s_nop 0
    buffer_load_dwordx4 v16, s[16:19], s41 offen lds
    v_lshrrev_b32 v0, 2, v26
    v_and_b32 v24, 1, v27
    v_lshl_or_b32 v24, v24, 2, v0
    v_lshlrev_b32 v24, 1, v24
    v_and_b32 v17, 3, v26
    v_lshrrev_b32 v18, 1, v17
    v_and_b32 v17, 1, v17
    v_lshl_add_u32 v0, v27, 3, v0
    v_lshlrev_b32 v0, 8, v0
    v_lshl_add_u32 v0, v17, 3, v0
    s_lshl_b32 s35, s31, 3
    s_add_u32 s35, s35, 0
    v_add_u32 v19, s35, v18
    v_xor_b32 v19, v19, v24
    v_lshl_add_u32 v1, v19, 4, v0
    s_lshl_b32 s35, s32, 3
    s_add_u32 s35, s35, 0
    v_add_u32 v19, s35, v18
    v_xor_b32 v19, v19, v24
    v_lshl_add_u32 v5, v19, 4, v0
    s_lshl_b32 s35, s31, 3
    s_add_u32 s35, s35, 2
    v_add_u32 v19, s35, v18
    v_xor_b32 v19, v19, v24
    v_lshl_add_u32 v2, v19, 4, v0
    s_lshl_b32 s35, s32, 3
    s_add_u32 s35, s35, 2
    v_add_u32 v19, s35, v18
    v_xor_b32 v19, v19, v24
    v_lshl_add_u32 v6, v19, 4, v0
    s_lshl_b32 s35, s31, 3
    s_add_u32 s35, s35, 4
    v_add_u32 v19, s35, v18
    v_xor_b32 v19, v19, v24
    v_lshl_add_u32 v3, v19, 4, v0
    s_lshl_b32 s35, s32, 3
    s_add_u32 s35, s35, 4
    v_add_u32 v19, s35, v18
    v_xor_b32 v19, v19, v24
    v_lshl_add_u32 v7, v19, 4, v0
    s_lshl_b32 s35, s31, 3
    s_add_u32 s35, s35, 6
    v_add_u32 v19, s35, v18
    v_xor_b32 v19, v19, v24
    v_lshl_add_u32 v4, v19, 4, v0
    s_lshl_b32 s35, s32, 3
    s_add_u32 s35, s35, 6
    v_add_u32 v19, s35, v18
    v_xor_b32 v19, v19, v24
    v_lshl_add_u32 v8, v19, 4, v0
    v_add_u32 v5, 16384, v5
    v_add_u32 v6, 16384, v6
    v_add_u32 v7, 16384, v7
    v_add_u32 v8, 16384, v8
    v_mov_b32 v17, 0
    v_mov_b32 v18, 0
    v_mov_b32 v19, 0
    v_mov_b32 v20, 0
    v_mov_b32 v21, 0
    v_mov_b32 v22, 0
    v_mov_b32 v23, 0
    v_mov_b32 v24, 0
    v_mov_b32 v128, 0
    v_mov_b32 v129, 0
    v_mov_b32 v130, 0
    v_mov_b32 v131, 0
    v_mov_b32 v132, 0
    v_mov_b32 v133, 0
    v_mov_b32 v134, 0
    v_mov_b32 v135, 0
    v_mov_b32 v136, 0
    v_mov_b32 v137, 0
    v_mov_b32 v138, 0
    v_mov_b32 v139, 0
    v_mov_b32 v140, 0
    v_mov_b32 v141, 0
    v_mov_b32 v142, 0
    v_mov_b32 v143, 0
    v_mov_b32 v144, 0
    v_mov_b32 v145, 0
    v_mov_b32 v146, 0
    v_mov_b32 v147, 0
    v_mov_b32 v148, 0
    v_mov_b32 v149, 0
    v_mov_b32 v150, 0
    v_mov_b32 v151, 0
    v_mov_b32 v152, 0
    v_mov_b32 v153, 0
    v_mov_b32 v154, 0
    v_mov_b32 v155, 0
    v_mov_b32 v156, 0
    v_mov_b32 v157, 0
    v_mov_b32 v158, 0
    v_mov_b32 v159, 0
    v_mov_b32 v160, 0
    v_mov_b32 v161, 0
    v_mov_b32 v162, 0
    v_mov_b32 v163, 0
    v_mov_b32 v164, 0
    v_mov_b32 v165, 0
    v_mov_b32 v166, 0
    v_mov_b32 v167, 0
    v_mov_b32 v168, 0
    v_mov_b32 v169, 0
    v_mov_b32 v170, 0
    v_mov_b32 v171, 0
    v_mov_b32 v172, 0
    v_mov_b32 v173, 0
    v_mov_b32 v174, 0
    v_mov_b32 v175, 0
    v_mov_b32 v176, 0
    v_mov_b32 v177, 0
    v_mov_b32 v178, 0
    v_mov_b32 v179, 0
    v_mov_b32 v180, 0
    v_mov_b32 v181, 0
    v_mov_b32 v182, 0
    v_mov_b32 v183, 0
    v_mov_b32 v184, 0
    v_mov_b32 v185, 0
    v_mov_b32 v186, 0
    v_mov_b32 v187, 0
    v_mov_b32 v188, 0
    v_mov_b32 v189, 0
    v_mov_b32 v190, 0
    v_mov_b32 v191, 0
    v_mov_b32 v192, 0
    v_mov_b32 v193, 0
    v_mov_b32 v194, 0
    v_mov_b32 v195, 0
    v_mov_b32 v196, 0
    v_mov_b32 v197, 0
    v_mov_b32 v198, 0
    v_mov_b32 v199, 0
    v_mov_b32 v200, 0
    v_mov_b32 v201, 0
    v_mov_b32 v202, 0
    v_mov_b32 v203, 0
    v_mov_b32 v204, 0
    v_mov_b32 v205, 0
    v_mov_b32 v206, 0
    v_mov_b32 v207, 0
    v_mov_b32 v208, 0
    v_mov_b32 v209, 0
    v_mov_b32 v210, 0
    v_mov_b32 v211, 0
    v_mov_b32 v212, 0
    v_mov_b32 v213, 0
    v_mov_b32 v214, 0
    v_mov_b32 v215, 0
    v_mov_b32 v216, 0
    v_mov_b32 v217, 0
    v_mov_b32 v218, 0
    v_mov_b32 v219, 0
    v_mov_b32 v220, 0
    v_mov_b32 v221, 0
    v_mov_b32 v222, 0
    v_mov_b32 v223, 0
    v_mov_b32 v224, 0
    v_mov_b32 v225, 0
    v_mov_b32 v226, 0
    v_mov_b32 v227, 0
    v_mov_b32 v228, 0
    v_mov_b32 v229, 0
    v_mov_b32 v230, 0
    v_mov_b32 v231, 0
    v_mov_b32 v232, 0
    v_mov_b32 v233, 0
    v_mov_b32 v234, 0
    v_mov_b32 v235, 0
    v_mov_b32 v236, 0
    v_mov_b32 v237, 0
    v_mov_b32 v238, 0
    v_mov_b32 v239, 0
    v_mov_b32 v240, 0
    v_mov_b32 v241, 0
    v_mov_b32 v242, 0
    v_mov_b32 v243, 0
    v_mov_b32 v244, 0
    v_mov_b32 v245, 0
    v_mov_b32 v246, 0
    v_mov_b32 v247, 0
    v_mov_b32 v248, 0
    v_mov_b32 v249, 0
    v_mov_b32 v250, 0
    v_mov_b32 v251, 0
    v_mov_b32 v252, 0
    v_mov_b32 v253, 0
    v_mov_b32 v254, 0
    v_mov_b32 v255, 0
    s_mov_b32 s43, 0x3f803f80
    s_mov_b32 s44, 0x3d372713
    s_waitcnt vmcnt(12)
    s_barrier
    s_mov_b32 s40, 524288
    s_mov_b32 s41, 458752
    s_lshl_b32 s42, s30, 12
    s_add_u32 m0, s42, 98304
    s_nop 0
    buffer_load_dwordx4 v9, s[8:11], s40 offen lds
    s_add_u32 m0, s42, 114688
    s_nop 0
    buffer_load_dwordx4 v13, s[12:15], s41 offen lds
    s_add_u32 m0, s42, 131072
    s_nop 0
    buffer_load_dwordx4 v13, s[16:19], s41 offen lds
    s_add_u32 m0, s42, 99328
    s_nop 0
    buffer_load_dwordx4 v10, s[8:11], s40 offen lds
    s_add_u32 m0, s42, 115712
    s_nop 0
    buffer_load_dwordx4 v14, s[12:15], s41 offen lds
    s_add_u32 m0, s42, 132096
    s_nop 0
    buffer_load_dwordx4 v14, s[16:19], s41 offen lds
    s_add_u32 m0, s42, 100352
    s_nop 0
    buffer_load_dwordx4 v11, s[8:11], s40 offen lds
    s_add_u32 m0, s42, 116736
    s_nop 0
    buffer_load_dwordx4 v15, s[12:15], s41 offen lds
    s_add_u32 m0, s42, 133120
    s_nop 0
    buffer_load_dwordx4 v15, s[16:19], s41 offen lds
    s_add_u32 m0, s42, 101376
    s_nop 0
    buffer_load_dwordx4 v12, s[8:11], s40 offen lds
    s_add_u32 m0, s42, 117760
    s_nop 0
    buffer_load_dwordx4 v16, s[12:15], s41 offen lds
    s_add_u32 m0, s42, 134144
    s_nop 0
    buffer_load_dwordx4 v16, s[16:19], s41 offen lds
    ds_read_b64_tr_b16 v[28:29], v1 offset:0
    ds_read_b64_tr_b16 v[30:31], v1 offset:1024
    ds_read_b64_tr_b16 v[32:33], v2 offset:0
    ds_read_b64_tr_b16 v[34:35], v2 offset:1024
    ds_read_b64_tr_b16 v[36:37], v3 offset:0
    ds_read_b64_tr_b16 v[38:39], v3 offset:1024
    ds_read_b64_tr_b16 v[40:41], v4 offset:0
    ds_read_b64_tr_b16 v[42:43], v4 offset:1024
    ds_read_b64_tr_b16 v[44:45], v5 offset:0
    ds_read_b64_tr_b16 v[46:47], v5 offset:1024
    ds_read_b64_tr_b16 v[48:49], v6 offset:0
    ds_read_b64_tr_b16 v[50:51], v6 offset:1024
    ds_read_b64_tr_b16 v[52:53], v7 offset:0
    ds_read_b64_tr_b16 v[54:55], v7 offset:1024
    ds_read_b64_tr_b16 v[56:57], v8 offset:0
    ds_read_b64_tr_b16 v[58:59], v8 offset:1024
    ds_read_b64_tr_b16 v[60:61], v5 offset:16384
    ds_read_b64_tr_b16 v[62:63], v5 offset:17408
    ds_read_b64_tr_b16 v[64:65], v6 offset:16384
    ds_read_b64_tr_b16 v[66:67], v6 offset:17408
    ds_read_b64_tr_b16 v[68:69], v7 offset:16384
    ds_read_b64_tr_b16 v[70:71], v7 offset:17408
    ds_read_b64_tr_b16 v[72:73], v8 offset:16384
    ds_read_b64_tr_b16 v[74:75], v8 offset:17408
    s_waitcnt lgkmcnt(0)
    ds_read_b64_tr_b16 v[76:77], v1 offset:8192
    ds_read_b64_tr_b16 v[78:79], v1 offset:9216
    ds_read_b64_tr_b16 v[80:81], v2 offset:8192
    ds_read_b64_tr_b16 v[82:83], v2 offset:9216
    ds_read_b64_tr_b16 v[84:85], v3 offset:8192
    ds_read_b64_tr_b16 v[86:87], v3 offset:9216
    ds_read_b64_tr_b16 v[88:89], v4 offset:8192
    ds_read_b64_tr_b16 v[90:91], v4 offset:9216
    ds_read_b64_tr_b16 v[92:93], v5 offset:8192
    ds_read_b64_tr_b16 v[94:95], v5 offset:9216
    ds_read_b64_tr_b16 v[96:97], v6 offset:8192
    ds_read_b64_tr_b16 v[98:99], v6 offset:9216
    ds_read_b64_tr_b16 v[100:101], v7 offset:8192
    ds_read_b64_tr_b16 v[102:103], v7 offset:9216
    ds_read_b64_tr_b16 v[104:105], v8 offset:8192
    ds_read_b64_tr_b16 v[106:107], v8 offset:9216
    ds_read_b64_tr_b16 v[108:109], v5 offset:24576
    ds_read_b64_tr_b16 v[110:111], v5 offset:25600
    ds_read_b64_tr_b16 v[112:113], v6 offset:24576
    ds_read_b64_tr_b16 v[114:115], v6 offset:25600
    ds_read_b64_tr_b16 v[116:117], v7 offset:24576
    ds_read_b64_tr_b16 v[118:119], v7 offset:25600
    ds_read_b64_tr_b16 v[120:121], v8 offset:24576
    ds_read_b64_tr_b16 v[122:123], v8 offset:25600
    v_mfma_f32_16x16x32_bf16 v[128:131], v[28:31], v[44:47], v[128:131]
    v_mfma_f32_16x16x32_bf16 v[132:135], v[28:31], v[48:51], v[132:135]
    v_mfma_f32_16x16x32_bf16 v[136:139], v[28:31], v[52:55], v[136:139]
    v_mfma_f32_16x16x32_bf16 v[140:143], v[28:31], v[56:59], v[140:143]
    v_mfma_f32_16x16x32_bf16 v[144:147], v[28:31], v[60:63], v[144:147]
    v_mfma_f32_16x16x32_bf16 v[148:151], v[28:31], v[64:67], v[148:151]
    v_mfma_f32_16x16x32_bf16 v[152:155], v[28:31], v[68:71], v[152:155]
    v_mfma_f32_16x16x32_bf16 v[156:159], v[28:31], v[72:75], v[156:159]
    v_dot2_f32_bf16 v17, v28, s43, v17
    v_dot2_f32_bf16 v21, v28, v28, v21
    v_dot2_f32_bf16 v17, v29, s43, v17
    v_dot2_f32_bf16 v21, v29, v29, v21
    v_dot2_f32_bf16 v17, v30, s43, v17
    v_dot2_f32_bf16 v21, v30, v30, v21
    v_dot2_f32_bf16 v17, v31, s43, v17
    v_dot2_f32_bf16 v21, v31, v31, v21
    v_mfma_f32_16x16x32_bf16 v[160:163], v[32:35], v[44:47], v[160:163]
    v_mfma_f32_16x16x32_bf16 v[164:167], v[32:35], v[48:51], v[164:167]
    v_mfma_f32_16x16x32_bf16 v[168:171], v[32:35], v[52:55], v[168:171]
    v_mfma_f32_16x16x32_bf16 v[172:175], v[32:35], v[56:59], v[172:175]
    v_mfma_f32_16x16x32_bf16 v[176:179], v[32:35], v[60:63], v[176:179]
    v_mfma_f32_16x16x32_bf16 v[180:183], v[32:35], v[64:67], v[180:183]
    v_mfma_f32_16x16x32_bf16 v[184:187], v[32:35], v[68:71], v[184:187]
    v_mfma_f32_16x16x32_bf16 v[188:191], v[32:35], v[72:75], v[188:191]
    v_dot2_f32_bf16 v18, v32, s43, v18
    v_dot2_f32_bf16 v22, v32, v32, v22
    v_dot2_f32_bf16 v18, v33, s43, v18
    v_dot2_f32_bf16 v22, v33, v33, v22
    v_dot2_f32_bf16 v18, v34, s43, v18
    v_dot2_f32_bf16 v22, v34, v34, v22
    v_dot2_f32_bf16 v18, v35, s43, v18
    v_dot2_f32_bf16 v22, v35, v35, v22
    v_mfma_f32_16x16x32_bf16 v[192:195], v[36:39], v[44:47], v[192:195]
    v_mfma_f32_16x16x32_bf16 v[196:199], v[36:39], v[48:51], v[196:199]
    v_mfma_f32_16x16x32_bf16 v[200:203], v[36:39], v[52:55], v[200:203]
    v_mfma_f32_16x16x32_bf16 v[204:207], v[36:39], v[56:59], v[204:207]
    v_mfma_f32_16x16x32_bf16 v[208:211], v[36:39], v[60:63], v[208:211]
    v_mfma_f32_16x16x32_bf16 v[212:215], v[36:39], v[64:67], v[212:215]
    v_mfma_f32_16x16x32_bf16 v[216:219], v[36:39], v[68:71], v[216:219]
    v_mfma_f32_16x16x32_bf16 v[220:223], v[36:39], v[72:75], v[220:223]
    v_dot2_f32_bf16 v19, v36, s43, v19
    v_dot2_f32_bf16 v23, v36, v36, v23
    v_dot2_f32_bf16 v19, v37, s43, v19
    v_dot2_f32_bf16 v23, v37, v37, v23
    v_dot2_f32_bf16 v19, v38, s43, v19
    v_dot2_f32_bf16 v23, v38, v38, v23
    v_dot2_f32_bf16 v19, v39, s43, v19
    v_dot2_f32_bf16 v23, v39, v39, v23
    v_mfma_f32_16x16x32_bf16 v[224:227], v[40:43], v[44:47], v[224:227]
    v_mfma_f32_16x16x32_bf16 v[228:231], v[40:43], v[48:51], v[228:231]
    v_mfma_f32_16x16x32_bf16 v[232:235], v[40:43], v[52:55], v[232:235]
    v_mfma_f32_16x16x32_bf16 v[236:239], v[40:43], v[56:59], v[236:239]
    v_mfma_f32_16x16x32_bf16 v[240:243], v[40:43], v[60:63], v[240:243]
    v_mfma_f32_16x16x32_bf16 v[244:247], v[40:43], v[64:67], v[244:247]
    v_mfma_f32_16x16x32_bf16 v[248:251], v[40:43], v[68:71], v[248:251]
    v_mfma_f32_16x16x32_bf16 v[252:255], v[40:43], v[72:75], v[252:255]
    v_dot2_f32_bf16 v20, v40, s43, v20
    v_dot2_f32_bf16 v24, v40, v40, v24
    v_dot2_f32_bf16 v20, v41, s43, v20
    v_dot2_f32_bf16 v24, v41, v41, v24
    v_dot2_f32_bf16 v20, v42, s43, v20
    v_dot2_f32_bf16 v24, v42, v42, v24
    v_dot2_f32_bf16 v20, v43, s43, v20
    v_dot2_f32_bf16 v24, v43, v43, v24
    s_waitcnt lgkmcnt(0)
    v_mfma_f32_16x16x32_bf16 v[128:131], v[76:79], v[92:95], v[128:131]
    v_mfma_f32_16x16x32_bf16 v[132:135], v[76:79], v[96:99], v[132:135]
    v_mfma_f32_16x16x32_bf16 v[136:139], v[76:79], v[100:103], v[136:139]
    v_mfma_f32_16x16x32_bf16 v[140:143], v[76:79], v[104:107], v[140:143]
    v_mfma_f32_16x16x32_bf16 v[144:147], v[76:79], v[108:111], v[144:147]
    v_mfma_f32_16x16x32_bf16 v[148:151], v[76:79], v[112:115], v[148:151]
    v_mfma_f32_16x16x32_bf16 v[152:155], v[76:79], v[116:119], v[152:155]
    v_mfma_f32_16x16x32_bf16 v[156:159], v[76:79], v[120:123], v[156:159]
    v_dot2_f32_bf16 v17, v76, s43, v17
    v_dot2_f32_bf16 v21, v76, v76, v21
    v_dot2_f32_bf16 v17, v77, s43, v17
    v_dot2_f32_bf16 v21, v77, v77, v21
    v_dot2_f32_bf16 v17, v78, s43, v17
    v_dot2_f32_bf16 v21, v78, v78, v21
    v_dot2_f32_bf16 v17, v79, s43, v17
    v_dot2_f32_bf16 v21, v79, v79, v21
    v_mfma_f32_16x16x32_bf16 v[160:163], v[80:83], v[92:95], v[160:163]
    v_mfma_f32_16x16x32_bf16 v[164:167], v[80:83], v[96:99], v[164:167]
    v_mfma_f32_16x16x32_bf16 v[168:171], v[80:83], v[100:103], v[168:171]
    v_mfma_f32_16x16x32_bf16 v[172:175], v[80:83], v[104:107], v[172:175]
    v_mfma_f32_16x16x32_bf16 v[176:179], v[80:83], v[108:111], v[176:179]
    v_mfma_f32_16x16x32_bf16 v[180:183], v[80:83], v[112:115], v[180:183]
    v_mfma_f32_16x16x32_bf16 v[184:187], v[80:83], v[116:119], v[184:187]
    v_mfma_f32_16x16x32_bf16 v[188:191], v[80:83], v[120:123], v[188:191]
    v_dot2_f32_bf16 v18, v80, s43, v18
    v_dot2_f32_bf16 v22, v80, v80, v22
    v_dot2_f32_bf16 v18, v81, s43, v18
    v_dot2_f32_bf16 v22, v81, v81, v22
    v_dot2_f32_bf16 v18, v82, s43, v18
    v_dot2_f32_bf16 v22, v82, v82, v22
    v_dot2_f32_bf16 v18, v83, s43, v18
    v_dot2_f32_bf16 v22, v83, v83, v22
    v_mfma_f32_16x16x32_bf16 v[192:195], v[84:87], v[92:95], v[192:195]
    v_mfma_f32_16x16x32_bf16 v[196:199], v[84:87], v[96:99], v[196:199]
    v_mfma_f32_16x16x32_bf16 v[200:203], v[84:87], v[100:103], v[200:203]
    v_mfma_f32_16x16x32_bf16 v[204:207], v[84:87], v[104:107], v[204:207]
    v_mfma_f32_16x16x32_bf16 v[208:211], v[84:87], v[108:111], v[208:211]
    v_mfma_f32_16x16x32_bf16 v[212:215], v[84:87], v[112:115], v[212:215]
    v_mfma_f32_16x16x32_bf16 v[216:219], v[84:87], v[116:119], v[216:219]
    v_mfma_f32_16x16x32_bf16 v[220:223], v[84:87], v[120:123], v[220:223]
    v_dot2_f32_bf16 v19, v84, s43, v19
    v_dot2_f32_bf16 v23, v84, v84, v23
    v_dot2_f32_bf16 v19, v85, s43, v19
    v_dot2_f32_bf16 v23, v85, v85, v23
    v_dot2_f32_bf16 v19, v86, s43, v19
    v_dot2_f32_bf16 v23, v86, v86, v23
    v_dot2_f32_bf16 v19, v87, s43, v19
    v_dot2_f32_bf16 v23, v87, v87, v23
    v_mfma_f32_16x16x32_bf16 v[224:227], v[88:91], v[92:95], v[224:227]
    v_mfma_f32_16x16x32_bf16 v[228:231], v[88:91], v[96:99], v[228:231]
    v_mfma_f32_16x16x32_bf16 v[232:235], v[88:91], v[100:103], v[232:235]
    v_mfma_f32_16x16x32_bf16 v[236:239], v[88:91], v[104:107], v[236:239]
    v_mfma_f32_16x16x32_bf16 v[240:243], v[88:91], v[108:111], v[240:243]
    v_mfma_f32_16x16x32_bf16 v[244:247], v[88:91], v[112:115], v[244:247]
    v_mfma_f32_16x16x32_bf16 v[248:251], v[88:91], v[116:119], v[248:251]
    v_mfma_f32_16x16x32_bf16 v[252:255], v[88:91], v[120:123], v[252:255]
    v_dot2_f32_bf16 v20, v88, s43, v20
    v_dot2_f32_bf16 v24, v88, v88, v24
    v_dot2_f32_bf16 v20, v89, s43, v20
    v_dot2_f32_bf16 v24, v89, v89, v24
    v_dot2_f32_bf16 v20, v90, s43, v20
    v_dot2_f32_bf16 v24, v90, v90, v24
    v_dot2_f32_bf16 v20, v91, s43, v20
    v_dot2_f32_bf16 v24, v91, v91, v24
    v_add_u32 v1, 49152, v1
    v_add_u32 v2, 49152, v2
    v_add_u32 v3, 49152, v3
    v_add_u32 v4, 49152, v4
    v_add_u32 v5, 49152, v5
    v_add_u32 v6, 49152, v6
    v_add_u32 v7, 49152, v7
    v_add_u32 v8, 49152, v8
    s_waitcnt vmcnt(12)
    s_barrier
    s_mov_b32 s40, 786432
    s_mov_b32 s41, 688128
    s_lshl_b32 s42, s30, 12
    s_add_u32 m0, s42, 0
    s_nop 0
    buffer_load_dwordx4 v9, s[8:11], s40 offen lds
    s_add_u32 m0, s42, 16384
    s_nop 0
    buffer_load_dwordx4 v13, s[12:15], s41 offen lds
    s_add_u32 m0, s42, 32768
    s_nop 0
    buffer_load_dwordx4 v13, s[16:19], s41 offen lds
    s_add_u32 m0, s42, 1024
    s_nop 0
    buffer_load_dwordx4 v10, s[8:11], s40 offen lds
    s_add_u32 m0, s42, 17408
    s_nop 0
    buffer_load_dwordx4 v14, s[12:15], s41 offen lds
    s_add_u32 m0, s42, 33792
    s_nop 0
    buffer_load_dwordx4 v14, s[16:19], s41 offen lds
    s_add_u32 m0, s42, 2048
    s_nop 0
    buffer_load_dwordx4 v11, s[8:11], s40 offen lds
    s_add_u32 m0, s42, 18432
    s_nop 0
    buffer_load_dwordx4 v15, s[12:15], s41 offen lds
    s_add_u32 m0, s42, 34816
    s_nop 0
    buffer_load_dwordx4 v15, s[16:19], s41 offen lds
    s_add_u32 m0, s42, 3072
    s_nop 0
    buffer_load_dwordx4 v12, s[8:11], s40 offen lds
    s_add_u32 m0, s42, 19456
    s_nop 0
    buffer_load_dwordx4 v16, s[12:15], s41 offen lds
    s_add_u32 m0, s42, 35840
    s_nop 0
    buffer_load_dwordx4 v16, s[16:19], s41 offen lds
    ds_read_b64_tr_b16 v[28:29], v1 offset:0
    ds_read_b64_tr_b16 v[30:31], v1 offset:1024
    ds_read_b64_tr_b16 v[32:33], v2 offset:0
    ds_read_b64_tr_b16 v[34:35], v2 offset:1024
    ds_read_b64_tr_b16 v[36:37], v3 offset:0
    ds_read_b64_tr_b16 v[38:39], v3 offset:1024
    ds_read_b64_tr_b16 v[40:41], v4 offset:0
    ds_read_b64_tr_b16 v[42:43], v4 offset:1024
    ds_read_b64_tr_b16 v[44:45], v5 offset:0
    ds_read_b64_tr_b16 v[46:47], v5 offset:1024
    ds_read_b64_tr_b16 v[48:49], v6 offset:0
    ds_read_b64_tr_b16 v[50:51], v6 offset:1024
    ds_read_b64_tr_b16 v[52:53], v7 offset:0
    ds_read_b64_tr_b16 v[54:55], v7 offset:1024
    ds_read_b64_tr_b16 v[56:57], v8 offset:0
    ds_read_b64_tr_b16 v[58:59], v8 offset:1024
    ds_read_b64_tr_b16 v[60:61], v5 offset:16384
    ds_read_b64_tr_b16 v[62:63], v5 offset:17408
    ds_read_b64_tr_b16 v[64:65], v6 offset:16384
    ds_read_b64_tr_b16 v[66:67], v6 offset:17408
    ds_read_b64_tr_b16 v[68:69], v7 offset:16384
    ds_read_b64_tr_b16 v[70:71], v7 offset:17408
    ds_read_b64_tr_b16 v[72:73], v8 offset:16384
    ds_read_b64_tr_b16 v[74:75], v8 offset:17408
    s_waitcnt lgkmcnt(0)
    ds_read_b64_tr_b16 v[76:77], v1 offset:8192
    ds_read_b64_tr_b16 v[78:79], v1 offset:9216
    ds_read_b64_tr_b16 v[80:81], v2 offset:8192
    ds_read_b64_tr_b16 v[82:83], v2 offset:9216
    ds_read_b64_tr_b16 v[84:85], v3 offset:8192
    ds_read_b64_tr_b16 v[86:87], v3 offset:9216
    ds_read_b64_tr_b16 v[88:89], v4 offset:8192
    ds_read_b64_tr_b16 v[90:91], v4 offset:9216
    ds_read_b64_tr_b16 v[92:93], v5 offset:8192
    ds_read_b64_tr_b16 v[94:95], v5 offset:9216
    ds_read_b64_tr_b16 v[96:97], v6 offset:8192
    ds_read_b64_tr_b16 v[98:99], v6 offset:9216
    ds_read_b64_tr_b16 v[100:101], v7 offset:8192
    ds_read_b64_tr_b16 v[102:103], v7 offset:9216
    ds_read_b64_tr_b16 v[104:105], v8 offset:8192
    ds_read_b64_tr_b16 v[106:107], v8 offset:9216
    ds_read_b64_tr_b16 v[108:109], v5 offset:24576
    ds_read_b64_tr_b16 v[110:111], v5 offset:25600
    ds_read_b64_tr_b16 v[112:113], v6 offset:24576
    ds_read_b64_tr_b16 v[114:115], v6 offset:25600
    ds_read_b64_tr_b16 v[116:117], v7 offset:24576
    ds_read_b64_tr_b16 v[118:119], v7 offset:25600
    ds_read_b64_tr_b16 v[120:121], v8 offset:24576
    ds_read_b64_tr_b16 v[122:123], v8 offset:25600
    v_mfma_f32_16x16x32_bf16 v[128:131], v[28:31], v[44:47], v[128:131]
    v_mfma_f32_16x16x32_bf16 v[132:135], v[28:31], v[48:51], v[132:135]
    v_mfma_f32_16x16x32_bf16 v[136:139], v[28:31], v[52:55], v[136:139]
    v_mfma_f32_16x16x32_bf16 v[140:143], v[28:31], v[56:59], v[140:143]
    v_mfma_f32_16x16x32_bf16 v[144:147], v[28:31], v[60:63], v[144:147]
    v_mfma_f32_16x16x32_bf16 v[148:151], v[28:31], v[64:67], v[148:151]
    v_mfma_f32_16x16x32_bf16 v[152:155], v[28:31], v[68:71], v[152:155]
    v_mfma_f32_16x16x32_bf16 v[156:159], v[28:31], v[72:75], v[156:159]
    v_dot2_f32_bf16 v17, v28, s43, v17
    v_dot2_f32_bf16 v21, v28, v28, v21
    v_dot2_f32_bf16 v17, v29, s43, v17
    v_dot2_f32_bf16 v21, v29, v29, v21
    v_dot2_f32_bf16 v17, v30, s43, v17
    v_dot2_f32_bf16 v21, v30, v30, v21
    v_dot2_f32_bf16 v17, v31, s43, v17
    v_dot2_f32_bf16 v21, v31, v31, v21
    v_mfma_f32_16x16x32_bf16 v[160:163], v[32:35], v[44:47], v[160:163]
    v_mfma_f32_16x16x32_bf16 v[164:167], v[32:35], v[48:51], v[164:167]
    v_mfma_f32_16x16x32_bf16 v[168:171], v[32:35], v[52:55], v[168:171]
    v_mfma_f32_16x16x32_bf16 v[172:175], v[32:35], v[56:59], v[172:175]
    v_mfma_f32_16x16x32_bf16 v[176:179], v[32:35], v[60:63], v[176:179]
    v_mfma_f32_16x16x32_bf16 v[180:183], v[32:35], v[64:67], v[180:183]
    v_mfma_f32_16x16x32_bf16 v[184:187], v[32:35], v[68:71], v[184:187]
    v_mfma_f32_16x16x32_bf16 v[188:191], v[32:35], v[72:75], v[188:191]
    v_dot2_f32_bf16 v18, v32, s43, v18
    v_dot2_f32_bf16 v22, v32, v32, v22
    v_dot2_f32_bf16 v18, v33, s43, v18
    v_dot2_f32_bf16 v22, v33, v33, v22
    v_dot2_f32_bf16 v18, v34, s43, v18
    v_dot2_f32_bf16 v22, v34, v34, v22
    v_dot2_f32_bf16 v18, v35, s43, v18
    v_dot2_f32_bf16 v22, v35, v35, v22
    v_mfma_f32_16x16x32_bf16 v[192:195], v[36:39], v[44:47], v[192:195]
    v_mfma_f32_16x16x32_bf16 v[196:199], v[36:39], v[48:51], v[196:199]
    v_mfma_f32_16x16x32_bf16 v[200:203], v[36:39], v[52:55], v[200:203]
    v_mfma_f32_16x16x32_bf16 v[204:207], v[36:39], v[56:59], v[204:207]
    v_mfma_f32_16x16x32_bf16 v[208:211], v[36:39], v[60:63], v[208:211]
    v_mfma_f32_16x16x32_bf16 v[212:215], v[36:39], v[64:67], v[212:215]
    v_mfma_f32_16x16x32_bf16 v[216:219], v[36:39], v[68:71], v[216:219]
    v_mfma_f32_16x16x32_bf16 v[220:223], v[36:39], v[72:75], v[220:223]
    v_dot2_f32_bf16 v19, v36, s43, v19
    v_dot2_f32_bf16 v23, v36, v36, v23
    v_dot2_f32_bf16 v19, v37, s43, v19
    v_dot2_f32_bf16 v23, v37, v37, v23
    v_dot2_f32_bf16 v19, v38, s43, v19
    v_dot2_f32_bf16 v23, v38, v38, v23
    v_dot2_f32_bf16 v19, v39, s43, v19
    v_dot2_f32_bf16 v23, v39, v39, v23
    v_mfma_f32_16x16x32_bf16 v[224:227], v[40:43], v[44:47], v[224:227]
    v_mfma_f32_16x16x32_bf16 v[228:231], v[40:43], v[48:51], v[228:231]
    v_mfma_f32_16x16x32_bf16 v[232:235], v[40:43], v[52:55], v[232:235]
    v_mfma_f32_16x16x32_bf16 v[236:239], v[40:43], v[56:59], v[236:239]
    v_mfma_f32_16x16x32_bf16 v[240:243], v[40:43], v[60:63], v[240:243]
    v_mfma_f32_16x16x32_bf16 v[244:247], v[40:43], v[64:67], v[244:247]
    v_mfma_f32_16x16x32_bf16 v[248:251], v[40:43], v[68:71], v[248:251]
    v_mfma_f32_16x16x32_bf16 v[252:255], v[40:43], v[72:75], v[252:255]
    v_dot2_f32_bf16 v20, v40, s43, v20
    v_dot2_f32_bf16 v24, v40, v40, v24
    v_dot2_f32_bf16 v20, v41, s43, v20
    v_dot2_f32_bf16 v24, v41, v41, v24
    v_dot2_f32_bf16 v20, v42, s43, v20
    v_dot2_f32_bf16 v24, v42, v42, v24
    v_dot2_f32_bf16 v20, v43, s43, v20
    v_dot2_f32_bf16 v24, v43, v43, v24
    s_waitcnt lgkmcnt(0)
    v_mfma_f32_16x16x32_bf16 v[128:131], v[76:79], v[92:95], v[128:131]
    v_mfma_f32_16x16x32_bf16 v[132:135], v[76:79], v[96:99], v[132:135]
    v_mfma_f32_16x16x32_bf16 v[136:139], v[76:79], v[100:103], v[136:139]
    v_mfma_f32_16x16x32_bf16 v[140:143], v[76:79], v[104:107], v[140:143]
    v_mfma_f32_16x16x32_bf16 v[144:147], v[76:79], v[108:111], v[144:147]
    v_mfma_f32_16x16x32_bf16 v[148:151], v[76:79], v[112:115], v[148:151]
    v_mfma_f32_16x16x32_bf16 v[152:155], v[76:79], v[116:119], v[152:155]
    v_mfma_f32_16x16x32_bf16 v[156:159], v[76:79], v[120:123], v[156:159]
    v_dot2_f32_bf16 v17, v76, s43, v17
    v_dot2_f32_bf16 v21, v76, v76, v21
    v_dot2_f32_bf16 v17, v77, s43, v17
    v_dot2_f32_bf16 v21, v77, v77, v21
    v_dot2_f32_bf16 v17, v78, s43, v17
    v_dot2_f32_bf16 v21, v78, v78, v21
    v_dot2_f32_bf16 v17, v79, s43, v17
    v_dot2_f32_bf16 v21, v79, v79, v21
    v_mfma_f32_16x16x32_bf16 v[160:163], v[80:83], v[92:95], v[160:163]
    v_mfma_f32_16x16x32_bf16 v[164:167], v[80:83], v[96:99], v[164:167]
    v_mfma_f32_16x16x32_bf16 v[168:171], v[80:83], v[100:103], v[168:171]
    v_mfma_f32_16x16x32_bf16 v[172:175], v[80:83], v[104:107], v[172:175]
    v_mfma_f32_16x16x32_bf16 v[176:179], v[80:83], v[108:111], v[176:179]
    v_mfma_f32_16x16x32_bf16 v[180:183], v[80:83], v[112:115], v[180:183]
    v_mfma_f32_16x16x32_bf16 v[184:187], v[80:83], v[116:119], v[184:187]
    v_mfma_f32_16x16x32_bf16 v[188:191], v[80:83], v[120:123], v[188:191]
    v_dot2_f32_bf16 v18, v80, s43, v18
    v_dot2_f32_bf16 v22, v80, v80, v22
    v_dot2_f32_bf16 v18, v81, s43, v18
    v_dot2_f32_bf16 v22, v81, v81, v22
    v_dot2_f32_bf16 v18, v82, s43, v18
    v_dot2_f32_bf16 v22, v82, v82, v22
    v_dot2_f32_bf16 v18, v83, s43, v18
    v_dot2_f32_bf16 v22, v83, v83, v22
    v_mfma_f32_16x16x32_bf16 v[192:195], v[84:87], v[92:95], v[192:195]
    v_mfma_f32_16x16x32_bf16 v[196:199], v[84:87], v[96:99], v[196:199]
    v_mfma_f32_16x16x32_bf16 v[200:203], v[84:87], v[100:103], v[200:203]
    v_mfma_f32_16x16x32_bf16 v[204:207], v[84:87], v[104:107], v[204:207]
    v_mfma_f32_16x16x32_bf16 v[208:211], v[84:87], v[108:111], v[208:211]
    v_mfma_f32_16x16x32_bf16 v[212:215], v[84:87], v[112:115], v[212:215]
    v_mfma_f32_16x16x32_bf16 v[216:219], v[84:87], v[116:119], v[216:219]
    v_mfma_f32_16x16x32_bf16 v[220:223], v[84:87], v[120:123], v[220:223]
    v_dot2_f32_bf16 v19, v84, s43, v19
    v_dot2_f32_bf16 v23, v84, v84, v23
    v_dot2_f32_bf16 v19, v85, s43, v19
    v_dot2_f32_bf16 v23, v85, v85, v23
    v_dot2_f32_bf16 v19, v86, s43, v19
    v_dot2_f32_bf16 v23, v86, v86, v23
    v_dot2_f32_bf16 v19, v87, s43, v19
    v_dot2_f32_bf16 v23, v87, v87, v23
    v_mfma_f32_16x16x32_bf16 v[224:227], v[88:91], v[92:95], v[224:227]
    v_mfma_f32_16x16x32_bf16 v[228:231], v[88:91], v[96:99], v[228:231]
    v_mfma_f32_16x16x32_bf16 v[232:235], v[88:91], v[100:103], v[232:235]
    v_mfma_f32_16x16x32_bf16 v[236:239], v[88:91], v[104:107], v[236:239]
    v_mfma_f32_16x16x32_bf16 v[240:243], v[88:91], v[108:111], v[240:243]
    v_mfma_f32_16x16x32_bf16 v[244:247], v[88:91], v[112:115], v[244:247]
    v_mfma_f32_16x16x32_bf16 v[248:251], v[88:91], v[116:119], v[248:251]
    v_mfma_f32_16x16x32_bf16 v[252:255], v[88:91], v[120:123], v[252:255]
    v_dot2_f32_bf16 v20, v88, s43, v20
    v_dot2_f32_bf16 v24, v88, v88, v24
    v_dot2_f32_bf16 v20, v89, s43, v20
    v_dot2_f32_bf16 v24, v89, v89, v24
    v_dot2_f32_bf16 v20, v90, s43, v20
    v_dot2_f32_bf16 v24, v90, v90, v24
    v_dot2_f32_bf16 v20, v91, s43, v20
    v_dot2_f32_bf16 v24, v91, v91, v24
    v_add_u32 v1, 49152, v1
    v_add_u32 v2, 49152, v2
    v_add_u32 v3, 49152, v3
    v_add_u32 v4, 49152, v4
    v_add_u32 v5, 49152, v5
    v_add_u32 v6, 49152, v6
    v_add_u32 v7, 49152, v7
    v_add_u32 v8, 49152, v8
    s_waitcnt vmcnt(12)
    s_barrier
    s_mov_b32 s40, 1048576
    s_mov_b32 s41, 917504
    s_lshl_b32 s42, s30, 12
    s_add_u32 m0, s42, 49152
    s_nop 0
    buffer_load_dwordx4 v9, s[8:11], s40 offen lds
    s_add_u32 m0, s42, 65536
    s_nop 0
    buffer_load_dwordx4 v13, s[12:15], s41 offen lds
    s_add_u32 m0, s42, 81920
    s_nop 0
    buffer_load_dwordx4 v13, s[16:19], s41 offen lds
    s_add_u32 m0, s42, 50176
    s_nop 0
    buffer_load_dwordx4 v10, s[8:11], s40 offen lds
    s_add_u32 m0, s42, 66560
    s_nop 0
    buffer_load_dwordx4 v14, s[12:15], s41 offen lds
    s_add_u32 m0, s42, 82944
    s_nop 0
    buffer_load_dwordx4 v14, s[16:19], s41 offen lds
    s_add_u32 m0, s42, 51200
    s_nop 0
    buffer_load_dwordx4 v11, s[8:11], s40 offen lds
    s_add_u32 m0, s42, 67584
    s_nop 0
    buffer_load_dwordx4 v15, s[12:15], s41 offen lds
    s_add_u32 m0, s42, 83968
    s_nop 0
    buffer_load_dwordx4 v15, s[16:19], s41 offen lds
    s_add_u32 m0, s42, 52224
    s_nop 0
    buffer_load_dwordx4 v12, s[8:11], s40 offen lds
    s_add_u32 m0, s42, 68608
    s_nop 0
    buffer_load_dwordx4 v16, s[12:15], s41 offen lds
    s_add_u32 m0, s42, 84992
    s_nop 0
    buffer_load_dwordx4 v16, s[16:19], s41 offen lds
    ds_read_b64_tr_b16 v[28:29], v1 offset:0
    ds_read_b64_tr_b16 v[30:31], v1 offset:1024
    ds_read_b64_tr_b16 v[32:33], v2 offset:0
    ds_read_b64_tr_b16 v[34:35], v2 offset:1024
    ds_read_b64_tr_b16 v[36:37], v3 offset:0
    ds_read_b64_tr_b16 v[38:39], v3 offset:1024
    ds_read_b64_tr_b16 v[40:41], v4 offset:0
    ds_read_b64_tr_b16 v[42:43], v4 offset:1024
    ds_read_b64_tr_b16 v[44:45], v5 offset:0
    ds_read_b64_tr_b16 v[46:47], v5 offset:1024
    ds_read_b64_tr_b16 v[48:49], v6 offset:0
    ds_read_b64_tr_b16 v[50:51], v6 offset:1024
    ds_read_b64_tr_b16 v[52:53], v7 offset:0
    ds_read_b64_tr_b16 v[54:55], v7 offset:1024
    ds_read_b64_tr_b16 v[56:57], v8 offset:0
    ds_read_b64_tr_b16 v[58:59], v8 offset:1024
    ds_read_b64_tr_b16 v[60:61], v5 offset:16384
    ds_read_b64_tr_b16 v[62:63], v5 offset:17408
    ds_read_b64_tr_b16 v[64:65], v6 offset:16384
    ds_read_b64_tr_b16 v[66:67], v6 offset:17408
    ds_read_b64_tr_b16 v[68:69], v7 offset:16384
    ds_read_b64_tr_b16 v[70:71], v7 offset:17408
    ds_read_b64_tr_b16 v[72:73], v8 offset:16384
    ds_read_b64_tr_b16 v[74:75], v8 offset:17408
    s_waitcnt lgkmcnt(0)
    ds_read_b64_tr_b16 v[76:77], v1 offset:8192
    ds_read_b64_tr_b16 v[78:79], v1 offset:9216
    ds_read_b64_tr_b16 v[80:81], v2 offset:8192
    ds_read_b64_tr_b16 v[82:83], v2 offset:9216
    ds_read_b64_tr_b16 v[84:85], v3 offset:8192
    ds_read_b64_tr_b16 v[86:87], v3 offset:9216
    ds_read_b64_tr_b16 v[88:89], v4 offset:8192
    ds_read_b64_tr_b16 v[90:91], v4 offset:9216
    ds_read_b64_tr_b16 v[92:93], v5 offset:8192
    ds_read_b64_tr_b16 v[94:95], v5 offset:9216
    ds_read_b64_tr_b16 v[96:97], v6 offset:8192
    ds_read_b64_tr_b16 v[98:99], v6 offset:9216
    ds_read_b64_tr_b16 v[100:101], v7 offset:8192
    ds_read_b64_tr_b16 v[102:103], v7 offset:9216
    ds_read_b64_tr_b16 v[104:105], v8 offset:8192
    ds_read_b64_tr_b16 v[106:107], v8 offset:9216
    ds_read_b64_tr_b16 v[108:109], v5 offset:24576
    ds_read_b64_tr_b16 v[110:111], v5 offset:25600
    ds_read_b64_tr_b16 v[112:113], v6 offset:24576
    ds_read_b64_tr_b16 v[114:115], v6 offset:25600
    ds_read_b64_tr_b16 v[116:117], v7 offset:24576
    ds_read_b64_tr_b16 v[118:119], v7 offset:25600
    ds_read_b64_tr_b16 v[120:121], v8 offset:24576
    ds_read_b64_tr_b16 v[122:123], v8 offset:25600
    v_mfma_f32_16x16x32_bf16 v[128:131], v[28:31], v[44:47], v[128:131]
    v_mfma_f32_16x16x32_bf16 v[132:135], v[28:31], v[48:51], v[132:135]
    v_mfma_f32_16x16x32_bf16 v[136:139], v[28:31], v[52:55], v[136:139]
    v_mfma_f32_16x16x32_bf16 v[140:143], v[28:31], v[56:59], v[140:143]
    v_mfma_f32_16x16x32_bf16 v[144:147], v[28:31], v[60:63], v[144:147]
    v_mfma_f32_16x16x32_bf16 v[148:151], v[28:31], v[64:67], v[148:151]
    v_mfma_f32_16x16x32_bf16 v[152:155], v[28:31], v[68:71], v[152:155]
    v_mfma_f32_16x16x32_bf16 v[156:159], v[28:31], v[72:75], v[156:159]
    v_dot2_f32_bf16 v17, v28, s43, v17
    v_dot2_f32_bf16 v21, v28, v28, v21
    v_dot2_f32_bf16 v17, v29, s43, v17
    v_dot2_f32_bf16 v21, v29, v29, v21
    v_dot2_f32_bf16 v17, v30, s43, v17
    v_dot2_f32_bf16 v21, v30, v30, v21
    v_dot2_f32_bf16 v17, v31, s43, v17
    v_dot2_f32_bf16 v21, v31, v31, v21
    v_mfma_f32_16x16x32_bf16 v[160:163], v[32:35], v[44:47], v[160:163]
    v_mfma_f32_16x16x32_bf16 v[164:167], v[32:35], v[48:51], v[164:167]
    v_mfma_f32_16x16x32_bf16 v[168:171], v[32:35], v[52:55], v[168:171]
    v_mfma_f32_16x16x32_bf16 v[172:175], v[32:35], v[56:59], v[172:175]
    v_mfma_f32_16x16x32_bf16 v[176:179], v[32:35], v[60:63], v[176:179]
    v_mfma_f32_16x16x32_bf16 v[180:183], v[32:35], v[64:67], v[180:183]
    v_mfma_f32_16x16x32_bf16 v[184:187], v[32:35], v[68:71], v[184:187]
    v_mfma_f32_16x16x32_bf16 v[188:191], v[32:35], v[72:75], v[188:191]
    v_dot2_f32_bf16 v18, v32, s43, v18
    v_dot2_f32_bf16 v22, v32, v32, v22
    v_dot2_f32_bf16 v18, v33, s43, v18
    v_dot2_f32_bf16 v22, v33, v33, v22
    v_dot2_f32_bf16 v18, v34, s43, v18
    v_dot2_f32_bf16 v22, v34, v34, v22
    v_dot2_f32_bf16 v18, v35, s43, v18
    v_dot2_f32_bf16 v22, v35, v35, v22
    v_mfma_f32_16x16x32_bf16 v[192:195], v[36:39], v[44:47], v[192:195]
    v_mfma_f32_16x16x32_bf16 v[196:199], v[36:39], v[48:51], v[196:199]
    v_mfma_f32_16x16x32_bf16 v[200:203], v[36:39], v[52:55], v[200:203]
    v_mfma_f32_16x16x32_bf16 v[204:207], v[36:39], v[56:59], v[204:207]
    v_mfma_f32_16x16x32_bf16 v[208:211], v[36:39], v[60:63], v[208:211]
    v_mfma_f32_16x16x32_bf16 v[212:215], v[36:39], v[64:67], v[212:215]
    v_mfma_f32_16x16x32_bf16 v[216:219], v[36:39], v[68:71], v[216:219]
    v_mfma_f32_16x16x32_bf16 v[220:223], v[36:39], v[72:75], v[220:223]
    v_dot2_f32_bf16 v19, v36, s43, v19
    v_dot2_f32_bf16 v23, v36, v36, v23
    v_dot2_f32_bf16 v19, v37, s43, v19
    v_dot2_f32_bf16 v23, v37, v37, v23
    v_dot2_f32_bf16 v19, v38, s43, v19
    v_dot2_f32_bf16 v23, v38, v38, v23
    v_dot2_f32_bf16 v19, v39, s43, v19
    v_dot2_f32_bf16 v23, v39, v39, v23
    v_mfma_f32_16x16x32_bf16 v[224:227], v[40:43], v[44:47], v[224:227]
    v_mfma_f32_16x16x32_bf16 v[228:231], v[40:43], v[48:51], v[228:231]
    v_mfma_f32_16x16x32_bf16 v[232:235], v[40:43], v[52:55], v[232:235]
    v_mfma_f32_16x16x32_bf16 v[236:239], v[40:43], v[56:59], v[236:239]
    v_mfma_f32_16x16x32_bf16 v[240:243], v[40:43], v[60:63], v[240:243]
    v_mfma_f32_16x16x32_bf16 v[244:247], v[40:43], v[64:67], v[244:247]
    v_mfma_f32_16x16x32_bf16 v[248:251], v[40:43], v[68:71], v[248:251]
    v_mfma_f32_16x16x32_bf16 v[252:255], v[40:43], v[72:75], v[252:255]
    v_dot2_f32_bf16 v20, v40, s43, v20
    v_dot2_f32_bf16 v24, v40, v40, v24
    v_dot2_f32_bf16 v20, v41, s43, v20
    v_dot2_f32_bf16 v24, v41, v41, v24
    v_dot2_f32_bf16 v20, v42, s43, v20
    v_dot2_f32_bf16 v24, v42, v42, v24
    v_dot2_f32_bf16 v20, v43, s43, v20
    v_dot2_f32_bf16 v24, v43, v43, v24
    s_waitcnt lgkmcnt(0)
    v_mfma_f32_16x16x32_bf16 v[128:131], v[76:79], v[92:95], v[128:131]
    v_mfma_f32_16x16x32_bf16 v[132:135], v[76:79], v[96:99], v[132:135]
    v_mfma_f32_16x16x32_bf16 v[136:139], v[76:79], v[100:103], v[136:139]
    v_mfma_f32_16x16x32_bf16 v[140:143], v[76:79], v[104:107], v[140:143]
    v_mfma_f32_16x16x32_bf16 v[144:147], v[76:79], v[108:111], v[144:147]
    v_mfma_f32_16x16x32_bf16 v[148:151], v[76:79], v[112:115], v[148:151]
    v_mfma_f32_16x16x32_bf16 v[152:155], v[76:79], v[116:119], v[152:155]
    v_mfma_f32_16x16x32_bf16 v[156:159], v[76:79], v[120:123], v[156:159]
    v_dot2_f32_bf16 v17, v76, s43, v17
    v_dot2_f32_bf16 v21, v76, v76, v21
    v_dot2_f32_bf16 v17, v77, s43, v17
    v_dot2_f32_bf16 v21, v77, v77, v21
    v_dot2_f32_bf16 v17, v78, s43, v17
    v_dot2_f32_bf16 v21, v78, v78, v21
    v_dot2_f32_bf16 v17, v79, s43, v17
    v_dot2_f32_bf16 v21, v79, v79, v21
    v_mfma_f32_16x16x32_bf16 v[160:163], v[80:83], v[92:95], v[160:163]
    v_mfma_f32_16x16x32_bf16 v[164:167], v[80:83], v[96:99], v[164:167]
    v_mfma_f32_16x16x32_bf16 v[168:171], v[80:83], v[100:103], v[168:171]
    v_mfma_f32_16x16x32_bf16 v[172:175], v[80:83], v[104:107], v[172:175]
    v_mfma_f32_16x16x32_bf16 v[176:179], v[80:83], v[108:111], v[176:179]
    v_mfma_f32_16x16x32_bf16 v[180:183], v[80:83], v[112:115], v[180:183]
    v_mfma_f32_16x16x32_bf16 v[184:187], v[80:83], v[116:119], v[184:187]
    v_mfma_f32_16x16x32_bf16 v[188:191], v[80:83], v[120:123], v[188:191]
    v_dot2_f32_bf16 v18, v80, s43, v18
    v_dot2_f32_bf16 v22, v80, v80, v22
    v_dot2_f32_bf16 v18, v81, s43, v18
    v_dot2_f32_bf16 v22, v81, v81, v22
    v_dot2_f32_bf16 v18, v82, s43, v18
    v_dot2_f32_bf16 v22, v82, v82, v22
    v_dot2_f32_bf16 v18, v83, s43, v18
    v_dot2_f32_bf16 v22, v83, v83, v22
    v_mfma_f32_16x16x32_bf16 v[192:195], v[84:87], v[92:95], v[192:195]
    v_mfma_f32_16x16x32_bf16 v[196:199], v[84:87], v[96:99], v[196:199]
    v_mfma_f32_16x16x32_bf16 v[200:203], v[84:87], v[100:103], v[200:203]
    v_mfma_f32_16x16x32_bf16 v[204:207], v[84:87], v[104:107], v[204:207]
    v_mfma_f32_16x16x32_bf16 v[208:211], v[84:87], v[108:111], v[208:211]
    v_mfma_f32_16x16x32_bf16 v[212:215], v[84:87], v[112:115], v[212:215]
    v_mfma_f32_16x16x32_bf16 v[216:219], v[84:87], v[116:119], v[216:219]
    v_mfma_f32_16x16x32_bf16 v[220:223], v[84:87], v[120:123], v[220:223]
    v_dot2_f32_bf16 v19, v84, s43, v19
    v_dot2_f32_bf16 v23, v84, v84, v23
    v_dot2_f32_bf16 v19, v85, s43, v19
    v_dot2_f32_bf16 v23, v85, v85, v23
    v_dot2_f32_bf16 v19, v86, s43, v19
    v_dot2_f32_bf16 v23, v86, v86, v23
    v_dot2_f32_bf16 v19, v87, s43, v19
    v_dot2_f32_bf16 v23, v87, v87, v23
    v_mfma_f32_16x16x32_bf16 v[224:227], v[88:91], v[92:95], v[224:227]
    v_mfma_f32_16x16x32_bf16 v[228:231], v[88:91], v[96:99], v[228:231]
    v_mfma_f32_16x16x32_bf16 v[232:235], v[88:91], v[100:103], v[232:235]
    v_mfma_f32_16x16x32_bf16 v[236:239], v[88:91], v[104:107], v[236:239]
    v_mfma_f32_16x16x32_bf16 v[240:243], v[88:91], v[108:111], v[240:243]
    v_mfma_f32_16x16x32_bf16 v[244:247], v[88:91], v[112:115], v[244:247]
    v_mfma_f32_16x16x32_bf16 v[248:251], v[88:91], v[116:119], v[248:251]
    v_mfma_f32_16x16x32_bf16 v[252:255], v[88:91], v[120:123], v[252:255]
    v_dot2_f32_bf16 v20, v88, s43, v20
    v_dot2_f32_bf16 v24, v88, v88, v24
    v_dot2_f32_bf16 v20, v89, s43, v20
    v_dot2_f32_bf16 v24, v89, v89, v24
    v_dot2_f32_bf16 v20, v90, s43, v20
    v_dot2_f32_bf16 v24, v90, v90, v24
    v_dot2_f32_bf16 v20, v91, s43, v20
    v_dot2_f32_bf16 v24, v91, v91, v24
    v_add_u32 v1, -98304, v1
    v_add_u32 v2, -98304, v2
    v_add_u32 v3, -98304, v3
    v_add_u32 v4, -98304, v4
    v_add_u32 v5, -98304, v5
    v_add_u32 v6, -98304, v6
    v_add_u32 v7, -98304, v7
    v_add_u32 v8, -98304, v8
    s_waitcnt vmcnt(12)
    s_barrier
    s_mov_b32 s40, 1310720
    s_mov_b32 s41, 1146880
    s_lshl_b32 s42, s30, 12
    s_add_u32 m0, s42, 98304
    s_nop 0
    buffer_load_dwordx4 v9, s[8:11], s40 offen lds
    s_add_u32 m0, s42, 114688
    s_nop 0
    buffer_load_dwordx4 v13, s[12:15], s41 offen lds
    s_add_u32 m0, s42, 131072
    s_nop 0
    buffer_load_dwordx4 v13, s[16:19], s41 offen lds
    s_add_u32 m0, s42, 99328
    s_nop 0
    buffer_load_dwordx4 v10, s[8:11], s40 offen lds
    s_add_u32 m0, s42, 115712
    s_nop 0
    buffer_load_dwordx4 v14, s[12:15], s41 offen lds
    s_add_u32 m0, s42, 132096
    s_nop 0
    buffer_load_dwordx4 v14, s[16:19], s41 offen lds
    s_add_u32 m0, s42, 100352
    s_nop 0
    buffer_load_dwordx4 v11, s[8:11], s40 offen lds
    s_add_u32 m0, s42, 116736
    s_nop 0
    buffer_load_dwordx4 v15, s[12:15], s41 offen lds
    s_add_u32 m0, s42, 133120
    s_nop 0
    buffer_load_dwordx4 v15, s[16:19], s41 offen lds
    s_add_u32 m0, s42, 101376
    s_nop 0
    buffer_load_dwordx4 v12, s[8:11], s40 offen lds
    s_add_u32 m0, s42, 117760
    s_nop 0
    buffer_load_dwordx4 v16, s[12:15], s41 offen lds
    s_add_u32 m0, s42, 134144
    s_nop 0
    buffer_load_dwordx4 v16, s[16:19], s41 offen lds
    ds_read_b64_tr_b16 v[28:29], v1 offset:0
    ds_read_b64_tr_b16 v[30:31], v1 offset:1024
    ds_read_b64_tr_b16 v[32:33], v2 offset:0
    ds_read_b64_tr_b16 v[34:35], v2 offset:1024
    ds_read_b64_tr_b16 v[36:37], v3 offset:0
    ds_read_b64_tr_b16 v[38:39], v3 offset:1024
    ds_read_b64_tr_b16 v[40:41], v4 offset:0
    ds_read_b64_tr_b16 v[42:43], v4 offset:1024
    ds_read_b64_tr_b16 v[44:45], v5 offset:0
    ds_read_b64_tr_b16 v[46:47], v5 offset:1024
    ds_read_b64_tr_b16 v[48:49], v6 offset:0
    ds_read_b64_tr_b16 v[50:51], v6 offset:1024
    ds_read_b64_tr_b16 v[52:53], v7 offset:0
    ds_read_b64_tr_b16 v[54:55], v7 offset:1024
    ds_read_b64_tr_b16 v[56:57], v8 offset:0
    ds_read_b64_tr_b16 v[58:59], v8 offset:1024
    ds_read_b64_tr_b16 v[60:61], v5 offset:16384
    ds_read_b64_tr_b16 v[62:63], v5 offset:17408
    ds_read_b64_tr_b16 v[64:65], v6 offset:16384
    ds_read_b64_tr_b16 v[66:67], v6 offset:17408
    ds_read_b64_tr_b16 v[68:69], v7 offset:16384
    ds_read_b64_tr_b16 v[70:71], v7 offset:17408
    ds_read_b64_tr_b16 v[72:73], v8 offset:16384
    ds_read_b64_tr_b16 v[74:75], v8 offset:17408
    s_waitcnt lgkmcnt(0)
    ds_read_b64_tr_b16 v[76:77], v1 offset:8192
    ds_read_b64_tr_b16 v[78:79], v1 offset:9216
    ds_read_b64_tr_b16 v[80:81], v2 offset:8192
    ds_read_b64_tr_b16 v[82:83], v2 offset:9216
    ds_read_b64_tr_b16 v[84:85], v3 offset:8192
    ds_read_b64_tr_b16 v[86:87], v3 offset:9216
    ds_read_b64_tr_b16 v[88:89], v4 offset:8192
    ds_read_b64_tr_b16 v[90:91], v4 offset:9216
    ds_read_b64_tr_b16 v[92:93], v5 offset:8192
    ds_read_b64_tr_b16 v[94:95], v5 offset:9216
    ds_read_b64_tr_b16 v[96:97], v6 offset:8192
    ds_read_b64_tr_b16 v[98:99], v6 offset:9216
    ds_read_b64_tr_b16 v[100:101], v7 offset:8192
    ds_read_b64_tr_b16 v[102:103], v7 offset:9216
    ds_read_b64_tr_b16 v[104:105], v8 offset:8192
    ds_read_b64_tr_b16 v[106:107], v8 offset:9216
    ds_read_b64_tr_b16 v[108:109], v5 offset:24576
    ds_read_b64_tr_b16 v[110:111], v5 offset:25600
    ds_read_b64_tr_b16 v[112:113], v6 offset:24576
    ds_read_b64_tr_b16 v[114:115], v6 offset:25600
    ds_read_b64_tr_b16 v[116:117], v7 offset:24576
    ds_read_b64_tr_b16 v[118:119], v7 offset:25600
    ds_read_b64_tr_b16 v[120:121], v8 offset:24576
    ds_read_b64_tr_b16 v[122:123], v8 offset:25600
    v_mfma_f32_16x16x32_bf16 v[128:131], v[28:31], v[44:47], v[128:131]
    v_mfma_f32_16x16x32_bf16 v[132:135], v[28:31], v[48:51], v[132:135]
    v_mfma_f32_16x16x32_bf16 v[136:139], v[28:31], v[52:55], v[136:139]
    v_mfma_f32_16x16x32_bf16 v[140:143], v[28:31], v[56:59], v[140:143]
    v_mfma_f32_16x16x32_bf16 v[144:147], v[28:31], v[60:63], v[144:147]
    v_mfma_f32_16x16x32_bf16 v[148:151], v[28:31], v[64:67], v[148:151]
    v_mfma_f32_16x16x32_bf16 v[152:155], v[28:31], v[68:71], v[152:155]
    v_mfma_f32_16x16x32_bf16 v[156:159], v[28:31], v[72:75], v[156:159]
    v_dot2_f32_bf16 v17, v28, s43, v17
    v_dot2_f32_bf16 v21, v28, v28, v21
    v_dot2_f32_bf16 v17, v29, s43, v17
    v_dot2_f32_bf16 v21, v29, v29, v21
    v_dot2_f32_bf16 v17, v30, s43, v17
    v_dot2_f32_bf16 v21, v30, v30, v21
    v_dot2_f32_bf16 v17, v31, s43, v17
    v_dot2_f32_bf16 v21, v31, v31, v21
    v_mfma_f32_16x16x32_bf16 v[160:163], v[32:35], v[44:47], v[160:163]
    v_mfma_f32_16x16x32_bf16 v[164:167], v[32:35], v[48:51], v[164:167]
    v_mfma_f32_16x16x32_bf16 v[168:171], v[32:35], v[52:55], v[168:171]
    v_mfma_f32_16x16x32_bf16 v[172:175], v[32:35], v[56:59], v[172:175]
    v_mfma_f32_16x16x32_bf16 v[176:179], v[32:35], v[60:63], v[176:179]
    v_mfma_f32_16x16x32_bf16 v[180:183], v[32:35], v[64:67], v[180:183]
    v_mfma_f32_16x16x32_bf16 v[184:187], v[32:35], v[68:71], v[184:187]
    v_mfma_f32_16x16x32_bf16 v[188:191], v[32:35], v[72:75], v[188:191]
    v_dot2_f32_bf16 v18, v32, s43, v18
    v_dot2_f32_bf16 v22, v32, v32, v22
    v_dot2_f32_bf16 v18, v33, s43, v18
    v_dot2_f32_bf16 v22, v33, v33, v22
    v_dot2_f32_bf16 v18, v34, s43, v18
    v_dot2_f32_bf16 v22, v34, v34, v22
    v_dot2_f32_bf16 v18, v35, s43, v18
    v_dot2_f32_bf16 v22, v35, v35, v22
    v_mfma_f32_16x16x32_bf16 v[192:195], v[36:39], v[44:47], v[192:195]
    v_mfma_f32_16x16x32_bf16 v[196:199], v[36:39], v[48:51], v[196:199]
    v_mfma_f32_16x16x32_bf16 v[200:203], v[36:39], v[52:55], v[200:203]
    v_mfma_f32_16x16x32_bf16 v[204:207], v[36:39], v[56:59], v[204:207]
    v_mfma_f32_16x16x32_bf16 v[208:211], v[36:39], v[60:63], v[208:211]
    v_mfma_f32_16x16x32_bf16 v[212:215], v[36:39], v[64:67], v[212:215]
    v_mfma_f32_16x16x32_bf16 v[216:219], v[36:39], v[68:71], v[216:219]
    v_mfma_f32_16x16x32_bf16 v[220:223], v[36:39], v[72:75], v[220:223]
    v_dot2_f32_bf16 v19, v36, s43, v19
    v_dot2_f32_bf16 v23, v36, v36, v23
    v_dot2_f32_bf16 v19, v37, s43, v19
    v_dot2_f32_bf16 v23, v37, v37, v23
    v_dot2_f32_bf16 v19, v38, s43, v19
    v_dot2_f32_bf16 v23, v38, v38, v23
    v_dot2_f32_bf16 v19, v39, s43, v19
    v_dot2_f32_bf16 v23, v39, v39, v23
    v_mfma_f32_16x16x32_bf16 v[224:227], v[40:43], v[44:47], v[224:227]
    v_mfma_f32_16x16x32_bf16 v[228:231], v[40:43], v[48:51], v[228:231]
    v_mfma_f32_16x16x32_bf16 v[232:235], v[40:43], v[52:55], v[232:235]
    v_mfma_f32_16x16x32_bf16 v[236:239], v[40:43], v[56:59], v[236:239]
    v_mfma_f32_16x16x32_bf16 v[240:243], v[40:43], v[60:63], v[240:243]
    v_mfma_f32_16x16x32_bf16 v[244:247], v[40:43], v[64:67], v[244:247]
    v_mfma_f32_16x16x32_bf16 v[248:251], v[40:43], v[68:71], v[248:251]
    v_mfma_f32_16x16x32_bf16 v[252:255], v[40:43], v[72:75], v[252:255]
    v_dot2_f32_bf16 v20, v40, s43, v20
    v_dot2_f32_bf16 v24, v40, v40, v24
    v_dot2_f32_bf16 v20, v41, s43, v20
    v_dot2_f32_bf16 v24, v41, v41, v24
    v_dot2_f32_bf16 v20, v42, s43, v20
    v_dot2_f32_bf16 v24, v42, v42, v24
    v_dot2_f32_bf16 v20, v43, s43, v20
    v_dot2_f32_bf16 v24, v43, v43, v24
    s_waitcnt lgkmcnt(0)
    v_mfma_f32_16x16x32_bf16 v[128:131], v[76:79], v[92:95], v[128:131]
    v_mfma_f32_16x16x32_bf16 v[132:135], v[76:79], v[96:99], v[132:135]
    v_mfma_f32_16x16x32_bf16 v[136:139], v[76:79], v[100:103], v[136:139]
    v_mfma_f32_16x16x32_bf16 v[140:143], v[76:79], v[104:107], v[140:143]
    v_mfma_f32_16x16x32_bf16 v[144:147], v[76:79], v[108:111], v[144:147]
    v_mfma_f32_16x16x32_bf16 v[148:151], v[76:79], v[112:115], v[148:151]
    v_mfma_f32_16x16x32_bf16 v[152:155], v[76:79], v[116:119], v[152:155]
    v_mfma_f32_16x16x32_bf16 v[156:159], v[76:79], v[120:123], v[156:159]
    v_dot2_f32_bf16 v17, v76, s43, v17
    v_dot2_f32_bf16 v21, v76, v76, v21
    v_dot2_f32_bf16 v17, v77, s43, v17
    v_dot2_f32_bf16 v21, v77, v77, v21
    v_dot2_f32_bf16 v17, v78, s43, v17
    v_dot2_f32_bf16 v21, v78, v78, v21
    v_dot2_f32_bf16 v17, v79, s43, v17
    v_dot2_f32_bf16 v21, v79, v79, v21
    v_mfma_f32_16x16x32_bf16 v[160:163], v[80:83], v[92:95], v[160:163]
    v_mfma_f32_16x16x32_bf16 v[164:167], v[80:83], v[96:99], v[164:167]
    v_mfma_f32_16x16x32_bf16 v[168:171], v[80:83], v[100:103], v[168:171]
    v_mfma_f32_16x16x32_bf16 v[172:175], v[80:83], v[104:107], v[172:175]
    v_mfma_f32_16x16x32_bf16 v[176:179], v[80:83], v[108:111], v[176:179]
    v_mfma_f32_16x16x32_bf16 v[180:183], v[80:83], v[112:115], v[180:183]
    v_mfma_f32_16x16x32_bf16 v[184:187], v[80:83], v[116:119], v[184:187]
    v_mfma_f32_16x16x32_bf16 v[188:191], v[80:83], v[120:123], v[188:191]
    v_dot2_f32_bf16 v18, v80, s43, v18
    v_dot2_f32_bf16 v22, v80, v80, v22
    v_dot2_f32_bf16 v18, v81, s43, v18
    v_dot2_f32_bf16 v22, v81, v81, v22
    v_dot2_f32_bf16 v18, v82, s43, v18
    v_dot2_f32_bf16 v22, v82, v82, v22
    v_dot2_f32_bf16 v18, v83, s43, v18
    v_dot2_f32_bf16 v22, v83, v83, v22
    v_mfma_f32_16x16x32_bf16 v[192:195], v[84:87], v[92:95], v[192:195]
    v_mfma_f32_16x16x32_bf16 v[196:199], v[84:87], v[96:99], v[196:199]
    v_mfma_f32_16x16x32_bf16 v[200:203], v[84:87], v[100:103], v[200:203]
    v_mfma_f32_16x16x32_bf16 v[204:207], v[84:87], v[104:107], v[204:207]
    v_mfma_f32_16x16x32_bf16 v[208:211], v[84:87], v[108:111], v[208:211]
    v_mfma_f32_16x16x32_bf16 v[212:215], v[84:87], v[112:115], v[212:215]
    v_mfma_f32_16x16x32_bf16 v[216:219], v[84:87], v[116:119], v[216:219]
    v_mfma_f32_16x16x32_bf16 v[220:223], v[84:87], v[120:123], v[220:223]
    v_dot2_f32_bf16 v19, v84, s43, v19
    v_dot2_f32_bf16 v23, v84, v84, v23
    v_dot2_f32_bf16 v19, v85, s43, v19
    v_dot2_f32_bf16 v23, v85, v85, v23
    v_dot2_f32_bf16 v19, v86, s43, v19
    v_dot2_f32_bf16 v23, v86, v86, v23
    v_dot2_f32_bf16 v19, v87, s43, v19
    v_dot2_f32_bf16 v23, v87, v87, v23
    v_mfma_f32_16x16x32_bf16 v[224:227], v[88:91], v[92:95], v[224:227]
    v_mfma_f32_16x16x32_bf16 v[228:231], v[88:91], v[96:99], v[228:231]
    v_mfma_f32_16x16x32_bf16 v[232:235], v[88:91], v[100:103], v[232:235]
    v_mfma_f32_16x16x32_bf16 v[236:239], v[88:91], v[104:107], v[236:239]
    v_mfma_f32_16x16x32_bf16 v[240:243], v[88:91], v[108:111], v[240:243]
    v_mfma_f32_16x16x32_bf16 v[244:247], v[88:91], v[112:115], v[244:247]
    v_mfma_f32_16x16x32_bf16 v[248:251], v[88:91], v[116:119], v[248:251]
    v_mfma_f32_16x16x32_bf16 v[252:255], v[88:91], v[120:123], v[252:255]
    v_dot2_f32_bf16 v20, v88, s43, v20
    v_dot2_f32_bf16 v24, v88, v88, v24
    v_dot2_f32_bf16 v20, v89, s43, v20
    v_dot2_f32_bf16 v24, v89, v89, v24
    v_dot2_f32_bf16 v20, v90, s43, v20
    v_dot2_f32_bf16 v24, v90, v90, v24
    v_dot2_f32_bf16 v20, v91, s43, v20
    v_dot2_f32_bf16 v24, v91, v91, v24
    v_add_u32 v1, 49152, v1
    v_add_u32 v2, 49152, v2
    v_add_u32 v3, 49152, v3
    v_add_u32 v4, 49152, v4
    v_add_u32 v5, 49152, v5
    v_add_u32 v6, 49152, v6
    v_add_u32 v7, 49152, v7
    v_add_u32 v8, 49152, v8
    s_waitcnt vmcnt(12)
    s_barrier
    s_mov_b32 s40, 1572864
    s_mov_b32 s41, 1376256
    s_lshl_b32 s42, s30, 12
    s_add_u32 m0, s42, 0
    s_nop 0
    buffer_load_dwordx4 v9, s[8:11], s40 offen lds
    s_add_u32 m0, s42, 16384
    s_nop 0
    buffer_load_dwordx4 v13, s[12:15], s41 offen lds
    s_add_u32 m0, s42, 32768
    s_nop 0
    buffer_load_dwordx4 v13, s[16:19], s41 offen lds
    s_add_u32 m0, s42, 1024
    s_nop 0
    buffer_load_dwordx4 v10, s[8:11], s40 offen lds
    s_add_u32 m0, s42, 17408
    s_nop 0
    buffer_load_dwordx4 v14, s[12:15], s41 offen lds
    s_add_u32 m0, s42, 33792
    s_nop 0
    buffer_load_dwordx4 v14, s[16:19], s41 offen lds
    s_add_u32 m0, s42, 2048
    s_nop 0
    buffer_load_dwordx4 v11, s[8:11], s40 offen lds
    s_add_u32 m0, s42, 18432
    s_nop 0
    buffer_load_dwordx4 v15, s[12:15], s41 offen lds
    s_add_u32 m0, s42, 34816
    s_nop 0
    buffer_load_dwordx4 v15, s[16:19], s41 offen lds
    s_add_u32 m0, s42, 3072
    s_nop 0
    buffer_load_dwordx4 v12, s[8:11], s40 offen lds
    s_add_u32 m0, s42, 19456
    s_nop 0
    buffer_load_dwordx4 v16, s[12:15], s41 offen lds
    s_add_u32 m0, s42, 35840
    s_nop 0
    buffer_load_dwordx4 v16, s[16:19], s41 offen lds
    ds_read_b64_tr_b16 v[28:29], v1 offset:0
    ds_read_b64_tr_b16 v[30:31], v1 offset:1024
    ds_read_b64_tr_b16 v[32:33], v2 offset:0
    ds_read_b64_tr_b16 v[34:35], v2 offset:1024
    ds_read_b64_tr_b16 v[36:37], v3 offset:0
    ds_read_b64_tr_b16 v[38:39], v3 offset:1024
    ds_read_b64_tr_b16 v[40:41], v4 offset:0
    ds_read_b64_tr_b16 v[42:43], v4 offset:1024
    ds_read_b64_tr_b16 v[44:45], v5 offset:0
    ds_read_b64_tr_b16 v[46:47], v5 offset:1024
    ds_read_b64_tr_b16 v[48:49], v6 offset:0
    ds_read_b64_tr_b16 v[50:51], v6 offset:1024
    ds_read_b64_tr_b16 v[52:53], v7 offset:0
    ds_read_b64_tr_b16 v[54:55], v7 offset:1024
    ds_read_b64_tr_b16 v[56:57], v8 offset:0
    ds_read_b64_tr_b16 v[58:59], v8 offset:1024
    ds_read_b64_tr_b16 v[60:61], v5 offset:16384
    ds_read_b64_tr_b16 v[62:63], v5 offset:17408
    ds_read_b64_tr_b16 v[64:65], v6 offset:16384
    ds_read_b64_tr_b16 v[66:67], v6 offset:17408
    ds_read_b64_tr_b16 v[68:69], v7 offset:16384
    ds_read_b64_tr_b16 v[70:71], v7 offset:17408
    ds_read_b64_tr_b16 v[72:73], v8 offset:16384
    ds_read_b64_tr_b16 v[74:75], v8 offset:17408
    s_waitcnt lgkmcnt(0)
    ds_read_b64_tr_b16 v[76:77], v1 offset:8192
    ds_read_b64_tr_b16 v[78:79], v1 offset:9216
    ds_read_b64_tr_b16 v[80:81], v2 offset:8192
    ds_read_b64_tr_b16 v[82:83], v2 offset:9216
    ds_read_b64_tr_b16 v[84:85], v3 offset:8192
    ds_read_b64_tr_b16 v[86:87], v3 offset:9216
    ds_read_b64_tr_b16 v[88:89], v4 offset:8192
    ds_read_b64_tr_b16 v[90:91], v4 offset:9216
    ds_read_b64_tr_b16 v[92:93], v5 offset:8192
    ds_read_b64_tr_b16 v[94:95], v5 offset:9216
    ds_read_b64_tr_b16 v[96:97], v6 offset:8192
    ds_read_b64_tr_b16 v[98:99], v6 offset:9216
    ds_read_b64_tr_b16 v[100:101], v7 offset:8192
    ds_read_b64_tr_b16 v[102:103], v7 offset:9216
    ds_read_b64_tr_b16 v[104:105], v8 offset:8192
    ds_read_b64_tr_b16 v[106:107], v8 offset:9216
    ds_read_b64_tr_b16 v[108:109], v5 offset:24576
    ds_read_b64_tr_b16 v[110:111], v5 offset:25600
    ds_read_b64_tr_b16 v[112:113], v6 offset:24576
    ds_read_b64_tr_b16 v[114:115], v6 offset:25600
    ds_read_b64_tr_b16 v[116:117], v7 offset:24576
    ds_read_b64_tr_b16 v[118:119], v7 offset:25600
    ds_read_b64_tr_b16 v[120:121], v8 offset:24576
    ds_read_b64_tr_b16 v[122:123], v8 offset:25600
    v_mfma_f32_16x16x32_bf16 v[128:131], v[28:31], v[44:47], v[128:131]
    v_mfma_f32_16x16x32_bf16 v[132:135], v[28:31], v[48:51], v[132:135]
    v_mfma_f32_16x16x32_bf16 v[136:139], v[28:31], v[52:55], v[136:139]
    v_mfma_f32_16x16x32_bf16 v[140:143], v[28:31], v[56:59], v[140:143]
    v_mfma_f32_16x16x32_bf16 v[144:147], v[28:31], v[60:63], v[144:147]
    v_mfma_f32_16x16x32_bf16 v[148:151], v[28:31], v[64:67], v[148:151]
    v_mfma_f32_16x16x32_bf16 v[152:155], v[28:31], v[68:71], v[152:155]
    v_mfma_f32_16x16x32_bf16 v[156:159], v[28:31], v[72:75], v[156:159]
    v_dot2_f32_bf16 v17, v28, s43, v17
    v_dot2_f32_bf16 v21, v28, v28, v21
    v_dot2_f32_bf16 v17, v29, s43, v17
    v_dot2_f32_bf16 v21, v29, v29, v21
    v_dot2_f32_bf16 v17, v30, s43, v17
    v_dot2_f32_bf16 v21, v30, v30, v21
    v_dot2_f32_bf16 v17, v31, s43, v17
    v_dot2_f32_bf16 v21, v31, v31, v21
    v_mfma_f32_16x16x32_bf16 v[160:163], v[32:35], v[44:47], v[160:163]
    v_mfma_f32_16x16x32_bf16 v[164:167], v[32:35], v[48:51], v[164:167]
    v_mfma_f32_16x16x32_bf16 v[168:171], v[32:35], v[52:55], v[168:171]
    v_mfma_f32_16x16x32_bf16 v[172:175], v[32:35], v[56:59], v[172:175]
    v_mfma_f32_16x16x32_bf16 v[176:179], v[32:35], v[60:63], v[176:179]
    v_mfma_f32_16x16x32_bf16 v[180:183], v[32:35], v[64:67], v[180:183]
    v_mfma_f32_16x16x32_bf16 v[184:187], v[32:35], v[68:71], v[184:187]
    v_mfma_f32_16x16x32_bf16 v[188:191], v[32:35], v[72:75], v[188:191]
    v_dot2_f32_bf16 v18, v32, s43, v18
    v_dot2_f32_bf16 v22, v32, v32, v22
    v_dot2_f32_bf16 v18, v33, s43, v18
    v_dot2_f32_bf16 v22, v33, v33, v22
    v_dot2_f32_bf16 v18, v34, s43, v18
    v_dot2_f32_bf16 v22, v34, v34, v22
    v_dot2_f32_bf16 v18, v35, s43, v18
    v_dot2_f32_bf16 v22, v35, v35, v22
    v_mfma_f32_16x16x32_bf16 v[192:195], v[36:39], v[44:47], v[192:195]
    v_mfma_f32_16x16x32_bf16 v[196:199], v[36:39], v[48:51], v[196:199]
    v_mfma_f32_16x16x32_bf16 v[200:203], v[36:39], v[52:55], v[200:203]
    v_mfma_f32_16x16x32_bf16 v[204:207], v[36:39], v[56:59], v[204:207]
    v_mfma_f32_16x16x32_bf16 v[208:211], v[36:39], v[60:63], v[208:211]
    v_mfma_f32_16x16x32_bf16 v[212:215], v[36:39], v[64:67], v[212:215]
    v_mfma_f32_16x16x32_bf16 v[216:219], v[36:39], v[68:71], v[216:219]
    v_mfma_f32_16x16x32_bf16 v[220:223], v[36:39], v[72:75], v[220:223]
    v_dot2_f32_bf16 v19, v36, s43, v19
    v_dot2_f32_bf16 v23, v36, v36, v23
    v_dot2_f32_bf16 v19, v37, s43, v19
    v_dot2_f32_bf16 v23, v37, v37, v23
    v_dot2_f32_bf16 v19, v38, s43, v19
    v_dot2_f32_bf16 v23, v38, v38, v23
    v_dot2_f32_bf16 v19, v39, s43, v19
    v_dot2_f32_bf16 v23, v39, v39, v23
    v_mfma_f32_16x16x32_bf16 v[224:227], v[40:43], v[44:47], v[224:227]
    v_mfma_f32_16x16x32_bf16 v[228:231], v[40:43], v[48:51], v[228:231]
    v_mfma_f32_16x16x32_bf16 v[232:235], v[40:43], v[52:55], v[232:235]
    v_mfma_f32_16x16x32_bf16 v[236:239], v[40:43], v[56:59], v[236:239]
    v_mfma_f32_16x16x32_bf16 v[240:243], v[40:43], v[60:63], v[240:243]
    v_mfma_f32_16x16x32_bf16 v[244:247], v[40:43], v[64:67], v[244:247]
    v_mfma_f32_16x16x32_bf16 v[248:251], v[40:43], v[68:71], v[248:251]
    v_mfma_f32_16x16x32_bf16 v[252:255], v[40:43], v[72:75], v[252:255]
    v_dot2_f32_bf16 v20, v40, s43, v20
    v_dot2_f32_bf16 v24, v40, v40, v24
    v_dot2_f32_bf16 v20, v41, s43, v20
    v_dot2_f32_bf16 v24, v41, v41, v24
    v_dot2_f32_bf16 v20, v42, s43, v20
    v_dot2_f32_bf16 v24, v42, v42, v24
    v_dot2_f32_bf16 v20, v43, s43, v20
    v_dot2_f32_bf16 v24, v43, v43, v24
    s_waitcnt lgkmcnt(0)
    v_mfma_f32_16x16x32_bf16 v[128:131], v[76:79], v[92:95], v[128:131]
    v_mfma_f32_16x16x32_bf16 v[132:135], v[76:79], v[96:99], v[132:135]
    v_mfma_f32_16x16x32_bf16 v[136:139], v[76:79], v[100:103], v[136:139]
    v_mfma_f32_16x16x32_bf16 v[140:143], v[76:79], v[104:107], v[140:143]
    v_mfma_f32_16x16x32_bf16 v[144:147], v[76:79], v[108:111], v[144:147]
    v_mfma_f32_16x16x32_bf16 v[148:151], v[76:79], v[112:115], v[148:151]
    v_mfma_f32_16x16x32_bf16 v[152:155], v[76:79], v[116:119], v[152:155]
    v_mfma_f32_16x16x32_bf16 v[156:159], v[76:79], v[120:123], v[156:159]
    v_dot2_f32_bf16 v17, v76, s43, v17
    v_dot2_f32_bf16 v21, v76, v76, v21
    v_dot2_f32_bf16 v17, v77, s43, v17
    v_dot2_f32_bf16 v21, v77, v77, v21
    v_dot2_f32_bf16 v17, v78, s43, v17
    v_dot2_f32_bf16 v21, v78, v78, v21
    v_dot2_f32_bf16 v17, v79, s43, v17
    v_dot2_f32_bf16 v21, v79, v79, v21
    v_mfma_f32_16x16x32_bf16 v[160:163], v[80:83], v[92:95], v[160:163]
    v_mfma_f32_16x16x32_bf16 v[164:167], v[80:83], v[96:99], v[164:167]
    v_mfma_f32_16x16x32_bf16 v[168:171], v[80:83], v[100:103], v[168:171]
    v_mfma_f32_16x16x32_bf16 v[172:175], v[80:83], v[104:107], v[172:175]
    v_mfma_f32_16x16x32_bf16 v[176:179], v[80:83], v[108:111], v[176:179]
    v_mfma_f32_16x16x32_bf16 v[180:183], v[80:83], v[112:115], v[180:183]
    v_mfma_f32_16x16x32_bf16 v[184:187], v[80:83], v[116:119], v[184:187]
    v_mfma_f32_16x16x32_bf16 v[188:191], v[80:83], v[120:123], v[188:191]
    v_dot2_f32_bf16 v18, v80, s43, v18
    v_dot2_f32_bf16 v22, v80, v80, v22
    v_dot2_f32_bf16 v18, v81, s43, v18
    v_dot2_f32_bf16 v22, v81, v81, v22
    v_dot2_f32_bf16 v18, v82, s43, v18
    v_dot2_f32_bf16 v22, v82, v82, v22
    v_dot2_f32_bf16 v18, v83, s43, v18
    v_dot2_f32_bf16 v22, v83, v83, v22
    v_mfma_f32_16x16x32_bf16 v[192:195], v[84:87], v[92:95], v[192:195]
    v_mfma_f32_16x16x32_bf16 v[196:199], v[84:87], v[96:99], v[196:199]
    v_mfma_f32_16x16x32_bf16 v[200:203], v[84:87], v[100:103], v[200:203]
    v_mfma_f32_16x16x32_bf16 v[204:207], v[84:87], v[104:107], v[204:207]
    v_mfma_f32_16x16x32_bf16 v[208:211], v[84:87], v[108:111], v[208:211]
    v_mfma_f32_16x16x32_bf16 v[212:215], v[84:87], v[112:115], v[212:215]
    v_mfma_f32_16x16x32_bf16 v[216:219], v[84:87], v[116:119], v[216:219]
    v_mfma_f32_16x16x32_bf16 v[220:223], v[84:87], v[120:123], v[220:223]
    v_dot2_f32_bf16 v19, v84, s43, v19
    v_dot2_f32_bf16 v23, v84, v84, v23
    v_dot2_f32_bf16 v19, v85, s43, v19
    v_dot2_f32_bf16 v23, v85, v85, v23
    v_dot2_f32_bf16 v19, v86, s43, v19
    v_dot2_f32_bf16 v23, v86, v86, v23
    v_dot2_f32_bf16 v19, v87, s43, v19
    v_dot2_f32_bf16 v23, v87, v87, v23
    v_mfma_f32_16x16x32_bf16 v[224:227], v[88:91], v[92:95], v[224:227]
    v_mfma_f32_16x16x32_bf16 v[228:231], v[88:91], v[96:99], v[228:231]
    v_mfma_f32_16x16x32_bf16 v[232:235], v[88:91], v[100:103], v[232:235]
    v_mfma_f32_16x16x32_bf16 v[236:239], v[88:91], v[104:107], v[236:239]
    v_mfma_f32_16x16x32_bf16 v[240:243], v[88:91], v[108:111], v[240:243]
    v_mfma_f32_16x16x32_bf16 v[244:247], v[88:91], v[112:115], v[244:247]
    v_mfma_f32_16x16x32_bf16 v[248:251], v[88:91], v[116:119], v[248:251]
    v_mfma_f32_16x16x32_bf16 v[252:255], v[88:91], v[120:123], v[252:255]
    v_dot2_f32_bf16 v20, v88, s43, v20
    v_dot2_f32_bf16 v24, v88, v88, v24
    v_dot2_f32_bf16 v20, v89, s43, v20
    v_dot2_f32_bf16 v24, v89, v89, v24
    v_dot2_f32_bf16 v20, v90, s43, v20
    v_dot2_f32_bf16 v24, v90, v90, v24
    v_dot2_f32_bf16 v20, v91, s43, v20
    v_dot2_f32_bf16 v24, v91, v91, v24
    v_add_u32 v1, 49152, v1
    v_add_u32 v2, 49152, v2
    v_add_u32 v3, 49152, v3
    v_add_u32 v4, 49152, v4
    v_add_u32 v5, 49152, v5
    v_add_u32 v6, 49152, v6
    v_add_u32 v7, 49152, v7
    v_add_u32 v8, 49152, v8
    s_waitcnt vmcnt(12)
    s_barrier
    s_mov_b32 s40, 1835008
    s_mov_b32 s41, 1605632
    s_lshl_b32 s42, s30, 12
    s_add_u32 m0, s42, 49152
    s_nop 0
    buffer_load_dwordx4 v9, s[8:11], s40 offen lds
    s_add_u32 m0, s42, 65536
    s_nop 0
    buffer_load_dwordx4 v13, s[12:15], s41 offen lds
    s_add_u32 m0, s42, 81920
    s_nop 0
    buffer_load_dwordx4 v13, s[16:19], s41 offen lds
    s_add_u32 m0, s42, 50176
    s_nop 0
    buffer_load_dwordx4 v10, s[8:11], s40 offen lds
    s_add_u32 m0, s42, 66560
    s_nop 0
    buffer_load_dwordx4 v14, s[12:15], s41 offen lds
    s_add_u32 m0, s42, 82944
    s_nop 0
    buffer_load_dwordx4 v14, s[16:19], s41 offen lds
    s_add_u32 m0, s42, 51200
    s_nop 0
    buffer_load_dwordx4 v11, s[8:11], s40 offen lds
    s_add_u32 m0, s42, 67584
    s_nop 0
    buffer_load_dwordx4 v15, s[12:15], s41 offen lds
    s_add_u32 m0, s42, 83968
    s_nop 0
    buffer_load_dwordx4 v15, s[16:19], s41 offen lds
    s_add_u32 m0, s42, 52224
    s_nop 0
    buffer_load_dwordx4 v12, s[8:11], s40 offen lds
    s_add_u32 m0, s42, 68608
    s_nop 0
    buffer_load_dwordx4 v16, s[12:15], s41 offen lds
    s_add_u32 m0, s42, 84992
    s_nop 0
    buffer_load_dwordx4 v16, s[16:19], s41 offen lds
    ds_read_b64_tr_b16 v[28:29], v1 offset:0
    ds_read_b64_tr_b16 v[30:31], v1 offset:1024
    ds_read_b64_tr_b16 v[32:33], v2 offset:0
    ds_read_b64_tr_b16 v[34:35], v2 offset:1024
    ds_read_b64_tr_b16 v[36:37], v3 offset:0
    ds_read_b64_tr_b16 v[38:39], v3 offset:1024
    ds_read_b64_tr_b16 v[40:41], v4 offset:0
    ds_read_b64_tr_b16 v[42:43], v4 offset:1024
    ds_read_b64_tr_b16 v[44:45], v5 offset:0
    ds_read_b64_tr_b16 v[46:47], v5 offset:1024
    ds_read_b64_tr_b16 v[48:49], v6 offset:0
    ds_read_b64_tr_b16 v[50:51], v6 offset:1024
    ds_read_b64_tr_b16 v[52:53], v7 offset:0
    ds_read_b64_tr_b16 v[54:55], v7 offset:1024
    ds_read_b64_tr_b16 v[56:57], v8 offset:0
    ds_read_b64_tr_b16 v[58:59], v8 offset:1024
    ds_read_b64_tr_b16 v[60:61], v5 offset:16384
    ds_read_b64_tr_b16 v[62:63], v5 offset:17408
    ds_read_b64_tr_b16 v[64:65], v6 offset:16384
    ds_read_b64_tr_b16 v[66:67], v6 offset:17408
    ds_read_b64_tr_b16 v[68:69], v7 offset:16384
    ds_read_b64_tr_b16 v[70:71], v7 offset:17408
    ds_read_b64_tr_b16 v[72:73], v8 offset:16384
    ds_read_b64_tr_b16 v[74:75], v8 offset:17408
    s_waitcnt lgkmcnt(0)
    ds_read_b64_tr_b16 v[76:77], v1 offset:8192
    ds_read_b64_tr_b16 v[78:79], v1 offset:9216
    ds_read_b64_tr_b16 v[80:81], v2 offset:8192
    ds_read_b64_tr_b16 v[82:83], v2 offset:9216
    ds_read_b64_tr_b16 v[84:85], v3 offset:8192
    ds_read_b64_tr_b16 v[86:87], v3 offset:9216
    ds_read_b64_tr_b16 v[88:89], v4 offset:8192
    ds_read_b64_tr_b16 v[90:91], v4 offset:9216
    ds_read_b64_tr_b16 v[92:93], v5 offset:8192
    ds_read_b64_tr_b16 v[94:95], v5 offset:9216
    ds_read_b64_tr_b16 v[96:97], v6 offset:8192
    ds_read_b64_tr_b16 v[98:99], v6 offset:9216
    ds_read_b64_tr_b16 v[100:101], v7 offset:8192
    ds_read_b64_tr_b16 v[102:103], v7 offset:9216
    ds_read_b64_tr_b16 v[104:105], v8 offset:8192
    ds_read_b64_tr_b16 v[106:107], v8 offset:9216
    ds_read_b64_tr_b16 v[108:109], v5 offset:24576
    ds_read_b64_tr_b16 v[110:111], v5 offset:25600
    ds_read_b64_tr_b16 v[112:113], v6 offset:24576
    ds_read_b64_tr_b16 v[114:115], v6 offset:25600
    ds_read_b64_tr_b16 v[116:117], v7 offset:24576
    ds_read_b64_tr_b16 v[118:119], v7 offset:25600
    ds_read_b64_tr_b16 v[120:121], v8 offset:24576
    ds_read_b64_tr_b16 v[122:123], v8 offset:25600
    v_mfma_f32_16x16x32_bf16 v[128:131], v[28:31], v[44:47], v[128:131]
    v_mfma_f32_16x16x32_bf16 v[132:135], v[28:31], v[48:51], v[132:135]
    v_mfma_f32_16x16x32_bf16 v[136:139], v[28:31], v[52:55], v[136:139]
    v_mfma_f32_16x16x32_bf16 v[140:143], v[28:31], v[56:59], v[140:143]
    v_mfma_f32_16x16x32_bf16 v[144:147], v[28:31], v[60:63], v[144:147]
    v_mfma_f32_16x16x32_bf16 v[148:151], v[28:31], v[64:67], v[148:151]
    v_mfma_f32_16x16x32_bf16 v[152:155], v[28:31], v[68:71], v[152:155]
    v_mfma_f32_16x16x32_bf16 v[156:159], v[28:31], v[72:75], v[156:159]
    v_dot2_f32_bf16 v17, v28, s43, v17
    v_dot2_f32_bf16 v21, v28, v28, v21
    v_dot2_f32_bf16 v17, v29, s43, v17
    v_dot2_f32_bf16 v21, v29, v29, v21
    v_dot2_f32_bf16 v17, v30, s43, v17
    v_dot2_f32_bf16 v21, v30, v30, v21
    v_dot2_f32_bf16 v17, v31, s43, v17
    v_dot2_f32_bf16 v21, v31, v31, v21
    v_mfma_f32_16x16x32_bf16 v[160:163], v[32:35], v[44:47], v[160:163]
    v_mfma_f32_16x16x32_bf16 v[164:167], v[32:35], v[48:51], v[164:167]
    v_mfma_f32_16x16x32_bf16 v[168:171], v[32:35], v[52:55], v[168:171]
    v_mfma_f32_16x16x32_bf16 v[172:175], v[32:35], v[56:59], v[172:175]
    v_mfma_f32_16x16x32_bf16 v[176:179], v[32:35], v[60:63], v[176:179]
    v_mfma_f32_16x16x32_bf16 v[180:183], v[32:35], v[64:67], v[180:183]
    v_mfma_f32_16x16x32_bf16 v[184:187], v[32:35], v[68:71], v[184:187]
    v_mfma_f32_16x16x32_bf16 v[188:191], v[32:35], v[72:75], v[188:191]
    v_dot2_f32_bf16 v18, v32, s43, v18
    v_dot2_f32_bf16 v22, v32, v32, v22
    v_dot2_f32_bf16 v18, v33, s43, v18
    v_dot2_f32_bf16 v22, v33, v33, v22
    v_dot2_f32_bf16 v18, v34, s43, v18
    v_dot2_f32_bf16 v22, v34, v34, v22
    v_dot2_f32_bf16 v18, v35, s43, v18
    v_dot2_f32_bf16 v22, v35, v35, v22
    v_mfma_f32_16x16x32_bf16 v[192:195], v[36:39], v[44:47], v[192:195]
    v_mfma_f32_16x16x32_bf16 v[196:199], v[36:39], v[48:51], v[196:199]
    v_mfma_f32_16x16x32_bf16 v[200:203], v[36:39], v[52:55], v[200:203]
    v_mfma_f32_16x16x32_bf16 v[204:207], v[36:39], v[56:59], v[204:207]
    v_mfma_f32_16x16x32_bf16 v[208:211], v[36:39], v[60:63], v[208:211]
    v_mfma_f32_16x16x32_bf16 v[212:215], v[36:39], v[64:67], v[212:215]
    v_mfma_f32_16x16x32_bf16 v[216:219], v[36:39], v[68:71], v[216:219]
    v_mfma_f32_16x16x32_bf16 v[220:223], v[36:39], v[72:75], v[220:223]
    v_dot2_f32_bf16 v19, v36, s43, v19
    v_dot2_f32_bf16 v23, v36, v36, v23
    v_dot2_f32_bf16 v19, v37, s43, v19
    v_dot2_f32_bf16 v23, v37, v37, v23
    v_dot2_f32_bf16 v19, v38, s43, v19
    v_dot2_f32_bf16 v23, v38, v38, v23
    v_dot2_f32_bf16 v19, v39, s43, v19
    v_dot2_f32_bf16 v23, v39, v39, v23
    v_mfma_f32_16x16x32_bf16 v[224:227], v[40:43], v[44:47], v[224:227]
    v_mfma_f32_16x16x32_bf16 v[228:231], v[40:43], v[48:51], v[228:231]
    v_mfma_f32_16x16x32_bf16 v[232:235], v[40:43], v[52:55], v[232:235]
    v_mfma_f32_16x16x32_bf16 v[236:239], v[40:43], v[56:59], v[236:239]
    v_mfma_f32_16x16x32_bf16 v[240:243], v[40:43], v[60:63], v[240:243]
    v_mfma_f32_16x16x32_bf16 v[244:247], v[40:43], v[64:67], v[244:247]
    v_mfma_f32_16x16x32_bf16 v[248:251], v[40:43], v[68:71], v[248:251]
    v_mfma_f32_16x16x32_bf16 v[252:255], v[40:43], v[72:75], v[252:255]
    v_dot2_f32_bf16 v20, v40, s43, v20
    v_dot2_f32_bf16 v24, v40, v40, v24
    v_dot2_f32_bf16 v20, v41, s43, v20
    v_dot2_f32_bf16 v24, v41, v41, v24
    v_dot2_f32_bf16 v20, v42, s43, v20
    v_dot2_f32_bf16 v24, v42, v42, v24
    v_dot2_f32_bf16 v20, v43, s43, v20
    v_dot2_f32_bf16 v24, v43, v43, v24
    s_waitcnt lgkmcnt(0)
    v_mfma_f32_16x16x32_bf16 v[128:131], v[76:79], v[92:95], v[128:131]
    v_mfma_f32_16x16x32_bf16 v[132:135], v[76:79], v[96:99], v[132:135]
    v_mfma_f32_16x16x32_bf16 v[136:139], v[76:79], v[100:103], v[136:139]
    v_mfma_f32_16x16x32_bf16 v[140:143], v[76:79], v[104:107], v[140:143]
    v_mfma_f32_16x16x32_bf16 v[144:147], v[76:79], v[108:111], v[144:147]
    v_mfma_f32_16x16x32_bf16 v[148:151], v[76:79], v[112:115], v[148:151]
    v_mfma_f32_16x16x32_bf16 v[152:155], v[76:79], v[116:119], v[152:155]
    v_mfma_f32_16x16x32_bf16 v[156:159], v[76:79], v[120:123], v[156:159]
    v_dot2_f32_bf16 v17, v76, s43, v17
    v_dot2_f32_bf16 v21, v76, v76, v21
    v_dot2_f32_bf16 v17, v77, s43, v17
    v_dot2_f32_bf16 v21, v77, v77, v21
    v_dot2_f32_bf16 v17, v78, s43, v17
    v_dot2_f32_bf16 v21, v78, v78, v21
    v_dot2_f32_bf16 v17, v79, s43, v17
    v_dot2_f32_bf16 v21, v79, v79, v21
    v_mfma_f32_16x16x32_bf16 v[160:163], v[80:83], v[92:95], v[160:163]
    v_mfma_f32_16x16x32_bf16 v[164:167], v[80:83], v[96:99], v[164:167]
    v_mfma_f32_16x16x32_bf16 v[168:171], v[80:83], v[100:103], v[168:171]
    v_mfma_f32_16x16x32_bf16 v[172:175], v[80:83], v[104:107], v[172:175]
    v_mfma_f32_16x16x32_bf16 v[176:179], v[80:83], v[108:111], v[176:179]
    v_mfma_f32_16x16x32_bf16 v[180:183], v[80:83], v[112:115], v[180:183]
    v_mfma_f32_16x16x32_bf16 v[184:187], v[80:83], v[116:119], v[184:187]
    v_mfma_f32_16x16x32_bf16 v[188:191], v[80:83], v[120:123], v[188:191]
    v_dot2_f32_bf16 v18, v80, s43, v18
    v_dot2_f32_bf16 v22, v80, v80, v22
    v_dot2_f32_bf16 v18, v81, s43, v18
    v_dot2_f32_bf16 v22, v81, v81, v22
    v_dot2_f32_bf16 v18, v82, s43, v18
    v_dot2_f32_bf16 v22, v82, v82, v22
    v_dot2_f32_bf16 v18, v83, s43, v18
    v_dot2_f32_bf16 v22, v83, v83, v22
    v_mfma_f32_16x16x32_bf16 v[192:195], v[84:87], v[92:95], v[192:195]
    v_mfma_f32_16x16x32_bf16 v[196:199], v[84:87], v[96:99], v[196:199]
    v_mfma_f32_16x16x32_bf16 v[200:203], v[84:87], v[100:103], v[200:203]
    v_mfma_f32_16x16x32_bf16 v[204:207], v[84:87], v[104:107], v[204:207]
    v_mfma_f32_16x16x32_bf16 v[208:211], v[84:87], v[108:111], v[208:211]
    v_mfma_f32_16x16x32_bf16 v[212:215], v[84:87], v[112:115], v[212:215]
    v_mfma_f32_16x16x32_bf16 v[216:219], v[84:87], v[116:119], v[216:219]
    v_mfma_f32_16x16x32_bf16 v[220:223], v[84:87], v[120:123], v[220:223]
    v_dot2_f32_bf16 v19, v84, s43, v19
    v_dot2_f32_bf16 v23, v84, v84, v23
    v_dot2_f32_bf16 v19, v85, s43, v19
    v_dot2_f32_bf16 v23, v85, v85, v23
    v_dot2_f32_bf16 v19, v86, s43, v19
    v_dot2_f32_bf16 v23, v86, v86, v23
    v_dot2_f32_bf16 v19, v87, s43, v19
    v_dot2_f32_bf16 v23, v87, v87, v23
    v_mfma_f32_16x16x32_bf16 v[224:227], v[88:91], v[92:95], v[224:227]
    v_mfma_f32_16x16x32_bf16 v[228:231], v[88:91], v[96:99], v[228:231]
    v_mfma_f32_16x16x32_bf16 v[232:235], v[88:91], v[100:103], v[232:235]
    v_mfma_f32_16x16x32_bf16 v[236:239], v[88:91], v[104:107], v[236:239]
    v_mfma_f32_16x16x32_bf16 v[240:243], v[88:91], v[108:111], v[240:243]
    v_mfma_f32_16x16x32_bf16 v[244:247], v[88:91], v[112:115], v[244:247]
    v_mfma_f32_16x16x32_bf16 v[248:251], v[88:91], v[116:119], v[248:251]
    v_mfma_f32_16x16x32_bf16 v[252:255], v[88:91], v[120:123], v[252:255]
    v_dot2_f32_bf16 v20, v88, s43, v20
    v_dot2_f32_bf16 v24, v88, v88, v24
    v_dot2_f32_bf16 v20, v89, s43, v20
    v_dot2_f32_bf16 v24, v89, v89, v24
    v_dot2_f32_bf16 v20, v90, s43, v20
    v_dot2_f32_bf16 v24, v90, v90, v24
    v_dot2_f32_bf16 v20, v91, s43, v20
    v_dot2_f32_bf16 v24, v91, v91, v24
    v_add_u32 v1, -98304, v1
    v_add_u32 v2, -98304, v2
    v_add_u32 v3, -98304, v3
    v_add_u32 v4, -98304, v4
    v_add_u32 v5, -98304, v5
    v_add_u32 v6, -98304, v6
    v_add_u32 v7, -98304, v7
    v_add_u32 v8, -98304, v8
    s_waitcnt vmcnt(12)
    s_barrier
    ds_read_b64_tr_b16 v[28:29], v1 offset:0
    ds_read_b64_tr_b16 v[30:31], v1 offset:1024
    ds_read_b64_tr_b16 v[32:33], v2 offset:0
    ds_read_b64_tr_b16 v[34:35], v2 offset:1024
    ds_read_b64_tr_b16 v[36:37], v3 offset:0
    ds_read_b64_tr_b16 v[38:39], v3 offset:1024
    ds_read_b64_tr_b16 v[40:41], v4 offset:0
    ds_read_b64_tr_b16 v[42:43], v4 offset:1024
    ds_read_b64_tr_b16 v[44:45], v5 offset:0
    ds_read_b64_tr_b16 v[46:47], v5 offset:1024
    ds_read_b64_tr_b16 v[48:49], v6 offset:0
    ds_read_b64_tr_b16 v[50:51], v6 offset:1024
    ds_read_b64_tr_b16 v[52:53], v7 offset:0
    ds_read_b64_tr_b16 v[54:55], v7 offset:1024
    ds_read_b64_tr_b16 v[56:57], v8 offset:0
    ds_read_b64_tr_b16 v[58:59], v8 offset:1024
    ds_read_b64_tr_b16 v[60:61], v5 offset:16384
    ds_read_b64_tr_b16 v[62:63], v5 offset:17408
    ds_read_b64_tr_b16 v[64:65], v6 offset:16384
    ds_read_b64_tr_b16 v[66:67], v6 offset:17408
    ds_read_b64_tr_b16 v[68:69], v7 offset:16384
    ds_read_b64_tr_b16 v[70:71], v7 offset:17408
    ds_read_b64_tr_b16 v[72:73], v8 offset:16384
    ds_read_b64_tr_b16 v[74:75], v8 offset:17408
    s_waitcnt lgkmcnt(0)
    ds_read_b64_tr_b16 v[76:77], v1 offset:8192
    ds_read_b64_tr_b16 v[78:79], v1 offset:9216
    ds_read_b64_tr_b16 v[80:81], v2 offset:8192
    ds_read_b64_tr_b16 v[82:83], v2 offset:9216
    ds_read_b64_tr_b16 v[84:85], v3 offset:8192
    ds_read_b64_tr_b16 v[86:87], v3 offset:9216
    ds_read_b64_tr_b16 v[88:89], v4 offset:8192
    ds_read_b64_tr_b16 v[90:91], v4 offset:9216
    ds_read_b64_tr_b16 v[92:93], v5 offset:8192
    ds_read_b64_tr_b16 v[94:95], v5 offset:9216
    ds_read_b64_tr_b16 v[96:97], v6 offset:8192
    ds_read_b64_tr_b16 v[98:99], v6 offset:9216
    ds_read_b64_tr_b16 v[100:101], v7 offset:8192
    ds_read_b64_tr_b16 v[102:103], v7 offset:9216
    ds_read_b64_tr_b16 v[104:105], v8 offset:8192
    ds_read_b64_tr_b16 v[106:107], v8 offset:9216
    ds_read_b64_tr_b16 v[108:109], v5 offset:24576
    ds_read_b64_tr_b16 v[110:111], v5 offset:25600
    ds_read_b64_tr_b16 v[112:113], v6 offset:24576
    ds_read_b64_tr_b16 v[114:115], v6 offset:25600
    ds_read_b64_tr_b16 v[116:117], v7 offset:24576
    ds_read_b64_tr_b16 v[118:119], v7 offset:25600
    ds_read_b64_tr_b16 v[120:121], v8 offset:24576
    ds_read_b64_tr_b16 v[122:123], v8 offset:25600
    v_mfma_f32_16x16x32_bf16 v[128:131], v[28:31], v[44:47], v[128:131]
    v_mfma_f32_16x16x32_bf16 v[132:135], v[28:31], v[48:51], v[132:135]
    v_mfma_f32_16x16x32_bf16 v[136:139], v[28:31], v[52:55], v[136:139]
    v_mfma_f32_16x16x32_bf16 v[140:143], v[28:31], v[56:59], v[140:143]
    v_mfma_f32_16x16x32_bf16 v[144:147], v[28:31], v[60:63], v[144:147]
    v_mfma_f32_16x16x32_bf16 v[148:151], v[28:31], v[64:67], v[148:151]
    v_mfma_f32_16x16x32_bf16 v[152:155], v[28:31], v[68:71], v[152:155]
    v_mfma_f32_16x16x32_bf16 v[156:159], v[28:31], v[72:75], v[156:159]
    v_dot2_f32_bf16 v17, v28, s43, v17
    v_dot2_f32_bf16 v21, v28, v28, v21
    v_dot2_f32_bf16 v17, v29, s43, v17
    v_dot2_f32_bf16 v21, v29, v29, v21
    v_dot2_f32_bf16 v17, v30, s43, v17
    v_dot2_f32_bf16 v21, v30, v30, v21
    v_dot2_f32_bf16 v17, v31, s43, v17
    v_dot2_f32_bf16 v21, v31, v31, v21
    v_mfma_f32_16x16x32_bf16 v[160:163], v[32:35], v[44:47], v[160:163]
    v_mfma_f32_16x16x32_bf16 v[164:167], v[32:35], v[48:51], v[164:167]
    v_mfma_f32_16x16x32_bf16 v[168:171], v[32:35], v[52:55], v[168:171]
    v_mfma_f32_16x16x32_bf16 v[172:175], v[32:35], v[56:59], v[172:175]
    v_mfma_f32_16x16x32_bf16 v[176:179], v[32:35], v[60:63], v[176:179]
    v_mfma_f32_16x16x32_bf16 v[180:183], v[32:35], v[64:67], v[180:183]
    v_mfma_f32_16x16x32_bf16 v[184:187], v[32:35], v[68:71], v[184:187]
    v_mfma_f32_16x16x32_bf16 v[188:191], v[32:35], v[72:75], v[188:191]
    v_dot2_f32_bf16 v18, v32, s43, v18
    v_dot2_f32_bf16 v22, v32, v32, v22
    v_dot2_f32_bf16 v18, v33, s43, v18
    v_dot2_f32_bf16 v22, v33, v33, v22
    v_dot2_f32_bf16 v18, v34, s43, v18
    v_dot2_f32_bf16 v22, v34, v34, v22
    v_dot2_f32_bf16 v18, v35, s43, v18
    v_dot2_f32_bf16 v22, v35, v35, v22
    v_mfma_f32_16x16x32_bf16 v[192:195], v[36:39], v[44:47], v[192:195]
    v_mfma_f32_16x16x32_bf16 v[196:199], v[36:39], v[48:51], v[196:199]
    v_mfma_f32_16x16x32_bf16 v[200:203], v[36:39], v[52:55], v[200:203]
    v_mfma_f32_16x16x32_bf16 v[204:207], v[36:39], v[56:59], v[204:207]
    v_mfma_f32_16x16x32_bf16 v[208:211], v[36:39], v[60:63], v[208:211]
    v_mfma_f32_16x16x32_bf16 v[212:215], v[36:39], v[64:67], v[212:215]
    v_mfma_f32_16x16x32_bf16 v[216:219], v[36:39], v[68:71], v[216:219]
    v_mfma_f32_16x16x32_bf16 v[220:223], v[36:39], v[72:75], v[220:223]
    v_dot2_f32_bf16 v19, v36, s43, v19
    v_dot2_f32_bf16 v23, v36, v36, v23
    v_dot2_f32_bf16 v19, v37, s43, v19
    v_dot2_f32_bf16 v23, v37, v37, v23
    v_dot2_f32_bf16 v19, v38, s43, v19
    v_dot2_f32_bf16 v23, v38, v38, v23
    v_dot2_f32_bf16 v19, v39, s43, v19
    v_dot2_f32_bf16 v23, v39, v39, v23
    v_mfma_f32_16x16x32_bf16 v[224:227], v[40:43], v[44:47], v[224:227]
    v_mfma_f32_16x16x32_bf16 v[228:231], v[40:43], v[48:51], v[228:231]
    v_mfma_f32_16x16x32_bf16 v[232:235], v[40:43], v[52:55], v[232:235]
    v_mfma_f32_16x16x32_bf16 v[236:239], v[40:43], v[56:59], v[236:239]
    v_mfma_f32_16x16x32_bf16 v[240:243], v[40:43], v[60:63], v[240:243]
    v_mfma_f32_16x16x32_bf16 v[244:247], v[40:43], v[64:67], v[244:247]
    v_mfma_f32_16x16x32_bf16 v[248:251], v[40:43], v[68:71], v[248:251]
    v_mfma_f32_16x16x32_bf16 v[252:255], v[40:43], v[72:75], v[252:255]
    v_dot2_f32_bf16 v20, v40, s43, v20
    v_dot2_f32_bf16 v24, v40, v40, v24
    v_dot2_f32_bf16 v20, v41, s43, v20
    v_dot2_f32_bf16 v24, v41, v41, v24
    v_dot2_f32_bf16 v20, v42, s43, v20
    v_dot2_f32_bf16 v24, v42, v42, v24
    v_dot2_f32_bf16 v20, v43, s43, v20
    v_dot2_f32_bf16 v24, v43, v43, v24
    s_waitcnt lgkmcnt(0)
    v_mfma_f32_16x16x32_bf16 v[128:131], v[76:79], v[92:95], v[128:131]
    v_mfma_f32_16x16x32_bf16 v[132:135], v[76:79], v[96:99], v[132:135]
    v_mfma_f32_16x16x32_bf16 v[136:139], v[76:79], v[100:103], v[136:139]
    v_mfma_f32_16x16x32_bf16 v[140:143], v[76:79], v[104:107], v[140:143]
    v_mfma_f32_16x16x32_bf16 v[144:147], v[76:79], v[108:111], v[144:147]
    v_mfma_f32_16x16x32_bf16 v[148:151], v[76:79], v[112:115], v[148:151]
    v_mfma_f32_16x16x32_bf16 v[152:155], v[76:79], v[116:119], v[152:155]
    v_mfma_f32_16x16x32_bf16 v[156:159], v[76:79], v[120:123], v[156:159]
    v_dot2_f32_bf16 v17, v76, s43, v17
    v_dot2_f32_bf16 v21, v76, v76, v21
    v_dot2_f32_bf16 v17, v77, s43, v17
    v_dot2_f32_bf16 v21, v77, v77, v21
    v_dot2_f32_bf16 v17, v78, s43, v17
    v_dot2_f32_bf16 v21, v78, v78, v21
    v_dot2_f32_bf16 v17, v79, s43, v17
    v_dot2_f32_bf16 v21, v79, v79, v21
    v_mfma_f32_16x16x32_bf16 v[160:163], v[80:83], v[92:95], v[160:163]
    v_mfma_f32_16x16x32_bf16 v[164:167], v[80:83], v[96:99], v[164:167]
    v_mfma_f32_16x16x32_bf16 v[168:171], v[80:83], v[100:103], v[168:171]
    v_mfma_f32_16x16x32_bf16 v[172:175], v[80:83], v[104:107], v[172:175]
    v_mfma_f32_16x16x32_bf16 v[176:179], v[80:83], v[108:111], v[176:179]
    v_mfma_f32_16x16x32_bf16 v[180:183], v[80:83], v[112:115], v[180:183]
    v_mfma_f32_16x16x32_bf16 v[184:187], v[80:83], v[116:119], v[184:187]
    v_mfma_f32_16x16x32_bf16 v[188:191], v[80:83], v[120:123], v[188:191]
    v_dot2_f32_bf16 v18, v80, s43, v18
    v_dot2_f32_bf16 v22, v80, v80, v22
    v_dot2_f32_bf16 v18, v81, s43, v18
    v_dot2_f32_bf16 v22, v81, v81, v22
    v_dot2_f32_bf16 v18, v82, s43, v18
    v_dot2_f32_bf16 v22, v82, v82, v22
    v_dot2_f32_bf16 v18, v83, s43, v18
    v_dot2_f32_bf16 v22, v83, v83, v22
    v_mfma_f32_16x16x32_bf16 v[192:195], v[84:87], v[92:95], v[192:195]
    v_mfma_f32_16x16x32_bf16 v[196:199], v[84:87], v[96:99], v[196:199]
    v_mfma_f32_16x16x32_bf16 v[200:203], v[84:87], v[100:103], v[200:203]
    v_mfma_f32_16x16x32_bf16 v[204:207], v[84:87], v[104:107], v[204:207]
    v_mfma_f32_16x16x32_bf16 v[208:211], v[84:87], v[108:111], v[208:211]
    v_mfma_f32_16x16x32_bf16 v[212:215], v[84:87], v[112:115], v[212:215]
    v_mfma_f32_16x16x32_bf16 v[216:219], v[84:87], v[116:119], v[216:219]
    v_mfma_f32_16x16x32_bf16 v[220:223], v[84:87], v[120:123], v[220:223]
    v_dot2_f32_bf16 v19, v84, s43, v19
    v_dot2_f32_bf16 v23, v84, v84, v23
    v_dot2_f32_bf16 v19, v85, s43, v19
    v_dot2_f32_bf16 v23, v85, v85, v23
    v_dot2_f32_bf16 v19, v86, s43, v19
    v_dot2_f32_bf16 v23, v86, v86, v23
    v_dot2_f32_bf16 v19, v87, s43, v19
    v_dot2_f32_bf16 v23, v87, v87, v23
    v_mfma_f32_16x16x32_bf16 v[224:227], v[88:91], v[92:95], v[224:227]
    v_mfma_f32_16x16x32_bf16 v[228:231], v[88:91], v[96:99], v[228:231]
    v_mfma_f32_16x16x32_bf16 v[232:235], v[88:91], v[100:103], v[232:235]
    v_mfma_f32_16x16x32_bf16 v[236:239], v[88:91], v[104:107], v[236:239]
    v_mfma_f32_16x16x32_bf16 v[240:243], v[88:91], v[108:111], v[240:243]
    v_mfma_f32_16x16x32_bf16 v[244:247], v[88:91], v[112:115], v[244:247]
    v_mfma_f32_16x16x32_bf16 v[248:251], v[88:91], v[116:119], v[248:251]
    v_mfma_f32_16x16x32_bf16 v[252:255], v[88:91], v[120:123], v[252:255]
    v_dot2_f32_bf16 v20, v88, s43, v20
    v_dot2_f32_bf16 v24, v88, v88, v24
    v_dot2_f32_bf16 v20, v89, s43, v20
    v_dot2_f32_bf16 v24, v89, v89, v24
    v_dot2_f32_bf16 v20, v90, s43, v20
    v_dot2_f32_bf16 v24, v90, v90, v24
    v_dot2_f32_bf16 v20, v91, s43, v20
    v_dot2_f32_bf16 v24, v91, v91, v24
    v_add_u32 v1, 49152, v1
    v_add_u32 v2, 49152, v2
    v_add_u32 v3, 49152, v3
    v_add_u32 v4, 49152, v4
    v_add_u32 v5, 49152, v5
    v_add_u32 v6, 49152, v6
    v_add_u32 v7, 49152, v7
    v_add_u32 v8, 49152, v8
    s_waitcnt vmcnt(0)
    s_barrier
    ds_read_b64_tr_b16 v[28:29], v1 offset:0
    ds_read_b64_tr_b16 v[30:31], v1 offset:1024
    ds_read_b64_tr_b16 v[32:33], v2 offset:0
    ds_read_b64_tr_b16 v[34:35], v2 offset:1024
    ds_read_b64_tr_b16 v[36:37], v3 offset:0
    ds_read_b64_tr_b16 v[38:39], v3 offset:1024
    ds_read_b64_tr_b16 v[40:41], v4 offset:0
    ds_read_b64_tr_b16 v[42:43], v4 offset:1024
    ds_read_b64_tr_b16 v[44:45], v5 offset:0
    ds_read_b64_tr_b16 v[46:47], v5 offset:1024
    ds_read_b64_tr_b16 v[48:49], v6 offset:0
    ds_read_b64_tr_b16 v[50:51], v6 offset:1024
    ds_read_b64_tr_b16 v[52:53], v7 offset:0
    ds_read_b64_tr_b16 v[54:55], v7 offset:1024
    ds_read_b64_tr_b16 v[56:57], v8 offset:0
    ds_read_b64_tr_b16 v[58:59], v8 offset:1024
    ds_read_b64_tr_b16 v[60:61], v5 offset:16384
    ds_read_b64_tr_b16 v[62:63], v5 offset:17408
    ds_read_b64_tr_b16 v[64:65], v6 offset:16384
    ds_read_b64_tr_b16 v[66:67], v6 offset:17408
    ds_read_b64_tr_b16 v[68:69], v7 offset:16384
    ds_read_b64_tr_b16 v[70:71], v7 offset:17408
    ds_read_b64_tr_b16 v[72:73], v8 offset:16384
    ds_read_b64_tr_b16 v[74:75], v8 offset:17408
    s_waitcnt lgkmcnt(0)
    ds_read_b64_tr_b16 v[76:77], v1 offset:8192
    ds_read_b64_tr_b16 v[78:79], v1 offset:9216
    ds_read_b64_tr_b16 v[80:81], v2 offset:8192
    ds_read_b64_tr_b16 v[82:83], v2 offset:9216
    ds_read_b64_tr_b16 v[84:85], v3 offset:8192
    ds_read_b64_tr_b16 v[86:87], v3 offset:9216
    ds_read_b64_tr_b16 v[88:89], v4 offset:8192
    ds_read_b64_tr_b16 v[90:91], v4 offset:9216
    ds_read_b64_tr_b16 v[92:93], v5 offset:8192
    ds_read_b64_tr_b16 v[94:95], v5 offset:9216
    ds_read_b64_tr_b16 v[96:97], v6 offset:8192
    ds_read_b64_tr_b16 v[98:99], v6 offset:9216
    ds_read_b64_tr_b16 v[100:101], v7 offset:8192
    ds_read_b64_tr_b16 v[102:103], v7 offset:9216
    ds_read_b64_tr_b16 v[104:105], v8 offset:8192
    ds_read_b64_tr_b16 v[106:107], v8 offset:9216
    ds_read_b64_tr_b16 v[108:109], v5 offset:24576
    ds_read_b64_tr_b16 v[110:111], v5 offset:25600
    ds_read_b64_tr_b16 v[112:113], v6 offset:24576
    ds_read_b64_tr_b16 v[114:115], v6 offset:25600
    ds_read_b64_tr_b16 v[116:117], v7 offset:24576
    ds_read_b64_tr_b16 v[118:119], v7 offset:25600
    ds_read_b64_tr_b16 v[120:121], v8 offset:24576
    ds_read_b64_tr_b16 v[122:123], v8 offset:25600
    v_mfma_f32_16x16x32_bf16 v[128:131], v[28:31], v[44:47], v[128:131]
    v_mfma_f32_16x16x32_bf16 v[132:135], v[28:31], v[48:51], v[132:135]
    v_mfma_f32_16x16x32_bf16 v[136:139], v[28:31], v[52:55], v[136:139]
    v_mfma_f32_16x16x32_bf16 v[140:143], v[28:31], v[56:59], v[140:143]
    v_mfma_f32_16x16x32_bf16 v[144:147], v[28:31], v[60:63], v[144:147]
    v_mfma_f32_16x16x32_bf16 v[148:151], v[28:31], v[64:67], v[148:151]
    v_mfma_f32_16x16x32_bf16 v[152:155], v[28:31], v[68:71], v[152:155]
    v_mfma_f32_16x16x32_bf16 v[156:159], v[28:31], v[72:75], v[156:159]
    v_dot2_f32_bf16 v17, v28, s43, v17
    v_dot2_f32_bf16 v21, v28, v28, v21
    v_dot2_f32_bf16 v17, v29, s43, v17
    v_dot2_f32_bf16 v21, v29, v29, v21
    v_dot2_f32_bf16 v17, v30, s43, v17
    v_dot2_f32_bf16 v21, v30, v30, v21
    v_dot2_f32_bf16 v17, v31, s43, v17
    v_dot2_f32_bf16 v21, v31, v31, v21
    v_mfma_f32_16x16x32_bf16 v[160:163], v[32:35], v[44:47], v[160:163]
    v_mfma_f32_16x16x32_bf16 v[164:167], v[32:35], v[48:51], v[164:167]
    v_mfma_f32_16x16x32_bf16 v[168:171], v[32:35], v[52:55], v[168:171]
    v_mfma_f32_16x16x32_bf16 v[172:175], v[32:35], v[56:59], v[172:175]
    v_mfma_f32_16x16x32_bf16 v[176:179], v[32:35], v[60:63], v[176:179]
    v_mfma_f32_16x16x32_bf16 v[180:183], v[32:35], v[64:67], v[180:183]
    v_mfma_f32_16x16x32_bf16 v[184:187], v[32:35], v[68:71], v[184:187]
    v_mfma_f32_16x16x32_bf16 v[188:191], v[32:35], v[72:75], v[188:191]
    v_dot2_f32_bf16 v18, v32, s43, v18
    v_dot2_f32_bf16 v22, v32, v32, v22
    v_dot2_f32_bf16 v18, v33, s43, v18
    v_dot2_f32_bf16 v22, v33, v33, v22
    v_dot2_f32_bf16 v18, v34, s43, v18
    v_dot2_f32_bf16 v22, v34, v34, v22
    v_dot2_f32_bf16 v18, v35, s43, v18
    v_dot2_f32_bf16 v22, v35, v35, v22
    v_mfma_f32_16x16x32_bf16 v[192:195], v[36:39], v[44:47], v[192:195]
    v_mfma_f32_16x16x32_bf16 v[196:199], v[36:39], v[48:51], v[196:199]
    v_mfma_f32_16x16x32_bf16 v[200:203], v[36:39], v[52:55], v[200:203]
    v_mfma_f32_16x16x32_bf16 v[204:207], v[36:39], v[56:59], v[204:207]
    v_mfma_f32_16x16x32_bf16 v[208:211], v[36:39], v[60:63], v[208:211]
    v_mfma_f32_16x16x32_bf16 v[212:215], v[36:39], v[64:67], v[212:215]
    v_mfma_f32_16x16x32_bf16 v[216:219], v[36:39], v[68:71], v[216:219]
    v_mfma_f32_16x16x32_bf16 v[220:223], v[36:39], v[72:75], v[220:223]
    v_dot2_f32_bf16 v19, v36, s43, v19
    v_dot2_f32_bf16 v23, v36, v36, v23
    v_dot2_f32_bf16 v19, v37, s43, v19
    v_dot2_f32_bf16 v23, v37, v37, v23
    v_dot2_f32_bf16 v19, v38, s43, v19
    v_dot2_f32_bf16 v23, v38, v38, v23
    v_dot2_f32_bf16 v19, v39, s43, v19
    v_dot2_f32_bf16 v23, v39, v39, v23
    v_mfma_f32_16x16x32_bf16 v[224:227], v[40:43], v[44:47], v[224:227]
    v_mfma_f32_16x16x32_bf16 v[228:231], v[40:43], v[48:51], v[228:231]
    v_mfma_f32_16x16x32_bf16 v[232:235], v[40:43], v[52:55], v[232:235]
    v_mfma_f32_16x16x32_bf16 v[236:239], v[40:43], v[56:59], v[236:239]
    v_mfma_f32_16x16x32_bf16 v[240:243], v[40:43], v[60:63], v[240:243]
    v_mfma_f32_16x16x32_bf16 v[244:247], v[40:43], v[64:67], v[244:247]
    v_mfma_f32_16x16x32_bf16 v[248:251], v[40:43], v[68:71], v[248:251]
    v_mfma_f32_16x16x32_bf16 v[252:255], v[40:43], v[72:75], v[252:255]
    v_dot2_f32_bf16 v20, v40, s43, v20
    v_dot2_f32_bf16 v24, v40, v40, v24
    v_dot2_f32_bf16 v20, v41, s43, v20
    v_dot2_f32_bf16 v24, v41, v41, v24
    v_dot2_f32_bf16 v20, v42, s43, v20
    v_dot2_f32_bf16 v24, v42, v42, v24
    v_dot2_f32_bf16 v20, v43, s43, v20
    v_dot2_f32_bf16 v24, v43, v43, v24
    s_waitcnt lgkmcnt(0)
    v_mfma_f32_16x16x32_bf16 v[128:131], v[76:79], v[92:95], v[128:131]
    v_mfma_f32_16x16x32_bf16 v[132:135], v[76:79], v[96:99], v[132:135]
    v_mfma_f32_16x16x32_bf16 v[136:139], v[76:79], v[100:103], v[136:139]
    v_mfma_f32_16x16x32_bf16 v[140:143], v[76:79], v[104:107], v[140:143]
    v_mfma_f32_16x16x32_bf16 v[144:147], v[76:79], v[108:111], v[144:147]
    v_mfma_f32_16x16x32_bf16 v[148:151], v[76:79], v[112:115], v[148:151]
    v_mfma_f32_16x16x32_bf16 v[152:155], v[76:79], v[116:119], v[152:155]
    v_mfma_f32_16x16x32_bf16 v[156:159], v[76:79], v[120:123], v[156:159]
    v_dot2_f32_bf16 v17, v76, s43, v17
    v_dot2_f32_bf16 v21, v76, v76, v21
    v_dot2_f32_bf16 v17, v77, s43, v17
    v_dot2_f32_bf16 v21, v77, v77, v21
    v_dot2_f32_bf16 v17, v78, s43, v17
    v_dot2_f32_bf16 v21, v78, v78, v21
    v_dot2_f32_bf16 v17, v79, s43, v17
    v_dot2_f32_bf16 v21, v79, v79, v21
    v_mfma_f32_16x16x32_bf16 v[160:163], v[80:83], v[92:95], v[160:163]
    v_mfma_f32_16x16x32_bf16 v[164:167], v[80:83], v[96:99], v[164:167]
    v_mfma_f32_16x16x32_bf16 v[168:171], v[80:83], v[100:103], v[168:171]
    v_mfma_f32_16x16x32_bf16 v[172:175], v[80:83], v[104:107], v[172:175]
    v_mfma_f32_16x16x32_bf16 v[176:179], v[80:83], v[108:111], v[176:179]
    v_mfma_f32_16x16x32_bf16 v[180:183], v[80:83], v[112:115], v[180:183]
    v_mfma_f32_16x16x32_bf16 v[184:187], v[80:83], v[116:119], v[184:187]
    v_mfma_f32_16x16x32_bf16 v[188:191], v[80:83], v[120:123], v[188:191]
    v_dot2_f32_bf16 v18, v80, s43, v18
    v_dot2_f32_bf16 v22, v80, v80, v22
    v_dot2_f32_bf16 v18, v81, s43, v18
    v_dot2_f32_bf16 v22, v81, v81, v22
    v_dot2_f32_bf16 v18, v82, s43, v18
    v_dot2_f32_bf16 v22, v82, v82, v22
    v_dot2_f32_bf16 v18, v83, s43, v18
    v_dot2_f32_bf16 v22, v83, v83, v22
    v_mfma_f32_16x16x32_bf16 v[192:195], v[84:87], v[92:95], v[192:195]
    v_mfma_f32_16x16x32_bf16 v[196:199], v[84:87], v[96:99], v[196:199]
    v_mfma_f32_16x16x32_bf16 v[200:203], v[84:87], v[100:103], v[200:203]
    v_mfma_f32_16x16x32_bf16 v[204:207], v[84:87], v[104:107], v[204:207]
    v_mfma_f32_16x16x32_bf16 v[208:211], v[84:87], v[108:111], v[208:211]
    v_mfma_f32_16x16x32_bf16 v[212:215], v[84:87], v[112:115], v[212:215]
    v_mfma_f32_16x16x32_bf16 v[216:219], v[84:87], v[116:119], v[216:219]
    v_mfma_f32_16x16x32_bf16 v[220:223], v[84:87], v[120:123], v[220:223]
    v_dot2_f32_bf16 v19, v84, s43, v19
    v_dot2_f32_bf16 v23, v84, v84, v23
    v_dot2_f32_bf16 v19, v85, s43, v19
    v_dot2_f32_bf16 v23, v85, v85, v23
    v_dot2_f32_bf16 v19, v86, s43, v19
    v_dot2_f32_bf16 v23, v86, v86, v23
    v_dot2_f32_bf16 v19, v87, s43, v19
    v_dot2_f32_bf16 v23, v87, v87, v23
    v_mfma_f32_16x16x32_bf16 v[224:227], v[88:91], v[92:95], v[224:227]
    v_mfma_f32_16x16x32_bf16 v[228:231], v[88:91], v[96:99], v[228:231]
    v_mfma_f32_16x16x32_bf16 v[232:235], v[88:91], v[100:103], v[232:235]
    v_mfma_f32_16x16x32_bf16 v[236:239], v[88:91], v[104:107], v[236:239]
    v_mfma_f32_16x16x32_bf16 v[240:243], v[88:91], v[108:111], v[240:243]
    v_mfma_f32_16x16x32_bf16 v[244:247], v[88:91], v[112:115], v[244:247]
    v_mfma_f32_16x16x32_bf16 v[248:251], v[88:91], v[116:119], v[248:251]
    v_mfma_f32_16x16x32_bf16 v[252:255], v[88:91], v[120:123], v[252:255]
    v_dot2_f32_bf16 v20, v88, s43, v20
    v_dot2_f32_bf16 v24, v88, v88, v24
    v_dot2_f32_bf16 v20, v89, s43, v20
    v_dot2_f32_bf16 v24, v89, v89, v24
    v_dot2_f32_bf16 v20, v90, s43, v20
    v_dot2_f32_bf16 v24, v90, v90, v24
    v_dot2_f32_bf16 v20, v91, s43, v20
    v_dot2_f32_bf16 v24, v91, v91, v24
    v_add_u32 v1, 49152, v1
    v_add_u32 v2, 49152, v2
    v_add_u32 v3, 49152, v3
    v_add_u32 v4, 49152, v4
    v_add_u32 v5, 49152, v5
    v_add_u32 v6, 49152, v6
    v_add_u32 v7, 49152, v7
    v_add_u32 v8, 49152, v8
    s_barrier
    s_lshl_b32 s35, s30, 12
    v_lshlrev_b32 v0, 5, v26
    v_lshl_add_u32 v0, v27, 3, v0
    v_add_u32 v0, s35, v0
    v_mov_b32 v2, v17
    v_mov_b32 v3, v21
    ds_write_b64 v0, v[2:3] offset:0
    v_mov_b32 v2, v18
    v_mov_b32 v3, v22
    ds_write_b64 v0, v[2:3] offset:512
    v_mov_b32 v2, v19
    v_mov_b32 v3, v23
    ds_write_b64 v0, v[2:3] offset:1024
    v_mov_b32 v2, v20
    v_mov_b32 v3, v24
    ds_write_b64 v0, v[2:3] offset:1536
    v_lshl_add_u32 v1, v25, 5, s35
    s_waitcnt lgkmcnt(0)
    ds_read_b128 v[2:5], v1
    ds_read_b128 v[6:9], v1 offset:16
    s_waitcnt lgkmcnt(0)
    v_add_f32 v2, v2, v4
    v_add_f32 v6, v6, v8
    v_add_f32 v2, v2, v6
    v_add_f32 v3, v3, v5
    v_add_f32 v7, v7, v9
    v_add_f32 v3, v3, v7
    v_mul_f32 v6, 0x3b000000, v2
    v_mul_f32 v7, 0x3b000000, v3
    v_fma_f32 v7, -v6, v6, v7
    v_max_f32 v7, 0, v7
    v_cvt_pk_bf16_f32 v6, v6, v7
    s_nop 0
    v_lshlrev_b32 v4, 16, v6
    v_and_b32 v7, 0xffff0000, v6
    v_add_f32 v7, 0x3727c5ac, v7
    v_cvt_pk_bf16_f32 v7, v7, v7
    s_nop 0
    v_lshlrev_b32 v7, 16, v7
    v_sqrt_f32 v7, v7
    s_nop 0
    v_cvt_pk_bf16_f32 v7, v7, v7
    s_nop 0
    v_lshlrev_b32 v7, 16, v7
    v_rcp_f32 v5, v7
    s_nop 0
    v_lshl_add_u32 v1, v25, 3, s35
    ds_write_b64 v1, v[4:5] offset:2048
    s_lshl_b32 s36, s32, 6
    s_add_u32 s36, s36, s34
    v_add_u32 v2, s36, v26
    v_lshlrev_b32 v2, 2, v2
    s_movk_i32 s39, 0
    buffer_load_dword v28, v2, s[24:27], s39 offen offset:0
    s_movk_i32 s39, 0
    buffer_load_dword v29, v2, s[24:27], s39 offen offset:64
    s_movk_i32 s39, 0
    buffer_load_dword v30, v2, s[24:27], s39 offen offset:128
    s_movk_i32 s39, 0
    buffer_load_dword v31, v2, s[24:27], s39 offen offset:192
    s_movk_i32 s39, 7168
    buffer_load_dword v32, v2, s[24:27], s39 offen offset:0
    s_movk_i32 s39, 7168
    buffer_load_dword v33, v2, s[24:27], s39 offen offset:64
    s_movk_i32 s39, 7168
    buffer_load_dword v34, v2, s[24:27], s39 offen offset:128
    s_movk_i32 s39, 7168
    buffer_load_dword v35, v2, s[24:27], s39 offen offset:192
    v_lshl_add_u32 v1, v27, 5, s35
    s_waitcnt lgkmcnt(0)
    ds_read_b64 v[40:41], v1 offset:2048
    ds_read_b64 v[42:43], v1 offset:2056
    ds_read_b64 v[44:45], v1 offset:2064
    ds_read_b64 v[46:47], v1 offset:2072
    ds_read_b64 v[48:49], v1 offset:2176
    ds_read_b64 v[50:51], v1 offset:2184
    ds_read_b64 v[52:53], v1 offset:2192
    ds_read_b64 v[54:55], v1 offset:2200
    ds_read_b64 v[56:57], v1 offset:2304
    ds_read_b64 v[58:59], v1 offset:2312
    ds_read_b64 v[60:61], v1 offset:2320
    ds_read_b64 v[62:63], v1 offset:2328
    ds_read_b64 v[64:65], v1 offset:2432
    ds_read_b64 v[66:67], v1 offset:2440
    ds_read_b64 v[68:69], v1 offset:2448
    ds_read_b64 v[70:71], v1 offset:2456
    v_lshlrev_b32 v3, 12, v2
    v_lshrrev_b32 v3, 2, v3
    v_lshl_add_u32 v3, v27, 3, v3
    s_lshl_b32 s37, s31, 6
    s_add_u32 s37, s37, s33
    s_lshl_b32 s37, s37, 1
    s_waitcnt vmcnt(0) lgkmcnt(0)
    v_fma_f32 v80, -v40, v28, v128
    v_mul_f32 v80, v80, v41
    v_fma_f32 v81, -v42, v28, v129
    v_mul_f32 v81, v81, v43
    v_fma_f32 v82, -v44, v28, v130
    v_mul_f32 v82, v82, v45
    v_fma_f32 v83, -v46, v28, v131
    v_mul_f32 v83, v83, v47
    v_fma_f32 v84, -v40, v32, v144
    v_mul_f32 v84, v84, v41
    v_fma_f32 v85, -v42, v32, v145
    v_mul_f32 v85, v85, v43
    v_fma_f32 v86, -v44, v32, v146
    v_mul_f32 v86, v86, v45
    v_fma_f32 v87, -v46, v32, v147
    v_mul_f32 v87, v87, v47
    v_cvt_pk_bf16_f32 v80, v80, v80
    v_cvt_pk_bf16_f32 v81, v81, v81
    v_cvt_pk_bf16_f32 v82, v82, v82
    v_cvt_pk_bf16_f32 v83, v83, v83
    v_cvt_pk_bf16_f32 v84, v84, v84
    v_cvt_pk_bf16_f32 v85, v85, v85
    v_cvt_pk_bf16_f32 v86, v86, v86
    v_cvt_pk_bf16_f32 v87, v87, v87
    s_nop 0
    v_lshlrev_b32 v80, 16, v80
    v_lshlrev_b32 v81, 16, v81
    v_lshlrev_b32 v82, 16, v82
    v_lshlrev_b32 v83, 16, v83
    v_lshlrev_b32 v84, 16, v84
    v_lshlrev_b32 v85, 16, v85
    v_lshlrev_b32 v86, 16, v86
    v_lshlrev_b32 v87, 16, v87
    v_mul_f32 v88, v80, v80
    v_fma_f32 v88, v88, s44, 1.0
    v_mul_f32 v88, v88, v80
    v_mul_f32 v88, 0xc0135761, v88
    v_exp_f32 v88, v88
    s_nop 0
    v_add_f32 v88, 1.0, v88
    v_rcp_f32 v88, v88
    s_nop 0
    v_mul_f32 v88, v88, v80
    v_cvt_pk_bf16_f32 v88, v88, v88
    s_nop 0
    v_lshlrev_b32 v88, 16, v88
    v_mul_f32 v88, v88, v84
    v_mul_f32 v89, v81, v81
    v_fma_f32 v89, v89, s44, 1.0
    v_mul_f32 v89, v89, v81
    v_mul_f32 v89, 0xc0135761, v89
    v_exp_f32 v89, v89
    s_nop 0
    v_add_f32 v89, 1.0, v89
    v_rcp_f32 v89, v89
    s_nop 0
    v_mul_f32 v89, v89, v81
    v_cvt_pk_bf16_f32 v89, v89, v89
    s_nop 0
    v_lshlrev_b32 v89, 16, v89
    v_mul_f32 v89, v89, v85
    v_mul_f32 v90, v82, v82
    v_fma_f32 v90, v90, s44, 1.0
    v_mul_f32 v90, v90, v82
    v_mul_f32 v90, 0xc0135761, v90
    v_exp_f32 v90, v90
    s_nop 0
    v_add_f32 v90, 1.0, v90
    v_rcp_f32 v90, v90
    s_nop 0
    v_mul_f32 v90, v90, v82
    v_cvt_pk_bf16_f32 v90, v90, v90
    s_nop 0
    v_lshlrev_b32 v90, 16, v90
    v_mul_f32 v90, v90, v86
    v_mul_f32 v91, v83, v83
    v_fma_f32 v91, v91, s44, 1.0
    v_mul_f32 v91, v91, v83
    v_mul_f32 v91, 0xc0135761, v91
    v_exp_f32 v91, v91
    s_nop 0
    v_add_f32 v91, 1.0, v91
    v_rcp_f32 v91, v91
    s_nop 0
    v_mul_f32 v91, v91, v83
    v_cvt_pk_bf16_f32 v91, v91, v91
    s_nop 0
    v_lshlrev_b32 v91, 16, v91
    v_mul_f32 v91, v91, v87
    v_cvt_pk_bf16_f32 v96, v88, v89
    v_cvt_pk_bf16_f32 v97, v90, v91
    s_add_u32 s38, s37, 0
    s_nop 0
    buffer_store_dwordx2 v[96:97], v3, s[20:23], s38 offen offset:0
    s_nop 0
    v_fma_f32 v80, -v40, v29, v132
    v_mul_f32 v80, v80, v41
    v_fma_f32 v81, -v42, v29, v133
    v_mul_f32 v81, v81, v43
    v_fma_f32 v82, -v44, v29, v134
    v_mul_f32 v82, v82, v45
    v_fma_f32 v83, -v46, v29, v135
    v_mul_f32 v83, v83, v47
    v_fma_f32 v84, -v40, v33, v148
    v_mul_f32 v84, v84, v41
    v_fma_f32 v85, -v42, v33, v149
    v_mul_f32 v85, v85, v43
    v_fma_f32 v86, -v44, v33, v150
    v_mul_f32 v86, v86, v45
    v_fma_f32 v87, -v46, v33, v151
    v_mul_f32 v87, v87, v47
    v_cvt_pk_bf16_f32 v80, v80, v80
    v_cvt_pk_bf16_f32 v81, v81, v81
    v_cvt_pk_bf16_f32 v82, v82, v82
    v_cvt_pk_bf16_f32 v83, v83, v83
    v_cvt_pk_bf16_f32 v84, v84, v84
    v_cvt_pk_bf16_f32 v85, v85, v85
    v_cvt_pk_bf16_f32 v86, v86, v86
    v_cvt_pk_bf16_f32 v87, v87, v87
    s_nop 0
    v_lshlrev_b32 v80, 16, v80
    v_lshlrev_b32 v81, 16, v81
    v_lshlrev_b32 v82, 16, v82
    v_lshlrev_b32 v83, 16, v83
    v_lshlrev_b32 v84, 16, v84
    v_lshlrev_b32 v85, 16, v85
    v_lshlrev_b32 v86, 16, v86
    v_lshlrev_b32 v87, 16, v87
    v_mul_f32 v88, v80, v80
    v_fma_f32 v88, v88, s44, 1.0
    v_mul_f32 v88, v88, v80
    v_mul_f32 v88, 0xc0135761, v88
    v_exp_f32 v88, v88
    s_nop 0
    v_add_f32 v88, 1.0, v88
    v_rcp_f32 v88, v88
    s_nop 0
    v_mul_f32 v88, v88, v80
    v_cvt_pk_bf16_f32 v88, v88, v88
    s_nop 0
    v_lshlrev_b32 v88, 16, v88
    v_mul_f32 v88, v88, v84
    v_mul_f32 v89, v81, v81
    v_fma_f32 v89, v89, s44, 1.0
    v_mul_f32 v89, v89, v81
    v_mul_f32 v89, 0xc0135761, v89
    v_exp_f32 v89, v89
    s_nop 0
    v_add_f32 v89, 1.0, v89
    v_rcp_f32 v89, v89
    s_nop 0
    v_mul_f32 v89, v89, v81
    v_cvt_pk_bf16_f32 v89, v89, v89
    s_nop 0
    v_lshlrev_b32 v89, 16, v89
    v_mul_f32 v89, v89, v85
    v_mul_f32 v90, v82, v82
    v_fma_f32 v90, v90, s44, 1.0
    v_mul_f32 v90, v90, v82
    v_mul_f32 v90, 0xc0135761, v90
    v_exp_f32 v90, v90
    s_nop 0
    v_add_f32 v90, 1.0, v90
    v_rcp_f32 v90, v90
    s_nop 0
    v_mul_f32 v90, v90, v82
    v_cvt_pk_bf16_f32 v90, v90, v90
    s_nop 0
    v_lshlrev_b32 v90, 16, v90
    v_mul_f32 v90, v90, v86
    v_mul_f32 v91, v83, v83
    v_fma_f32 v91, v91, s44, 1.0
    v_mul_f32 v91, v91, v83
    v_mul_f32 v91, 0xc0135761, v91
    v_exp_f32 v91, v91
    s_nop 0
    v_add_f32 v91, 1.0, v91
    v_rcp_f32 v91, v91
    s_nop 0
    v_mul_f32 v91, v91, v83
    v_cvt_pk_bf16_f32 v91, v91, v91
    s_nop 0
    v_lshlrev_b32 v91, 16, v91
    v_mul_f32 v91, v91, v87
    v_cvt_pk_bf16_f32 v96, v88, v89
    v_cvt_pk_bf16_f32 v97, v90, v91
    s_add_u32 s38, s37, 65536
    s_nop 0
    buffer_store_dwordx2 v[96:97], v3, s[20:23], s38 offen offset:0
    s_nop 0
    v_fma_f32 v80, -v40, v30, v136
    v_mul_f32 v80, v80, v41
    v_fma_f32 v81, -v42, v30, v137
    v_mul_f32 v81, v81, v43
    v_fma_f32 v82, -v44, v30, v138
    v_mul_f32 v82, v82, v45
    v_fma_f32 v83, -v46, v30, v139
    v_mul_f32 v83, v83, v47
    v_fma_f32 v84, -v40, v34, v152
    v_mul_f32 v84, v84, v41
    v_fma_f32 v85, -v42, v34, v153
    v_mul_f32 v85, v85, v43
    v_fma_f32 v86, -v44, v34, v154
    v_mul_f32 v86, v86, v45
    v_fma_f32 v87, -v46, v34, v155
    v_mul_f32 v87, v87, v47
    v_cvt_pk_bf16_f32 v80, v80, v80
    v_cvt_pk_bf16_f32 v81, v81, v81
    v_cvt_pk_bf16_f32 v82, v82, v82
    v_cvt_pk_bf16_f32 v83, v83, v83
    v_cvt_pk_bf16_f32 v84, v84, v84
    v_cvt_pk_bf16_f32 v85, v85, v85
    v_cvt_pk_bf16_f32 v86, v86, v86
    v_cvt_pk_bf16_f32 v87, v87, v87
    s_nop 0
    v_lshlrev_b32 v80, 16, v80
    v_lshlrev_b32 v81, 16, v81
    v_lshlrev_b32 v82, 16, v82
    v_lshlrev_b32 v83, 16, v83
    v_lshlrev_b32 v84, 16, v84
    v_lshlrev_b32 v85, 16, v85
    v_lshlrev_b32 v86, 16, v86
    v_lshlrev_b32 v87, 16, v87
    v_mul_f32 v88, v80, v80
    v_fma_f32 v88, v88, s44, 1.0
    v_mul_f32 v88, v88, v80
    v_mul_f32 v88, 0xc0135761, v88
    v_exp_f32 v88, v88
    s_nop 0
    v_add_f32 v88, 1.0, v88
    v_rcp_f32 v88, v88
    s_nop 0
    v_mul_f32 v88, v88, v80
    v_cvt_pk_bf16_f32 v88, v88, v88
    s_nop 0
    v_lshlrev_b32 v88, 16, v88
    v_mul_f32 v88, v88, v84
    v_mul_f32 v89, v81, v81
    v_fma_f32 v89, v89, s44, 1.0
    v_mul_f32 v89, v89, v81
    v_mul_f32 v89, 0xc0135761, v89
    v_exp_f32 v89, v89
    s_nop 0
    v_add_f32 v89, 1.0, v89
    v_rcp_f32 v89, v89
    s_nop 0
    v_mul_f32 v89, v89, v81
    v_cvt_pk_bf16_f32 v89, v89, v89
    s_nop 0
    v_lshlrev_b32 v89, 16, v89
    v_mul_f32 v89, v89, v85
    v_mul_f32 v90, v82, v82
    v_fma_f32 v90, v90, s44, 1.0
    v_mul_f32 v90, v90, v82
    v_mul_f32 v90, 0xc0135761, v90
    v_exp_f32 v90, v90
    s_nop 0
    v_add_f32 v90, 1.0, v90
    v_rcp_f32 v90, v90
    s_nop 0
    v_mul_f32 v90, v90, v82
    v_cvt_pk_bf16_f32 v90, v90, v90
    s_nop 0
    v_lshlrev_b32 v90, 16, v90
    v_mul_f32 v90, v90, v86
    v_mul_f32 v91, v83, v83
    v_fma_f32 v91, v91, s44, 1.0
    v_mul_f32 v91, v91, v83
    v_mul_f32 v91, 0xc0135761, v91
    v_exp_f32 v91, v91
    s_nop 0
    v_add_f32 v91, 1.0, v91
    v_rcp_f32 v91, v91
    s_nop 0
    v_mul_f32 v91, v91, v83
    v_cvt_pk_bf16_f32 v91, v91, v91
    s_nop 0
    v_lshlrev_b32 v91, 16, v91
    v_mul_f32 v91, v91, v87
    v_cvt_pk_bf16_f32 v96, v88, v89
    v_cvt_pk_bf16_f32 v97, v90, v91
    s_add_u32 s38, s37, 131072
    s_nop 0
    buffer_store_dwordx2 v[96:97], v3, s[20:23], s38 offen offset:0
    s_nop 0
    v_fma_f32 v80, -v40, v31, v140
    v_mul_f32 v80, v80, v41
    v_fma_f32 v81, -v42, v31, v141
    v_mul_f32 v81, v81, v43
    v_fma_f32 v82, -v44, v31, v142
    v_mul_f32 v82, v82, v45
    v_fma_f32 v83, -v46, v31, v143
    v_mul_f32 v83, v83, v47
    v_fma_f32 v84, -v40, v35, v156
    v_mul_f32 v84, v84, v41
    v_fma_f32 v85, -v42, v35, v157
    v_mul_f32 v85, v85, v43
    v_fma_f32 v86, -v44, v35, v158
    v_mul_f32 v86, v86, v45
    v_fma_f32 v87, -v46, v35, v159
    v_mul_f32 v87, v87, v47
    v_cvt_pk_bf16_f32 v80, v80, v80
    v_cvt_pk_bf16_f32 v81, v81, v81
    v_cvt_pk_bf16_f32 v82, v82, v82
    v_cvt_pk_bf16_f32 v83, v83, v83
    v_cvt_pk_bf16_f32 v84, v84, v84
    v_cvt_pk_bf16_f32 v85, v85, v85
    v_cvt_pk_bf16_f32 v86, v86, v86
    v_cvt_pk_bf16_f32 v87, v87, v87
    s_nop 0
    v_lshlrev_b32 v80, 16, v80
    v_lshlrev_b32 v81, 16, v81
    v_lshlrev_b32 v82, 16, v82
    v_lshlrev_b32 v83, 16, v83
    v_lshlrev_b32 v84, 16, v84
    v_lshlrev_b32 v85, 16, v85
    v_lshlrev_b32 v86, 16, v86
    v_lshlrev_b32 v87, 16, v87
    v_mul_f32 v88, v80, v80
    v_fma_f32 v88, v88, s44, 1.0
    v_mul_f32 v88, v88, v80
    v_mul_f32 v88, 0xc0135761, v88
    v_exp_f32 v88, v88
    s_nop 0
    v_add_f32 v88, 1.0, v88
    v_rcp_f32 v88, v88
    s_nop 0
    v_mul_f32 v88, v88, v80
    v_cvt_pk_bf16_f32 v88, v88, v88
    s_nop 0
    v_lshlrev_b32 v88, 16, v88
    v_mul_f32 v88, v88, v84
    v_mul_f32 v89, v81, v81
    v_fma_f32 v89, v89, s44, 1.0
    v_mul_f32 v89, v89, v81
    v_mul_f32 v89, 0xc0135761, v89
    v_exp_f32 v89, v89
    s_nop 0
    v_add_f32 v89, 1.0, v89
    v_rcp_f32 v89, v89
    s_nop 0
    v_mul_f32 v89, v89, v81
    v_cvt_pk_bf16_f32 v89, v89, v89
    s_nop 0
    v_lshlrev_b32 v89, 16, v89
    v_mul_f32 v89, v89, v85
    v_mul_f32 v90, v82, v82
    v_fma_f32 v90, v90, s44, 1.0
    v_mul_f32 v90, v90, v82
    v_mul_f32 v90, 0xc0135761, v90
    v_exp_f32 v90, v90
    s_nop 0
    v_add_f32 v90, 1.0, v90
    v_rcp_f32 v90, v90
    s_nop 0
    v_mul_f32 v90, v90, v82
    v_cvt_pk_bf16_f32 v90, v90, v90
    s_nop 0
    v_lshlrev_b32 v90, 16, v90
    v_mul_f32 v90, v90, v86
    v_mul_f32 v91, v83, v83
    v_fma_f32 v91, v91, s44, 1.0
    v_mul_f32 v91, v91, v83
    v_mul_f32 v91, 0xc0135761, v91
    v_exp_f32 v91, v91
    s_nop 0
    v_add_f32 v91, 1.0, v91
    v_rcp_f32 v91, v91
    s_nop 0
    v_mul_f32 v91, v91, v83
    v_cvt_pk_bf16_f32 v91, v91, v91
    s_nop 0
    v_lshlrev_b32 v91, 16, v91
    v_mul_f32 v91, v91, v87
    v_cvt_pk_bf16_f32 v96, v88, v89
    v_cvt_pk_bf16_f32 v97, v90, v91
    s_add_u32 s38, s37, 196608
    s_nop 0
    buffer_store_dwordx2 v[96:97], v3, s[20:23], s38 offen offset:0
    s_nop 0
    v_fma_f32 v80, -v48, v28, v160
    v_mul_f32 v80, v80, v49
    v_fma_f32 v81, -v50, v28, v161
    v_mul_f32 v81, v81, v51
    v_fma_f32 v82, -v52, v28, v162
    v_mul_f32 v82, v82, v53
    v_fma_f32 v83, -v54, v28, v163
    v_mul_f32 v83, v83, v55
    v_fma_f32 v84, -v48, v32, v176
    v_mul_f32 v84, v84, v49
    v_fma_f32 v85, -v50, v32, v177
    v_mul_f32 v85, v85, v51
    v_fma_f32 v86, -v52, v32, v178
    v_mul_f32 v86, v86, v53
    v_fma_f32 v87, -v54, v32, v179
    v_mul_f32 v87, v87, v55
    v_cvt_pk_bf16_f32 v80, v80, v80
    v_cvt_pk_bf16_f32 v81, v81, v81
    v_cvt_pk_bf16_f32 v82, v82, v82
    v_cvt_pk_bf16_f32 v83, v83, v83
    v_cvt_pk_bf16_f32 v84, v84, v84
    v_cvt_pk_bf16_f32 v85, v85, v85
    v_cvt_pk_bf16_f32 v86, v86, v86
    v_cvt_pk_bf16_f32 v87, v87, v87
    s_nop 0
    v_lshlrev_b32 v80, 16, v80
    v_lshlrev_b32 v81, 16, v81
    v_lshlrev_b32 v82, 16, v82
    v_lshlrev_b32 v83, 16, v83
    v_lshlrev_b32 v84, 16, v84
    v_lshlrev_b32 v85, 16, v85
    v_lshlrev_b32 v86, 16, v86
    v_lshlrev_b32 v87, 16, v87
    v_mul_f32 v88, v80, v80
    v_fma_f32 v88, v88, s44, 1.0
    v_mul_f32 v88, v88, v80
    v_mul_f32 v88, 0xc0135761, v88
    v_exp_f32 v88, v88
    s_nop 0
    v_add_f32 v88, 1.0, v88
    v_rcp_f32 v88, v88
    s_nop 0
    v_mul_f32 v88, v88, v80
    v_cvt_pk_bf16_f32 v88, v88, v88
    s_nop 0
    v_lshlrev_b32 v88, 16, v88
    v_mul_f32 v88, v88, v84
    v_mul_f32 v89, v81, v81
    v_fma_f32 v89, v89, s44, 1.0
    v_mul_f32 v89, v89, v81
    v_mul_f32 v89, 0xc0135761, v89
    v_exp_f32 v89, v89
    s_nop 0
    v_add_f32 v89, 1.0, v89
    v_rcp_f32 v89, v89
    s_nop 0
    v_mul_f32 v89, v89, v81
    v_cvt_pk_bf16_f32 v89, v89, v89
    s_nop 0
    v_lshlrev_b32 v89, 16, v89
    v_mul_f32 v89, v89, v85
    v_mul_f32 v90, v82, v82
    v_fma_f32 v90, v90, s44, 1.0
    v_mul_f32 v90, v90, v82
    v_mul_f32 v90, 0xc0135761, v90
    v_exp_f32 v90, v90
    s_nop 0
    v_add_f32 v90, 1.0, v90
    v_rcp_f32 v90, v90
    s_nop 0
    v_mul_f32 v90, v90, v82
    v_cvt_pk_bf16_f32 v90, v90, v90
    s_nop 0
    v_lshlrev_b32 v90, 16, v90
    v_mul_f32 v90, v90, v86
    v_mul_f32 v91, v83, v83
    v_fma_f32 v91, v91, s44, 1.0
    v_mul_f32 v91, v91, v83
    v_mul_f32 v91, 0xc0135761, v91
    v_exp_f32 v91, v91
    s_nop 0
    v_add_f32 v91, 1.0, v91
    v_rcp_f32 v91, v91
    s_nop 0
    v_mul_f32 v91, v91, v83
    v_cvt_pk_bf16_f32 v91, v91, v91
    s_nop 0
    v_lshlrev_b32 v91, 16, v91
    v_mul_f32 v91, v91, v87
    v_cvt_pk_bf16_f32 v96, v88, v89
    v_cvt_pk_bf16_f32 v97, v90, v91
    s_add_u32 s38, s37, 0
    s_nop 0
    buffer_store_dwordx2 v[96:97], v3, s[20:23], s38 offen offset:32
    s_nop 0
    v_fma_f32 v80, -v48, v29, v164
    v_mul_f32 v80, v80, v49
    v_fma_f32 v81, -v50, v29, v165
    v_mul_f32 v81, v81, v51
    v_fma_f32 v82, -v52, v29, v166
    v_mul_f32 v82, v82, v53
    v_fma_f32 v83, -v54, v29, v167
    v_mul_f32 v83, v83, v55
    v_fma_f32 v84, -v48, v33, v180
    v_mul_f32 v84, v84, v49
    v_fma_f32 v85, -v50, v33, v181
    v_mul_f32 v85, v85, v51
    v_fma_f32 v86, -v52, v33, v182
    v_mul_f32 v86, v86, v53
    v_fma_f32 v87, -v54, v33, v183
    v_mul_f32 v87, v87, v55
    v_cvt_pk_bf16_f32 v80, v80, v80
    v_cvt_pk_bf16_f32 v81, v81, v81
    v_cvt_pk_bf16_f32 v82, v82, v82
    v_cvt_pk_bf16_f32 v83, v83, v83
    v_cvt_pk_bf16_f32 v84, v84, v84
    v_cvt_pk_bf16_f32 v85, v85, v85
    v_cvt_pk_bf16_f32 v86, v86, v86
    v_cvt_pk_bf16_f32 v87, v87, v87
    s_nop 0
    v_lshlrev_b32 v80, 16, v80
    v_lshlrev_b32 v81, 16, v81
    v_lshlrev_b32 v82, 16, v82
    v_lshlrev_b32 v83, 16, v83
    v_lshlrev_b32 v84, 16, v84
    v_lshlrev_b32 v85, 16, v85
    v_lshlrev_b32 v86, 16, v86
    v_lshlrev_b32 v87, 16, v87
    v_mul_f32 v88, v80, v80
    v_fma_f32 v88, v88, s44, 1.0
    v_mul_f32 v88, v88, v80
    v_mul_f32 v88, 0xc0135761, v88
    v_exp_f32 v88, v88
    s_nop 0
    v_add_f32 v88, 1.0, v88
    v_rcp_f32 v88, v88
    s_nop 0
    v_mul_f32 v88, v88, v80
    v_cvt_pk_bf16_f32 v88, v88, v88
    s_nop 0
    v_lshlrev_b32 v88, 16, v88
    v_mul_f32 v88, v88, v84
    v_mul_f32 v89, v81, v81
    v_fma_f32 v89, v89, s44, 1.0
    v_mul_f32 v89, v89, v81
    v_mul_f32 v89, 0xc0135761, v89
    v_exp_f32 v89, v89
    s_nop 0
    v_add_f32 v89, 1.0, v89
    v_rcp_f32 v89, v89
    s_nop 0
    v_mul_f32 v89, v89, v81
    v_cvt_pk_bf16_f32 v89, v89, v89
    s_nop 0
    v_lshlrev_b32 v89, 16, v89
    v_mul_f32 v89, v89, v85
    v_mul_f32 v90, v82, v82
    v_fma_f32 v90, v90, s44, 1.0
    v_mul_f32 v90, v90, v82
    v_mul_f32 v90, 0xc0135761, v90
    v_exp_f32 v90, v90
    s_nop 0
    v_add_f32 v90, 1.0, v90
    v_rcp_f32 v90, v90
    s_nop 0
    v_mul_f32 v90, v90, v82
    v_cvt_pk_bf16_f32 v90, v90, v90
    s_nop 0
    v_lshlrev_b32 v90, 16, v90
    v_mul_f32 v90, v90, v86
    v_mul_f32 v91, v83, v83
    v_fma_f32 v91, v91, s44, 1.0
    v_mul_f32 v91, v91, v83
    v_mul_f32 v91, 0xc0135761, v91
    v_exp_f32 v91, v91
    s_nop 0
    v_add_f32 v91, 1.0, v91
    v_rcp_f32 v91, v91
    s_nop 0
    v_mul_f32 v91, v91, v83
    v_cvt_pk_bf16_f32 v91, v91, v91
    s_nop 0
    v_lshlrev_b32 v91, 16, v91
    v_mul_f32 v91, v91, v87
    v_cvt_pk_bf16_f32 v96, v88, v89
    v_cvt_pk_bf16_f32 v97, v90, v91
    s_add_u32 s38, s37, 65536
    s_nop 0
    buffer_store_dwordx2 v[96:97], v3, s[20:23], s38 offen offset:32
    s_nop 0
    v_fma_f32 v80, -v48, v30, v168
    v_mul_f32 v80, v80, v49
    v_fma_f32 v81, -v50, v30, v169
    v_mul_f32 v81, v81, v51
    v_fma_f32 v82, -v52, v30, v170
    v_mul_f32 v82, v82, v53
    v_fma_f32 v83, -v54, v30, v171
    v_mul_f32 v83, v83, v55
    v_fma_f32 v84, -v48, v34, v184
    v_mul_f32 v84, v84, v49
    v_fma_f32 v85, -v50, v34, v185
    v_mul_f32 v85, v85, v51
    v_fma_f32 v86, -v52, v34, v186
    v_mul_f32 v86, v86, v53
    v_fma_f32 v87, -v54, v34, v187
    v_mul_f32 v87, v87, v55
    v_cvt_pk_bf16_f32 v80, v80, v80
    v_cvt_pk_bf16_f32 v81, v81, v81
    v_cvt_pk_bf16_f32 v82, v82, v82
    v_cvt_pk_bf16_f32 v83, v83, v83
    v_cvt_pk_bf16_f32 v84, v84, v84
    v_cvt_pk_bf16_f32 v85, v85, v85
    v_cvt_pk_bf16_f32 v86, v86, v86
    v_cvt_pk_bf16_f32 v87, v87, v87
    s_nop 0
    v_lshlrev_b32 v80, 16, v80
    v_lshlrev_b32 v81, 16, v81
    v_lshlrev_b32 v82, 16, v82
    v_lshlrev_b32 v83, 16, v83
    v_lshlrev_b32 v84, 16, v84
    v_lshlrev_b32 v85, 16, v85
    v_lshlrev_b32 v86, 16, v86
    v_lshlrev_b32 v87, 16, v87
    v_mul_f32 v88, v80, v80
    v_fma_f32 v88, v88, s44, 1.0
    v_mul_f32 v88, v88, v80
    v_mul_f32 v88, 0xc0135761, v88
    v_exp_f32 v88, v88
    s_nop 0
    v_add_f32 v88, 1.0, v88
    v_rcp_f32 v88, v88
    s_nop 0
    v_mul_f32 v88, v88, v80
    v_cvt_pk_bf16_f32 v88, v88, v88
    s_nop 0
    v_lshlrev_b32 v88, 16, v88
    v_mul_f32 v88, v88, v84
    v_mul_f32 v89, v81, v81
    v_fma_f32 v89, v89, s44, 1.0
    v_mul_f32 v89, v89, v81
    v_mul_f32 v89, 0xc0135761, v89
    v_exp_f32 v89, v89
    s_nop 0
    v_add_f32 v89, 1.0, v89
    v_rcp_f32 v89, v89
    s_nop 0
    v_mul_f32 v89, v89, v81
    v_cvt_pk_bf16_f32 v89, v89, v89
    s_nop 0
    v_lshlrev_b32 v89, 16, v89
    v_mul_f32 v89, v89, v85
    v_mul_f32 v90, v82, v82
    v_fma_f32 v90, v90, s44, 1.0
    v_mul_f32 v90, v90, v82
    v_mul_f32 v90, 0xc0135761, v90
    v_exp_f32 v90, v90
    s_nop 0
    v_add_f32 v90, 1.0, v90
    v_rcp_f32 v90, v90
    s_nop 0
    v_mul_f32 v90, v90, v82
    v_cvt_pk_bf16_f32 v90, v90, v90
    s_nop 0
    v_lshlrev_b32 v90, 16, v90
    v_mul_f32 v90, v90, v86
    v_mul_f32 v91, v83, v83
    v_fma_f32 v91, v91, s44, 1.0
    v_mul_f32 v91, v91, v83
    v_mul_f32 v91, 0xc0135761, v91
    v_exp_f32 v91, v91
    s_nop 0
    v_add_f32 v91, 1.0, v91
    v_rcp_f32 v91, v91
    s_nop 0
    v_mul_f32 v91, v91, v83
    v_cvt_pk_bf16_f32 v91, v91, v91
    s_nop 0
    v_lshlrev_b32 v91, 16, v91
    v_mul_f32 v91, v91, v87
    v_cvt_pk_bf16_f32 v96, v88, v89
    v_cvt_pk_bf16_f32 v97, v90, v91
    s_add_u32 s38, s37, 131072
    s_nop 0
    buffer_store_dwordx2 v[96:97], v3, s[20:23], s38 offen offset:32
    s_nop 0
    v_fma_f32 v80, -v48, v31, v172
    v_mul_f32 v80, v80, v49
    v_fma_f32 v81, -v50, v31, v173
    v_mul_f32 v81, v81, v51
    v_fma_f32 v82, -v52, v31, v174
    v_mul_f32 v82, v82, v53
    v_fma_f32 v83, -v54, v31, v175
    v_mul_f32 v83, v83, v55
    v_fma_f32 v84, -v48, v35, v188
    v_mul_f32 v84, v84, v49
    v_fma_f32 v85, -v50, v35, v189
    v_mul_f32 v85, v85, v51
    v_fma_f32 v86, -v52, v35, v190
    v_mul_f32 v86, v86, v53
    v_fma_f32 v87, -v54, v35, v191
    v_mul_f32 v87, v87, v55
    v_cvt_pk_bf16_f32 v80, v80, v80
    v_cvt_pk_bf16_f32 v81, v81, v81
    v_cvt_pk_bf16_f32 v82, v82, v82
    v_cvt_pk_bf16_f32 v83, v83, v83
    v_cvt_pk_bf16_f32 v84, v84, v84
    v_cvt_pk_bf16_f32 v85, v85, v85
    v_cvt_pk_bf16_f32 v86, v86, v86
    v_cvt_pk_bf16_f32 v87, v87, v87
    s_nop 0
    v_lshlrev_b32 v80, 16, v80
    v_lshlrev_b32 v81, 16, v81
    v_lshlrev_b32 v82, 16, v82
    v_lshlrev_b32 v83, 16, v83
    v_lshlrev_b32 v84, 16, v84
    v_lshlrev_b32 v85, 16, v85
    v_lshlrev_b32 v86, 16, v86
    v_lshlrev_b32 v87, 16, v87
    v_mul_f32 v88, v80, v80
    v_fma_f32 v88, v88, s44, 1.0
    v_mul_f32 v88, v88, v80
    v_mul_f32 v88, 0xc0135761, v88
    v_exp_f32 v88, v88
    s_nop 0
    v_add_f32 v88, 1.0, v88
    v_rcp_f32 v88, v88
    s_nop 0
    v_mul_f32 v88, v88, v80
    v_cvt_pk_bf16_f32 v88, v88, v88
    s_nop 0
    v_lshlrev_b32 v88, 16, v88
    v_mul_f32 v88, v88, v84
    v_mul_f32 v89, v81, v81
    v_fma_f32 v89, v89, s44, 1.0
    v_mul_f32 v89, v89, v81
    v_mul_f32 v89, 0xc0135761, v89
    v_exp_f32 v89, v89
    s_nop 0
    v_add_f32 v89, 1.0, v89
    v_rcp_f32 v89, v89
    s_nop 0
    v_mul_f32 v89, v89, v81
    v_cvt_pk_bf16_f32 v89, v89, v89
    s_nop 0
    v_lshlrev_b32 v89, 16, v89
    v_mul_f32 v89, v89, v85
    v_mul_f32 v90, v82, v82
    v_fma_f32 v90, v90, s44, 1.0
    v_mul_f32 v90, v90, v82
    v_mul_f32 v90, 0xc0135761, v90
    v_exp_f32 v90, v90
    s_nop 0
    v_add_f32 v90, 1.0, v90
    v_rcp_f32 v90, v90
    s_nop 0
    v_mul_f32 v90, v90, v82
    v_cvt_pk_bf16_f32 v90, v90, v90
    s_nop 0
    v_lshlrev_b32 v90, 16, v90
    v_mul_f32 v90, v90, v86
    v_mul_f32 v91, v83, v83
    v_fma_f32 v91, v91, s44, 1.0
    v_mul_f32 v91, v91, v83
    v_mul_f32 v91, 0xc0135761, v91
    v_exp_f32 v91, v91
    s_nop 0
    v_add_f32 v91, 1.0, v91
    v_rcp_f32 v91, v91
    s_nop 0
    v_mul_f32 v91, v91, v83
    v_cvt_pk_bf16_f32 v91, v91, v91
    s_nop 0
    v_lshlrev_b32 v91, 16, v91
    v_mul_f32 v91, v91, v87
    v_cvt_pk_bf16_f32 v96, v88, v89
    v_cvt_pk_bf16_f32 v97, v90, v91
    s_add_u32 s38, s37, 196608
    s_nop 0
    buffer_store_dwordx2 v[96:97], v3, s[20:23], s38 offen offset:32
    s_nop 0
    v_fma_f32 v80, -v56, v28, v192
    v_mul_f32 v80, v80, v57
    v_fma_f32 v81, -v58, v28, v193
    v_mul_f32 v81, v81, v59
    v_fma_f32 v82, -v60, v28, v194
    v_mul_f32 v82, v82, v61
    v_fma_f32 v83, -v62, v28, v195
    v_mul_f32 v83, v83, v63
    v_fma_f32 v84, -v56, v32, v208
    v_mul_f32 v84, v84, v57
    v_fma_f32 v85, -v58, v32, v209
    v_mul_f32 v85, v85, v59
    v_fma_f32 v86, -v60, v32, v210
    v_mul_f32 v86, v86, v61
    v_fma_f32 v87, -v62, v32, v211
    v_mul_f32 v87, v87, v63
    v_cvt_pk_bf16_f32 v80, v80, v80
    v_cvt_pk_bf16_f32 v81, v81, v81
    v_cvt_pk_bf16_f32 v82, v82, v82
    v_cvt_pk_bf16_f32 v83, v83, v83
    v_cvt_pk_bf16_f32 v84, v84, v84
    v_cvt_pk_bf16_f32 v85, v85, v85
    v_cvt_pk_bf16_f32 v86, v86, v86
    v_cvt_pk_bf16_f32 v87, v87, v87
    s_nop 0
    v_lshlrev_b32 v80, 16, v80
    v_lshlrev_b32 v81, 16, v81
    v_lshlrev_b32 v82, 16, v82
    v_lshlrev_b32 v83, 16, v83
    v_lshlrev_b32 v84, 16, v84
    v_lshlrev_b32 v85, 16, v85
    v_lshlrev_b32 v86, 16, v86
    v_lshlrev_b32 v87, 16, v87
    v_mul_f32 v88, v80, v80
    v_fma_f32 v88, v88, s44, 1.0
    v_mul_f32 v88, v88, v80
    v_mul_f32 v88, 0xc0135761, v88
    v_exp_f32 v88, v88
    s_nop 0
    v_add_f32 v88, 1.0, v88
    v_rcp_f32 v88, v88
    s_nop 0
    v_mul_f32 v88, v88, v80
    v_cvt_pk_bf16_f32 v88, v88, v88
    s_nop 0
    v_lshlrev_b32 v88, 16, v88
    v_mul_f32 v88, v88, v84
    v_mul_f32 v89, v81, v81
    v_fma_f32 v89, v89, s44, 1.0
    v_mul_f32 v89, v89, v81
    v_mul_f32 v89, 0xc0135761, v89
    v_exp_f32 v89, v89
    s_nop 0
    v_add_f32 v89, 1.0, v89
    v_rcp_f32 v89, v89
    s_nop 0
    v_mul_f32 v89, v89, v81
    v_cvt_pk_bf16_f32 v89, v89, v89
    s_nop 0
    v_lshlrev_b32 v89, 16, v89
    v_mul_f32 v89, v89, v85
    v_mul_f32 v90, v82, v82
    v_fma_f32 v90, v90, s44, 1.0
    v_mul_f32 v90, v90, v82
    v_mul_f32 v90, 0xc0135761, v90
    v_exp_f32 v90, v90
    s_nop 0
    v_add_f32 v90, 1.0, v90
    v_rcp_f32 v90, v90
    s_nop 0
    v_mul_f32 v90, v90, v82
    v_cvt_pk_bf16_f32 v90, v90, v90
    s_nop 0
    v_lshlrev_b32 v90, 16, v90
    v_mul_f32 v90, v90, v86
    v_mul_f32 v91, v83, v83
    v_fma_f32 v91, v91, s44, 1.0
    v_mul_f32 v91, v91, v83
    v_mul_f32 v91, 0xc0135761, v91
    v_exp_f32 v91, v91
    s_nop 0
    v_add_f32 v91, 1.0, v91
    v_rcp_f32 v91, v91
    s_nop 0
    v_mul_f32 v91, v91, v83
    v_cvt_pk_bf16_f32 v91, v91, v91
    s_nop 0
    v_lshlrev_b32 v91, 16, v91
    v_mul_f32 v91, v91, v87
    v_cvt_pk_bf16_f32 v96, v88, v89
    v_cvt_pk_bf16_f32 v97, v90, v91
    s_add_u32 s38, s37, 0
    s_nop 0
    buffer_store_dwordx2 v[96:97], v3, s[20:23], s38 offen offset:64
    s_nop 0
    v_fma_f32 v80, -v56, v29, v196
    v_mul_f32 v80, v80, v57
    v_fma_f32 v81, -v58, v29, v197
    v_mul_f32 v81, v81, v59
    v_fma_f32 v82, -v60, v29, v198
    v_mul_f32 v82, v82, v61
    v_fma_f32 v83, -v62, v29, v199
    v_mul_f32 v83, v83, v63
    v_fma_f32 v84, -v56, v33, v212
    v_mul_f32 v84, v84, v57
    v_fma_f32 v85, -v58, v33, v213
    v_mul_f32 v85, v85, v59
    v_fma_f32 v86, -v60, v33, v214
    v_mul_f32 v86, v86, v61
    v_fma_f32 v87, -v62, v33, v215
    v_mul_f32 v87, v87, v63
    v_cvt_pk_bf16_f32 v80, v80, v80
    v_cvt_pk_bf16_f32 v81, v81, v81
    v_cvt_pk_bf16_f32 v82, v82, v82
    v_cvt_pk_bf16_f32 v83, v83, v83
    v_cvt_pk_bf16_f32 v84, v84, v84
    v_cvt_pk_bf16_f32 v85, v85, v85
    v_cvt_pk_bf16_f32 v86, v86, v86
    v_cvt_pk_bf16_f32 v87, v87, v87
    s_nop 0
    v_lshlrev_b32 v80, 16, v80
    v_lshlrev_b32 v81, 16, v81
    v_lshlrev_b32 v82, 16, v82
    v_lshlrev_b32 v83, 16, v83
    v_lshlrev_b32 v84, 16, v84
    v_lshlrev_b32 v85, 16, v85
    v_lshlrev_b32 v86, 16, v86
    v_lshlrev_b32 v87, 16, v87
    v_mul_f32 v88, v80, v80
    v_fma_f32 v88, v88, s44, 1.0
    v_mul_f32 v88, v88, v80
    v_mul_f32 v88, 0xc0135761, v88
    v_exp_f32 v88, v88
    s_nop 0
    v_add_f32 v88, 1.0, v88
    v_rcp_f32 v88, v88
    s_nop 0
    v_mul_f32 v88, v88, v80
    v_cvt_pk_bf16_f32 v88, v88, v88
    s_nop 0
    v_lshlrev_b32 v88, 16, v88
    v_mul_f32 v88, v88, v84
    v_mul_f32 v89, v81, v81
    v_fma_f32 v89, v89, s44, 1.0
    v_mul_f32 v89, v89, v81
    v_mul_f32 v89, 0xc0135761, v89
    v_exp_f32 v89, v89
    s_nop 0
    v_add_f32 v89, 1.0, v89
    v_rcp_f32 v89, v89
    s_nop 0
    v_mul_f32 v89, v89, v81
    v_cvt_pk_bf16_f32 v89, v89, v89
    s_nop 0
    v_lshlrev_b32 v89, 16, v89
    v_mul_f32 v89, v89, v85
    v_mul_f32 v90, v82, v82
    v_fma_f32 v90, v90, s44, 1.0
    v_mul_f32 v90, v90, v82
    v_mul_f32 v90, 0xc0135761, v90
    v_exp_f32 v90, v90
    s_nop 0
    v_add_f32 v90, 1.0, v90
    v_rcp_f32 v90, v90
    s_nop 0
    v_mul_f32 v90, v90, v82
    v_cvt_pk_bf16_f32 v90, v90, v90
    s_nop 0
    v_lshlrev_b32 v90, 16, v90
    v_mul_f32 v90, v90, v86
    v_mul_f32 v91, v83, v83
    v_fma_f32 v91, v91, s44, 1.0
    v_mul_f32 v91, v91, v83
    v_mul_f32 v91, 0xc0135761, v91
    v_exp_f32 v91, v91
    s_nop 0
    v_add_f32 v91, 1.0, v91
    v_rcp_f32 v91, v91
    s_nop 0
    v_mul_f32 v91, v91, v83
    v_cvt_pk_bf16_f32 v91, v91, v91
    s_nop 0
    v_lshlrev_b32 v91, 16, v91
    v_mul_f32 v91, v91, v87
    v_cvt_pk_bf16_f32 v96, v88, v89
    v_cvt_pk_bf16_f32 v97, v90, v91
    s_add_u32 s38, s37, 65536
    s_nop 0
    buffer_store_dwordx2 v[96:97], v3, s[20:23], s38 offen offset:64
    s_nop 0
    v_fma_f32 v80, -v56, v30, v200
    v_mul_f32 v80, v80, v57
    v_fma_f32 v81, -v58, v30, v201
    v_mul_f32 v81, v81, v59
    v_fma_f32 v82, -v60, v30, v202
    v_mul_f32 v82, v82, v61
    v_fma_f32 v83, -v62, v30, v203
    v_mul_f32 v83, v83, v63
    v_fma_f32 v84, -v56, v34, v216
    v_mul_f32 v84, v84, v57
    v_fma_f32 v85, -v58, v34, v217
    v_mul_f32 v85, v85, v59
    v_fma_f32 v86, -v60, v34, v218
    v_mul_f32 v86, v86, v61
    v_fma_f32 v87, -v62, v34, v219
    v_mul_f32 v87, v87, v63
    v_cvt_pk_bf16_f32 v80, v80, v80
    v_cvt_pk_bf16_f32 v81, v81, v81
    v_cvt_pk_bf16_f32 v82, v82, v82
    v_cvt_pk_bf16_f32 v83, v83, v83
    v_cvt_pk_bf16_f32 v84, v84, v84
    v_cvt_pk_bf16_f32 v85, v85, v85
    v_cvt_pk_bf16_f32 v86, v86, v86
    v_cvt_pk_bf16_f32 v87, v87, v87
    s_nop 0
    v_lshlrev_b32 v80, 16, v80
    v_lshlrev_b32 v81, 16, v81
    v_lshlrev_b32 v82, 16, v82
    v_lshlrev_b32 v83, 16, v83
    v_lshlrev_b32 v84, 16, v84
    v_lshlrev_b32 v85, 16, v85
    v_lshlrev_b32 v86, 16, v86
    v_lshlrev_b32 v87, 16, v87
    v_mul_f32 v88, v80, v80
    v_fma_f32 v88, v88, s44, 1.0
    v_mul_f32 v88, v88, v80
    v_mul_f32 v88, 0xc0135761, v88
    v_exp_f32 v88, v88
    s_nop 0
    v_add_f32 v88, 1.0, v88
    v_rcp_f32 v88, v88
    s_nop 0
    v_mul_f32 v88, v88, v80
    v_cvt_pk_bf16_f32 v88, v88, v88
    s_nop 0
    v_lshlrev_b32 v88, 16, v88
    v_mul_f32 v88, v88, v84
    v_mul_f32 v89, v81, v81
    v_fma_f32 v89, v89, s44, 1.0
    v_mul_f32 v89, v89, v81
    v_mul_f32 v89, 0xc0135761, v89
    v_exp_f32 v89, v89
    s_nop 0
    v_add_f32 v89, 1.0, v89
    v_rcp_f32 v89, v89
    s_nop 0
    v_mul_f32 v89, v89, v81
    v_cvt_pk_bf16_f32 v89, v89, v89
    s_nop 0
    v_lshlrev_b32 v89, 16, v89
    v_mul_f32 v89, v89, v85
    v_mul_f32 v90, v82, v82
    v_fma_f32 v90, v90, s44, 1.0
    v_mul_f32 v90, v90, v82
    v_mul_f32 v90, 0xc0135761, v90
    v_exp_f32 v90, v90
    s_nop 0
    v_add_f32 v90, 1.0, v90
    v_rcp_f32 v90, v90
    s_nop 0
    v_mul_f32 v90, v90, v82
    v_cvt_pk_bf16_f32 v90, v90, v90
    s_nop 0
    v_lshlrev_b32 v90, 16, v90
    v_mul_f32 v90, v90, v86
    v_mul_f32 v91, v83, v83
    v_fma_f32 v91, v91, s44, 1.0
    v_mul_f32 v91, v91, v83
    v_mul_f32 v91, 0xc0135761, v91
    v_exp_f32 v91, v91
    s_nop 0
    v_add_f32 v91, 1.0, v91
    v_rcp_f32 v91, v91
    s_nop 0
    v_mul_f32 v91, v91, v83
    v_cvt_pk_bf16_f32 v91, v91, v91
    s_nop 0
    v_lshlrev_b32 v91, 16, v91
    v_mul_f32 v91, v91, v87
    v_cvt_pk_bf16_f32 v96, v88, v89
    v_cvt_pk_bf16_f32 v97, v90, v91
    s_add_u32 s38, s37, 131072
    s_nop 0
    buffer_store_dwordx2 v[96:97], v3, s[20:23], s38 offen offset:64
    s_nop 0
    v_fma_f32 v80, -v56, v31, v204
    v_mul_f32 v80, v80, v57
    v_fma_f32 v81, -v58, v31, v205
    v_mul_f32 v81, v81, v59
    v_fma_f32 v82, -v60, v31, v206
    v_mul_f32 v82, v82, v61
    v_fma_f32 v83, -v62, v31, v207
    v_mul_f32 v83, v83, v63
    v_fma_f32 v84, -v56, v35, v220
    v_mul_f32 v84, v84, v57
    v_fma_f32 v85, -v58, v35, v221
    v_mul_f32 v85, v85, v59
    v_fma_f32 v86, -v60, v35, v222
    v_mul_f32 v86, v86, v61
    v_fma_f32 v87, -v62, v35, v223
    v_mul_f32 v87, v87, v63
    v_cvt_pk_bf16_f32 v80, v80, v80
    v_cvt_pk_bf16_f32 v81, v81, v81
    v_cvt_pk_bf16_f32 v82, v82, v82
    v_cvt_pk_bf16_f32 v83, v83, v83
    v_cvt_pk_bf16_f32 v84, v84, v84
    v_cvt_pk_bf16_f32 v85, v85, v85
    v_cvt_pk_bf16_f32 v86, v86, v86
    v_cvt_pk_bf16_f32 v87, v87, v87
    s_nop 0
    v_lshlrev_b32 v80, 16, v80
    v_lshlrev_b32 v81, 16, v81
    v_lshlrev_b32 v82, 16, v82
    v_lshlrev_b32 v83, 16, v83
    v_lshlrev_b32 v84, 16, v84
    v_lshlrev_b32 v85, 16, v85
    v_lshlrev_b32 v86, 16, v86
    v_lshlrev_b32 v87, 16, v87
    v_mul_f32 v88, v80, v80
    v_fma_f32 v88, v88, s44, 1.0
    v_mul_f32 v88, v88, v80
    v_mul_f32 v88, 0xc0135761, v88
    v_exp_f32 v88, v88
    s_nop 0
    v_add_f32 v88, 1.0, v88
    v_rcp_f32 v88, v88
    s_nop 0
    v_mul_f32 v88, v88, v80
    v_cvt_pk_bf16_f32 v88, v88, v88
    s_nop 0
    v_lshlrev_b32 v88, 16, v88
    v_mul_f32 v88, v88, v84
    v_mul_f32 v89, v81, v81
    v_fma_f32 v89, v89, s44, 1.0
    v_mul_f32 v89, v89, v81
    v_mul_f32 v89, 0xc0135761, v89
    v_exp_f32 v89, v89
    s_nop 0
    v_add_f32 v89, 1.0, v89
    v_rcp_f32 v89, v89
    s_nop 0
    v_mul_f32 v89, v89, v81
    v_cvt_pk_bf16_f32 v89, v89, v89
    s_nop 0
    v_lshlrev_b32 v89, 16, v89
    v_mul_f32 v89, v89, v85
    v_mul_f32 v90, v82, v82
    v_fma_f32 v90, v90, s44, 1.0
    v_mul_f32 v90, v90, v82
    v_mul_f32 v90, 0xc0135761, v90
    v_exp_f32 v90, v90
    s_nop 0
    v_add_f32 v90, 1.0, v90
    v_rcp_f32 v90, v90
    s_nop 0
    v_mul_f32 v90, v90, v82
    v_cvt_pk_bf16_f32 v90, v90, v90
    s_nop 0
    v_lshlrev_b32 v90, 16, v90
    v_mul_f32 v90, v90, v86
    v_mul_f32 v91, v83, v83
    v_fma_f32 v91, v91, s44, 1.0
    v_mul_f32 v91, v91, v83
    v_mul_f32 v91, 0xc0135761, v91
    v_exp_f32 v91, v91
    s_nop 0
    v_add_f32 v91, 1.0, v91
    v_rcp_f32 v91, v91
    s_nop 0
    v_mul_f32 v91, v91, v83
    v_cvt_pk_bf16_f32 v91, v91, v91
    s_nop 0
    v_lshlrev_b32 v91, 16, v91
    v_mul_f32 v91, v91, v87
    v_cvt_pk_bf16_f32 v96, v88, v89
    v_cvt_pk_bf16_f32 v97, v90, v91
    s_add_u32 s38, s37, 196608
    s_nop 0
    buffer_store_dwordx2 v[96:97], v3, s[20:23], s38 offen offset:64
    s_nop 0
    v_fma_f32 v80, -v64, v28, v224
    v_mul_f32 v80, v80, v65
    v_fma_f32 v81, -v66, v28, v225
    v_mul_f32 v81, v81, v67
    v_fma_f32 v82, -v68, v28, v226
    v_mul_f32 v82, v82, v69
    v_fma_f32 v83, -v70, v28, v227
    v_mul_f32 v83, v83, v71
    v_fma_f32 v84, -v64, v32, v240
    v_mul_f32 v84, v84, v65
    v_fma_f32 v85, -v66, v32, v241
    v_mul_f32 v85, v85, v67
    v_fma_f32 v86, -v68, v32, v242
    v_mul_f32 v86, v86, v69
    v_fma_f32 v87, -v70, v32, v243
    v_mul_f32 v87, v87, v71
    v_cvt_pk_bf16_f32 v80, v80, v80
    v_cvt_pk_bf16_f32 v81, v81, v81
    v_cvt_pk_bf16_f32 v82, v82, v82
    v_cvt_pk_bf16_f32 v83, v83, v83
    v_cvt_pk_bf16_f32 v84, v84, v84
    v_cvt_pk_bf16_f32 v85, v85, v85
    v_cvt_pk_bf16_f32 v86, v86, v86
    v_cvt_pk_bf16_f32 v87, v87, v87
    s_nop 0
    v_lshlrev_b32 v80, 16, v80
    v_lshlrev_b32 v81, 16, v81
    v_lshlrev_b32 v82, 16, v82
    v_lshlrev_b32 v83, 16, v83
    v_lshlrev_b32 v84, 16, v84
    v_lshlrev_b32 v85, 16, v85
    v_lshlrev_b32 v86, 16, v86
    v_lshlrev_b32 v87, 16, v87
    v_mul_f32 v88, v80, v80
    v_fma_f32 v88, v88, s44, 1.0
    v_mul_f32 v88, v88, v80
    v_mul_f32 v88, 0xc0135761, v88
    v_exp_f32 v88, v88
    s_nop 0
    v_add_f32 v88, 1.0, v88
    v_rcp_f32 v88, v88
    s_nop 0
    v_mul_f32 v88, v88, v80
    v_cvt_pk_bf16_f32 v88, v88, v88
    s_nop 0
    v_lshlrev_b32 v88, 16, v88
    v_mul_f32 v88, v88, v84
    v_mul_f32 v89, v81, v81
    v_fma_f32 v89, v89, s44, 1.0
    v_mul_f32 v89, v89, v81
    v_mul_f32 v89, 0xc0135761, v89
    v_exp_f32 v89, v89
    s_nop 0
    v_add_f32 v89, 1.0, v89
    v_rcp_f32 v89, v89
    s_nop 0
    v_mul_f32 v89, v89, v81
    v_cvt_pk_bf16_f32 v89, v89, v89
    s_nop 0
    v_lshlrev_b32 v89, 16, v89
    v_mul_f32 v89, v89, v85
    v_mul_f32 v90, v82, v82
    v_fma_f32 v90, v90, s44, 1.0
    v_mul_f32 v90, v90, v82
    v_mul_f32 v90, 0xc0135761, v90
    v_exp_f32 v90, v90
    s_nop 0
    v_add_f32 v90, 1.0, v90
    v_rcp_f32 v90, v90
    s_nop 0
    v_mul_f32 v90, v90, v82
    v_cvt_pk_bf16_f32 v90, v90, v90
    s_nop 0
    v_lshlrev_b32 v90, 16, v90
    v_mul_f32 v90, v90, v86
    v_mul_f32 v91, v83, v83
    v_fma_f32 v91, v91, s44, 1.0
    v_mul_f32 v91, v91, v83
    v_mul_f32 v91, 0xc0135761, v91
    v_exp_f32 v91, v91
    s_nop 0
    v_add_f32 v91, 1.0, v91
    v_rcp_f32 v91, v91
    s_nop 0
    v_mul_f32 v91, v91, v83
    v_cvt_pk_bf16_f32 v91, v91, v91
    s_nop 0
    v_lshlrev_b32 v91, 16, v91
    v_mul_f32 v91, v91, v87
    v_cvt_pk_bf16_f32 v96, v88, v89
    v_cvt_pk_bf16_f32 v97, v90, v91
    s_add_u32 s38, s37, 0
    s_nop 0
    buffer_store_dwordx2 v[96:97], v3, s[20:23], s38 offen offset:96
    s_nop 0
    v_fma_f32 v80, -v64, v29, v228
    v_mul_f32 v80, v80, v65
    v_fma_f32 v81, -v66, v29, v229
    v_mul_f32 v81, v81, v67
    v_fma_f32 v82, -v68, v29, v230
    v_mul_f32 v82, v82, v69
    v_fma_f32 v83, -v70, v29, v231
    v_mul_f32 v83, v83, v71
    v_fma_f32 v84, -v64, v33, v244
    v_mul_f32 v84, v84, v65
    v_fma_f32 v85, -v66, v33, v245
    v_mul_f32 v85, v85, v67
    v_fma_f32 v86, -v68, v33, v246
    v_mul_f32 v86, v86, v69
    v_fma_f32 v87, -v70, v33, v247
    v_mul_f32 v87, v87, v71
    v_cvt_pk_bf16_f32 v80, v80, v80
    v_cvt_pk_bf16_f32 v81, v81, v81
    v_cvt_pk_bf16_f32 v82, v82, v82
    v_cvt_pk_bf16_f32 v83, v83, v83
    v_cvt_pk_bf16_f32 v84, v84, v84
    v_cvt_pk_bf16_f32 v85, v85, v85
    v_cvt_pk_bf16_f32 v86, v86, v86
    v_cvt_pk_bf16_f32 v87, v87, v87
    s_nop 0
    v_lshlrev_b32 v80, 16, v80
    v_lshlrev_b32 v81, 16, v81
    v_lshlrev_b32 v82, 16, v82
    v_lshlrev_b32 v83, 16, v83
    v_lshlrev_b32 v84, 16, v84
    v_lshlrev_b32 v85, 16, v85
    v_lshlrev_b32 v86, 16, v86
    v_lshlrev_b32 v87, 16, v87
    v_mul_f32 v88, v80, v80
    v_fma_f32 v88, v88, s44, 1.0
    v_mul_f32 v88, v88, v80
    v_mul_f32 v88, 0xc0135761, v88
    v_exp_f32 v88, v88
    s_nop 0
    v_add_f32 v88, 1.0, v88
    v_rcp_f32 v88, v88
    s_nop 0
    v_mul_f32 v88, v88, v80
    v_cvt_pk_bf16_f32 v88, v88, v88
    s_nop 0
    v_lshlrev_b32 v88, 16, v88
    v_mul_f32 v88, v88, v84
    v_mul_f32 v89, v81, v81
    v_fma_f32 v89, v89, s44, 1.0
    v_mul_f32 v89, v89, v81
    v_mul_f32 v89, 0xc0135761, v89
    v_exp_f32 v89, v89
    s_nop 0
    v_add_f32 v89, 1.0, v89
    v_rcp_f32 v89, v89
    s_nop 0
    v_mul_f32 v89, v89, v81
    v_cvt_pk_bf16_f32 v89, v89, v89
    s_nop 0
    v_lshlrev_b32 v89, 16, v89
    v_mul_f32 v89, v89, v85
    v_mul_f32 v90, v82, v82
    v_fma_f32 v90, v90, s44, 1.0
    v_mul_f32 v90, v90, v82
    v_mul_f32 v90, 0xc0135761, v90
    v_exp_f32 v90, v90
    s_nop 0
    v_add_f32 v90, 1.0, v90
    v_rcp_f32 v90, v90
    s_nop 0
    v_mul_f32 v90, v90, v82
    v_cvt_pk_bf16_f32 v90, v90, v90
    s_nop 0
    v_lshlrev_b32 v90, 16, v90
    v_mul_f32 v90, v90, v86
    v_mul_f32 v91, v83, v83
    v_fma_f32 v91, v91, s44, 1.0
    v_mul_f32 v91, v91, v83
    v_mul_f32 v91, 0xc0135761, v91
    v_exp_f32 v91, v91
    s_nop 0
    v_add_f32 v91, 1.0, v91
    v_rcp_f32 v91, v91
    s_nop 0
    v_mul_f32 v91, v91, v83
    v_cvt_pk_bf16_f32 v91, v91, v91
    s_nop 0
    v_lshlrev_b32 v91, 16, v91
    v_mul_f32 v91, v91, v87
    v_cvt_pk_bf16_f32 v96, v88, v89
    v_cvt_pk_bf16_f32 v97, v90, v91
    s_add_u32 s38, s37, 65536
    s_nop 0
    buffer_store_dwordx2 v[96:97], v3, s[20:23], s38 offen offset:96
    s_nop 0
    v_fma_f32 v80, -v64, v30, v232
    v_mul_f32 v80, v80, v65
    v_fma_f32 v81, -v66, v30, v233
    v_mul_f32 v81, v81, v67
    v_fma_f32 v82, -v68, v30, v234
    v_mul_f32 v82, v82, v69
    v_fma_f32 v83, -v70, v30, v235
    v_mul_f32 v83, v83, v71
    v_fma_f32 v84, -v64, v34, v248
    v_mul_f32 v84, v84, v65
    v_fma_f32 v85, -v66, v34, v249
    v_mul_f32 v85, v85, v67
    v_fma_f32 v86, -v68, v34, v250
    v_mul_f32 v86, v86, v69
    v_fma_f32 v87, -v70, v34, v251
    v_mul_f32 v87, v87, v71
    v_cvt_pk_bf16_f32 v80, v80, v80
    v_cvt_pk_bf16_f32 v81, v81, v81
    v_cvt_pk_bf16_f32 v82, v82, v82
    v_cvt_pk_bf16_f32 v83, v83, v83
    v_cvt_pk_bf16_f32 v84, v84, v84
    v_cvt_pk_bf16_f32 v85, v85, v85
    v_cvt_pk_bf16_f32 v86, v86, v86
    v_cvt_pk_bf16_f32 v87, v87, v87
    s_nop 0
    v_lshlrev_b32 v80, 16, v80
    v_lshlrev_b32 v81, 16, v81
    v_lshlrev_b32 v82, 16, v82
    v_lshlrev_b32 v83, 16, v83
    v_lshlrev_b32 v84, 16, v84
    v_lshlrev_b32 v85, 16, v85
    v_lshlrev_b32 v86, 16, v86
    v_lshlrev_b32 v87, 16, v87
    v_mul_f32 v88, v80, v80
    v_fma_f32 v88, v88, s44, 1.0
    v_mul_f32 v88, v88, v80
    v_mul_f32 v88, 0xc0135761, v88
    v_exp_f32 v88, v88
    s_nop 0
    v_add_f32 v88, 1.0, v88
    v_rcp_f32 v88, v88
    s_nop 0
    v_mul_f32 v88, v88, v80
    v_cvt_pk_bf16_f32 v88, v88, v88
    s_nop 0
    v_lshlrev_b32 v88, 16, v88
    v_mul_f32 v88, v88, v84
    v_mul_f32 v89, v81, v81
    v_fma_f32 v89, v89, s44, 1.0
    v_mul_f32 v89, v89, v81
    v_mul_f32 v89, 0xc0135761, v89
    v_exp_f32 v89, v89
    s_nop 0
    v_add_f32 v89, 1.0, v89
    v_rcp_f32 v89, v89
    s_nop 0
    v_mul_f32 v89, v89, v81
    v_cvt_pk_bf16_f32 v89, v89, v89
    s_nop 0
    v_lshlrev_b32 v89, 16, v89
    v_mul_f32 v89, v89, v85
    v_mul_f32 v90, v82, v82
    v_fma_f32 v90, v90, s44, 1.0
    v_mul_f32 v90, v90, v82
    v_mul_f32 v90, 0xc0135761, v90
    v_exp_f32 v90, v90
    s_nop 0
    v_add_f32 v90, 1.0, v90
    v_rcp_f32 v90, v90
    s_nop 0
    v_mul_f32 v90, v90, v82
    v_cvt_pk_bf16_f32 v90, v90, v90
    s_nop 0
    v_lshlrev_b32 v90, 16, v90
    v_mul_f32 v90, v90, v86
    v_mul_f32 v91, v83, v83
    v_fma_f32 v91, v91, s44, 1.0
    v_mul_f32 v91, v91, v83
    v_mul_f32 v91, 0xc0135761, v91
    v_exp_f32 v91, v91
    s_nop 0
    v_add_f32 v91, 1.0, v91
    v_rcp_f32 v91, v91
    s_nop 0
    v_mul_f32 v91, v91, v83
    v_cvt_pk_bf16_f32 v91, v91, v91
    s_nop 0
    v_lshlrev_b32 v91, 16, v91
    v_mul_f32 v91, v91, v87
    v_cvt_pk_bf16_f32 v96, v88, v89
    v_cvt_pk_bf16_f32 v97, v90, v91
    s_add_u32 s38, s37, 131072
    s_nop 0
    buffer_store_dwordx2 v[96:97], v3, s[20:23], s38 offen offset:96
    s_nop 0
    v_fma_f32 v80, -v64, v31, v236
    v_mul_f32 v80, v80, v65
    v_fma_f32 v81, -v66, v31, v237
    v_mul_f32 v81, v81, v67
    v_fma_f32 v82, -v68, v31, v238
    v_mul_f32 v82, v82, v69
    v_fma_f32 v83, -v70, v31, v239
    v_mul_f32 v83, v83, v71
    v_fma_f32 v84, -v64, v35, v252
    v_mul_f32 v84, v84, v65
    v_fma_f32 v85, -v66, v35, v253
    v_mul_f32 v85, v85, v67
    v_fma_f32 v86, -v68, v35, v254
    v_mul_f32 v86, v86, v69
    v_fma_f32 v87, -v70, v35, v255
    v_mul_f32 v87, v87, v71
    v_cvt_pk_bf16_f32 v80, v80, v80
    v_cvt_pk_bf16_f32 v81, v81, v81
    v_cvt_pk_bf16_f32 v82, v82, v82
    v_cvt_pk_bf16_f32 v83, v83, v83
    v_cvt_pk_bf16_f32 v84, v84, v84
    v_cvt_pk_bf16_f32 v85, v85, v85
    v_cvt_pk_bf16_f32 v86, v86, v86
    v_cvt_pk_bf16_f32 v87, v87, v87
    s_nop 0
    v_lshlrev_b32 v80, 16, v80
    v_lshlrev_b32 v81, 16, v81
    v_lshlrev_b32 v82, 16, v82
    v_lshlrev_b32 v83, 16, v83
    v_lshlrev_b32 v84, 16, v84
    v_lshlrev_b32 v85, 16, v85
    v_lshlrev_b32 v86, 16, v86
    v_lshlrev_b32 v87, 16, v87
    v_mul_f32 v88, v80, v80
    v_fma_f32 v88, v88, s44, 1.0
    v_mul_f32 v88, v88, v80
    v_mul_f32 v88, 0xc0135761, v88
    v_exp_f32 v88, v88
    s_nop 0
    v_add_f32 v88, 1.0, v88
    v_rcp_f32 v88, v88
    s_nop 0
    v_mul_f32 v88, v88, v80
    v_cvt_pk_bf16_f32 v88, v88, v88
    s_nop 0
    v_lshlrev_b32 v88, 16, v88
    v_mul_f32 v88, v88, v84
    v_mul_f32 v89, v81, v81
    v_fma_f32 v89, v89, s44, 1.0
    v_mul_f32 v89, v89, v81
    v_mul_f32 v89, 0xc0135761, v89
    v_exp_f32 v89, v89
    s_nop 0
    v_add_f32 v89, 1.0, v89
    v_rcp_f32 v89, v89
    s_nop 0
    v_mul_f32 v89, v89, v81
    v_cvt_pk_bf16_f32 v89, v89, v89
    s_nop 0
    v_lshlrev_b32 v89, 16, v89
    v_mul_f32 v89, v89, v85
    v_mul_f32 v90, v82, v82
    v_fma_f32 v90, v90, s44, 1.0
    v_mul_f32 v90, v90, v82
    v_mul_f32 v90, 0xc0135761, v90
    v_exp_f32 v90, v90
    s_nop 0
    v_add_f32 v90, 1.0, v90
    v_rcp_f32 v90, v90
    s_nop 0
    v_mul_f32 v90, v90, v82
    v_cvt_pk_bf16_f32 v90, v90, v90
    s_nop 0
    v_lshlrev_b32 v90, 16, v90
    v_mul_f32 v90, v90, v86
    v_mul_f32 v91, v83, v83
    v_fma_f32 v91, v91, s44, 1.0
    v_mul_f32 v91, v91, v83
    v_mul_f32 v91, 0xc0135761, v91
    v_exp_f32 v91, v91
    s_nop 0
    v_add_f32 v91, 1.0, v91
    v_rcp_f32 v91, v91
    s_nop 0
    v_mul_f32 v91, v91, v83
    v_cvt_pk_bf16_f32 v91, v91, v91
    s_nop 0
    v_lshlrev_b32 v91, 16, v91
    v_mul_f32 v91, v91, v87
    v_cvt_pk_bf16_f32 v96, v88, v89
    v_cvt_pk_bf16_f32 v97, v90, v91
    s_add_u32 s38, s37, 196608
    s_nop 0
    buffer_store_dwordx2 v[96:97], v3, s[20:23], s38 offen offset:96
    s_nop 0
g1a_exit:
    s_endpgm

.globl g2a_kernel
.p2align 8
.type g2a_kernel,@function
g2a_kernel:
    s_cmp_ge_u32 s2, 256
    s_cbranch_scc1 g2a_exit
    s_load_dwordx2 s[4:5], s[0:1], 120
    s_load_dwordx2 s[6:7], s[0:1], 96
    s_load_dwordx2 s[28:29], s[0:1], 104
    v_readfirstlane_b32 s30, v0
    s_lshr_b32 s30, s30, 6
    s_and_b32 s33, s2, 31
    s_lshl_b32 s33, s33, 6
    s_lshr_b32 s34, s2, 5
    s_lshl_b32 s34, s34, 6
    s_waitcnt lgkmcnt(0)
    s_add_u32 s8, s4, 0x800000
    s_addc_u32 s9, s5, 0
    s_and_b32 s9, s9, 0xffff
    s_mov_b32 s10, 0x700000
    s_mov_b32 s11, 0x00020000
    s_add_u32 s12, s6, 0x0
    s_addc_u32 s13, s7, 0
    s_and_b32 s13, s13, 0xffff
    s_mov_b32 s14, 0x1c0000
    s_mov_b32 s15, 0x00020000
    s_add_u32 s16, s4, 0x200000
    s_addc_u32 s17, s5, 0
    s_and_b32 s17, s17, 0xffff
    s_mov_b32 s18, 0x200000
    s_mov_b32 s19, 0x00020000
    s_add_u32 s20, s4, 0x400000
    s_addc_u32 s21, s5, 0
    s_and_b32 s21, s21, 0xffff
    s_mov_b32 s22, 0x200000
    s_mov_b32 s23, 0x00020000
    s_add_u32 s24, s4, 0x1410000
    s_addc_u32 s25, s5, 0
    s_and_b32 s25, s25, 0xffff
    s_mov_b32 s26, 0x4000
    s_mov_b32 s27, 0x00020000
    v_and_b32 v25, 63, v0
    v_and_b32 v26, 15, v25
    v_lshrrev_b32 v27, 4, v25
    v_and_b32 v0, 7, v25
    v_and_b32 v24, 1, v27
    v_lshlrev_b32 v24, 1, v24
    v_xor_b32 v0, v0, v24
    v_lshlrev_b32 v0, 4, v0
    s_lshl_b32 s35, s30, 5
    s_add_u32 s35, s35, 0
    v_lshrrev_b32 v24, 3, v25
    v_add_u32 v24, s35, v24
    v_lshl_add_u32 v9, v24, 12, v0
    s_lshl_b32 s36, s33, 1
    v_add_u32 v9, s36, v9
    v_lshl_add_u32 v13, v24, 10, v0
    s_lshl_b32 s36, s34, 1
    v_add_u32 v13, s36, v13
    v_and_b32 v0, 7, v25
    v_and_b32 v24, 1, v27
    v_lshlrev_b32 v24, 1, v24
    v_xor_b32 v0, v0, v24
    v_xor_b32 v0, 4, v0
    v_lshlrev_b32 v0, 4, v0
    s_lshl_b32 s35, s30, 5
    s_add_u32 s35, s35, 8
    v_lshrrev_b32 v24, 3, v25
    v_add_u32 v24, s35, v24
    v_lshl_add_u32 v10, v24, 12, v0
    s_lshl_b32 s36, s33, 1
    v_add_u32 v10, s36, v10
    v_lshl_add_u32 v14, v24, 10, v0
    s_lshl_b32 s36, s34, 1
    v_add_u32 v14, s36, v14
    v_and_b32 v0, 7, v25
    v_and_b32 v24, 1, v27
    v_lshlrev_b32 v24, 1, v24
    v_xor_b32 v0, v0, v24
    v_lshlrev_b32 v0, 4, v0
    s_lshl_b32 s35, s30, 5
    s_add_u32 s35, s35, 16
    v_lshrrev_b32 v24, 3, v25
    v_add_u32 v24, s35, v24
    v_lshl_add_u32 v11, v24, 12, v0
    s_lshl_b32 s36, s33, 1
    v_add_u32 v11, s36, v11
    v_lshl_add_u32 v15, v24, 10, v0
    s_lshl_b32 s36, s34, 1
    v_add_u32 v15, s36, v15
    v_and_b32 v0, 7, v25
    v_and_b32 v24, 1, v27
    v_lshlrev_b32 v24, 1, v24
    v_xor_b32 v0, v0, v24
    v_xor_b32 v0, 4, v0
    v_lshlrev_b32 v0, 4, v0
    s_lshl_b32 s35, s30, 5
    s_add_u32 s35, s35, 24
    v_lshrrev_b32 v24, 3, v25
    v_add_u32 v24, s35, v24
    v_lshl_add_u32 v12, v24, 12, v0
    s_lshl_b32 s36, s33, 1
    v_add_u32 v12, s36, v12
    v_lshl_add_u32 v16, v24, 10, v0
    s_lshl_b32 s36, s34, 1
    v_add_u32 v16, s36, v16
    s_lshl_b32 s42, s30, 14
    s_mov_b32 s40, 0
    s_mov_b32 s41, 0
    s_add_u32 m0, s42, 0
    s_nop 0
    buffer_load_dwordx4 v9, s[8:11], s40 offen lds
    s_add_u32 m0, s42, 4096
    s_nop 0
    buffer_load_dwordx4 v13, s[12:15], s41 offen lds
    s_add_u32 m0, s42, 1024
    s_nop 0
    buffer_load_dwordx4 v10, s[8:11], s40 offen lds
    s_add_u32 m0, s42, 5120
    s_nop 0
    buffer_load_dwordx4 v14, s[12:15], s41 offen lds
    s_add_u32 m0, s42, 2048
    s_nop 0
    buffer_load_dwordx4 v11, s[8:11], s40 offen lds
    s_add_u32 m0, s42, 6144
    s_nop 0
    buffer_load_dwordx4 v15, s[12:15], s41 offen lds
    s_add_u32 m0, s42, 3072
    s_nop 0
    buffer_load_dwordx4 v12, s[8:11], s40 offen lds
    s_add_u32 m0, s42, 7168
    s_nop 0
    buffer_load_dwordx4 v16, s[12:15], s41 offen lds
    v_lshrrev_b32 v0, 2, v26
    v_lshrrev_b32 v24, 1, v0
    v_and_b32 v17, 1, v27
    v_lshl_or_b32 v24, v17, 1, v24
    v_lshlrev_b32 v24, 1, v24
    v_and_b32 v17, 3, v26
    v_lshrrev_b32 v18, 1, v17
    v_and_b32 v17, 1, v17
    v_lshl_add_u32 v0, v27, 3, v0
    v_lshlrev_b32 v0, 7, v0
    v_lshl_add_u32 v0, v17, 3, v0
    v_add_u32 v0, s42, v0
    v_add_u32 v19, 0, v18
    v_xor_b32 v19, v19, v24
    v_lshl_add_u32 v1, v19, 4, v0
    v_add_u32 v19, 2, v18
    v_xor_b32 v19, v19, v24
    v_lshl_add_u32 v2, v19, 4, v0
    v_add_u32 v19, 4, v18
    v_xor_b32 v19, v19, v24
    v_lshl_add_u32 v3, v19, 4, v0
    v_add_u32 v19, 6, v18
    v_xor_b32 v19, v19, v24
    v_lshl_add_u32 v4, v19, 4, v0
    v_mov_b32 v64, 0
    v_mov_b32 v65, 0
    v_mov_b32 v66, 0
    v_mov_b32 v67, 0
    v_mov_b32 v68, 0
    v_mov_b32 v69, 0
    v_mov_b32 v70, 0
    v_mov_b32 v71, 0
    v_mov_b32 v72, 0
    v_mov_b32 v73, 0
    v_mov_b32 v74, 0
    v_mov_b32 v75, 0
    v_mov_b32 v76, 0
    v_mov_b32 v77, 0
    v_mov_b32 v78, 0
    v_mov_b32 v79, 0
    v_mov_b32 v80, 0
    v_mov_b32 v81, 0
    v_mov_b32 v82, 0
    v_mov_b32 v83, 0
    v_mov_b32 v84, 0
    v_mov_b32 v85, 0
    v_mov_b32 v86, 0
    v_mov_b32 v87, 0
    v_mov_b32 v88, 0
    v_mov_b32 v89, 0
    v_mov_b32 v90, 0
    v_mov_b32 v91, 0
    v_mov_b32 v92, 0
    v_mov_b32 v93, 0
    v_mov_b32 v94, 0
    v_mov_b32 v95, 0
    v_mov_b32 v96, 0
    v_mov_b32 v97, 0
    v_mov_b32 v98, 0
    v_mov_b32 v99, 0
    v_mov_b32 v100, 0
    v_mov_b32 v101, 0
    v_mov_b32 v102, 0
    v_mov_b32 v103, 0
    v_mov_b32 v104, 0
    v_mov_b32 v105, 0
    v_mov_b32 v106, 0
    v_mov_b32 v107, 0
    v_mov_b32 v108, 0
    v_mov_b32 v109, 0
    v_mov_b32 v110, 0
    v_mov_b32 v111, 0
    v_mov_b32 v112, 0
    v_mov_b32 v113, 0
    v_mov_b32 v114, 0
    v_mov_b32 v115, 0
    v_mov_b32 v116, 0
    v_mov_b32 v117, 0
    v_mov_b32 v118, 0
    v_mov_b32 v119, 0
    v_mov_b32 v120, 0
    v_mov_b32 v121, 0
    v_mov_b32 v122, 0
    v_mov_b32 v123, 0
    v_mov_b32 v124, 0
    v_mov_b32 v125, 0
    v_mov_b32 v126, 0
    v_mov_b32 v127, 0
    s_waitcnt vmcnt(0)
    s_mov_b32 s40, 524288
    s_mov_b32 s41, 131072
    s_add_u32 m0, s42, 8192
    s_nop 0
    buffer_load_dwordx4 v9, s[8:11], s40 offen lds
    s_add_u32 m0, s42, 12288
    s_nop 0
    buffer_load_dwordx4 v13, s[12:15], s41 offen lds
    s_add_u32 m0, s42, 9216
    s_nop 0
    buffer_load_dwordx4 v10, s[8:11], s40 offen lds
    s_add_u32 m0, s42, 13312
    s_nop 0
    buffer_load_dwordx4 v14, s[12:15], s41 offen lds
    s_add_u32 m0, s42, 10240
    s_nop 0
    buffer_load_dwordx4 v11, s[8:11], s40 offen lds
    s_add_u32 m0, s42, 14336
    s_nop 0
    buffer_load_dwordx4 v15, s[12:15], s41 offen lds
    s_add_u32 m0, s42, 11264
    s_nop 0
    buffer_load_dwordx4 v12, s[8:11], s40 offen lds
    s_add_u32 m0, s42, 15360
    s_nop 0
    buffer_load_dwordx4 v16, s[12:15], s41 offen lds
    ds_read_b64_tr_b16 v[28:29], v1 offset:0
    ds_read_b64_tr_b16 v[30:31], v1 offset:512
    ds_read_b64_tr_b16 v[32:33], v2 offset:0
    ds_read_b64_tr_b16 v[34:35], v2 offset:512
    ds_read_b64_tr_b16 v[36:37], v3 offset:0
    ds_read_b64_tr_b16 v[38:39], v3 offset:512
    ds_read_b64_tr_b16 v[40:41], v4 offset:0
    ds_read_b64_tr_b16 v[42:43], v4 offset:512
    ds_read_b64_tr_b16 v[44:45], v1 offset:4096
    ds_read_b64_tr_b16 v[46:47], v1 offset:4608
    ds_read_b64_tr_b16 v[48:49], v2 offset:4096
    ds_read_b64_tr_b16 v[50:51], v2 offset:4608
    ds_read_b64_tr_b16 v[52:53], v3 offset:4096
    ds_read_b64_tr_b16 v[54:55], v3 offset:4608
    ds_read_b64_tr_b16 v[56:57], v4 offset:4096
    ds_read_b64_tr_b16 v[58:59], v4 offset:4608
    s_waitcnt lgkmcnt(0)
    v_mfma_f32_16x16x32_bf16 v[64:67], v[28:31], v[44:47], v[64:67]
    v_mfma_f32_16x16x32_bf16 v[68:71], v[28:31], v[48:51], v[68:71]
    v_mfma_f32_16x16x32_bf16 v[72:75], v[28:31], v[52:55], v[72:75]
    v_mfma_f32_16x16x32_bf16 v[76:79], v[28:31], v[56:59], v[76:79]
    v_mfma_f32_16x16x32_bf16 v[80:83], v[32:35], v[44:47], v[80:83]
    v_mfma_f32_16x16x32_bf16 v[84:87], v[32:35], v[48:51], v[84:87]
    v_mfma_f32_16x16x32_bf16 v[88:91], v[32:35], v[52:55], v[88:91]
    v_mfma_f32_16x16x32_bf16 v[92:95], v[32:35], v[56:59], v[92:95]
    v_mfma_f32_16x16x32_bf16 v[96:99], v[36:39], v[44:47], v[96:99]
    v_mfma_f32_16x16x32_bf16 v[100:103], v[36:39], v[48:51], v[100:103]
    v_mfma_f32_16x16x32_bf16 v[104:107], v[36:39], v[52:55], v[104:107]
    v_mfma_f32_16x16x32_bf16 v[108:111], v[36:39], v[56:59], v[108:111]
    v_mfma_f32_16x16x32_bf16 v[112:115], v[40:43], v[44:47], v[112:115]
    v_mfma_f32_16x16x32_bf16 v[116:119], v[40:43], v[48:51], v[116:119]
    v_mfma_f32_16x16x32_bf16 v[120:123], v[40:43], v[52:55], v[120:123]
    v_mfma_f32_16x16x32_bf16 v[124:127], v[40:43], v[56:59], v[124:127]
    s_waitcnt vmcnt(0)
    s_mov_b32 s40, 1048576
    s_mov_b32 s41, 262144
    s_add_u32 m0, s42, 0
    s_nop 0
    buffer_load_dwordx4 v9, s[8:11], s40 offen lds
    s_add_u32 m0, s42, 4096
    s_nop 0
    buffer_load_dwordx4 v13, s[12:15], s41 offen lds
    s_add_u32 m0, s42, 1024
    s_nop 0
    buffer_load_dwordx4 v10, s[8:11], s40 offen lds
    s_add_u32 m0, s42, 5120
    s_nop 0
    buffer_load_dwordx4 v14, s[12:15], s41 offen lds
    s_add_u32 m0, s42, 2048
    s_nop 0
    buffer_load_dwordx4 v11, s[8:11], s40 offen lds
    s_add_u32 m0, s42, 6144
    s_nop 0
    buffer_load_dwordx4 v15, s[12:15], s41 offen lds
    s_add_u32 m0, s42, 3072
    s_nop 0
    buffer_load_dwordx4 v12, s[8:11], s40 offen lds
    s_add_u32 m0, s42, 7168
    s_nop 0
    buffer_load_dwordx4 v16, s[12:15], s41 offen lds
    ds_read_b64_tr_b16 v[28:29], v1 offset:8192
    ds_read_b64_tr_b16 v[30:31], v1 offset:8704
    ds_read_b64_tr_b16 v[32:33], v2 offset:8192
    ds_read_b64_tr_b16 v[34:35], v2 offset:8704
    ds_read_b64_tr_b16 v[36:37], v3 offset:8192
    ds_read_b64_tr_b16 v[38:39], v3 offset:8704
    ds_read_b64_tr_b16 v[40:41], v4 offset:8192
    ds_read_b64_tr_b16 v[42:43], v4 offset:8704
    ds_read_b64_tr_b16 v[44:45], v1 offset:12288
    ds_read_b64_tr_b16 v[46:47], v1 offset:12800
    ds_read_b64_tr_b16 v[48:49], v2 offset:12288
    ds_read_b64_tr_b16 v[50:51], v2 offset:12800
    ds_read_b64_tr_b16 v[52:53], v3 offset:12288
    ds_read_b64_tr_b16 v[54:55], v3 offset:12800
    ds_read_b64_tr_b16 v[56:57], v4 offset:12288
    ds_read_b64_tr_b16 v[58:59], v4 offset:12800
    s_waitcnt lgkmcnt(0)
    v_mfma_f32_16x16x32_bf16 v[64:67], v[28:31], v[44:47], v[64:67]
    v_mfma_f32_16x16x32_bf16 v[68:71], v[28:31], v[48:51], v[68:71]
    v_mfma_f32_16x16x32_bf16 v[72:75], v[28:31], v[52:55], v[72:75]
    v_mfma_f32_16x16x32_bf16 v[76:79], v[28:31], v[56:59], v[76:79]
    v_mfma_f32_16x16x32_bf16 v[80:83], v[32:35], v[44:47], v[80:83]
    v_mfma_f32_16x16x32_bf16 v[84:87], v[32:35], v[48:51], v[84:87]
    v_mfma_f32_16x16x32_bf16 v[88:91], v[32:35], v[52:55], v[88:91]
    v_mfma_f32_16x16x32_bf16 v[92:95], v[32:35], v[56:59], v[92:95]
    v_mfma_f32_16x16x32_bf16 v[96:99], v[36:39], v[44:47], v[96:99]
    v_mfma_f32_16x16x32_bf16 v[100:103], v[36:39], v[48:51], v[100:103]
    v_mfma_f32_16x16x32_bf16 v[104:107], v[36:39], v[52:55], v[104:107]
    v_mfma_f32_16x16x32_bf16 v[108:111], v[36:39], v[56:59], v[108:111]
    v_mfma_f32_16x16x32_bf16 v[112:115], v[40:43], v[44:47], v[112:115]
    v_mfma_f32_16x16x32_bf16 v[116:119], v[40:43], v[48:51], v[116:119]
    v_mfma_f32_16x16x32_bf16 v[120:123], v[40:43], v[52:55], v[120:123]
    v_mfma_f32_16x16x32_bf16 v[124:127], v[40:43], v[56:59], v[124:127]
    s_waitcnt vmcnt(0)
    s_mov_b32 s40, 1572864
    s_mov_b32 s41, 393216
    s_add_u32 m0, s42, 8192
    s_nop 0
    buffer_load_dwordx4 v9, s[8:11], s40 offen lds
    s_add_u32 m0, s42, 12288
    s_nop 0
    buffer_load_dwordx4 v13, s[12:15], s41 offen lds
    s_add_u32 m0, s42, 9216
    s_nop 0
    buffer_load_dwordx4 v10, s[8:11], s40 offen lds
    s_add_u32 m0, s42, 13312
    s_nop 0
    buffer_load_dwordx4 v14, s[12:15], s41 offen lds
    s_add_u32 m0, s42, 10240
    s_nop 0
    buffer_load_dwordx4 v11, s[8:11], s40 offen lds
    s_add_u32 m0, s42, 14336
    s_nop 0
    buffer_load_dwordx4 v15, s[12:15], s41 offen lds
    s_add_u32 m0, s42, 11264
    s_nop 0
    buffer_load_dwordx4 v12, s[8:11], s40 offen lds
    s_add_u32 m0, s42, 15360
    s_nop 0
    buffer_load_dwordx4 v16, s[12:15], s41 offen lds
    ds_read_b64_tr_b16 v[28:29], v1 offset:0
    ds_read_b64_tr_b16 v[30:31], v1 offset:512
    ds_read_b64_tr_b16 v[32:33], v2 offset:0
    ds_read_b64_tr_b16 v[34:35], v2 offset:512
    ds_read_b64_tr_b16 v[36:37], v3 offset:0
    ds_read_b64_tr_b16 v[38:39], v3 offset:512
    ds_read_b64_tr_b16 v[40:41], v4 offset:0
    ds_read_b64_tr_b16 v[42:43], v4 offset:512
    ds_read_b64_tr_b16 v[44:45], v1 offset:4096
    ds_read_b64_tr_b16 v[46:47], v1 offset:4608
    ds_read_b64_tr_b16 v[48:49], v2 offset:4096
    ds_read_b64_tr_b16 v[50:51], v2 offset:4608
    ds_read_b64_tr_b16 v[52:53], v3 offset:4096
    ds_read_b64_tr_b16 v[54:55], v3 offset:4608
    ds_read_b64_tr_b16 v[56:57], v4 offset:4096
    ds_read_b64_tr_b16 v[58:59], v4 offset:4608
    s_waitcnt lgkmcnt(0)
    v_mfma_f32_16x16x32_bf16 v[64:67], v[28:31], v[44:47], v[64:67]
    v_mfma_f32_16x16x32_bf16 v[68:71], v[28:31], v[48:51], v[68:71]
    v_mfma_f32_16x16x32_bf16 v[72:75], v[28:31], v[52:55], v[72:75]
    v_mfma_f32_16x16x32_bf16 v[76:79], v[28:31], v[56:59], v[76:79]
    v_mfma_f32_16x16x32_bf16 v[80:83], v[32:35], v[44:47], v[80:83]
    v_mfma_f32_16x16x32_bf16 v[84:87], v[32:35], v[48:51], v[84:87]
    v_mfma_f32_16x16x32_bf16 v[88:91], v[32:35], v[52:55], v[88:91]
    v_mfma_f32_16x16x32_bf16 v[92:95], v[32:35], v[56:59], v[92:95]
    v_mfma_f32_16x16x32_bf16 v[96:99], v[36:39], v[44:47], v[96:99]
    v_mfma_f32_16x16x32_bf16 v[100:103], v[36:39], v[48:51], v[100:103]
    v_mfma_f32_16x16x32_bf16 v[104:107], v[36:39], v[52:55], v[104:107]
    v_mfma_f32_16x16x32_bf16 v[108:111], v[36:39], v[56:59], v[108:111]
    v_mfma_f32_16x16x32_bf16 v[112:115], v[40:43], v[44:47], v[112:115]
    v_mfma_f32_16x16x32_bf16 v[116:119], v[40:43], v[48:51], v[116:119]
    v_mfma_f32_16x16x32_bf16 v[120:123], v[40:43], v[52:55], v[120:123]
    v_mfma_f32_16x16x32_bf16 v[124:127], v[40:43], v[56:59], v[124:127]
    s_waitcnt vmcnt(0)
    s_mov_b32 s40, 2097152
    s_mov_b32 s41, 524288
    s_add_u32 m0, s42, 0
    s_nop 0
    buffer_load_dwordx4 v9, s[8:11], s40 offen lds
    s_add_u32 m0, s42, 4096
    s_nop 0
    buffer_load_dwordx4 v13, s[12:15], s41 offen lds
    s_add_u32 m0, s42, 1024
    s_nop 0
    buffer_load_dwordx4 v10, s[8:11], s40 offen lds
    s_add_u32 m0, s42, 5120
    s_nop 0
    buffer_load_dwordx4 v14, s[12:15], s41 offen lds
    s_add_u32 m0, s42, 2048
    s_nop 0
    buffer_load_dwordx4 v11, s[8:11], s40 offen lds
    s_add_u32 m0, s42, 6144
    s_nop 0
    buffer_load_dwordx4 v15, s[12:15], s41 offen lds
    s_add_u32 m0, s42, 3072
    s_nop 0
    buffer_load_dwordx4 v12, s[8:11], s40 offen lds
    s_add_u32 m0, s42, 7168
    s_nop 0
    buffer_load_dwordx4 v16, s[12:15], s41 offen lds
    ds_read_b64_tr_b16 v[28:29], v1 offset:8192
    ds_read_b64_tr_b16 v[30:31], v1 offset:8704
    ds_read_b64_tr_b16 v[32:33], v2 offset:8192
    ds_read_b64_tr_b16 v[34:35], v2 offset:8704
    ds_read_b64_tr_b16 v[36:37], v3 offset:8192
    ds_read_b64_tr_b16 v[38:39], v3 offset:8704
    ds_read_b64_tr_b16 v[40:41], v4 offset:8192
    ds_read_b64_tr_b16 v[42:43], v4 offset:8704
    ds_read_b64_tr_b16 v[44:45], v1 offset:12288
    ds_read_b64_tr_b16 v[46:47], v1 offset:12800
    ds_read_b64_tr_b16 v[48:49], v2 offset:12288
    ds_read_b64_tr_b16 v[50:51], v2 offset:12800
    ds_read_b64_tr_b16 v[52:53], v3 offset:12288
    ds_read_b64_tr_b16 v[54:55], v3 offset:12800
    ds_read_b64_tr_b16 v[56:57], v4 offset:12288
    ds_read_b64_tr_b16 v[58:59], v4 offset:12800
    s_waitcnt lgkmcnt(0)
    v_mfma_f32_16x16x32_bf16 v[64:67], v[28:31], v[44:47], v[64:67]
    v_mfma_f32_16x16x32_bf16 v[68:71], v[28:31], v[48:51], v[68:71]
    v_mfma_f32_16x16x32_bf16 v[72:75], v[28:31], v[52:55], v[72:75]
    v_mfma_f32_16x16x32_bf16 v[76:79], v[28:31], v[56:59], v[76:79]
    v_mfma_f32_16x16x32_bf16 v[80:83], v[32:35], v[44:47], v[80:83]
    v_mfma_f32_16x16x32_bf16 v[84:87], v[32:35], v[48:51], v[84:87]
    v_mfma_f32_16x16x32_bf16 v[88:91], v[32:35], v[52:55], v[88:91]
    v_mfma_f32_16x16x32_bf16 v[92:95], v[32:35], v[56:59], v[92:95]
    v_mfma_f32_16x16x32_bf16 v[96:99], v[36:39], v[44:47], v[96:99]
    v_mfma_f32_16x16x32_bf16 v[100:103], v[36:39], v[48:51], v[100:103]
    v_mfma_f32_16x16x32_bf16 v[104:107], v[36:39], v[52:55], v[104:107]
    v_mfma_f32_16x16x32_bf16 v[108:111], v[36:39], v[56:59], v[108:111]
    v_mfma_f32_16x16x32_bf16 v[112:115], v[40:43], v[44:47], v[112:115]
    v_mfma_f32_16x16x32_bf16 v[116:119], v[40:43], v[48:51], v[116:119]
    v_mfma_f32_16x16x32_bf16 v[120:123], v[40:43], v[52:55], v[120:123]
    v_mfma_f32_16x16x32_bf16 v[124:127], v[40:43], v[56:59], v[124:127]
    s_waitcnt vmcnt(0)
    s_mov_b32 s40, 2621440
    s_mov_b32 s41, 655360
    s_add_u32 m0, s42, 8192
    s_nop 0
    buffer_load_dwordx4 v9, s[8:11], s40 offen lds
    s_add_u32 m0, s42, 12288
    s_nop 0
    buffer_load_dwordx4 v13, s[12:15], s41 offen lds
    s_add_u32 m0, s42, 9216
    s_nop 0
    buffer_load_dwordx4 v10, s[8:11], s40 offen lds
    s_add_u32 m0, s42, 13312
    s_nop 0
    buffer_load_dwordx4 v14, s[12:15], s41 offen lds
    s_add_u32 m0, s42, 10240
    s_nop 0
    buffer_load_dwordx4 v11, s[8:11], s40 offen lds
    s_add_u32 m0, s42, 14336
    s_nop 0
    buffer_load_dwordx4 v15, s[12:15], s41 offen lds
    s_add_u32 m0, s42, 11264
    s_nop 0
    buffer_load_dwordx4 v12, s[8:11], s40 offen lds
    s_add_u32 m0, s42, 15360
    s_nop 0
    buffer_load_dwordx4 v16, s[12:15], s41 offen lds
    ds_read_b64_tr_b16 v[28:29], v1 offset:0
    ds_read_b64_tr_b16 v[30:31], v1 offset:512
    ds_read_b64_tr_b16 v[32:33], v2 offset:0
    ds_read_b64_tr_b16 v[34:35], v2 offset:512
    ds_read_b64_tr_b16 v[36:37], v3 offset:0
    ds_read_b64_tr_b16 v[38:39], v3 offset:512
    ds_read_b64_tr_b16 v[40:41], v4 offset:0
    ds_read_b64_tr_b16 v[42:43], v4 offset:512
    ds_read_b64_tr_b16 v[44:45], v1 offset:4096
    ds_read_b64_tr_b16 v[46:47], v1 offset:4608
    ds_read_b64_tr_b16 v[48:49], v2 offset:4096
    ds_read_b64_tr_b16 v[50:51], v2 offset:4608
    ds_read_b64_tr_b16 v[52:53], v3 offset:4096
    ds_read_b64_tr_b16 v[54:55], v3 offset:4608
    ds_read_b64_tr_b16 v[56:57], v4 offset:4096
    ds_read_b64_tr_b16 v[58:59], v4 offset:4608
    s_waitcnt lgkmcnt(0)
    v_mfma_f32_16x16x32_bf16 v[64:67], v[28:31], v[44:47], v[64:67]
    v_mfma_f32_16x16x32_bf16 v[68:71], v[28:31], v[48:51], v[68:71]
    v_mfma_f32_16x16x32_bf16 v[72:75], v[28:31], v[52:55], v[72:75]
    v_mfma_f32_16x16x32_bf16 v[76:79], v[28:31], v[56:59], v[76:79]
    v_mfma_f32_16x16x32_bf16 v[80:83], v[32:35], v[44:47], v[80:83]
    v_mfma_f32_16x16x32_bf16 v[84:87], v[32:35], v[48:51], v[84:87]
    v_mfma_f32_16x16x32_bf16 v[88:91], v[32:35], v[52:55], v[88:91]
    v_mfma_f32_16x16x32_bf16 v[92:95], v[32:35], v[56:59], v[92:95]
    v_mfma_f32_16x16x32_bf16 v[96:99], v[36:39], v[44:47], v[96:99]
    v_mfma_f32_16x16x32_bf16 v[100:103], v[36:39], v[48:51], v[100:103]
    v_mfma_f32_16x16x32_bf16 v[104:107], v[36:39], v[52:55], v[104:107]
    v_mfma_f32_16x16x32_bf16 v[108:111], v[36:39], v[56:59], v[108:111]
    v_mfma_f32_16x16x32_bf16 v[112:115], v[40:43], v[44:47], v[112:115]
    v_mfma_f32_16x16x32_bf16 v[116:119], v[40:43], v[48:51], v[116:119]
    v_mfma_f32_16x16x32_bf16 v[120:123], v[40:43], v[52:55], v[120:123]
    v_mfma_f32_16x16x32_bf16 v[124:127], v[40:43], v[56:59], v[124:127]
    s_waitcnt vmcnt(0)
    s_mov_b32 s40, 3145728
    s_mov_b32 s41, 786432
    s_add_u32 m0, s42, 0
    s_nop 0
    buffer_load_dwordx4 v9, s[8:11], s40 offen lds
    s_add_u32 m0, s42, 4096
    s_nop 0
    buffer_load_dwordx4 v13, s[12:15], s41 offen lds
    s_add_u32 m0, s42, 1024
    s_nop 0
    buffer_load_dwordx4 v10, s[8:11], s40 offen lds
    s_add_u32 m0, s42, 5120
    s_nop 0
    buffer_load_dwordx4 v14, s[12:15], s41 offen lds
    s_add_u32 m0, s42, 2048
    s_nop 0
    buffer_load_dwordx4 v11, s[8:11], s40 offen lds
    s_add_u32 m0, s42, 6144
    s_nop 0
    buffer_load_dwordx4 v15, s[12:15], s41 offen lds
    s_add_u32 m0, s42, 3072
    s_nop 0
    buffer_load_dwordx4 v12, s[8:11], s40 offen lds
    s_add_u32 m0, s42, 7168
    s_nop 0
    buffer_load_dwordx4 v16, s[12:15], s41 offen lds
    ds_read_b64_tr_b16 v[28:29], v1 offset:8192
    ds_read_b64_tr_b16 v[30:31], v1 offset:8704
    ds_read_b64_tr_b16 v[32:33], v2 offset:8192
    ds_read_b64_tr_b16 v[34:35], v2 offset:8704
    ds_read_b64_tr_b16 v[36:37], v3 offset:8192
    ds_read_b64_tr_b16 v[38:39], v3 offset:8704
    ds_read_b64_tr_b16 v[40:41], v4 offset:8192
    ds_read_b64_tr_b16 v[42:43], v4 offset:8704
    ds_read_b64_tr_b16 v[44:45], v1 offset:12288
    ds_read_b64_tr_b16 v[46:47], v1 offset:12800
    ds_read_b64_tr_b16 v[48:49], v2 offset:12288
    ds_read_b64_tr_b16 v[50:51], v2 offset:12800
    ds_read_b64_tr_b16 v[52:53], v3 offset:12288
    ds_read_b64_tr_b16 v[54:55], v3 offset:12800
    ds_read_b64_tr_b16 v[56:57], v4 offset:12288
    ds_read_b64_tr_b16 v[58:59], v4 offset:12800
    s_waitcnt lgkmcnt(0)
    v_mfma_f32_16x16x32_bf16 v[64:67], v[28:31], v[44:47], v[64:67]
    v_mfma_f32_16x16x32_bf16 v[68:71], v[28:31], v[48:51], v[68:71]
    v_mfma_f32_16x16x32_bf16 v[72:75], v[28:31], v[52:55], v[72:75]
    v_mfma_f32_16x16x32_bf16 v[76:79], v[28:31], v[56:59], v[76:79]
    v_mfma_f32_16x16x32_bf16 v[80:83], v[32:35], v[44:47], v[80:83]
    v_mfma_f32_16x16x32_bf16 v[84:87], v[32:35], v[48:51], v[84:87]
    v_mfma_f32_16x16x32_bf16 v[88:91], v[32:35], v[52:55], v[88:91]
    v_mfma_f32_16x16x32_bf16 v[92:95], v[32:35], v[56:59], v[92:95]
    v_mfma_f32_16x16x32_bf16 v[96:99], v[36:39], v[44:47], v[96:99]
    v_mfma_f32_16x16x32_bf16 v[100:103], v[36:39], v[48:51], v[100:103]
    v_mfma_f32_16x16x32_bf16 v[104:107], v[36:39], v[52:55], v[104:107]
    v_mfma_f32_16x16x32_bf16 v[108:111], v[36:39], v[56:59], v[108:111]
    v_mfma_f32_16x16x32_bf16 v[112:115], v[40:43], v[44:47], v[112:115]
    v_mfma_f32_16x16x32_bf16 v[116:119], v[40:43], v[48:51], v[116:119]
    v_mfma_f32_16x16x32_bf16 v[120:123], v[40:43], v[52:55], v[120:123]
    v_mfma_f32_16x16x32_bf16 v[124:127], v[40:43], v[56:59], v[124:127]
    s_waitcnt vmcnt(0)
    s_mov_b32 s40, 3670016
    s_mov_b32 s41, 917504
    s_add_u32 m0, s42, 8192
    s_nop 0
    buffer_load_dwordx4 v9, s[8:11], s40 offen lds
    s_add_u32 m0, s42, 12288
    s_nop 0
    buffer_load_dwordx4 v13, s[12:15], s41 offen lds
    s_add_u32 m0, s42, 9216
    s_nop 0
    buffer_load_dwordx4 v10, s[8:11], s40 offen lds
    s_add_u32 m0, s42, 13312
    s_nop 0
    buffer_load_dwordx4 v14, s[12:15], s41 offen lds
    s_add_u32 m0, s42, 10240
    s_nop 0
    buffer_load_dwordx4 v11, s[8:11], s40 offen lds
    s_add_u32 m0, s42, 14336
    s_nop 0
    buffer_load_dwordx4 v15, s[12:15], s41 offen lds
    s_add_u32 m0, s42, 11264
    s_nop 0
    buffer_load_dwordx4 v12, s[8:11], s40 offen lds
    s_add_u32 m0, s42, 15360
    s_nop 0
    buffer_load_dwordx4 v16, s[12:15], s41 offen lds
    ds_read_b64_tr_b16 v[28:29], v1 offset:0
    ds_read_b64_tr_b16 v[30:31], v1 offset:512
    ds_read_b64_tr_b16 v[32:33], v2 offset:0
    ds_read_b64_tr_b16 v[34:35], v2 offset:512
    ds_read_b64_tr_b16 v[36:37], v3 offset:0
    ds_read_b64_tr_b16 v[38:39], v3 offset:512
    ds_read_b64_tr_b16 v[40:41], v4 offset:0
    ds_read_b64_tr_b16 v[42:43], v4 offset:512
    ds_read_b64_tr_b16 v[44:45], v1 offset:4096
    ds_read_b64_tr_b16 v[46:47], v1 offset:4608
    ds_read_b64_tr_b16 v[48:49], v2 offset:4096
    ds_read_b64_tr_b16 v[50:51], v2 offset:4608
    ds_read_b64_tr_b16 v[52:53], v3 offset:4096
    ds_read_b64_tr_b16 v[54:55], v3 offset:4608
    ds_read_b64_tr_b16 v[56:57], v4 offset:4096
    ds_read_b64_tr_b16 v[58:59], v4 offset:4608
    s_waitcnt lgkmcnt(0)
    v_mfma_f32_16x16x32_bf16 v[64:67], v[28:31], v[44:47], v[64:67]
    v_mfma_f32_16x16x32_bf16 v[68:71], v[28:31], v[48:51], v[68:71]
    v_mfma_f32_16x16x32_bf16 v[72:75], v[28:31], v[52:55], v[72:75]
    v_mfma_f32_16x16x32_bf16 v[76:79], v[28:31], v[56:59], v[76:79]
    v_mfma_f32_16x16x32_bf16 v[80:83], v[32:35], v[44:47], v[80:83]
    v_mfma_f32_16x16x32_bf16 v[84:87], v[32:35], v[48:51], v[84:87]
    v_mfma_f32_16x16x32_bf16 v[88:91], v[32:35], v[52:55], v[88:91]
    v_mfma_f32_16x16x32_bf16 v[92:95], v[32:35], v[56:59], v[92:95]
    v_mfma_f32_16x16x32_bf16 v[96:99], v[36:39], v[44:47], v[96:99]
    v_mfma_f32_16x16x32_bf16 v[100:103], v[36:39], v[48:51], v[100:103]
    v_mfma_f32_16x16x32_bf16 v[104:107], v[36:39], v[52:55], v[104:107]
    v_mfma_f32_16x16x32_bf16 v[108:111], v[36:39], v[56:59], v[108:111]
    v_mfma_f32_16x16x32_bf16 v[112:115], v[40:43], v[44:47], v[112:115]
    v_mfma_f32_16x16x32_bf16 v[116:119], v[40:43], v[48:51], v[116:119]
    v_mfma_f32_16x16x32_bf16 v[120:123], v[40:43], v[52:55], v[120:123]
    v_mfma_f32_16x16x32_bf16 v[124:127], v[40:43], v[56:59], v[124:127]
    s_waitcnt vmcnt(0)
    s_mov_b32 s40, 4194304
    s_mov_b32 s41, 1048576
    s_add_u32 m0, s42, 0
    s_nop 0
    buffer_load_dwordx4 v9, s[8:11], s40 offen lds
    s_add_u32 m0, s42, 4096
    s_nop 0
    buffer_load_dwordx4 v13, s[12:15], s41 offen lds
    s_add_u32 m0, s42, 1024
    s_nop 0
    buffer_load_dwordx4 v10, s[8:11], s40 offen lds
    s_add_u32 m0, s42, 5120
    s_nop 0
    buffer_load_dwordx4 v14, s[12:15], s41 offen lds
    s_add_u32 m0, s42, 2048
    s_nop 0
    buffer_load_dwordx4 v11, s[8:11], s40 offen lds
    s_add_u32 m0, s42, 6144
    s_nop 0
    buffer_load_dwordx4 v15, s[12:15], s41 offen lds
    s_add_u32 m0, s42, 3072
    s_nop 0
    buffer_load_dwordx4 v12, s[8:11], s40 offen lds
    s_add_u32 m0, s42, 7168
    s_nop 0
    buffer_load_dwordx4 v16, s[12:15], s41 offen lds
    ds_read_b64_tr_b16 v[28:29], v1 offset:8192
    ds_read_b64_tr_b16 v[30:31], v1 offset:8704
    ds_read_b64_tr_b16 v[32:33], v2 offset:8192
    ds_read_b64_tr_b16 v[34:35], v2 offset:8704
    ds_read_b64_tr_b16 v[36:37], v3 offset:8192
    ds_read_b64_tr_b16 v[38:39], v3 offset:8704
    ds_read_b64_tr_b16 v[40:41], v4 offset:8192
    ds_read_b64_tr_b16 v[42:43], v4 offset:8704
    ds_read_b64_tr_b16 v[44:45], v1 offset:12288
    ds_read_b64_tr_b16 v[46:47], v1 offset:12800
    ds_read_b64_tr_b16 v[48:49], v2 offset:12288
    ds_read_b64_tr_b16 v[50:51], v2 offset:12800
    ds_read_b64_tr_b16 v[52:53], v3 offset:12288
    ds_read_b64_tr_b16 v[54:55], v3 offset:12800
    ds_read_b64_tr_b16 v[56:57], v4 offset:12288
    ds_read_b64_tr_b16 v[58:59], v4 offset:12800
    s_waitcnt lgkmcnt(0)
    v_mfma_f32_16x16x32_bf16 v[64:67], v[28:31], v[44:47], v[64:67]
    v_mfma_f32_16x16x32_bf16 v[68:71], v[28:31], v[48:51], v[68:71]
    v_mfma_f32_16x16x32_bf16 v[72:75], v[28:31], v[52:55], v[72:75]
    v_mfma_f32_16x16x32_bf16 v[76:79], v[28:31], v[56:59], v[76:79]
    v_mfma_f32_16x16x32_bf16 v[80:83], v[32:35], v[44:47], v[80:83]
    v_mfma_f32_16x16x32_bf16 v[84:87], v[32:35], v[48:51], v[84:87]
    v_mfma_f32_16x16x32_bf16 v[88:91], v[32:35], v[52:55], v[88:91]
    v_mfma_f32_16x16x32_bf16 v[92:95], v[32:35], v[56:59], v[92:95]
    v_mfma_f32_16x16x32_bf16 v[96:99], v[36:39], v[44:47], v[96:99]
    v_mfma_f32_16x16x32_bf16 v[100:103], v[36:39], v[48:51], v[100:103]
    v_mfma_f32_16x16x32_bf16 v[104:107], v[36:39], v[52:55], v[104:107]
    v_mfma_f32_16x16x32_bf16 v[108:111], v[36:39], v[56:59], v[108:111]
    v_mfma_f32_16x16x32_bf16 v[112:115], v[40:43], v[44:47], v[112:115]
    v_mfma_f32_16x16x32_bf16 v[116:119], v[40:43], v[48:51], v[116:119]
    v_mfma_f32_16x16x32_bf16 v[120:123], v[40:43], v[52:55], v[120:123]
    v_mfma_f32_16x16x32_bf16 v[124:127], v[40:43], v[56:59], v[124:127]
    s_waitcnt vmcnt(0)
    s_mov_b32 s40, 4718592
    s_mov_b32 s41, 1179648
    s_add_u32 m0, s42, 8192
    s_nop 0
    buffer_load_dwordx4 v9, s[8:11], s40 offen lds
    s_add_u32 m0, s42, 12288
    s_nop 0
    buffer_load_dwordx4 v13, s[12:15], s41 offen lds
    s_add_u32 m0, s42, 9216
    s_nop 0
    buffer_load_dwordx4 v10, s[8:11], s40 offen lds
    s_add_u32 m0, s42, 13312
    s_nop 0
    buffer_load_dwordx4 v14, s[12:15], s41 offen lds
    s_add_u32 m0, s42, 10240
    s_nop 0
    buffer_load_dwordx4 v11, s[8:11], s40 offen lds
    s_add_u32 m0, s42, 14336
    s_nop 0
    buffer_load_dwordx4 v15, s[12:15], s41 offen lds
    s_add_u32 m0, s42, 11264
    s_nop 0
    buffer_load_dwordx4 v12, s[8:11], s40 offen lds
    s_add_u32 m0, s42, 15360
    s_nop 0
    buffer_load_dwordx4 v16, s[12:15], s41 offen lds
    ds_read_b64_tr_b16 v[28:29], v1 offset:0
    ds_read_b64_tr_b16 v[30:31], v1 offset:512
    ds_read_b64_tr_b16 v[32:33], v2 offset:0
    ds_read_b64_tr_b16 v[34:35], v2 offset:512
    ds_read_b64_tr_b16 v[36:37], v3 offset:0
    ds_read_b64_tr_b16 v[38:39], v3 offset:512
    ds_read_b64_tr_b16 v[40:41], v4 offset:0
    ds_read_b64_tr_b16 v[42:43], v4 offset:512
    ds_read_b64_tr_b16 v[44:45], v1 offset:4096
    ds_read_b64_tr_b16 v[46:47], v1 offset:4608
    ds_read_b64_tr_b16 v[48:49], v2 offset:4096
    ds_read_b64_tr_b16 v[50:51], v2 offset:4608
    ds_read_b64_tr_b16 v[52:53], v3 offset:4096
    ds_read_b64_tr_b16 v[54:55], v3 offset:4608
    ds_read_b64_tr_b16 v[56:57], v4 offset:4096
    ds_read_b64_tr_b16 v[58:59], v4 offset:4608
    s_waitcnt lgkmcnt(0)
    v_mfma_f32_16x16x32_bf16 v[64:67], v[28:31], v[44:47], v[64:67]
    v_mfma_f32_16x16x32_bf16 v[68:71], v[28:31], v[48:51], v[68:71]
    v_mfma_f32_16x16x32_bf16 v[72:75], v[28:31], v[52:55], v[72:75]
    v_mfma_f32_16x16x32_bf16 v[76:79], v[28:31], v[56:59], v[76:79]
    v_mfma_f32_16x16x32_bf16 v[80:83], v[32:35], v[44:47], v[80:83]
    v_mfma_f32_16x16x32_bf16 v[84:87], v[32:35], v[48:51], v[84:87]
    v_mfma_f32_16x16x32_bf16 v[88:91], v[32:35], v[52:55], v[88:91]
    v_mfma_f32_16x16x32_bf16 v[92:95], v[32:35], v[56:59], v[92:95]
    v_mfma_f32_16x16x32_bf16 v[96:99], v[36:39], v[44:47], v[96:99]
    v_mfma_f32_16x16x32_bf16 v[100:103], v[36:39], v[48:51], v[100:103]
    v_mfma_f32_16x16x32_bf16 v[104:107], v[36:39], v[52:55], v[104:107]
    v_mfma_f32_16x16x32_bf16 v[108:111], v[36:39], v[56:59], v[108:111]
    v_mfma_f32_16x16x32_bf16 v[112:115], v[40:43], v[44:47], v[112:115]
    v_mfma_f32_16x16x32_bf16 v[116:119], v[40:43], v[48:51], v[116:119]
    v_mfma_f32_16x16x32_bf16 v[120:123], v[40:43], v[52:55], v[120:123]
    v_mfma_f32_16x16x32_bf16 v[124:127], v[40:43], v[56:59], v[124:127]
    s_waitcnt vmcnt(0)
    s_mov_b32 s40, 5242880
    s_mov_b32 s41, 1310720
    s_add_u32 m0, s42, 0
    s_nop 0
    buffer_load_dwordx4 v9, s[8:11], s40 offen lds
    s_add_u32 m0, s42, 4096
    s_nop 0
    buffer_load_dwordx4 v13, s[12:15], s41 offen lds
    s_add_u32 m0, s42, 1024
    s_nop 0
    buffer_load_dwordx4 v10, s[8:11], s40 offen lds
    s_add_u32 m0, s42, 5120
    s_nop 0
    buffer_load_dwordx4 v14, s[12:15], s41 offen lds
    s_add_u32 m0, s42, 2048
    s_nop 0
    buffer_load_dwordx4 v11, s[8:11], s40 offen lds
    s_add_u32 m0, s42, 6144
    s_nop 0
    buffer_load_dwordx4 v15, s[12:15], s41 offen lds
    s_add_u32 m0, s42, 3072
    s_nop 0
    buffer_load_dwordx4 v12, s[8:11], s40 offen lds
    s_add_u32 m0, s42, 7168
    s_nop 0
    buffer_load_dwordx4 v16, s[12:15], s41 offen lds
    ds_read_b64_tr_b16 v[28:29], v1 offset:8192
    ds_read_b64_tr_b16 v[30:31], v1 offset:8704
    ds_read_b64_tr_b16 v[32:33], v2 offset:8192
    ds_read_b64_tr_b16 v[34:35], v2 offset:8704
    ds_read_b64_tr_b16 v[36:37], v3 offset:8192
    ds_read_b64_tr_b16 v[38:39], v3 offset:8704
    ds_read_b64_tr_b16 v[40:41], v4 offset:8192
    ds_read_b64_tr_b16 v[42:43], v4 offset:8704
    ds_read_b64_tr_b16 v[44:45], v1 offset:12288
    ds_read_b64_tr_b16 v[46:47], v1 offset:12800
    ds_read_b64_tr_b16 v[48:49], v2 offset:12288
    ds_read_b64_tr_b16 v[50:51], v2 offset:12800
    ds_read_b64_tr_b16 v[52:53], v3 offset:12288
    ds_read_b64_tr_b16 v[54:55], v3 offset:12800
    ds_read_b64_tr_b16 v[56:57], v4 offset:12288
    ds_read_b64_tr_b16 v[58:59], v4 offset:12800
    s_waitcnt lgkmcnt(0)
    v_mfma_f32_16x16x32_bf16 v[64:67], v[28:31], v[44:47], v[64:67]
    v_mfma_f32_16x16x32_bf16 v[68:71], v[28:31], v[48:51], v[68:71]
    v_mfma_f32_16x16x32_bf16 v[72:75], v[28:31], v[52:55], v[72:75]
    v_mfma_f32_16x16x32_bf16 v[76:79], v[28:31], v[56:59], v[76:79]
    v_mfma_f32_16x16x32_bf16 v[80:83], v[32:35], v[44:47], v[80:83]
    v_mfma_f32_16x16x32_bf16 v[84:87], v[32:35], v[48:51], v[84:87]
    v_mfma_f32_16x16x32_bf16 v[88:91], v[32:35], v[52:55], v[88:91]
    v_mfma_f32_16x16x32_bf16 v[92:95], v[32:35], v[56:59], v[92:95]
    v_mfma_f32_16x16x32_bf16 v[96:99], v[36:39], v[44:47], v[96:99]
    v_mfma_f32_16x16x32_bf16 v[100:103], v[36:39], v[48:51], v[100:103]
    v_mfma_f32_16x16x32_bf16 v[104:107], v[36:39], v[52:55], v[104:107]
    v_mfma_f32_16x16x32_bf16 v[108:111], v[36:39], v[56:59], v[108:111]
    v_mfma_f32_16x16x32_bf16 v[112:115], v[40:43], v[44:47], v[112:115]
    v_mfma_f32_16x16x32_bf16 v[116:119], v[40:43], v[48:51], v[116:119]
    v_mfma_f32_16x16x32_bf16 v[120:123], v[40:43], v[52:55], v[120:123]
    v_mfma_f32_16x16x32_bf16 v[124:127], v[40:43], v[56:59], v[124:127]
    s_waitcnt vmcnt(0)
    s_mov_b32 s40, 5767168
    s_mov_b32 s41, 1441792
    s_add_u32 m0, s42, 8192
    s_nop 0
    buffer_load_dwordx4 v9, s[8:11], s40 offen lds
    s_add_u32 m0, s42, 12288
    s_nop 0
    buffer_load_dwordx4 v13, s[12:15], s41 offen lds
    s_add_u32 m0, s42, 9216
    s_nop 0
    buffer_load_dwordx4 v10, s[8:11], s40 offen lds
    s_add_u32 m0, s42, 13312
    s_nop 0
    buffer_load_dwordx4 v14, s[12:15], s41 offen lds
    s_add_u32 m0, s42, 10240
    s_nop 0
    buffer_load_dwordx4 v11, s[8:11], s40 offen lds
    s_add_u32 m0, s42, 14336
    s_nop 0
    buffer_load_dwordx4 v15, s[12:15], s41 offen lds
    s_add_u32 m0, s42, 11264
    s_nop 0
    buffer_load_dwordx4 v12, s[8:11], s40 offen lds
    s_add_u32 m0, s42, 15360
    s_nop 0
    buffer_load_dwordx4 v16, s[12:15], s41 offen lds
    ds_read_b64_tr_b16 v[28:29], v1 offset:0
    ds_read_b64_tr_b16 v[30:31], v1 offset:512
    ds_read_b64_tr_b16 v[32:33], v2 offset:0
    ds_read_b64_tr_b16 v[34:35], v2 offset:512
    ds_read_b64_tr_b16 v[36:37], v3 offset:0
    ds_read_b64_tr_b16 v[38:39], v3 offset:512
    ds_read_b64_tr_b16 v[40:41], v4 offset:0
    ds_read_b64_tr_b16 v[42:43], v4 offset:512
    ds_read_b64_tr_b16 v[44:45], v1 offset:4096
    ds_read_b64_tr_b16 v[46:47], v1 offset:4608
    ds_read_b64_tr_b16 v[48:49], v2 offset:4096
    ds_read_b64_tr_b16 v[50:51], v2 offset:4608
    ds_read_b64_tr_b16 v[52:53], v3 offset:4096
    ds_read_b64_tr_b16 v[54:55], v3 offset:4608
    ds_read_b64_tr_b16 v[56:57], v4 offset:4096
    ds_read_b64_tr_b16 v[58:59], v4 offset:4608
    s_waitcnt lgkmcnt(0)
    v_mfma_f32_16x16x32_bf16 v[64:67], v[28:31], v[44:47], v[64:67]
    v_mfma_f32_16x16x32_bf16 v[68:71], v[28:31], v[48:51], v[68:71]
    v_mfma_f32_16x16x32_bf16 v[72:75], v[28:31], v[52:55], v[72:75]
    v_mfma_f32_16x16x32_bf16 v[76:79], v[28:31], v[56:59], v[76:79]
    v_mfma_f32_16x16x32_bf16 v[80:83], v[32:35], v[44:47], v[80:83]
    v_mfma_f32_16x16x32_bf16 v[84:87], v[32:35], v[48:51], v[84:87]
    v_mfma_f32_16x16x32_bf16 v[88:91], v[32:35], v[52:55], v[88:91]
    v_mfma_f32_16x16x32_bf16 v[92:95], v[32:35], v[56:59], v[92:95]
    v_mfma_f32_16x16x32_bf16 v[96:99], v[36:39], v[44:47], v[96:99]
    v_mfma_f32_16x16x32_bf16 v[100:103], v[36:39], v[48:51], v[100:103]
    v_mfma_f32_16x16x32_bf16 v[104:107], v[36:39], v[52:55], v[104:107]
    v_mfma_f32_16x16x32_bf16 v[108:111], v[36:39], v[56:59], v[108:111]
    v_mfma_f32_16x16x32_bf16 v[112:115], v[40:43], v[44:47], v[112:115]
    v_mfma_f32_16x16x32_bf16 v[116:119], v[40:43], v[48:51], v[116:119]
    v_mfma_f32_16x16x32_bf16 v[120:123], v[40:43], v[52:55], v[120:123]
    v_mfma_f32_16x16x32_bf16 v[124:127], v[40:43], v[56:59], v[124:127]
    s_waitcnt vmcnt(0)
    s_mov_b32 s40, 6291456
    s_mov_b32 s41, 1572864
    s_add_u32 m0, s42, 0
    s_nop 0
    buffer_load_dwordx4 v9, s[8:11], s40 offen lds
    s_add_u32 m0, s42, 4096
    s_nop 0
    buffer_load_dwordx4 v13, s[12:15], s41 offen lds
    s_add_u32 m0, s42, 1024
    s_nop 0
    buffer_load_dwordx4 v10, s[8:11], s40 offen lds
    s_add_u32 m0, s42, 5120
    s_nop 0
    buffer_load_dwordx4 v14, s[12:15], s41 offen lds
    s_add_u32 m0, s42, 2048
    s_nop 0
    buffer_load_dwordx4 v11, s[8:11], s40 offen lds
    s_add_u32 m0, s42, 6144
    s_nop 0
    buffer_load_dwordx4 v15, s[12:15], s41 offen lds
    s_add_u32 m0, s42, 3072
    s_nop 0
    buffer_load_dwordx4 v12, s[8:11], s40 offen lds
    s_add_u32 m0, s42, 7168
    s_nop 0
    buffer_load_dwordx4 v16, s[12:15], s41 offen lds
    ds_read_b64_tr_b16 v[28:29], v1 offset:8192
    ds_read_b64_tr_b16 v[30:31], v1 offset:8704
    ds_read_b64_tr_b16 v[32:33], v2 offset:8192
    ds_read_b64_tr_b16 v[34:35], v2 offset:8704
    ds_read_b64_tr_b16 v[36:37], v3 offset:8192
    ds_read_b64_tr_b16 v[38:39], v3 offset:8704
    ds_read_b64_tr_b16 v[40:41], v4 offset:8192
    ds_read_b64_tr_b16 v[42:43], v4 offset:8704
    ds_read_b64_tr_b16 v[44:45], v1 offset:12288
    ds_read_b64_tr_b16 v[46:47], v1 offset:12800
    ds_read_b64_tr_b16 v[48:49], v2 offset:12288
    ds_read_b64_tr_b16 v[50:51], v2 offset:12800
    ds_read_b64_tr_b16 v[52:53], v3 offset:12288
    ds_read_b64_tr_b16 v[54:55], v3 offset:12800
    ds_read_b64_tr_b16 v[56:57], v4 offset:12288
    ds_read_b64_tr_b16 v[58:59], v4 offset:12800
    s_waitcnt lgkmcnt(0)
    v_mfma_f32_16x16x32_bf16 v[64:67], v[28:31], v[44:47], v[64:67]
    v_mfma_f32_16x16x32_bf16 v[68:71], v[28:31], v[48:51], v[68:71]
    v_mfma_f32_16x16x32_bf16 v[72:75], v[28:31], v[52:55], v[72:75]
    v_mfma_f32_16x16x32_bf16 v[76:79], v[28:31], v[56:59], v[76:79]
    v_mfma_f32_16x16x32_bf16 v[80:83], v[32:35], v[44:47], v[80:83]
    v_mfma_f32_16x16x32_bf16 v[84:87], v[32:35], v[48:51], v[84:87]
    v_mfma_f32_16x16x32_bf16 v[88:91], v[32:35], v[52:55], v[88:91]
    v_mfma_f32_16x16x32_bf16 v[92:95], v[32:35], v[56:59], v[92:95]
    v_mfma_f32_16x16x32_bf16 v[96:99], v[36:39], v[44:47], v[96:99]
    v_mfma_f32_16x16x32_bf16 v[100:103], v[36:39], v[48:51], v[100:103]
    v_mfma_f32_16x16x32_bf16 v[104:107], v[36:39], v[52:55], v[104:107]
    v_mfma_f32_16x16x32_bf16 v[108:111], v[36:39], v[56:59], v[108:111]
    v_mfma_f32_16x16x32_bf16 v[112:115], v[40:43], v[44:47], v[112:115]
    v_mfma_f32_16x16x32_bf16 v[116:119], v[40:43], v[48:51], v[116:119]
    v_mfma_f32_16x16x32_bf16 v[120:123], v[40:43], v[52:55], v[120:123]
    v_mfma_f32_16x16x32_bf16 v[124:127], v[40:43], v[56:59], v[124:127]
    s_waitcnt vmcnt(0)
    s_mov_b32 s40, 6815744
    s_mov_b32 s41, 1703936
    s_add_u32 m0, s42, 8192
    s_nop 0
    buffer_load_dwordx4 v9, s[8:11], s40 offen lds
    s_add_u32 m0, s42, 12288
    s_nop 0
    buffer_load_dwordx4 v13, s[12:15], s41 offen lds
    s_add_u32 m0, s42, 9216
    s_nop 0
    buffer_load_dwordx4 v10, s[8:11], s40 offen lds
    s_add_u32 m0, s42, 13312
    s_nop 0
    buffer_load_dwordx4 v14, s[12:15], s41 offen lds
    s_add_u32 m0, s42, 10240
    s_nop 0
    buffer_load_dwordx4 v11, s[8:11], s40 offen lds
    s_add_u32 m0, s42, 14336
    s_nop 0
    buffer_load_dwordx4 v15, s[12:15], s41 offen lds
    s_add_u32 m0, s42, 11264
    s_nop 0
    buffer_load_dwordx4 v12, s[8:11], s40 offen lds
    s_add_u32 m0, s42, 15360
    s_nop 0
    buffer_load_dwordx4 v16, s[12:15], s41 offen lds
    ds_read_b64_tr_b16 v[28:29], v1 offset:0
    ds_read_b64_tr_b16 v[30:31], v1 offset:512
    ds_read_b64_tr_b16 v[32:33], v2 offset:0
    ds_read_b64_tr_b16 v[34:35], v2 offset:512
    ds_read_b64_tr_b16 v[36:37], v3 offset:0
    ds_read_b64_tr_b16 v[38:39], v3 offset:512
    ds_read_b64_tr_b16 v[40:41], v4 offset:0
    ds_read_b64_tr_b16 v[42:43], v4 offset:512
    ds_read_b64_tr_b16 v[44:45], v1 offset:4096
    ds_read_b64_tr_b16 v[46:47], v1 offset:4608
    ds_read_b64_tr_b16 v[48:49], v2 offset:4096
    ds_read_b64_tr_b16 v[50:51], v2 offset:4608
    ds_read_b64_tr_b16 v[52:53], v3 offset:4096
    ds_read_b64_tr_b16 v[54:55], v3 offset:4608
    ds_read_b64_tr_b16 v[56:57], v4 offset:4096
    ds_read_b64_tr_b16 v[58:59], v4 offset:4608
    s_waitcnt lgkmcnt(0)
    v_mfma_f32_16x16x32_bf16 v[64:67], v[28:31], v[44:47], v[64:67]
    v_mfma_f32_16x16x32_bf16 v[68:71], v[28:31], v[48:51], v[68:71]
    v_mfma_f32_16x16x32_bf16 v[72:75], v[28:31], v[52:55], v[72:75]
    v_mfma_f32_16x16x32_bf16 v[76:79], v[28:31], v[56:59], v[76:79]
    v_mfma_f32_16x16x32_bf16 v[80:83], v[32:35], v[44:47], v[80:83]
    v_mfma_f32_16x16x32_bf16 v[84:87], v[32:35], v[48:51], v[84:87]
    v_mfma_f32_16x16x32_bf16 v[88:91], v[32:35], v[52:55], v[88:91]
    v_mfma_f32_16x16x32_bf16 v[92:95], v[32:35], v[56:59], v[92:95]
    v_mfma_f32_16x16x32_bf16 v[96:99], v[36:39], v[44:47], v[96:99]
    v_mfma_f32_16x16x32_bf16 v[100:103], v[36:39], v[48:51], v[100:103]
    v_mfma_f32_16x16x32_bf16 v[104:107], v[36:39], v[52:55], v[104:107]
    v_mfma_f32_16x16x32_bf16 v[108:111], v[36:39], v[56:59], v[108:111]
    v_mfma_f32_16x16x32_bf16 v[112:115], v[40:43], v[44:47], v[112:115]
    v_mfma_f32_16x16x32_bf16 v[116:119], v[40:43], v[48:51], v[116:119]
    v_mfma_f32_16x16x32_bf16 v[120:123], v[40:43], v[52:55], v[120:123]
    v_mfma_f32_16x16x32_bf16 v[124:127], v[40:43], v[56:59], v[124:127]
    s_waitcnt vmcnt(0)
    ds_read_b64_tr_b16 v[28:29], v1 offset:8192
    ds_read_b64_tr_b16 v[30:31], v1 offset:8704
    ds_read_b64_tr_b16 v[32:33], v2 offset:8192
    ds_read_b64_tr_b16 v[34:35], v2 offset:8704
    ds_read_b64_tr_b16 v[36:37], v3 offset:8192
    ds_read_b64_tr_b16 v[38:39], v3 offset:8704
    ds_read_b64_tr_b16 v[40:41], v4 offset:8192
    ds_read_b64_tr_b16 v[42:43], v4 offset:8704
    ds_read_b64_tr_b16 v[44:45], v1 offset:12288
    ds_read_b64_tr_b16 v[46:47], v1 offset:12800
    ds_read_b64_tr_b16 v[48:49], v2 offset:12288
    ds_read_b64_tr_b16 v[50:51], v2 offset:12800
    ds_read_b64_tr_b16 v[52:53], v3 offset:12288
    ds_read_b64_tr_b16 v[54:55], v3 offset:12800
    ds_read_b64_tr_b16 v[56:57], v4 offset:12288
    ds_read_b64_tr_b16 v[58:59], v4 offset:12800
    s_waitcnt lgkmcnt(0)
    v_mfma_f32_16x16x32_bf16 v[64:67], v[28:31], v[44:47], v[64:67]
    v_mfma_f32_16x16x32_bf16 v[68:71], v[28:31], v[48:51], v[68:71]
    v_mfma_f32_16x16x32_bf16 v[72:75], v[28:31], v[52:55], v[72:75]
    v_mfma_f32_16x16x32_bf16 v[76:79], v[28:31], v[56:59], v[76:79]
    v_mfma_f32_16x16x32_bf16 v[80:83], v[32:35], v[44:47], v[80:83]
    v_mfma_f32_16x16x32_bf16 v[84:87], v[32:35], v[48:51], v[84:87]
    v_mfma_f32_16x16x32_bf16 v[88:91], v[32:35], v[52:55], v[88:91]
    v_mfma_f32_16x16x32_bf16 v[92:95], v[32:35], v[56:59], v[92:95]
    v_mfma_f32_16x16x32_bf16 v[96:99], v[36:39], v[44:47], v[96:99]
    v_mfma_f32_16x16x32_bf16 v[100:103], v[36:39], v[48:51], v[100:103]
    v_mfma_f32_16x16x32_bf16 v[104:107], v[36:39], v[52:55], v[104:107]
    v_mfma_f32_16x16x32_bf16 v[108:111], v[36:39], v[56:59], v[108:111]
    v_mfma_f32_16x16x32_bf16 v[112:115], v[40:43], v[44:47], v[112:115]
    v_mfma_f32_16x16x32_bf16 v[116:119], v[40:43], v[48:51], v[116:119]
    v_mfma_f32_16x16x32_bf16 v[120:123], v[40:43], v[52:55], v[120:123]
    v_mfma_f32_16x16x32_bf16 v[124:127], v[40:43], v[56:59], v[124:127]
    s_waitcnt lgkmcnt(0)
    s_nop 7
    v_lshl_add_u32 v1, v25, 4, s42
    ds_write_b128 v1, v[64:67] offset:0
    ds_write_b128 v1, v[68:71] offset:1024
    ds_write_b128 v1, v[72:75] offset:2048
    ds_write_b128 v1, v[76:79] offset:3072
    ds_write_b128 v1, v[80:83] offset:4096
    ds_write_b128 v1, v[84:87] offset:5120
    ds_write_b128 v1, v[88:91] offset:6144
    ds_write_b128 v1, v[92:95] offset:7168
    ds_write_b128 v1, v[96:99] offset:8192
    ds_write_b128 v1, v[100:103] offset:9216
    ds_write_b128 v1, v[104:107] offset:10240
    ds_write_b128 v1, v[108:111] offset:11264
    ds_write_b128 v1, v[112:115] offset:12288
    ds_write_b128 v1, v[116:119] offset:13312
    ds_write_b128 v1, v[120:123] offset:14336
    ds_write_b128 v1, v[124:127] offset:15360
    v_lshlrev_b32 v2, 12, v26
    v_lshl_add_u32 v2, v27, 3, v2
    s_lshl_b32 s37, s34, 12
    s_lshl_b32 s35, s30, 4
    s_add_u32 s35, s35, s33
    s_lshl_b32 s35, s35, 1
    s_add_u32 s37, s37, s35
    s_add_u32 s44, s37, 0
    buffer_load_dwordx2 v[28:29], v2, s[16:19], s44 offen
    s_add_u32 s45, s37, 65536
    buffer_load_dwordx2 v[30:31], v2, s[16:19], s45 offen
    s_add_u32 s46, s37, 131072
    buffer_load_dwordx2 v[32:33], v2, s[16:19], s46 offen
    s_add_u32 s47, s37, 196608
    buffer_load_dwordx2 v[34:35], v2, s[16:19], s47 offen
    s_waitcnt lgkmcnt(0)
    s_barrier
    s_lshl_b32 s35, s30, 12
    v_lshl_add_u32 v1, v25, 4, s35
    ds_read_b128 v[64:67], v1 offset:0
    ds_read_b128 v[68:71], v1 offset:1024
    ds_read_b128 v[72:75], v1 offset:2048
    ds_read_b128 v[76:79], v1 offset:3072
    ds_read_b128 v[80:83], v1 offset:16384
    ds_read_b128 v[84:87], v1 offset:17408
    ds_read_b128 v[88:91], v1 offset:18432
    ds_read_b128 v[92:95], v1 offset:19456
    ds_read_b128 v[96:99], v1 offset:32768
    ds_read_b128 v[100:103], v1 offset:33792
    ds_read_b128 v[104:107], v1 offset:34816
    ds_read_b128 v[108:111], v1 offset:35840
    ds_read_b128 v[112:115], v1 offset:49152
    ds_read_b128 v[116:119], v1 offset:50176
    ds_read_b128 v[120:123], v1 offset:51200
    ds_read_b128 v[124:127], v1 offset:52224
    s_waitcnt vmcnt(0) lgkmcnt(0)
    v_add_f32 v64, v64, v80
    v_add_f32 v65, v65, v81
    v_add_f32 v66, v66, v82
    v_add_f32 v67, v67, v83
    v_add_f32 v68, v68, v84
    v_add_f32 v69, v69, v85
    v_add_f32 v70, v70, v86
    v_add_f32 v71, v71, v87
    v_add_f32 v72, v72, v88
    v_add_f32 v73, v73, v89
    v_add_f32 v74, v74, v90
    v_add_f32 v75, v75, v91
    v_add_f32 v76, v76, v92
    v_add_f32 v77, v77, v93
    v_add_f32 v78, v78, v94
    v_add_f32 v79, v79, v95
    v_add_f32 v64, v64, v96
    v_add_f32 v65, v65, v97
    v_add_f32 v66, v66, v98
    v_add_f32 v67, v67, v99
    v_add_f32 v68, v68, v100
    v_add_f32 v69, v69, v101
    v_add_f32 v70, v70, v102
    v_add_f32 v71, v71, v103
    v_add_f32 v72, v72, v104
    v_add_f32 v73, v73, v105
    v_add_f32 v74, v74, v106
    v_add_f32 v75, v75, v107
    v_add_f32 v76, v76, v108
    v_add_f32 v77, v77, v109
    v_add_f32 v78, v78, v110
    v_add_f32 v79, v79, v111
    v_add_f32 v64, v64, v112
    v_add_f32 v65, v65, v113
    v_add_f32 v66, v66, v114
    v_add_f32 v67, v67, v115
    v_add_f32 v68, v68, v116
    v_add_f32 v69, v69, v117
    v_add_f32 v70, v70, v118
    v_add_f32 v71, v71, v119
    v_add_f32 v72, v72, v120
    v_add_f32 v73, v73, v121
    v_add_f32 v74, v74, v122
    v_add_f32 v75, v75, v123
    v_add_f32 v76, v76, v124
    v_add_f32 v77, v77, v125
    v_add_f32 v78, v78, v126
    v_add_f32 v79, v79, v127
    v_mov_b32 v40, 0
    v_mov_b32 v41, 0
    v_mov_b32 v42, 0
    v_mov_b32 v43, 0
    v_mov_b32 v44, 0
    v_mov_b32 v45, 0
    v_mov_b32 v46, 0
    v_mov_b32 v47, 0
    v_cvt_pk_bf16_f32 v50, v64, v65
    v_cvt_pk_bf16_f32 v51, v66, v67
    s_nop 0
    v_lshlrev_b32 v52, 16, v50
    v_lshlrev_b32 v53, 16, v28
    v_add_f32 v52, v52, v53
    v_and_b32 v53, 0xffff0000, v50
    v_and_b32 v54, 0xffff0000, v28
    v_add_f32 v53, v53, v54
    v_cvt_pk_bf16_f32 v56, v52, v53
    s_nop 0
    v_lshlrev_b32 v52, 16, v56
    v_and_b32 v53, 0xffff0000, v56
    v_add_f32 v40, v40, v52
    v_fma_f32 v44, v52, v52, v44
    v_add_f32 v41, v41, v53
    v_fma_f32 v45, v53, v53, v45
    v_lshlrev_b32 v52, 16, v51
    v_lshlrev_b32 v53, 16, v29
    v_add_f32 v52, v52, v53
    v_and_b32 v53, 0xffff0000, v51
    v_and_b32 v54, 0xffff0000, v29
    v_add_f32 v53, v53, v54
    v_cvt_pk_bf16_f32 v57, v52, v53
    s_nop 0
    v_lshlrev_b32 v52, 16, v57
    v_and_b32 v53, 0xffff0000, v57
    v_add_f32 v42, v42, v52
    v_fma_f32 v46, v52, v52, v46
    v_add_f32 v43, v43, v53
    v_fma_f32 v47, v53, v53, v47
    buffer_store_dwordx2 v[56:57], v2, s[20:23], s44 offen
    s_nop 0
    v_cvt_pk_bf16_f32 v50, v68, v69
    v_cvt_pk_bf16_f32 v51, v70, v71
    s_nop 0
    v_lshlrev_b32 v52, 16, v50
    v_lshlrev_b32 v53, 16, v30
    v_add_f32 v52, v52, v53
    v_and_b32 v53, 0xffff0000, v50
    v_and_b32 v54, 0xffff0000, v30
    v_add_f32 v53, v53, v54
    v_cvt_pk_bf16_f32 v56, v52, v53
    s_nop 0
    v_lshlrev_b32 v52, 16, v56
    v_and_b32 v53, 0xffff0000, v56
    v_add_f32 v40, v40, v52
    v_fma_f32 v44, v52, v52, v44
    v_add_f32 v41, v41, v53
    v_fma_f32 v45, v53, v53, v45
    v_lshlrev_b32 v52, 16, v51
    v_lshlrev_b32 v53, 16, v31
    v_add_f32 v52, v52, v53
    v_and_b32 v53, 0xffff0000, v51
    v_and_b32 v54, 0xffff0000, v31
    v_add_f32 v53, v53, v54
    v_cvt_pk_bf16_f32 v57, v52, v53
    s_nop 0
    v_lshlrev_b32 v52, 16, v57
    v_and_b32 v53, 0xffff0000, v57
    v_add_f32 v42, v42, v52
    v_fma_f32 v46, v52, v52, v46
    v_add_f32 v43, v43, v53
    v_fma_f32 v47, v53, v53, v47
    buffer_store_dwordx2 v[56:57], v2, s[20:23], s45 offen
    s_nop 0
    v_cvt_pk_bf16_f32 v50, v72, v73
    v_cvt_pk_bf16_f32 v51, v74, v75
    s_nop 0
    v_lshlrev_b32 v52, 16, v50
    v_lshlrev_b32 v53, 16, v32
    v_add_f32 v52, v52, v53
    v_and_b32 v53, 0xffff0000, v50
    v_and_b32 v54, 0xffff0000, v32
    v_add_f32 v53, v53, v54
    v_cvt_pk_bf16_f32 v56, v52, v53
    s_nop 0
    v_lshlrev_b32 v52, 16, v56
    v_and_b32 v53, 0xffff0000, v56
    v_add_f32 v40, v40, v52
    v_fma_f32 v44, v52, v52, v44
    v_add_f32 v41, v41, v53
    v_fma_f32 v45, v53, v53, v45
    v_lshlrev_b32 v52, 16, v51
    v_lshlrev_b32 v53, 16, v33
    v_add_f32 v52, v52, v53
    v_and_b32 v53, 0xffff0000, v51
    v_and_b32 v54, 0xffff0000, v33
    v_add_f32 v53, v53, v54
    v_cvt_pk_bf16_f32 v57, v52, v53
    s_nop 0
    v_lshlrev_b32 v52, 16, v57
    v_and_b32 v53, 0xffff0000, v57
    v_add_f32 v42, v42, v52
    v_fma_f32 v46, v52, v52, v46
    v_add_f32 v43, v43, v53
    v_fma_f32 v47, v53, v53, v47
    buffer_store_dwordx2 v[56:57], v2, s[20:23], s46 offen
    s_nop 0
    v_cvt_pk_bf16_f32 v50, v76, v77
    v_cvt_pk_bf16_f32 v51, v78, v79
    s_nop 0
    v_lshlrev_b32 v52, 16, v50
    v_lshlrev_b32 v53, 16, v34
    v_add_f32 v52, v52, v53
    v_and_b32 v53, 0xffff0000, v50
    v_and_b32 v54, 0xffff0000, v34
    v_add_f32 v53, v53, v54
    v_cvt_pk_bf16_f32 v56, v52, v53
    s_nop 0
    v_lshlrev_b32 v52, 16, v56
    v_and_b32 v53, 0xffff0000, v56
    v_add_f32 v40, v40, v52
    v_fma_f32 v44, v52, v52, v44
    v_add_f32 v41, v41, v53
    v_fma_f32 v45, v53, v53, v45
    v_lshlrev_b32 v52, 16, v51
    v_lshlrev_b32 v53, 16, v35
    v_add_f32 v52, v52, v53
    v_and_b32 v53, 0xffff0000, v51
    v_and_b32 v54, 0xffff0000, v35
    v_add_f32 v53, v53, v54
    v_cvt_pk_bf16_f32 v57, v52, v53
    s_nop 0
    v_lshlrev_b32 v52, 16, v57
    v_and_b32 v53, 0xffff0000, v57
    v_add_f32 v42, v42, v52
    v_fma_f32 v46, v52, v52, v46
    v_add_f32 v43, v43, v53
    v_fma_f32 v47, v53, v53, v47
    buffer_store_dwordx2 v[56:57], v2, s[20:23], s47 offen
    s_nop 0
    v_add_f32_dpp v40, v40, v40 row_shr:1 row_mask:0xf bank_mask:0xf bound_ctrl:0
    s_nop 1
    v_add_f32_dpp v40, v40, v40 row_shr:2 row_mask:0xf bank_mask:0xf bound_ctrl:0
    s_nop 1
    v_add_f32_dpp v40, v40, v40 row_shr:4 row_mask:0xf bank_mask:0xf bound_ctrl:0
    s_nop 1
    v_add_f32_dpp v40, v40, v40 row_shr:8 row_mask:0xf bank_mask:0xf bound_ctrl:0
    s_nop 1
    v_add_f32_dpp v41, v41, v41 row_shr:1 row_mask:0xf bank_mask:0xf bound_ctrl:0
    s_nop 1
    v_add_f32_dpp v41, v41, v41 row_shr:2 row_mask:0xf bank_mask:0xf bound_ctrl:0
    s_nop 1
    v_add_f32_dpp v41, v41, v41 row_shr:4 row_mask:0xf bank_mask:0xf bound_ctrl:0
    s_nop 1
    v_add_f32_dpp v41, v41, v41 row_shr:8 row_mask:0xf bank_mask:0xf bound_ctrl:0
    s_nop 1
    v_add_f32_dpp v42, v42, v42 row_shr:1 row_mask:0xf bank_mask:0xf bound_ctrl:0
    s_nop 1
    v_add_f32_dpp v42, v42, v42 row_shr:2 row_mask:0xf bank_mask:0xf bound_ctrl:0
    s_nop 1
    v_add_f32_dpp v42, v42, v42 row_shr:4 row_mask:0xf bank_mask:0xf bound_ctrl:0
    s_nop 1
    v_add_f32_dpp v42, v42, v42 row_shr:8 row_mask:0xf bank_mask:0xf bound_ctrl:0
    s_nop 1
    v_add_f32_dpp v43, v43, v43 row_shr:1 row_mask:0xf bank_mask:0xf bound_ctrl:0
    s_nop 1
    v_add_f32_dpp v43, v43, v43 row_shr:2 row_mask:0xf bank_mask:0xf bound_ctrl:0
    s_nop 1
    v_add_f32_dpp v43, v43, v43 row_shr:4 row_mask:0xf bank_mask:0xf bound_ctrl:0
    s_nop 1
    v_add_f32_dpp v43, v43, v43 row_shr:8 row_mask:0xf bank_mask:0xf bound_ctrl:0
    s_nop 1
    v_add_f32_dpp v44, v44, v44 row_shr:1 row_mask:0xf bank_mask:0xf bound_ctrl:0
    s_nop 1
    v_add_f32_dpp v44, v44, v44 row_shr:2 row_mask:0xf bank_mask:0xf bound_ctrl:0
    s_nop 1
    v_add_f32_dpp v44, v44, v44 row_shr:4 row_mask:0xf bank_mask:0xf bound_ctrl:0
    s_nop 1
    v_add_f32_dpp v44, v44, v44 row_shr:8 row_mask:0xf bank_mask:0xf bound_ctrl:0
    s_nop 1
    v_add_f32_dpp v45, v45, v45 row_shr:1 row_mask:0xf bank_mask:0xf bound_ctrl:0
    s_nop 1
    v_add_f32_dpp v45, v45, v45 row_shr:2 row_mask:0xf bank_mask:0xf bound_ctrl:0
    s_nop 1
    v_add_f32_dpp v45, v45, v45 row_shr:4 row_mask:0xf bank_mask:0xf bound_ctrl:0
    s_nop 1
    v_add_f32_dpp v45, v45, v45 row_shr:8 row_mask:0xf bank_mask:0xf bound_ctrl:0
    s_nop 1
    v_add_f32_dpp v46, v46, v46 row_shr:1 row_mask:0xf bank_mask:0xf bound_ctrl:0
    s_nop 1
    v_add_f32_dpp v46, v46, v46 row_shr:2 row_mask:0xf bank_mask:0xf bound_ctrl:0
    s_nop 1
    v_add_f32_dpp v46, v46, v46 row_shr:4 row_mask:0xf bank_mask:0xf bound_ctrl:0
    s_nop 1
    v_add_f32_dpp v46, v46, v46 row_shr:8 row_mask:0xf bank_mask:0xf bound_ctrl:0
    s_nop 1
    v_add_f32_dpp v47, v47, v47 row_shr:1 row_mask:0xf bank_mask:0xf bound_ctrl:0
    s_nop 1
    v_add_f32_dpp v47, v47, v47 row_shr:2 row_mask:0xf bank_mask:0xf bound_ctrl:0
    s_nop 1
    v_add_f32_dpp v47, v47, v47 row_shr:4 row_mask:0xf bank_mask:0xf bound_ctrl:0
    s_nop 1
    v_add_f32_dpp v47, v47, v47 row_shr:8 row_mask:0xf bank_mask:0xf bound_ctrl:0
    s_nop 1
    s_lshl_b32 s35, s30, 4
    s_add_u32 s35, s35, s33
    s_lshl_b32 s35, s35, 3
    v_lshlrev_b32 v3, 5, v27
    v_cmp_eq_u32 vcc, 15, v26
    s_and_saveexec_b64 s[48:49], vcc
    buffer_atomic_add_f32 v40, v3, s[24:27], s35 offen offset:0
    buffer_atomic_add_f32 v44, v3, s[24:27], s35 offen offset:4
    buffer_atomic_add_f32 v41, v3, s[24:27], s35 offen offset:8
    buffer_atomic_add_f32 v45, v3, s[24:27], s35 offen offset:12
    buffer_atomic_add_f32 v42, v3, s[24:27], s35 offen offset:16
    buffer_atomic_add_f32 v46, v3, s[24:27], s35 offen offset:20
    buffer_atomic_add_f32 v43, v3, s[24:27], s35 offen offset:24
    buffer_atomic_add_f32 v47, v3, s[24:27], s35 offen offset:28
g2a_exit:
    s_endpgm

.globl conv2_kernel
.p2align 8
.type conv2_kernel,@function
conv2_kernel:
    s_cmp_ge_u32 s2, 256
    s_cbranch_scc1 conv2_exit
    s_load_dwordx2 s[4:5], s[0:1], 120
    s_load_dwordx2 s[6:7], s[0:1], 64
    v_readfirstlane_b32 s30, v0
    s_lshr_b32 s30, s30, 6
    s_lshr_b32 s31, s30, 1
    s_and_b32 s32, s30, 1
    s_lshl_b32 s33, s2, 1
    s_add_u32 s34, s33, s31
    s_waitcnt lgkmcnt(0)
    s_add_u32 s8, s4, 0x400000
    s_addc_u32 s9, s5, 0
    s_and_b32 s9, s9, 0xffff
    s_mov_b32 s10, 0x200000
    s_mov_b32 s11, 0x00020000
    s_add_u32 s12, s4, 0x1410000
    s_addc_u32 s13, s5, 0
    s_and_b32 s13, s13, 0xffff
    s_mov_b32 s14, 0x4000
    s_mov_b32 s15, 0x00020000
    s_add_u32 s16, s4, 0x1000000
    s_addc_u32 s17, s5, 0
    s_and_b32 s17, s17, 0xffff
    s_mov_b32 s18, 0x208000
    s_mov_b32 s19, 0x00020000
    s_add_u32 s20, s4, 0x600000
    s_addc_u32 s21, s5, 0
    s_and_b32 s21, s21, 0xffff
    s_mov_b32 s22, 0x200000
    s_mov_b32 s23, 0x00020000
    s_lshl_b32 s37, s34, 1
    s_and_b32 s38, s37, 0xfffffffc
    s_load_dword s39, s[6:7], s38
    v_and_b32 v1, 63, v0
    v_lshlrev_b32 v2, 4, v1
    s_mul_i32 s40, s34, 4160
    s_mul_i32 s41, s31, 21216
    s_lshl_b32 s42, s32, 1
    s_add_u32 s43, s42, 0
    s_mul_i32 s44, s43, 4160
    s_add_u32 s44, s44, s41
    s_lshl_b32 s45, s43, 1
    s_add_u32 s45, s45, 34
    s_add_u32 s45, s45, s40
    s_mov_b32 m0, s44
    s_nop 0
    buffer_load_dwordx4 v2, s[16:19], s45 offen offset:0 lds
    buffer_load_dwordx4 v2, s[16:19], s45 offen offset:1024 lds
    buffer_load_dwordx4 v2, s[16:19], s45 offen offset:2048 lds
    buffer_load_dwordx4 v2, s[16:19], s45 offen offset:3072 lds
    s_add_u32 s44, s44, 4096
    s_add_u32 s45, s45, 4096
    s_mov_b32 m0, s44
    s_mov_b64 exec, 3
    buffer_load_dwordx4 v2, s[16:19], s45 offen lds
    s_mov_b64 exec, -1
    s_add_u32 s43, s42, 1
    s_mul_i32 s44, s43, 4160
    s_add_u32 s44, s44, s41
    s_lshl_b32 s45, s43, 1
    s_add_u32 s45, s45, 34
    s_add_u32 s45, s45, s40
    s_mov_b32 m0, s44
    s_nop 0
    buffer_load_dwordx4 v2, s[16:19], s45 offen offset:0 lds
    buffer_load_dwordx4 v2, s[16:19], s45 offen offset:1024 lds
    buffer_load_dwordx4 v2, s[16:19], s45 offen offset:2048 lds
    buffer_load_dwordx4 v2, s[16:19], s45 offen offset:3072 lds
    s_add_u32 s44, s44, 4096
    s_add_u32 s45, s45, 4096
    s_mov_b32 m0, s44
    s_mov_b64 exec, 3
    buffer_load_dwordx4 v2, s[16:19], s45 offen lds
    s_mov_b64 exec, -1
    v_lshlrev_b32 v3, 4, v0
    s_lshl_b32 s35, s33, 12
    s_add_u32 s36, s35, 4096
    buffer_load_dwordx4 v[8:11], v3, s[8:11], s35 offen
    buffer_load_dwordx4 v[12:15], v3, s[8:11], s36 offen
    v_lshlrev_b32 v4, 6, v0
    buffer_load_dwordx4 v[16:19], v4, s[12:15], 0 offen offset:0
    buffer_load_dwordx4 v[20:23], v4, s[12:15], 0 offen offset:16
    buffer_load_dwordx4 v[24:27], v4, s[12:15], 0 offen offset:32
    buffer_load_dwordx4 v[28:31], v4, s[12:15], 0 offen offset:48
    v_and_b32 v5, 15, v1
    v_lshrrev_b32 v6, 4, v1
    v_lshlrev_b32 v7, 5, v5
    v_lshl_add_u32 v7, v6, 3, v7
    s_lshl_b32 s46, s34, 12
    buffer_load_dwordx2 v[32:33], v7, s[8:11], s46 offen offset:0
    buffer_load_dwordx2 v[34:35], v7, s[8:11], s46 offen offset:512
    buffer_load_dwordx2 v[36:37], v7, s[8:11], s46 offen offset:1024
    buffer_load_dwordx2 v[38:39], v7, s[8:11], s46 offen offset:1536
    buffer_load_dwordx2 v[40:41], v7, s[8:11], s46 offen offset:2048
    buffer_load_dwordx2 v[42:43], v7, s[8:11], s46 offen offset:2560
    buffer_load_dwordx2 v[44:45], v7, s[8:11], s46 offen offset:3072
    buffer_load_dwordx2 v[46:47], v7, s[8:11], s46 offen offset:3584
    s_waitcnt vmcnt(8)
    v_mul_f32 v64, 0x3b000000, v16
    v_mul_f32 v65, 0x3b000000, v17
    v_fma_f32 v65, -v64, v64, v65
    v_max_f32 v65, 0, v65
    v_cvt_pk_bf16_f32 v64, v64, v65
    s_nop 0
    v_lshlrev_b32 v48, 16, v64
    v_and_b32 v65, 0xffff0000, v64
    v_add_f32 v65, 0x3727c5ac, v65
    v_cvt_pk_bf16_f32 v65, v65, v65
    s_nop 0
    v_lshlrev_b32 v65, 16, v65
    v_sqrt_f32 v65, v65
    s_nop 0
    v_cvt_pk_bf16_f32 v65, v65, v65
    s_nop 0
    v_lshlrev_b32 v65, 16, v65
    v_rcp_f32 v56, v65
    s_nop 0
    v_mul_f32 v64, 0x3b000000, v18
    v_mul_f32 v65, 0x3b000000, v19
    v_fma_f32 v65, -v64, v64, v65
    v_max_f32 v65, 0, v65
    v_cvt_pk_bf16_f32 v64, v64, v65
    s_nop 0
    v_lshlrev_b32 v49, 16, v64
    v_and_b32 v65, 0xffff0000, v64
    v_add_f32 v65, 0x3727c5ac, v65
    v_cvt_pk_bf16_f32 v65, v65, v65
    s_nop 0
    v_lshlrev_b32 v65, 16, v65
    v_sqrt_f32 v65, v65
    s_nop 0
    v_cvt_pk_bf16_f32 v65, v65, v65
    s_nop 0
    v_lshlrev_b32 v65, 16, v65
    v_rcp_f32 v57, v65
    s_nop 0
    v_mul_f32 v64, 0x3b000000, v20
    v_mul_f32 v65, 0x3b000000, v21
    v_fma_f32 v65, -v64, v64, v65
    v_max_f32 v65, 0, v65
    v_cvt_pk_bf16_f32 v64, v64, v65
    s_nop 0
    v_lshlrev_b32 v50, 16, v64
    v_and_b32 v65, 0xffff0000, v64
    v_add_f32 v65, 0x3727c5ac, v65
    v_cvt_pk_bf16_f32 v65, v65, v65
    s_nop 0
    v_lshlrev_b32 v65, 16, v65
    v_sqrt_f32 v65, v65
    s_nop 0
    v_cvt_pk_bf16_f32 v65, v65, v65
    s_nop 0
    v_lshlrev_b32 v65, 16, v65
    v_rcp_f32 v58, v65
    s_nop 0
    v_mul_f32 v64, 0x3b000000, v22
    v_mul_f32 v65, 0x3b000000, v23
    v_fma_f32 v65, -v64, v64, v65
    v_max_f32 v65, 0, v65
    v_cvt_pk_bf16_f32 v64, v64, v65
    s_nop 0
    v_lshlrev_b32 v51, 16, v64
    v_and_b32 v65, 0xffff0000, v64
    v_add_f32 v65, 0x3727c5ac, v65
    v_cvt_pk_bf16_f32 v65, v65, v65
    s_nop 0
    v_lshlrev_b32 v65, 16, v65
    v_sqrt_f32 v65, v65
    s_nop 0
    v_cvt_pk_bf16_f32 v65, v65, v65
    s_nop 0
    v_lshlrev_b32 v65, 16, v65
    v_rcp_f32 v59, v65
    s_nop 0
    v_mul_f32 v64, 0x3b000000, v24
    v_mul_f32 v65, 0x3b000000, v25
    v_fma_f32 v65, -v64, v64, v65
    v_max_f32 v65, 0, v65
    v_cvt_pk_bf16_f32 v64, v64, v65
    s_nop 0
    v_lshlrev_b32 v52, 16, v64
    v_and_b32 v65, 0xffff0000, v64
    v_add_f32 v65, 0x3727c5ac, v65
    v_cvt_pk_bf16_f32 v65, v65, v65
    s_nop 0
    v_lshlrev_b32 v65, 16, v65
    v_sqrt_f32 v65, v65
    s_nop 0
    v_cvt_pk_bf16_f32 v65, v65, v65
    s_nop 0
    v_lshlrev_b32 v65, 16, v65
    v_rcp_f32 v60, v65
    s_nop 0
    v_mul_f32 v64, 0x3b000000, v26
    v_mul_f32 v65, 0x3b000000, v27
    v_fma_f32 v65, -v64, v64, v65
    v_max_f32 v65, 0, v65
    v_cvt_pk_bf16_f32 v64, v64, v65
    s_nop 0
    v_lshlrev_b32 v53, 16, v64
    v_and_b32 v65, 0xffff0000, v64
    v_add_f32 v65, 0x3727c5ac, v65
    v_cvt_pk_bf16_f32 v65, v65, v65
    s_nop 0
    v_lshlrev_b32 v65, 16, v65
    v_sqrt_f32 v65, v65
    s_nop 0
    v_cvt_pk_bf16_f32 v65, v65, v65
    s_nop 0
    v_lshlrev_b32 v65, 16, v65
    v_rcp_f32 v61, v65
    s_nop 0
    v_mul_f32 v64, 0x3b000000, v28
    v_mul_f32 v65, 0x3b000000, v29
    v_fma_f32 v65, -v64, v64, v65
    v_max_f32 v65, 0, v65
    v_cvt_pk_bf16_f32 v64, v64, v65
    s_nop 0
    v_lshlrev_b32 v54, 16, v64
    v_and_b32 v65, 0xffff0000, v64
    v_add_f32 v65, 0x3727c5ac, v65
    v_cvt_pk_bf16_f32 v65, v65, v65
    s_nop 0
    v_lshlrev_b32 v65, 16, v65
    v_sqrt_f32 v65, v65
    s_nop 0
    v_cvt_pk_bf16_f32 v65, v65, v65
    s_nop 0
    v_lshlrev_b32 v65, 16, v65
    v_rcp_f32 v62, v65
    s_nop 0
    v_mul_f32 v64, 0x3b000000, v30
    v_mul_f32 v65, 0x3b000000, v31
    v_fma_f32 v65, -v64, v64, v65
    v_max_f32 v65, 0, v65
    v_cvt_pk_bf16_f32 v64, v64, v65
    s_nop 0
    v_lshlrev_b32 v55, 16, v64
    v_and_b32 v65, 0xffff0000, v64
    v_add_f32 v65, 0x3727c5ac, v65
    v_cvt_pk_bf16_f32 v65, v65, v65
    s_nop 0
    v_lshlrev_b32 v65, 16, v65
    v_sqrt_f32 v65, v65
    s_nop 0
    v_cvt_pk_bf16_f32 v65, v65, v65
    s_nop 0
    v_lshlrev_b32 v65, 16, v65
    v_rcp_f32 v63, v65
    s_nop 0
    v_lshlrev_b32 v64, 16, v8
    v_sub_f32 v64, v64, v48
    v_cvt_pk_bf16_f32 v64, v64, v64
    s_nop 0
    v_lshlrev_b32 v64, 16, v64
    v_mul_f32 v66, v64, v56
    v_and_b32 v64, 0xffff0000, v8
    v_sub_f32 v64, v64, v49
    v_cvt_pk_bf16_f32 v64, v64, v64
    s_nop 0
    v_lshlrev_b32 v64, 16, v64
    v_mul_f32 v67, v64, v57
    v_lshlrev_b32 v64, 16, v9
    v_sub_f32 v64, v64, v50
    v_cvt_pk_bf16_f32 v64, v64, v64
    s_nop 0
    v_lshlrev_b32 v64, 16, v64
    v_mul_f32 v68, v64, v58
    v_and_b32 v64, 0xffff0000, v9
    v_sub_f32 v64, v64, v51
    v_cvt_pk_bf16_f32 v64, v64, v64
    s_nop 0
    v_lshlrev_b32 v64, 16, v64
    v_mul_f32 v69, v64, v59
    v_lshlrev_b32 v64, 16, v10
    v_sub_f32 v64, v64, v52
    v_cvt_pk_bf16_f32 v64, v64, v64
    s_nop 0
    v_lshlrev_b32 v64, 16, v64
    v_mul_f32 v70, v64, v60
    v_and_b32 v64, 0xffff0000, v10
    v_sub_f32 v64, v64, v53
    v_cvt_pk_bf16_f32 v64, v64, v64
    s_nop 0
    v_lshlrev_b32 v64, 16, v64
    v_mul_f32 v71, v64, v61
    v_lshlrev_b32 v64, 16, v11
    v_sub_f32 v64, v64, v54
    v_cvt_pk_bf16_f32 v64, v64, v64
    s_nop 0
    v_lshlrev_b32 v64, 16, v64
    v_mul_f32 v72, v64, v62
    v_and_b32 v64, 0xffff0000, v11
    v_sub_f32 v64, v64, v55
    v_cvt_pk_bf16_f32 v64, v64, v64
    s_nop 0
    v_lshlrev_b32 v64, 16, v64
    v_mul_f32 v73, v64, v63
    v_cvt_pk_bf16_f32 v74, v73, v72
    v_cvt_pk_bf16_f32 v75, v71, v70
    v_cvt_pk_bf16_f32 v76, v69, v68
    v_cvt_pk_bf16_f32 v77, v67, v66
    v_lshlrev_b32 v64, 4, v0
    v_sub_u32 v64, 20720, v64
    ds_write_b128 v64, v[74:77]
    v_lshlrev_b32 v64, 16, v12
    v_sub_f32 v64, v64, v48
    v_cvt_pk_bf16_f32 v64, v64, v64
    s_nop 0
    v_lshlrev_b32 v64, 16, v64
    v_mul_f32 v66, v64, v56
    v_and_b32 v64, 0xffff0000, v12
    v_sub_f32 v64, v64, v49
    v_cvt_pk_bf16_f32 v64, v64, v64
    s_nop 0
    v_lshlrev_b32 v64, 16, v64
    v_mul_f32 v67, v64, v57
    v_lshlrev_b32 v64, 16, v13
    v_sub_f32 v64, v64, v50
    v_cvt_pk_bf16_f32 v64, v64, v64
    s_nop 0
    v_lshlrev_b32 v64, 16, v64
    v_mul_f32 v68, v64, v58
    v_and_b32 v64, 0xffff0000, v13
    v_sub_f32 v64, v64, v51
    v_cvt_pk_bf16_f32 v64, v64, v64
    s_nop 0
    v_lshlrev_b32 v64, 16, v64
    v_mul_f32 v69, v64, v59
    v_lshlrev_b32 v64, 16, v14
    v_sub_f32 v64, v64, v52
    v_cvt_pk_bf16_f32 v64, v64, v64
    s_nop 0
    v_lshlrev_b32 v64, 16, v64
    v_mul_f32 v70, v64, v60
    v_and_b32 v64, 0xffff0000, v14
    v_sub_f32 v64, v64, v53
    v_cvt_pk_bf16_f32 v64, v64, v64
    s_nop 0
    v_lshlrev_b32 v64, 16, v64
    v_mul_f32 v71, v64, v61
    v_lshlrev_b32 v64, 16, v15
    v_sub_f32 v64, v64, v54
    v_cvt_pk_bf16_f32 v64, v64, v64
    s_nop 0
    v_lshlrev_b32 v64, 16, v64
    v_mul_f32 v72, v64, v62
    v_and_b32 v64, 0xffff0000, v15
    v_sub_f32 v64, v64, v55
    v_cvt_pk_bf16_f32 v64, v64, v64
    s_nop 0
    v_lshlrev_b32 v64, 16, v64
    v_mul_f32 v73, v64, v63
    v_cvt_pk_bf16_f32 v74, v73, v72
    v_cvt_pk_bf16_f32 v75, v71, v70
    v_cvt_pk_bf16_f32 v76, v69, v68
    v_cvt_pk_bf16_f32 v77, v67, v66
    v_lshlrev_b32 v64, 4, v0
    v_sub_u32 v64, 41936, v64
    ds_write_b128 v64, v[74:77]
    v_mov_b32 v74, 0
    v_mov_b32 v75, 0
    v_mov_b32 v76, 0
    v_mov_b32 v77, 0
    v_lshlrev_b32 v64, 4, v0
    v_cmp_gt_u32 vcc, 30, v0
    s_and_saveexec_b64 s[48:49], vcc
    ds_write_b128 v64, v[74:77] offset:20736
    ds_write_b128 v64, v[74:77] offset:41952
    s_mov_b64 exec, s[48:49]
    s_waitcnt lgkmcnt(0)
    s_and_b32 s40, s34, 1
    s_lshl_b32 s40, s40, 4
    s_lshr_b32 s39, s39, s40
    s_lshl_b32 s39, s39, 16
    s_add_u32 s41, s41, 17120
    v_lshlrev_b32 v64, 5, v5
    v_sub_u32 v64, s41, v64
    v_lshl_add_u32 v64, v6, 4, v64
    s_mul_i32 s41, s31, 21216
    v_lshrrev_b32 v65, 2, v5
    s_movk_i32 s47, 4160
    v_mul_lo_u32 v65, v65, s47
    v_add_u32 v65, s41, v65
    v_lshl_add_u32 v65, v6, 4, v65
    v_and_b32 v66, 3, v5
    v_lshl_add_u32 v65, v66, 3, v65
    s_add_u32 s41, s41, 17144
    v_lshlrev_b32 v66, 5, v5
    v_sub_u32 v66, s41, v66
    v_lshlrev_b32 v67, 3, v6
    v_sub_u32 v66, v66, v67
    s_waitcnt vmcnt(0) lgkmcnt(0)
    s_barrier
    s_cmp_eq_u32 s32, 1
    s_cbranch_scc1 conv2_h1
    v_mov_b32 v196, 0
    v_mov_b32 v197, 0
    v_mov_b32 v198, 0
    v_mov_b32 v199, 0
    v_mov_b32 v200, 0
    v_mov_b32 v201, 0
    v_mov_b32 v202, 0
    v_mov_b32 v203, 0
    v_mov_b32 v204, 0
    v_mov_b32 v205, 0
    v_mov_b32 v206, 0
    v_mov_b32 v207, 0
    v_mov_b32 v208, 0
    v_mov_b32 v209, 0
    v_mov_b32 v210, 0
    v_mov_b32 v211, 0
    v_mov_b32 v212, 0
    v_mov_b32 v213, 0
    v_mov_b32 v214, 0
    v_mov_b32 v215, 0
    ds_read_b128 v[68:71], v64 offset:3584
    ds_read_b128 v[72:75], v64 offset:3072
    ds_read_b128 v[76:79], v64 offset:2560
    ds_read_b128 v[80:83], v64 offset:2048
    ds_read_b128 v[84:87], v64 offset:1536
    ds_read_b64_tr_b16 v[132:133], v65 offset:0
    ds_read_b64_tr_b16 v[134:135], v65 offset:8
    ds_read_b64_tr_b16 v[136:137], v65 offset:512
    ds_read_b64_tr_b16 v[138:139], v65 offset:520
    ds_read_b64_tr_b16 v[140:141], v65 offset:1024
    ds_read_b64_tr_b16 v[142:143], v65 offset:1032
    ds_read_b64_tr_b16 v[144:145], v65 offset:1536
    ds_read_b64_tr_b16 v[146:147], v65 offset:1544
    ds_read_b64_tr_b16 v[148:149], v65 offset:2048
    ds_read_b64_tr_b16 v[150:151], v65 offset:2056
    s_waitcnt lgkmcnt(0)
    ds_read_b128 v[100:103], v64 offset:3648
    ds_read_b128 v[104:107], v64 offset:3136
    ds_read_b128 v[108:111], v64 offset:2624
    ds_read_b128 v[112:115], v64 offset:2112
    ds_read_b128 v[116:119], v64 offset:1600
    ds_read_b64_tr_b16 v[164:165], v65 offset:64
    ds_read_b64_tr_b16 v[166:167], v65 offset:72
    ds_read_b64_tr_b16 v[168:169], v65 offset:576
    ds_read_b64_tr_b16 v[170:171], v65 offset:584
    ds_read_b64_tr_b16 v[172:173], v65 offset:1088
    ds_read_b64_tr_b16 v[174:175], v65 offset:1096
    ds_read_b64_tr_b16 v[176:177], v65 offset:1600
    ds_read_b64_tr_b16 v[178:179], v65 offset:1608
    ds_read_b64_tr_b16 v[180:181], v65 offset:2112
    ds_read_b64_tr_b16 v[182:183], v65 offset:2120
    v_mfma_f32_16x16x32_bf16 v[196:199], v[132:135], v[68:71], v[196:199]
    v_mfma_f32_16x16x32_bf16 v[200:203], v[132:135], v[72:75], v[200:203]
    v_mfma_f32_16x16x32_bf16 v[204:207], v[132:135], v[76:79], v[204:207]
    v_mfma_f32_16x16x32_bf16 v[208:211], v[132:135], v[80:83], v[208:211]
    v_mfma_f32_16x16x32_bf16 v[212:215], v[132:135], v[84:87], v[212:215]
    v_mfma_f32_16x16x32_bf16 v[200:203], v[136:139], v[68:71], v[200:203]
    v_mfma_f32_16x16x32_bf16 v[204:207], v[136:139], v[72:75], v[204:207]
    v_mfma_f32_16x16x32_bf16 v[208:211], v[136:139], v[76:79], v[208:211]
    v_mfma_f32_16x16x32_bf16 v[212:215], v[136:139], v[80:83], v[212:215]
    v_mfma_f32_16x16x32_bf16 v[204:207], v[140:143], v[68:71], v[204:207]
    v_mfma_f32_16x16x32_bf16 v[208:211], v[140:143], v[72:75], v[208:211]
    v_mfma_f32_16x16x32_bf16 v[212:215], v[140:143], v[76:79], v[212:215]
    v_mfma_f32_16x16x32_bf16 v[208:211], v[144:147], v[68:71], v[208:211]
    v_mfma_f32_16x16x32_bf16 v[212:215], v[144:147], v[72:75], v[212:215]
    v_mfma_f32_16x16x32_bf16 v[212:215], v[148:151], v[68:71], v[212:215]
    s_waitcnt lgkmcnt(0)
    ds_read_b128 v[68:71], v64 offset:3712
    ds_read_b128 v[72:75], v64 offset:3200
    ds_read_b128 v[76:79], v64 offset:2688
    ds_read_b128 v[80:83], v64 offset:2176
    ds_read_b128 v[84:87], v64 offset:1664
    ds_read_b64_tr_b16 v[132:133], v65 offset:128
    ds_read_b64_tr_b16 v[134:135], v65 offset:136
    ds_read_b64_tr_b16 v[136:137], v65 offset:640
    ds_read_b64_tr_b16 v[138:139], v65 offset:648
    ds_read_b64_tr_b16 v[140:141], v65 offset:1152
    ds_read_b64_tr_b16 v[142:143], v65 offset:1160
    ds_read_b64_tr_b16 v[144:145], v65 offset:1664
    ds_read_b64_tr_b16 v[146:147], v65 offset:1672
    ds_read_b64_tr_b16 v[148:149], v65 offset:2176
    ds_read_b64_tr_b16 v[150:151], v65 offset:2184
    v_mfma_f32_16x16x32_bf16 v[196:199], v[164:167], v[100:103], v[196:199]
    v_mfma_f32_16x16x32_bf16 v[200:203], v[164:167], v[104:107], v[200:203]
    v_mfma_f32_16x16x32_bf16 v[204:207], v[164:167], v[108:111], v[204:207]
    v_mfma_f32_16x16x32_bf16 v[208:211], v[164:167], v[112:115], v[208:211]
    v_mfma_f32_16x16x32_bf16 v[212:215], v[164:167], v[116:119], v[212:215]
    v_mfma_f32_16x16x32_bf16 v[200:203], v[168:171], v[100:103], v[200:203]
    v_mfma_f32_16x16x32_bf16 v[204:207], v[168:171], v[104:107], v[204:207]
    v_mfma_f32_16x16x32_bf16 v[208:211], v[168:171], v[108:111], v[208:211]
    v_mfma_f32_16x16x32_bf16 v[212:215], v[168:171], v[112:115], v[212:215]
    v_mfma_f32_16x16x32_bf16 v[204:207], v[172:175], v[100:103], v[204:207]
    v_mfma_f32_16x16x32_bf16 v[208:211], v[172:175], v[104:107], v[208:211]
    v_mfma_f32_16x16x32_bf16 v[212:215], v[172:175], v[108:111], v[212:215]
    v_mfma_f32_16x16x32_bf16 v[208:211], v[176:179], v[100:103], v[208:211]
    v_mfma_f32_16x16x32_bf16 v[212:215], v[176:179], v[104:107], v[212:215]
    v_mfma_f32_16x16x32_bf16 v[212:215], v[180:183], v[100:103], v[212:215]
    s_waitcnt lgkmcnt(0)
    ds_read_b128 v[100:103], v64 offset:3776
    ds_read_b128 v[104:107], v64 offset:3264
    ds_read_b128 v[108:111], v64 offset:2752
    ds_read_b128 v[112:115], v64 offset:2240
    ds_read_b128 v[116:119], v64 offset:1728
    ds_read_b64_tr_b16 v[164:165], v65 offset:192
    ds_read_b64_tr_b16 v[166:167], v65 offset:200
    ds_read_b64_tr_b16 v[168:169], v65 offset:704
    ds_read_b64_tr_b16 v[170:171], v65 offset:712
    ds_read_b64_tr_b16 v[172:173], v65 offset:1216
    ds_read_b64_tr_b16 v[174:175], v65 offset:1224
    ds_read_b64_tr_b16 v[176:177], v65 offset:1728
    ds_read_b64_tr_b16 v[178:179], v65 offset:1736
    ds_read_b64_tr_b16 v[180:181], v65 offset:2240
    ds_read_b64_tr_b16 v[182:183], v65 offset:2248
    v_mfma_f32_16x16x32_bf16 v[196:199], v[132:135], v[68:71], v[196:199]
    v_mfma_f32_16x16x32_bf16 v[200:203], v[132:135], v[72:75], v[200:203]
    v_mfma_f32_16x16x32_bf16 v[204:207], v[132:135], v[76:79], v[204:207]
    v_mfma_f32_16x16x32_bf16 v[208:211], v[132:135], v[80:83], v[208:211]
    v_mfma_f32_16x16x32_bf16 v[212:215], v[132:135], v[84:87], v[212:215]
    v_mfma_f32_16x16x32_bf16 v[200:203], v[136:139], v[68:71], v[200:203]
    v_mfma_f32_16x16x32_bf16 v[204:207], v[136:139], v[72:75], v[204:207]
    v_mfma_f32_16x16x32_bf16 v[208:211], v[136:139], v[76:79], v[208:211]
    v_mfma_f32_16x16x32_bf16 v[212:215], v[136:139], v[80:83], v[212:215]
    v_mfma_f32_16x16x32_bf16 v[204:207], v[140:143], v[68:71], v[204:207]
    v_mfma_f32_16x16x32_bf16 v[208:211], v[140:143], v[72:75], v[208:211]
    v_mfma_f32_16x16x32_bf16 v[212:215], v[140:143], v[76:79], v[212:215]
    v_mfma_f32_16x16x32_bf16 v[208:211], v[144:147], v[68:71], v[208:211]
    v_mfma_f32_16x16x32_bf16 v[212:215], v[144:147], v[72:75], v[212:215]
    v_mfma_f32_16x16x32_bf16 v[212:215], v[148:151], v[68:71], v[212:215]
    s_waitcnt lgkmcnt(0)
    ds_read_b128 v[68:71], v64 offset:3840
    ds_read_b128 v[72:75], v64 offset:3328
    ds_read_b128 v[76:79], v64 offset:2816
    ds_read_b128 v[80:83], v64 offset:2304
    ds_read_b128 v[84:87], v64 offset:1792
    ds_read_b64_tr_b16 v[132:133], v65 offset:256
    ds_read_b64_tr_b16 v[134:135], v65 offset:264
    ds_read_b64_tr_b16 v[136:137], v65 offset:768
    ds_read_b64_tr_b16 v[138:139], v65 offset:776
    ds_read_b64_tr_b16 v[140:141], v65 offset:1280
    ds_read_b64_tr_b16 v[142:143], v65 offset:1288
    ds_read_b64_tr_b16 v[144:145], v65 offset:1792
    ds_read_b64_tr_b16 v[146:147], v65 offset:1800
    ds_read_b64_tr_b16 v[148:149], v65 offset:2304
    ds_read_b64_tr_b16 v[150:151], v65 offset:2312
    v_mfma_f32_16x16x32_bf16 v[196:199], v[164:167], v[100:103], v[196:199]
    v_mfma_f32_16x16x32_bf16 v[200:203], v[164:167], v[104:107], v[200:203]
    v_mfma_f32_16x16x32_bf16 v[204:207], v[164:167], v[108:111], v[204:207]
    v_mfma_f32_16x16x32_bf16 v[208:211], v[164:167], v[112:115], v[208:211]
    v_mfma_f32_16x16x32_bf16 v[212:215], v[164:167], v[116:119], v[212:215]
    v_mfma_f32_16x16x32_bf16 v[200:203], v[168:171], v[100:103], v[200:203]
    v_mfma_f32_16x16x32_bf16 v[204:207], v[168:171], v[104:107], v[204:207]
    v_mfma_f32_16x16x32_bf16 v[208:211], v[168:171], v[108:111], v[208:211]
    v_mfma_f32_16x16x32_bf16 v[212:215], v[168:171], v[112:115], v[212:215]
    v_mfma_f32_16x16x32_bf16 v[204:207], v[172:175], v[100:103], v[204:207]
    v_mfma_f32_16x16x32_bf16 v[208:211], v[172:175], v[104:107], v[208:211]
    v_mfma_f32_16x16x32_bf16 v[212:215], v[172:175], v[108:111], v[212:215]
    v_mfma_f32_16x16x32_bf16 v[208:211], v[176:179], v[100:103], v[208:211]
    v_mfma_f32_16x16x32_bf16 v[212:215], v[176:179], v[104:107], v[212:215]
    v_mfma_f32_16x16x32_bf16 v[212:215], v[180:183], v[100:103], v[212:215]
    s_waitcnt lgkmcnt(0)
    ds_read_b128 v[100:103], v64 offset:3904
    ds_read_b128 v[104:107], v64 offset:3392
    ds_read_b128 v[108:111], v64 offset:2880
    ds_read_b128 v[112:115], v64 offset:2368
    ds_read_b128 v[116:119], v64 offset:1856
    ds_read_b64_tr_b16 v[164:165], v65 offset:320
    ds_read_b64_tr_b16 v[166:167], v65 offset:328
    ds_read_b64_tr_b16 v[168:169], v65 offset:832
    ds_read_b64_tr_b16 v[170:171], v65 offset:840
    ds_read_b64_tr_b16 v[172:173], v65 offset:1344
    ds_read_b64_tr_b16 v[174:175], v65 offset:1352
    ds_read_b64_tr_b16 v[176:177], v65 offset:1856
    ds_read_b64_tr_b16 v[178:179], v65 offset:1864
    ds_read_b64_tr_b16 v[180:181], v65 offset:2368
    ds_read_b64_tr_b16 v[182:183], v65 offset:2376
    v_mfma_f32_16x16x32_bf16 v[196:199], v[132:135], v[68:71], v[196:199]
    v_mfma_f32_16x16x32_bf16 v[200:203], v[132:135], v[72:75], v[200:203]
    v_mfma_f32_16x16x32_bf16 v[204:207], v[132:135], v[76:79], v[204:207]
    v_mfma_f32_16x16x32_bf16 v[208:211], v[132:135], v[80:83], v[208:211]
    v_mfma_f32_16x16x32_bf16 v[212:215], v[132:135], v[84:87], v[212:215]
    v_mfma_f32_16x16x32_bf16 v[200:203], v[136:139], v[68:71], v[200:203]
    v_mfma_f32_16x16x32_bf16 v[204:207], v[136:139], v[72:75], v[204:207]
    v_mfma_f32_16x16x32_bf16 v[208:211], v[136:139], v[76:79], v[208:211]
    v_mfma_f32_16x16x32_bf16 v[212:215], v[136:139], v[80:83], v[212:215]
    v_mfma_f32_16x16x32_bf16 v[204:207], v[140:143], v[68:71], v[204:207]
    v_mfma_f32_16x16x32_bf16 v[208:211], v[140:143], v[72:75], v[208:211]
    v_mfma_f32_16x16x32_bf16 v[212:215], v[140:143], v[76:79], v[212:215]
    v_mfma_f32_16x16x32_bf16 v[208:211], v[144:147], v[68:71], v[208:211]
    v_mfma_f32_16x16x32_bf16 v[212:215], v[144:147], v[72:75], v[212:215]
    v_mfma_f32_16x16x32_bf16 v[212:215], v[148:151], v[68:71], v[212:215]
    s_waitcnt lgkmcnt(0)
    ds_read_b128 v[68:71], v64 offset:3968
    ds_read_b128 v[72:75], v64 offset:3456
    ds_read_b128 v[76:79], v64 offset:2944
    ds_read_b128 v[80:83], v64 offset:2432
    ds_read_b128 v[84:87], v64 offset:1920
    ds_read_b64_tr_b16 v[132:133], v65 offset:384
    ds_read_b64_tr_b16 v[134:135], v65 offset:392
    ds_read_b64_tr_b16 v[136:137], v65 offset:896
    ds_read_b64_tr_b16 v[138:139], v65 offset:904
    ds_read_b64_tr_b16 v[140:141], v65 offset:1408
    ds_read_b64_tr_b16 v[142:143], v65 offset:1416
    ds_read_b64_tr_b16 v[144:145], v65 offset:1920
    ds_read_b64_tr_b16 v[146:147], v65 offset:1928
    ds_read_b64_tr_b16 v[148:149], v65 offset:2432
    ds_read_b64_tr_b16 v[150:151], v65 offset:2440
    v_mfma_f32_16x16x32_bf16 v[196:199], v[164:167], v[100:103], v[196:199]
    v_mfma_f32_16x16x32_bf16 v[200:203], v[164:167], v[104:107], v[200:203]
    v_mfma_f32_16x16x32_bf16 v[204:207], v[164:167], v[108:111], v[204:207]
    v_mfma_f32_16x16x32_bf16 v[208:211], v[164:167], v[112:115], v[208:211]
    v_mfma_f32_16x16x32_bf16 v[212:215], v[164:167], v[116:119], v[212:215]
    v_mfma_f32_16x16x32_bf16 v[200:203], v[168:171], v[100:103], v[200:203]
    v_mfma_f32_16x16x32_bf16 v[204:207], v[168:171], v[104:107], v[204:207]
    v_mfma_f32_16x16x32_bf16 v[208:211], v[168:171], v[108:111], v[208:211]
    v_mfma_f32_16x16x32_bf16 v[212:215], v[168:171], v[112:115], v[212:215]
    v_mfma_f32_16x16x32_bf16 v[204:207], v[172:175], v[100:103], v[204:207]
    v_mfma_f32_16x16x32_bf16 v[208:211], v[172:175], v[104:107], v[208:211]
    v_mfma_f32_16x16x32_bf16 v[212:215], v[172:175], v[108:111], v[212:215]
    v_mfma_f32_16x16x32_bf16 v[208:211], v[176:179], v[100:103], v[208:211]
    v_mfma_f32_16x16x32_bf16 v[212:215], v[176:179], v[104:107], v[212:215]
    v_mfma_f32_16x16x32_bf16 v[212:215], v[180:183], v[100:103], v[212:215]
    s_waitcnt lgkmcnt(0)
    ds_read_b128 v[100:103], v64 offset:4032
    ds_read_b128 v[104:107], v64 offset:3520
    ds_read_b128 v[108:111], v64 offset:3008
    ds_read_b128 v[112:115], v64 offset:2496
    ds_read_b128 v[116:119], v64 offset:1984
    ds_read_b64_tr_b16 v[164:165], v65 offset:448
    ds_read_b64_tr_b16 v[166:167], v65 offset:456
    ds_read_b64_tr_b16 v[168:169], v65 offset:960
    ds_read_b64_tr_b16 v[170:171], v65 offset:968
    ds_read_b64_tr_b16 v[172:173], v65 offset:1472
    ds_read_b64_tr_b16 v[174:175], v65 offset:1480
    ds_read_b64_tr_b16 v[176:177], v65 offset:1984
    ds_read_b64_tr_b16 v[178:179], v65 offset:1992
    ds_read_b64_tr_b16 v[180:181], v65 offset:2496
    ds_read_b64_tr_b16 v[182:183], v65 offset:2504
    v_mfma_f32_16x16x32_bf16 v[196:199], v[132:135], v[68:71], v[196:199]
    v_mfma_f32_16x16x32_bf16 v[200:203], v[132:135], v[72:75], v[200:203]
    v_mfma_f32_16x16x32_bf16 v[204:207], v[132:135], v[76:79], v[204:207]
    v_mfma_f32_16x16x32_bf16 v[208:211], v[132:135], v[80:83], v[208:211]
    v_mfma_f32_16x16x32_bf16 v[212:215], v[132:135], v[84:87], v[212:215]
    v_mfma_f32_16x16x32_bf16 v[200:203], v[136:139], v[68:71], v[200:203]
    v_mfma_f32_16x16x32_bf16 v[204:207], v[136:139], v[72:75], v[204:207]
    v_mfma_f32_16x16x32_bf16 v[208:211], v[136:139], v[76:79], v[208:211]
    v_mfma_f32_16x16x32_bf16 v[212:215], v[136:139], v[80:83], v[212:215]
    v_mfma_f32_16x16x32_bf16 v[204:207], v[140:143], v[68:71], v[204:207]
    v_mfma_f32_16x16x32_bf16 v[208:211], v[140:143], v[72:75], v[208:211]
    v_mfma_f32_16x16x32_bf16 v[212:215], v[140:143], v[76:79], v[212:215]
    v_mfma_f32_16x16x32_bf16 v[208:211], v[144:147], v[68:71], v[208:211]
    v_mfma_f32_16x16x32_bf16 v[212:215], v[144:147], v[72:75], v[212:215]
    v_mfma_f32_16x16x32_bf16 v[212:215], v[148:151], v[68:71], v[212:215]
    s_waitcnt lgkmcnt(0)
    v_mfma_f32_16x16x32_bf16 v[196:199], v[164:167], v[100:103], v[196:199]
    v_mfma_f32_16x16x32_bf16 v[200:203], v[164:167], v[104:107], v[200:203]
    v_mfma_f32_16x16x32_bf16 v[204:207], v[164:167], v[108:111], v[204:207]
    v_mfma_f32_16x16x32_bf16 v[208:211], v[164:167], v[112:115], v[208:211]
    v_mfma_f32_16x16x32_bf16 v[212:215], v[164:167], v[116:119], v[212:215]
    v_mfma_f32_16x16x32_bf16 v[200:203], v[168:171], v[100:103], v[200:203]
    v_mfma_f32_16x16x32_bf16 v[204:207], v[168:171], v[104:107], v[204:207]
    v_mfma_f32_16x16x32_bf16 v[208:211], v[168:171], v[108:111], v[208:211]
    v_mfma_f32_16x16x32_bf16 v[212:215], v[168:171], v[112:115], v[212:215]
    v_mfma_f32_16x16x32_bf16 v[204:207], v[172:175], v[100:103], v[204:207]
    v_mfma_f32_16x16x32_bf16 v[208:211], v[172:175], v[104:107], v[208:211]
    v_mfma_f32_16x16x32_bf16 v[212:215], v[172:175], v[108:111], v[212:215]
    v_mfma_f32_16x16x32_bf16 v[208:211], v[176:179], v[100:103], v[208:211]
    v_mfma_f32_16x16x32_bf16 v[212:215], v[176:179], v[104:107], v[212:215]
    v_mfma_f32_16x16x32_bf16 v[212:215], v[180:183], v[100:103], v[212:215]
    ds_read_b64 v[220:221], v66 offset:3584
    ds_read_b64 v[222:223], v66 offset:3072
    ds_read_b64 v[224:225], v66 offset:2560
    ds_read_b64 v[226:227], v66 offset:2048
    ds_read_b64 v[228:229], v66 offset:1536
    s_nop 7
    s_waitcnt lgkmcnt(0)
    v_cvt_pk_bf16_f32 v230, v196, v197
    v_cvt_pk_bf16_f32 v231, v198, v199
    v_and_b32 v232, 0xffff0000, v221
    v_lshlrev_b32 v233, 16, v221
    v_and_b32 v234, 0xffff0000, v220
    v_lshlrev_b32 v235, 16, v220
    v_mul_f32 v232, s39, v232
    v_mul_f32 v233, s39, v233
    v_mul_f32 v234, s39, v234
    v_mul_f32 v235, s39, v235
    v_cvt_pk_bf16_f32 v232, v232, v233
    v_cvt_pk_bf16_f32 v233, v234, v235
    s_nop 0
    v_lshlrev_b32 v234, 16, v230
    v_lshlrev_b32 v235, 16, v232
    v_add_f32 v234, v234, v235
    v_and_b32 v235, 0xffff0000, v230
    v_and_b32 v236, 0xffff0000, v232
    v_add_f32 v235, v235, v236
    v_cvt_pk_bf16_f32 v234, v234, v235
    s_nop 0
    v_lshlrev_b32 v235, 16, v234
    v_lshlrev_b32 v236, 16, v32
    v_add_f32 v235, v235, v236
    v_and_b32 v234, 0xffff0000, v234
    v_and_b32 v236, 0xffff0000, v32
    v_add_f32 v234, v234, v236
    v_cvt_pk_bf16_f32 v238, v235, v234
    v_lshlrev_b32 v234, 16, v231
    v_lshlrev_b32 v235, 16, v233
    v_add_f32 v234, v234, v235
    v_and_b32 v235, 0xffff0000, v231
    v_and_b32 v236, 0xffff0000, v233
    v_add_f32 v235, v235, v236
    v_cvt_pk_bf16_f32 v234, v234, v235
    s_nop 0
    v_lshlrev_b32 v235, 16, v234
    v_lshlrev_b32 v236, 16, v33
    v_add_f32 v235, v235, v236
    v_and_b32 v234, 0xffff0000, v234
    v_and_b32 v236, 0xffff0000, v33
    v_add_f32 v234, v234, v236
    v_cvt_pk_bf16_f32 v239, v235, v234
    s_nop 0
    buffer_store_dwordx2 v[238:239], v7, s[20:23], s46 offen offset:0
    s_nop 0
    v_cvt_pk_bf16_f32 v230, v200, v201
    v_cvt_pk_bf16_f32 v231, v202, v203
    v_and_b32 v232, 0xffff0000, v223
    v_lshlrev_b32 v233, 16, v223
    v_and_b32 v234, 0xffff0000, v222
    v_lshlrev_b32 v235, 16, v222
    v_mul_f32 v232, s39, v232
    v_mul_f32 v233, s39, v233
    v_mul_f32 v234, s39, v234
    v_mul_f32 v235, s39, v235
    v_cvt_pk_bf16_f32 v232, v232, v233
    v_cvt_pk_bf16_f32 v233, v234, v235
    s_nop 0
    v_lshlrev_b32 v234, 16, v230
    v_lshlrev_b32 v235, 16, v232
    v_add_f32 v234, v234, v235
    v_and_b32 v235, 0xffff0000, v230
    v_and_b32 v236, 0xffff0000, v232
    v_add_f32 v235, v235, v236
    v_cvt_pk_bf16_f32 v234, v234, v235
    s_nop 0
    v_lshlrev_b32 v235, 16, v234
    v_lshlrev_b32 v236, 16, v34
    v_add_f32 v235, v235, v236
    v_and_b32 v234, 0xffff0000, v234
    v_and_b32 v236, 0xffff0000, v34
    v_add_f32 v234, v234, v236
    v_cvt_pk_bf16_f32 v238, v235, v234
    v_lshlrev_b32 v234, 16, v231
    v_lshlrev_b32 v235, 16, v233
    v_add_f32 v234, v234, v235
    v_and_b32 v235, 0xffff0000, v231
    v_and_b32 v236, 0xffff0000, v233
    v_add_f32 v235, v235, v236
    v_cvt_pk_bf16_f32 v234, v234, v235
    s_nop 0
    v_lshlrev_b32 v235, 16, v234
    v_lshlrev_b32 v236, 16, v35
    v_add_f32 v235, v235, v236
    v_and_b32 v234, 0xffff0000, v234
    v_and_b32 v236, 0xffff0000, v35
    v_add_f32 v234, v234, v236
    v_cvt_pk_bf16_f32 v239, v235, v234
    s_nop 0
    buffer_store_dwordx2 v[238:239], v7, s[20:23], s46 offen offset:512
    s_nop 0
    v_cvt_pk_bf16_f32 v230, v204, v205
    v_cvt_pk_bf16_f32 v231, v206, v207
    v_and_b32 v232, 0xffff0000, v225
    v_lshlrev_b32 v233, 16, v225
    v_and_b32 v234, 0xffff0000, v224
    v_lshlrev_b32 v235, 16, v224
    v_mul_f32 v232, s39, v232
    v_mul_f32 v233, s39, v233
    v_mul_f32 v234, s39, v234
    v_mul_f32 v235, s39, v235
    v_cvt_pk_bf16_f32 v232, v232, v233
    v_cvt_pk_bf16_f32 v233, v234, v235
    s_nop 0
    v_lshlrev_b32 v234, 16, v230
    v_lshlrev_b32 v235, 16, v232
    v_add_f32 v234, v234, v235
    v_and_b32 v235, 0xffff0000, v230
    v_and_b32 v236, 0xffff0000, v232
    v_add_f32 v235, v235, v236
    v_cvt_pk_bf16_f32 v234, v234, v235
    s_nop 0
    v_lshlrev_b32 v235, 16, v234
    v_lshlrev_b32 v236, 16, v36
    v_add_f32 v235, v235, v236
    v_and_b32 v234, 0xffff0000, v234
    v_and_b32 v236, 0xffff0000, v36
    v_add_f32 v234, v234, v236
    v_cvt_pk_bf16_f32 v238, v235, v234
    v_lshlrev_b32 v234, 16, v231
    v_lshlrev_b32 v235, 16, v233
    v_add_f32 v234, v234, v235
    v_and_b32 v235, 0xffff0000, v231
    v_and_b32 v236, 0xffff0000, v233
    v_add_f32 v235, v235, v236
    v_cvt_pk_bf16_f32 v234, v234, v235
    s_nop 0
    v_lshlrev_b32 v235, 16, v234
    v_lshlrev_b32 v236, 16, v37
    v_add_f32 v235, v235, v236
    v_and_b32 v234, 0xffff0000, v234
    v_and_b32 v236, 0xffff0000, v37
    v_add_f32 v234, v234, v236
    v_cvt_pk_bf16_f32 v239, v235, v234
    s_nop 0
    buffer_store_dwordx2 v[238:239], v7, s[20:23], s46 offen offset:1024
    s_nop 0
    v_cvt_pk_bf16_f32 v230, v208, v209
    v_cvt_pk_bf16_f32 v231, v210, v211
    v_and_b32 v232, 0xffff0000, v227
    v_lshlrev_b32 v233, 16, v227
    v_and_b32 v234, 0xffff0000, v226
    v_lshlrev_b32 v235, 16, v226
    v_mul_f32 v232, s39, v232
    v_mul_f32 v233, s39, v233
    v_mul_f32 v234, s39, v234
    v_mul_f32 v235, s39, v235
    v_cvt_pk_bf16_f32 v232, v232, v233
    v_cvt_pk_bf16_f32 v233, v234, v235
    s_nop 0
    v_lshlrev_b32 v234, 16, v230
    v_lshlrev_b32 v235, 16, v232
    v_add_f32 v234, v234, v235
    v_and_b32 v235, 0xffff0000, v230
    v_and_b32 v236, 0xffff0000, v232
    v_add_f32 v235, v235, v236
    v_cvt_pk_bf16_f32 v234, v234, v235
    s_nop 0
    v_lshlrev_b32 v235, 16, v234
    v_lshlrev_b32 v236, 16, v38
    v_add_f32 v235, v235, v236
    v_and_b32 v234, 0xffff0000, v234
    v_and_b32 v236, 0xffff0000, v38
    v_add_f32 v234, v234, v236
    v_cvt_pk_bf16_f32 v238, v235, v234
    v_lshlrev_b32 v234, 16, v231
    v_lshlrev_b32 v235, 16, v233
    v_add_f32 v234, v234, v235
    v_and_b32 v235, 0xffff0000, v231
    v_and_b32 v236, 0xffff0000, v233
    v_add_f32 v235, v235, v236
    v_cvt_pk_bf16_f32 v234, v234, v235
    s_nop 0
    v_lshlrev_b32 v235, 16, v234
    v_lshlrev_b32 v236, 16, v39
    v_add_f32 v235, v235, v236
    v_and_b32 v234, 0xffff0000, v234
    v_and_b32 v236, 0xffff0000, v39
    v_add_f32 v234, v234, v236
    v_cvt_pk_bf16_f32 v239, v235, v234
    s_nop 0
    buffer_store_dwordx2 v[238:239], v7, s[20:23], s46 offen offset:1536
    s_nop 0
    v_cvt_pk_bf16_f32 v230, v212, v213
    v_cvt_pk_bf16_f32 v231, v214, v215
    v_and_b32 v232, 0xffff0000, v229
    v_lshlrev_b32 v233, 16, v229
    v_and_b32 v234, 0xffff0000, v228
    v_lshlrev_b32 v235, 16, v228
    v_mul_f32 v232, s39, v232
    v_mul_f32 v233, s39, v233
    v_mul_f32 v234, s39, v234
    v_mul_f32 v235, s39, v235
    v_cvt_pk_bf16_f32 v232, v232, v233
    v_cvt_pk_bf16_f32 v233, v234, v235
    s_nop 0
    v_lshlrev_b32 v234, 16, v230
    v_lshlrev_b32 v235, 16, v232
    v_add_f32 v234, v234, v235
    v_and_b32 v235, 0xffff0000, v230
    v_and_b32 v236, 0xffff0000, v232
    v_add_f32 v235, v235, v236
    v_cvt_pk_bf16_f32 v234, v234, v235
    s_nop 0
    v_lshlrev_b32 v235, 16, v234
    v_lshlrev_b32 v236, 16, v40
    v_add_f32 v235, v235, v236
    v_and_b32 v234, 0xffff0000, v234
    v_and_b32 v236, 0xffff0000, v40
    v_add_f32 v234, v234, v236
    v_cvt_pk_bf16_f32 v238, v235, v234
    v_lshlrev_b32 v234, 16, v231
    v_lshlrev_b32 v235, 16, v233
    v_add_f32 v234, v234, v235
    v_and_b32 v235, 0xffff0000, v231
    v_and_b32 v236, 0xffff0000, v233
    v_add_f32 v235, v235, v236
    v_cvt_pk_bf16_f32 v234, v234, v235
    s_nop 0
    v_lshlrev_b32 v235, 16, v234
    v_lshlrev_b32 v236, 16, v41
    v_add_f32 v235, v235, v236
    v_and_b32 v234, 0xffff0000, v234
    v_and_b32 v236, 0xffff0000, v41
    v_add_f32 v234, v234, v236
    v_cvt_pk_bf16_f32 v239, v235, v234
    s_nop 0
    buffer_store_dwordx2 v[238:239], v7, s[20:23], s46 offen offset:2048
    s_nop 0
    s_endpgm
conv2_h1:
    v_mov_b32 v196, 0
    v_mov_b32 v197, 0
    v_mov_b32 v198, 0
    v_mov_b32 v199, 0
    v_mov_b32 v200, 0
    v_mov_b32 v201, 0
    v_mov_b32 v202, 0
    v_mov_b32 v203, 0
    v_mov_b32 v204, 0
    v_mov_b32 v205, 0
    v_mov_b32 v206, 0
    v_mov_b32 v207, 0
    ds_read_b128 v[68:71], v64 offset:3584
    ds_read_b128 v[72:75], v64 offset:3072
    ds_read_b128 v[76:79], v64 offset:2560
    ds_read_b128 v[80:83], v64 offset:2048
    ds_read_b128 v[84:87], v64 offset:1536
    ds_read_b128 v[88:91], v64 offset:1024
    ds_read_b128 v[92:95], v64 offset:512
    ds_read_b128 v[96:99], v64 offset:0
    ds_read_b64_tr_b16 v[132:133], v65 offset:0
    ds_read_b64_tr_b16 v[134:135], v65 offset:8
    ds_read_b64_tr_b16 v[136:137], v65 offset:512
    ds_read_b64_tr_b16 v[138:139], v65 offset:520
    ds_read_b64_tr_b16 v[140:141], v65 offset:1024
    ds_read_b64_tr_b16 v[142:143], v65 offset:1032
    ds_read_b64_tr_b16 v[144:145], v65 offset:1536
    ds_read_b64_tr_b16 v[146:147], v65 offset:1544
    ds_read_b64_tr_b16 v[148:149], v65 offset:2048
    ds_read_b64_tr_b16 v[150:151], v65 offset:2056
    ds_read_b64_tr_b16 v[152:153], v65 offset:2560
    ds_read_b64_tr_b16 v[154:155], v65 offset:2568
    ds_read_b64_tr_b16 v[156:157], v65 offset:3072
    ds_read_b64_tr_b16 v[158:159], v65 offset:3080
    ds_read_b64_tr_b16 v[160:161], v65 offset:3584
    ds_read_b64_tr_b16 v[162:163], v65 offset:3592
    s_waitcnt lgkmcnt(0)
    ds_read_b128 v[100:103], v64 offset:3648
    ds_read_b128 v[104:107], v64 offset:3136
    ds_read_b128 v[108:111], v64 offset:2624
    ds_read_b128 v[112:115], v64 offset:2112
    ds_read_b128 v[116:119], v64 offset:1600
    ds_read_b128 v[120:123], v64 offset:1088
    ds_read_b128 v[124:127], v64 offset:576
    ds_read_b128 v[128:131], v64 offset:64
    ds_read_b64_tr_b16 v[164:165], v65 offset:64
    ds_read_b64_tr_b16 v[166:167], v65 offset:72
    ds_read_b64_tr_b16 v[168:169], v65 offset:576
    ds_read_b64_tr_b16 v[170:171], v65 offset:584
    ds_read_b64_tr_b16 v[172:173], v65 offset:1088
    ds_read_b64_tr_b16 v[174:175], v65 offset:1096
    ds_read_b64_tr_b16 v[176:177], v65 offset:1600
    ds_read_b64_tr_b16 v[178:179], v65 offset:1608
    ds_read_b64_tr_b16 v[180:181], v65 offset:2112
    ds_read_b64_tr_b16 v[182:183], v65 offset:2120
    ds_read_b64_tr_b16 v[184:185], v65 offset:2624
    ds_read_b64_tr_b16 v[186:187], v65 offset:2632
    ds_read_b64_tr_b16 v[188:189], v65 offset:3136
    ds_read_b64_tr_b16 v[190:191], v65 offset:3144
    ds_read_b64_tr_b16 v[192:193], v65 offset:3648
    ds_read_b64_tr_b16 v[194:195], v65 offset:3656
    v_mfma_f32_16x16x32_bf16 v[196:199], v[132:135], v[88:91], v[196:199]
    v_mfma_f32_16x16x32_bf16 v[200:203], v[132:135], v[92:95], v[200:203]
    v_mfma_f32_16x16x32_bf16 v[204:207], v[132:135], v[96:99], v[204:207]
    v_mfma_f32_16x16x32_bf16 v[196:199], v[136:139], v[84:87], v[196:199]
    v_mfma_f32_16x16x32_bf16 v[200:203], v[136:139], v[88:91], v[200:203]
    v_mfma_f32_16x16x32_bf16 v[204:207], v[136:139], v[92:95], v[204:207]
    v_mfma_f32_16x16x32_bf16 v[196:199], v[140:143], v[80:83], v[196:199]
    v_mfma_f32_16x16x32_bf16 v[200:203], v[140:143], v[84:87], v[200:203]
    v_mfma_f32_16x16x32_bf16 v[204:207], v[140:143], v[88:91], v[204:207]
    v_mfma_f32_16x16x32_bf16 v[196:199], v[144:147], v[76:79], v[196:199]
    v_mfma_f32_16x16x32_bf16 v[200:203], v[144:147], v[80:83], v[200:203]
    v_mfma_f32_16x16x32_bf16 v[204:207], v[144:147], v[84:87], v[204:207]
    v_mfma_f32_16x16x32_bf16 v[196:199], v[148:151], v[72:75], v[196:199]
    v_mfma_f32_16x16x32_bf16 v[200:203], v[148:151], v[76:79], v[200:203]
    v_mfma_f32_16x16x32_bf16 v[204:207], v[148:151], v[80:83], v[204:207]
    v_mfma_f32_16x16x32_bf16 v[196:199], v[152:155], v[68:71], v[196:199]
    v_mfma_f32_16x16x32_bf16 v[200:203], v[152:155], v[72:75], v[200:203]
    v_mfma_f32_16x16x32_bf16 v[204:207], v[152:155], v[76:79], v[204:207]
    v_mfma_f32_16x16x32_bf16 v[200:203], v[156:159], v[68:71], v[200:203]
    v_mfma_f32_16x16x32_bf16 v[204:207], v[156:159], v[72:75], v[204:207]
    v_mfma_f32_16x16x32_bf16 v[204:207], v[160:163], v[68:71], v[204:207]
    s_waitcnt lgkmcnt(0)
    ds_read_b128 v[68:71], v64 offset:3712
    ds_read_b128 v[72:75], v64 offset:3200
    ds_read_b128 v[76:79], v64 offset:2688
    ds_read_b128 v[80:83], v64 offset:2176
    ds_read_b128 v[84:87], v64 offset:1664
    ds_read_b128 v[88:91], v64 offset:1152
    ds_read_b128 v[92:95], v64 offset:640
    ds_read_b128 v[96:99], v64 offset:128
    ds_read_b64_tr_b16 v[132:133], v65 offset:128
    ds_read_b64_tr_b16 v[134:135], v65 offset:136
    ds_read_b64_tr_b16 v[136:137], v65 offset:640
    ds_read_b64_tr_b16 v[138:139], v65 offset:648
    ds_read_b64_tr_b16 v[140:141], v65 offset:1152
    ds_read_b64_tr_b16 v[142:143], v65 offset:1160
    ds_read_b64_tr_b16 v[144:145], v65 offset:1664
    ds_read_b64_tr_b16 v[146:147], v65 offset:1672
    ds_read_b64_tr_b16 v[148:149], v65 offset:2176
    ds_read_b64_tr_b16 v[150:151], v65 offset:2184
    ds_read_b64_tr_b16 v[152:153], v65 offset:2688
    ds_read_b64_tr_b16 v[154:155], v65 offset:2696
    ds_read_b64_tr_b16 v[156:157], v65 offset:3200
    ds_read_b64_tr_b16 v[158:159], v65 offset:3208
    ds_read_b64_tr_b16 v[160:161], v65 offset:3712
    ds_read_b64_tr_b16 v[162:163], v65 offset:3720
    v_mfma_f32_16x16x32_bf16 v[196:199], v[164:167], v[120:123], v[196:199]
    v_mfma_f32_16x16x32_bf16 v[200:203], v[164:167], v[124:127], v[200:203]
    v_mfma_f32_16x16x32_bf16 v[204:207], v[164:167], v[128:131], v[204:207]
    v_mfma_f32_16x16x32_bf16 v[196:199], v[168:171], v[116:119], v[196:199]
    v_mfma_f32_16x16x32_bf16 v[200:203], v[168:171], v[120:123], v[200:203]
    v_mfma_f32_16x16x32_bf16 v[204:207], v[168:171], v[124:127], v[204:207]
    v_mfma_f32_16x16x32_bf16 v[196:199], v[172:175], v[112:115], v[196:199]
    v_mfma_f32_16x16x32_bf16 v[200:203], v[172:175], v[116:119], v[200:203]
    v_mfma_f32_16x16x32_bf16 v[204:207], v[172:175], v[120:123], v[204:207]
    v_mfma_f32_16x16x32_bf16 v[196:199], v[176:179], v[108:111], v[196:199]
    v_mfma_f32_16x16x32_bf16 v[200:203], v[176:179], v[112:115], v[200:203]
    v_mfma_f32_16x16x32_bf16 v[204:207], v[176:179], v[116:119], v[204:207]
    v_mfma_f32_16x16x32_bf16 v[196:199], v[180:183], v[104:107], v[196:199]
    v_mfma_f32_16x16x32_bf16 v[200:203], v[180:183], v[108:111], v[200:203]
    v_mfma_f32_16x16x32_bf16 v[204:207], v[180:183], v[112:115], v[204:207]
    v_mfma_f32_16x16x32_bf16 v[196:199], v[184:187], v[100:103], v[196:199]
    v_mfma_f32_16x16x32_bf16 v[200:203], v[184:187], v[104:107], v[200:203]
    v_mfma_f32_16x16x32_bf16 v[204:207], v[184:187], v[108:111], v[204:207]
    v_mfma_f32_16x16x32_bf16 v[200:203], v[188:191], v[100:103], v[200:203]
    v_mfma_f32_16x16x32_bf16 v[204:207], v[188:191], v[104:107], v[204:207]
    v_mfma_f32_16x16x32_bf16 v[204:207], v[192:195], v[100:103], v[204:207]
    s_waitcnt lgkmcnt(0)
    ds_read_b128 v[100:103], v64 offset:3776
    ds_read_b128 v[104:107], v64 offset:3264
    ds_read_b128 v[108:111], v64 offset:2752
    ds_read_b128 v[112:115], v64 offset:2240
    ds_read_b128 v[116:119], v64 offset:1728
    ds_read_b128 v[120:123], v64 offset:1216
    ds_read_b128 v[124:127], v64 offset:704
    ds_read_b128 v[128:131], v64 offset:192
    ds_read_b64_tr_b16 v[164:165], v65 offset:192
    ds_read_b64_tr_b16 v[166:167], v65 offset:200
    ds_read_b64_tr_b16 v[168:169], v65 offset:704
    ds_read_b64_tr_b16 v[170:171], v65 offset:712
    ds_read_b64_tr_b16 v[172:173], v65 offset:1216
    ds_read_b64_tr_b16 v[174:175], v65 offset:1224
    ds_read_b64_tr_b16 v[176:177], v65 offset:1728
    ds_read_b64_tr_b16 v[178:179], v65 offset:1736
    ds_read_b64_tr_b16 v[180:181], v65 offset:2240
    ds_read_b64_tr_b16 v[182:183], v65 offset:2248
    ds_read_b64_tr_b16 v[184:185], v65 offset:2752
    ds_read_b64_tr_b16 v[186:187], v65 offset:2760
    ds_read_b64_tr_b16 v[188:189], v65 offset:3264
    ds_read_b64_tr_b16 v[190:191], v65 offset:3272
    ds_read_b64_tr_b16 v[192:193], v65 offset:3776
    ds_read_b64_tr_b16 v[194:195], v65 offset:3784
    v_mfma_f32_16x16x32_bf16 v[196:199], v[132:135], v[88:91], v[196:199]
    v_mfma_f32_16x16x32_bf16 v[200:203], v[132:135], v[92:95], v[200:203]
    v_mfma_f32_16x16x32_bf16 v[204:207], v[132:135], v[96:99], v[204:207]
    v_mfma_f32_16x16x32_bf16 v[196:199], v[136:139], v[84:87], v[196:199]
    v_mfma_f32_16x16x32_bf16 v[200:203], v[136:139], v[88:91], v[200:203]
    v_mfma_f32_16x16x32_bf16 v[204:207], v[136:139], v[92:95], v[204:207]
    v_mfma_f32_16x16x32_bf16 v[196:199], v[140:143], v[80:83], v[196:199]
    v_mfma_f32_16x16x32_bf16 v[200:203], v[140:143], v[84:87], v[200:203]
    v_mfma_f32_16x16x32_bf16 v[204:207], v[140:143], v[88:91], v[204:207]
    v_mfma_f32_16x16x32_bf16 v[196:199], v[144:147], v[76:79], v[196:199]
    v_mfma_f32_16x16x32_bf16 v[200:203], v[144:147], v[80:83], v[200:203]
    v_mfma_f32_16x16x32_bf16 v[204:207], v[144:147], v[84:87], v[204:207]
    v_mfma_f32_16x16x32_bf16 v[196:199], v[148:151], v[72:75], v[196:199]
    v_mfma_f32_16x16x32_bf16 v[200:203], v[148:151], v[76:79], v[200:203]
    v_mfma_f32_16x16x32_bf16 v[204:207], v[148:151], v[80:83], v[204:207]
    v_mfma_f32_16x16x32_bf16 v[196:199], v[152:155], v[68:71], v[196:199]
    v_mfma_f32_16x16x32_bf16 v[200:203], v[152:155], v[72:75], v[200:203]
    v_mfma_f32_16x16x32_bf16 v[204:207], v[152:155], v[76:79], v[204:207]
    v_mfma_f32_16x16x32_bf16 v[200:203], v[156:159], v[68:71], v[200:203]
    v_mfma_f32_16x16x32_bf16 v[204:207], v[156:159], v[72:75], v[204:207]
    v_mfma_f32_16x16x32_bf16 v[204:207], v[160:163], v[68:71], v[204:207]
    s_waitcnt lgkmcnt(0)
    ds_read_b128 v[68:71], v64 offset:3840
    ds_read_b128 v[72:75], v64 offset:3328
    ds_read_b128 v[76:79], v64 offset:2816
    ds_read_b128 v[80:83], v64 offset:2304
    ds_read_b128 v[84:87], v64 offset:1792
    ds_read_b128 v[88:91], v64 offset:1280
    ds_read_b128 v[92:95], v64 offset:768
    ds_read_b128 v[96:99], v64 offset:256
    ds_read_b64_tr_b16 v[132:133], v65 offset:256
    ds_read_b64_tr_b16 v[134:135], v65 offset:264
    ds_read_b64_tr_b16 v[136:137], v65 offset:768
    ds_read_b64_tr_b16 v[138:139], v65 offset:776
    ds_read_b64_tr_b16 v[140:141], v65 offset:1280
    ds_read_b64_tr_b16 v[142:143], v65 offset:1288
    ds_read_b64_tr_b16 v[144:145], v65 offset:1792
    ds_read_b64_tr_b16 v[146:147], v65 offset:1800
    ds_read_b64_tr_b16 v[148:149], v65 offset:2304
    ds_read_b64_tr_b16 v[150:151], v65 offset:2312
    ds_read_b64_tr_b16 v[152:153], v65 offset:2816
    ds_read_b64_tr_b16 v[154:155], v65 offset:2824
    ds_read_b64_tr_b16 v[156:157], v65 offset:3328
    ds_read_b64_tr_b16 v[158:159], v65 offset:3336
    ds_read_b64_tr_b16 v[160:161], v65 offset:3840
    ds_read_b64_tr_b16 v[162:163], v65 offset:3848
    v_mfma_f32_16x16x32_bf16 v[196:199], v[164:167], v[120:123], v[196:199]
    v_mfma_f32_16x16x32_bf16 v[200:203], v[164:167], v[124:127], v[200:203]
    v_mfma_f32_16x16x32_bf16 v[204:207], v[164:167], v[128:131], v[204:207]
    v_mfma_f32_16x16x32_bf16 v[196:199], v[168:171], v[116:119], v[196:199]
    v_mfma_f32_16x16x32_bf16 v[200:203], v[168:171], v[120:123], v[200:203]
    v_mfma_f32_16x16x32_bf16 v[204:207], v[168:171], v[124:127], v[204:207]
    v_mfma_f32_16x16x32_bf16 v[196:199], v[172:175], v[112:115], v[196:199]
    v_mfma_f32_16x16x32_bf16 v[200:203], v[172:175], v[116:119], v[200:203]
    v_mfma_f32_16x16x32_bf16 v[204:207], v[172:175], v[120:123], v[204:207]
    v_mfma_f32_16x16x32_bf16 v[196:199], v[176:179], v[108:111], v[196:199]
    v_mfma_f32_16x16x32_bf16 v[200:203], v[176:179], v[112:115], v[200:203]
    v_mfma_f32_16x16x32_bf16 v[204:207], v[176:179], v[116:119], v[204:207]
    v_mfma_f32_16x16x32_bf16 v[196:199], v[180:183], v[104:107], v[196:199]
    v_mfma_f32_16x16x32_bf16 v[200:203], v[180:183], v[108:111], v[200:203]
    v_mfma_f32_16x16x32_bf16 v[204:207], v[180:183], v[112:115], v[204:207]
    v_mfma_f32_16x16x32_bf16 v[196:199], v[184:187], v[100:103], v[196:199]
    v_mfma_f32_16x16x32_bf16 v[200:203], v[184:187], v[104:107], v[200:203]
    v_mfma_f32_16x16x32_bf16 v[204:207], v[184:187], v[108:111], v[204:207]
    v_mfma_f32_16x16x32_bf16 v[200:203], v[188:191], v[100:103], v[200:203]
    v_mfma_f32_16x16x32_bf16 v[204:207], v[188:191], v[104:107], v[204:207]
    v_mfma_f32_16x16x32_bf16 v[204:207], v[192:195], v[100:103], v[204:207]
    s_waitcnt lgkmcnt(0)
    ds_read_b128 v[100:103], v64 offset:3904
    ds_read_b128 v[104:107], v64 offset:3392
    ds_read_b128 v[108:111], v64 offset:2880
    ds_read_b128 v[112:115], v64 offset:2368
    ds_read_b128 v[116:119], v64 offset:1856
    ds_read_b128 v[120:123], v64 offset:1344
    ds_read_b128 v[124:127], v64 offset:832
    ds_read_b128 v[128:131], v64 offset:320
    ds_read_b64_tr_b16 v[164:165], v65 offset:320
    ds_read_b64_tr_b16 v[166:167], v65 offset:328
    ds_read_b64_tr_b16 v[168:169], v65 offset:832
    ds_read_b64_tr_b16 v[170:171], v65 offset:840
    ds_read_b64_tr_b16 v[172:173], v65 offset:1344
    ds_read_b64_tr_b16 v[174:175], v65 offset:1352
    ds_read_b64_tr_b16 v[176:177], v65 offset:1856
    ds_read_b64_tr_b16 v[178:179], v65 offset:1864
    ds_read_b64_tr_b16 v[180:181], v65 offset:2368
    ds_read_b64_tr_b16 v[182:183], v65 offset:2376
    ds_read_b64_tr_b16 v[184:185], v65 offset:2880
    ds_read_b64_tr_b16 v[186:187], v65 offset:2888
    ds_read_b64_tr_b16 v[188:189], v65 offset:3392
    ds_read_b64_tr_b16 v[190:191], v65 offset:3400
    ds_read_b64_tr_b16 v[192:193], v65 offset:3904
    ds_read_b64_tr_b16 v[194:195], v65 offset:3912
    v_mfma_f32_16x16x32_bf16 v[196:199], v[132:135], v[88:91], v[196:199]
    v_mfma_f32_16x16x32_bf16 v[200:203], v[132:135], v[92:95], v[200:203]
    v_mfma_f32_16x16x32_bf16 v[204:207], v[132:135], v[96:99], v[204:207]
    v_mfma_f32_16x16x32_bf16 v[196:199], v[136:139], v[84:87], v[196:199]
    v_mfma_f32_16x16x32_bf16 v[200:203], v[136:139], v[88:91], v[200:203]
    v_mfma_f32_16x16x32_bf16 v[204:207], v[136:139], v[92:95], v[204:207]
    v_mfma_f32_16x16x32_bf16 v[196:199], v[140:143], v[80:83], v[196:199]
    v_mfma_f32_16x16x32_bf16 v[200:203], v[140:143], v[84:87], v[200:203]
    v_mfma_f32_16x16x32_bf16 v[204:207], v[140:143], v[88:91], v[204:207]
    v_mfma_f32_16x16x32_bf16 v[196:199], v[144:147], v[76:79], v[196:199]
    v_mfma_f32_16x16x32_bf16 v[200:203], v[144:147], v[80:83], v[200:203]
    v_mfma_f32_16x16x32_bf16 v[204:207], v[144:147], v[84:87], v[204:207]
    v_mfma_f32_16x16x32_bf16 v[196:199], v[148:151], v[72:75], v[196:199]
    v_mfma_f32_16x16x32_bf16 v[200:203], v[148:151], v[76:79], v[200:203]
    v_mfma_f32_16x16x32_bf16 v[204:207], v[148:151], v[80:83], v[204:207]
    v_mfma_f32_16x16x32_bf16 v[196:199], v[152:155], v[68:71], v[196:199]
    v_mfma_f32_16x16x32_bf16 v[200:203], v[152:155], v[72:75], v[200:203]
    v_mfma_f32_16x16x32_bf16 v[204:207], v[152:155], v[76:79], v[204:207]
    v_mfma_f32_16x16x32_bf16 v[200:203], v[156:159], v[68:71], v[200:203]
    v_mfma_f32_16x16x32_bf16 v[204:207], v[156:159], v[72:75], v[204:207]
    v_mfma_f32_16x16x32_bf16 v[204:207], v[160:163], v[68:71], v[204:207]
    s_waitcnt lgkmcnt(0)
    ds_read_b128 v[68:71], v64 offset:3968
    ds_read_b128 v[72:75], v64 offset:3456
    ds_read_b128 v[76:79], v64 offset:2944
    ds_read_b128 v[80:83], v64 offset:2432
    ds_read_b128 v[84:87], v64 offset:1920
    ds_read_b128 v[88:91], v64 offset:1408
    ds_read_b128 v[92:95], v64 offset:896
    ds_read_b128 v[96:99], v64 offset:384
    ds_read_b64_tr_b16 v[132:133], v65 offset:384
    ds_read_b64_tr_b16 v[134:135], v65 offset:392
    ds_read_b64_tr_b16 v[136:137], v65 offset:896
    ds_read_b64_tr_b16 v[138:139], v65 offset:904
    ds_read_b64_tr_b16 v[140:141], v65 offset:1408
    ds_read_b64_tr_b16 v[142:143], v65 offset:1416
    ds_read_b64_tr_b16 v[144:145], v65 offset:1920
    ds_read_b64_tr_b16 v[146:147], v65 offset:1928
    ds_read_b64_tr_b16 v[148:149], v65 offset:2432
    ds_read_b64_tr_b16 v[150:151], v65 offset:2440
    ds_read_b64_tr_b16 v[152:153], v65 offset:2944
    ds_read_b64_tr_b16 v[154:155], v65 offset:2952
    ds_read_b64_tr_b16 v[156:157], v65 offset:3456
    ds_read_b64_tr_b16 v[158:159], v65 offset:3464
    ds_read_b64_tr_b16 v[160:161], v65 offset:3968
    ds_read_b64_tr_b16 v[162:163], v65 offset:3976
    v_mfma_f32_16x16x32_bf16 v[196:199], v[164:167], v[120:123], v[196:199]
    v_mfma_f32_16x16x32_bf16 v[200:203], v[164:167], v[124:127], v[200:203]
    v_mfma_f32_16x16x32_bf16 v[204:207], v[164:167], v[128:131], v[204:207]
    v_mfma_f32_16x16x32_bf16 v[196:199], v[168:171], v[116:119], v[196:199]
    v_mfma_f32_16x16x32_bf16 v[200:203], v[168:171], v[120:123], v[200:203]
    v_mfma_f32_16x16x32_bf16 v[204:207], v[168:171], v[124:127], v[204:207]
    v_mfma_f32_16x16x32_bf16 v[196:199], v[172:175], v[112:115], v[196:199]
    v_mfma_f32_16x16x32_bf16 v[200:203], v[172:175], v[116:119], v[200:203]
    v_mfma_f32_16x16x32_bf16 v[204:207], v[172:175], v[120:123], v[204:207]
    v_mfma_f32_16x16x32_bf16 v[196:199], v[176:179], v[108:111], v[196:199]
    v_mfma_f32_16x16x32_bf16 v[200:203], v[176:179], v[112:115], v[200:203]
    v_mfma_f32_16x16x32_bf16 v[204:207], v[176:179], v[116:119], v[204:207]
    v_mfma_f32_16x16x32_bf16 v[196:199], v[180:183], v[104:107], v[196:199]
    v_mfma_f32_16x16x32_bf16 v[200:203], v[180:183], v[108:111], v[200:203]
    v_mfma_f32_16x16x32_bf16 v[204:207], v[180:183], v[112:115], v[204:207]
    v_mfma_f32_16x16x32_bf16 v[196:199], v[184:187], v[100:103], v[196:199]
    v_mfma_f32_16x16x32_bf16 v[200:203], v[184:187], v[104:107], v[200:203]
    v_mfma_f32_16x16x32_bf16 v[204:207], v[184:187], v[108:111], v[204:207]
    v_mfma_f32_16x16x32_bf16 v[200:203], v[188:191], v[100:103], v[200:203]
    v_mfma_f32_16x16x32_bf16 v[204:207], v[188:191], v[104:107], v[204:207]
    v_mfma_f32_16x16x32_bf16 v[204:207], v[192:195], v[100:103], v[204:207]
    s_waitcnt lgkmcnt(0)
    ds_read_b128 v[100:103], v64 offset:4032
    ds_read_b128 v[104:107], v64 offset:3520
    ds_read_b128 v[108:111], v64 offset:3008
    ds_read_b128 v[112:115], v64 offset:2496
    ds_read_b128 v[116:119], v64 offset:1984
    ds_read_b128 v[120:123], v64 offset:1472
    ds_read_b128 v[124:127], v64 offset:960
    ds_read_b128 v[128:131], v64 offset:448
    ds_read_b64_tr_b16 v[164:165], v65 offset:448
    ds_read_b64_tr_b16 v[166:167], v65 offset:456
    ds_read_b64_tr_b16 v[168:169], v65 offset:960
    ds_read_b64_tr_b16 v[170:171], v65 offset:968
    ds_read_b64_tr_b16 v[172:173], v65 offset:1472
    ds_read_b64_tr_b16 v[174:175], v65 offset:1480
    ds_read_b64_tr_b16 v[176:177], v65 offset:1984
    ds_read_b64_tr_b16 v[178:179], v65 offset:1992
    ds_read_b64_tr_b16 v[180:181], v65 offset:2496
    ds_read_b64_tr_b16 v[182:183], v65 offset:2504
    ds_read_b64_tr_b16 v[184:185], v65 offset:3008
    ds_read_b64_tr_b16 v[186:187], v65 offset:3016
    ds_read_b64_tr_b16 v[188:189], v65 offset:3520
    ds_read_b64_tr_b16 v[190:191], v65 offset:3528
    ds_read_b64_tr_b16 v[192:193], v65 offset:4032
    ds_read_b64_tr_b16 v[194:195], v65 offset:4040
    v_mfma_f32_16x16x32_bf16 v[196:199], v[132:135], v[88:91], v[196:199]
    v_mfma_f32_16x16x32_bf16 v[200:203], v[132:135], v[92:95], v[200:203]
    v_mfma_f32_16x16x32_bf16 v[204:207], v[132:135], v[96:99], v[204:207]
    v_mfma_f32_16x16x32_bf16 v[196:199], v[136:139], v[84:87], v[196:199]
    v_mfma_f32_16x16x32_bf16 v[200:203], v[136:139], v[88:91], v[200:203]
    v_mfma_f32_16x16x32_bf16 v[204:207], v[136:139], v[92:95], v[204:207]
    v_mfma_f32_16x16x32_bf16 v[196:199], v[140:143], v[80:83], v[196:199]
    v_mfma_f32_16x16x32_bf16 v[200:203], v[140:143], v[84:87], v[200:203]
    v_mfma_f32_16x16x32_bf16 v[204:207], v[140:143], v[88:91], v[204:207]
    v_mfma_f32_16x16x32_bf16 v[196:199], v[144:147], v[76:79], v[196:199]
    v_mfma_f32_16x16x32_bf16 v[200:203], v[144:147], v[80:83], v[200:203]
    v_mfma_f32_16x16x32_bf16 v[204:207], v[144:147], v[84:87], v[204:207]
    v_mfma_f32_16x16x32_bf16 v[196:199], v[148:151], v[72:75], v[196:199]
    v_mfma_f32_16x16x32_bf16 v[200:203], v[148:151], v[76:79], v[200:203]
    v_mfma_f32_16x16x32_bf16 v[204:207], v[148:151], v[80:83], v[204:207]
    v_mfma_f32_16x16x32_bf16 v[196:199], v[152:155], v[68:71], v[196:199]
    v_mfma_f32_16x16x32_bf16 v[200:203], v[152:155], v[72:75], v[200:203]
    v_mfma_f32_16x16x32_bf16 v[204:207], v[152:155], v[76:79], v[204:207]
    v_mfma_f32_16x16x32_bf16 v[200:203], v[156:159], v[68:71], v[200:203]
    v_mfma_f32_16x16x32_bf16 v[204:207], v[156:159], v[72:75], v[204:207]
    v_mfma_f32_16x16x32_bf16 v[204:207], v[160:163], v[68:71], v[204:207]
    s_waitcnt lgkmcnt(0)
    v_mfma_f32_16x16x32_bf16 v[196:199], v[164:167], v[120:123], v[196:199]
    v_mfma_f32_16x16x32_bf16 v[200:203], v[164:167], v[124:127], v[200:203]
    v_mfma_f32_16x16x32_bf16 v[204:207], v[164:167], v[128:131], v[204:207]
    v_mfma_f32_16x16x32_bf16 v[196:199], v[168:171], v[116:119], v[196:199]
    v_mfma_f32_16x16x32_bf16 v[200:203], v[168:171], v[120:123], v[200:203]
    v_mfma_f32_16x16x32_bf16 v[204:207], v[168:171], v[124:127], v[204:207]
    v_mfma_f32_16x16x32_bf16 v[196:199], v[172:175], v[112:115], v[196:199]
    v_mfma_f32_16x16x32_bf16 v[200:203], v[172:175], v[116:119], v[200:203]
    v_mfma_f32_16x16x32_bf16 v[204:207], v[172:175], v[120:123], v[204:207]
    v_mfma_f32_16x16x32_bf16 v[196:199], v[176:179], v[108:111], v[196:199]
    v_mfma_f32_16x16x32_bf16 v[200:203], v[176:179], v[112:115], v[200:203]
    v_mfma_f32_16x16x32_bf16 v[204:207], v[176:179], v[116:119], v[204:207]
    v_mfma_f32_16x16x32_bf16 v[196:199], v[180:183], v[104:107], v[196:199]
    v_mfma_f32_16x16x32_bf16 v[200:203], v[180:183], v[108:111], v[200:203]
    v_mfma_f32_16x16x32_bf16 v[204:207], v[180:183], v[112:115], v[204:207]
    v_mfma_f32_16x16x32_bf16 v[196:199], v[184:187], v[100:103], v[196:199]
    v_mfma_f32_16x16x32_bf16 v[200:203], v[184:187], v[104:107], v[200:203]
    v_mfma_f32_16x16x32_bf16 v[204:207], v[184:187], v[108:111], v[204:207]
    v_mfma_f32_16x16x32_bf16 v[200:203], v[188:191], v[100:103], v[200:203]
    v_mfma_f32_16x16x32_bf16 v[204:207], v[188:191], v[104:107], v[204:207]
    v_mfma_f32_16x16x32_bf16 v[204:207], v[192:195], v[100:103], v[204:207]
    ds_read_b64 v[220:221], v66 offset:1024
    ds_read_b64 v[222:223], v66 offset:512
    ds_read_b64 v[224:225], v66 offset:0
    s_nop 7
    s_waitcnt lgkmcnt(0)
    v_cvt_pk_bf16_f32 v230, v196, v197
    v_cvt_pk_bf16_f32 v231, v198, v199
    v_and_b32 v232, 0xffff0000, v221
    v_lshlrev_b32 v233, 16, v221
    v_and_b32 v234, 0xffff0000, v220
    v_lshlrev_b32 v235, 16, v220
    v_mul_f32 v232, s39, v232
    v_mul_f32 v233, s39, v233
    v_mul_f32 v234, s39, v234
    v_mul_f32 v235, s39, v235
    v_cvt_pk_bf16_f32 v232, v232, v233
    v_cvt_pk_bf16_f32 v233, v234, v235
    s_nop 0
    v_lshlrev_b32 v234, 16, v230
    v_lshlrev_b32 v235, 16, v232
    v_add_f32 v234, v234, v235
    v_and_b32 v235, 0xffff0000, v230
    v_and_b32 v236, 0xffff0000, v232
    v_add_f32 v235, v235, v236
    v_cvt_pk_bf16_f32 v234, v234, v235
    s_nop 0
    v_lshlrev_b32 v235, 16, v234
    v_lshlrev_b32 v236, 16, v42
    v_add_f32 v235, v235, v236
    v_and_b32 v234, 0xffff0000, v234
    v_and_b32 v236, 0xffff0000, v42
    v_add_f32 v234, v234, v236
    v_cvt_pk_bf16_f32 v238, v235, v234
    v_lshlrev_b32 v234, 16, v231
    v_lshlrev_b32 v235, 16, v233
    v_add_f32 v234, v234, v235
    v_and_b32 v235, 0xffff0000, v231
    v_and_b32 v236, 0xffff0000, v233
    v_add_f32 v235, v235, v236
    v_cvt_pk_bf16_f32 v234, v234, v235
    s_nop 0
    v_lshlrev_b32 v235, 16, v234
    v_lshlrev_b32 v236, 16, v43
    v_add_f32 v235, v235, v236
    v_and_b32 v234, 0xffff0000, v234
    v_and_b32 v236, 0xffff0000, v43
    v_add_f32 v234, v234, v236
    v_cvt_pk_bf16_f32 v239, v235, v234
    s_nop 0
    buffer_store_dwordx2 v[238:239], v7, s[20:23], s46 offen offset:2560
    s_nop 0
    v_cvt_pk_bf16_f32 v230, v200, v201
    v_cvt_pk_bf16_f32 v231, v202, v203
    v_and_b32 v232, 0xffff0000, v223
    v_lshlrev_b32 v233, 16, v223
    v_and_b32 v234, 0xffff0000, v222
    v_lshlrev_b32 v235, 16, v222
    v_mul_f32 v232, s39, v232
    v_mul_f32 v233, s39, v233
    v_mul_f32 v234, s39, v234
    v_mul_f32 v235, s39, v235
    v_cvt_pk_bf16_f32 v232, v232, v233
    v_cvt_pk_bf16_f32 v233, v234, v235
    s_nop 0
    v_lshlrev_b32 v234, 16, v230
    v_lshlrev_b32 v235, 16, v232
    v_add_f32 v234, v234, v235
    v_and_b32 v235, 0xffff0000, v230
    v_and_b32 v236, 0xffff0000, v232
    v_add_f32 v235, v235, v236
    v_cvt_pk_bf16_f32 v234, v234, v235
    s_nop 0
    v_lshlrev_b32 v235, 16, v234
    v_lshlrev_b32 v236, 16, v44
    v_add_f32 v235, v235, v236
    v_and_b32 v234, 0xffff0000, v234
    v_and_b32 v236, 0xffff0000, v44
    v_add_f32 v234, v234, v236
    v_cvt_pk_bf16_f32 v238, v235, v234
    v_lshlrev_b32 v234, 16, v231
    v_lshlrev_b32 v235, 16, v233
    v_add_f32 v234, v234, v235
    v_and_b32 v235, 0xffff0000, v231
    v_and_b32 v236, 0xffff0000, v233
    v_add_f32 v235, v235, v236
    v_cvt_pk_bf16_f32 v234, v234, v235
    s_nop 0
    v_lshlrev_b32 v235, 16, v234
    v_lshlrev_b32 v236, 16, v45
    v_add_f32 v235, v235, v236
    v_and_b32 v234, 0xffff0000, v234
    v_and_b32 v236, 0xffff0000, v45
    v_add_f32 v234, v234, v236
    v_cvt_pk_bf16_f32 v239, v235, v234
    s_nop 0
    buffer_store_dwordx2 v[238:239], v7, s[20:23], s46 offen offset:3072
    s_nop 0
    v_cvt_pk_bf16_f32 v230, v204, v205
    v_cvt_pk_bf16_f32 v231, v206, v207
    v_and_b32 v232, 0xffff0000, v225
    v_lshlrev_b32 v233, 16, v225
    v_and_b32 v234, 0xffff0000, v224
    v_lshlrev_b32 v235, 16, v224
    v_mul_f32 v232, s39, v232
    v_mul_f32 v233, s39, v233
    v_mul_f32 v234, s39, v234
    v_mul_f32 v235, s39, v235
    v_cvt_pk_bf16_f32 v232, v232, v233
    v_cvt_pk_bf16_f32 v233, v234, v235
    s_nop 0
    v_lshlrev_b32 v234, 16, v230
    v_lshlrev_b32 v235, 16, v232
    v_add_f32 v234, v234, v235
    v_and_b32 v235, 0xffff0000, v230
    v_and_b32 v236, 0xffff0000, v232
    v_add_f32 v235, v235, v236
    v_cvt_pk_bf16_f32 v234, v234, v235
    s_nop 0
    v_lshlrev_b32 v235, 16, v234
    v_lshlrev_b32 v236, 16, v46
    v_add_f32 v235, v235, v236
    v_and_b32 v234, 0xffff0000, v234
    v_and_b32 v236, 0xffff0000, v46
    v_add_f32 v234, v234, v236
    v_cvt_pk_bf16_f32 v238, v235, v234
    v_lshlrev_b32 v234, 16, v231
    v_lshlrev_b32 v235, 16, v233
    v_add_f32 v234, v234, v235
    v_and_b32 v235, 0xffff0000, v231
    v_and_b32 v236, 0xffff0000, v233
    v_add_f32 v235, v235, v236
    v_cvt_pk_bf16_f32 v234, v234, v235
    s_nop 0
    v_lshlrev_b32 v235, 16, v234
    v_lshlrev_b32 v236, 16, v47
    v_add_f32 v235, v235, v236
    v_and_b32 v234, 0xffff0000, v234
    v_and_b32 v236, 0xffff0000, v47
    v_add_f32 v234, v234, v236
    v_cvt_pk_bf16_f32 v239, v235, v234
    s_nop 0
    buffer_store_dwordx2 v[238:239], v7, s[20:23], s46 offen offset:3584
    s_nop 0
    s_endpgm
conv2_exit:
    s_endpgm

.globl g1b_kernel
.p2align 8
.type g1b_kernel,@function
g1b_kernel:
    s_cmp_ge_u32 s2, 224
    s_cbranch_scc1 g1b_exit
    s_load_dwordx2 s[4:5], s[0:1], 120
    s_load_dwordx2 s[6:7], s[0:1], 80
    s_load_dwordx2 s[28:29], s[0:1], 88
    v_readfirstlane_b32 s30, v0
    s_lshr_b32 s30, s30, 6
    s_lshr_b32 s31, s30, 1
    s_and_b32 s32, s30, 1
    s_and_b32 s33, s2, 15
    s_lshl_b32 s33, s33, 7
    s_lshr_b32 s34, s2, 4
    s_lshl_b32 s34, s34, 7
    s_waitcnt lgkmcnt(0)
    s_add_u32 s8, s4, 0x600000
    s_addc_u32 s9, s5, 0
    s_and_b32 s9, s9, 0xffff
    s_mov_b32 s10, 0x200000
    s_mov_b32 s11, 0x00020000
    s_add_u32 s12, s6, 0x0
    s_addc_u32 s13, s7, 0
    s_and_b32 s13, s13, 0xffff
    s_mov_b32 s14, 0x1c0000
    s_mov_b32 s15, 0x00020000
    s_add_u32 s16, s28, 0x0
    s_addc_u32 s17, s29, 0
    s_and_b32 s17, s17, 0xffff
    s_mov_b32 s18, 0x1c0000
    s_mov_b32 s19, 0x00020000
    s_add_u32 s20, s4, 0x800000
    s_addc_u32 s21, s5, 0
    s_and_b32 s21, s21, 0xffff
    s_mov_b32 s22, 0x700000
    s_mov_b32 s23, 0x00020000
    s_add_u32 s24, s4, 0x1420000
    s_addc_u32 s25, s5, 0
    s_and_b32 s25, s25, 0xffff
    s_mov_b32 s26, 0x3800
    s_mov_b32 s27, 0x00020000
    v_and_b32 v25, 63, v0
    v_and_b32 v26, 15, v25
    v_lshrrev_b32 v27, 4, v25
    v_lshlrev_b32 v0, 1, v27
    v_xor_b32 v0, v0, v26
    v_lshlrev_b32 v0, 4, v0
    s_lshl_b32 s35, s30, 4
    s_add_u32 s35, s35, 0
    v_add_u32 v24, s35, v27
    v_lshl_add_u32 v9, v24, 12, v0
    s_lshl_b32 s36, s33, 1
    v_add_u32 v9, s36, v9
    s_movk_i32 s36, 3584
    v_mul_lo_u32 v24, v24, s36
    v_add_u32 v13, v24, v0
    s_lshl_b32 s36, s34, 1
    v_add_u32 v13, s36, v13
    v_lshlrev_b32 v0, 1, v27
    v_xor_b32 v0, v0, v26
    v_lshlrev_b32 v0, 4, v0
    s_lshl_b32 s35, s30, 4
    s_add_u32 s35, s35, 4
    v_add_u32 v24, s35, v27
    v_lshl_add_u32 v10, v24, 12, v0
    s_lshl_b32 s36, s33, 1
    v_add_u32 v10, s36, v10
    s_movk_i32 s36, 3584
    v_mul_lo_u32 v24, v24, s36
    v_add_u32 v14, v24, v0
    s_lshl_b32 s36, s34, 1
    v_add_u32 v14, s36, v14
    v_lshlrev_b32 v0, 1, v27
    v_xor_b32 v0, v0, v26
    v_xor_b32 v0, 8, v0
    v_lshlrev_b32 v0, 4, v0
    s_lshl_b32 s35, s30, 4
    s_add_u32 s35, s35, 8
    v_add_u32 v24, s35, v27
    v_lshl_add_u32 v11, v24, 12, v0
    s_lshl_b32 s36, s33, 1
    v_add_u32 v11, s36, v11
    s_movk_i32 s36, 3584
    v_mul_lo_u32 v24, v24, s36
    v_add_u32 v15, v24, v0
    s_lshl_b32 s36, s34, 1
    v_add_u32 v15, s36, v15
    v_lshlrev_b32 v0, 1, v27
    v_xor_b32 v0, v0, v26
    v_xor_b32 v0, 8, v0
    v_lshlrev_b32 v0, 4, v0
    s_lshl_b32 s35, s30, 4
    s_add_u32 s35, s35, 12
    v_add_u32 v24, s35, v27
    v_lshl_add_u32 v12, v24, 12, v0
    s_lshl_b32 s36, s33, 1
    v_add_u32 v12, s36, v12
    s_movk_i32 s36, 3584
    v_mul_lo_u32 v24, v24, s36
    v_add_u32 v16, v24, v0
    s_lshl_b32 s36, s34, 1
    v_add_u32 v16, s36, v16
    s_mov_b32 s40, 0
    s_mov_b32 s41, 0
    s_lshl_b32 s42, s30, 12
    s_add_u32 m0, s42, 0
    s_nop 0
    buffer_load_dwordx4 v9, s[8:11], s40 offen lds
    s_add_u32 m0, s42, 16384
    s_nop 0
    buffer_load_dwordx4 v13, s[12:15], s41 offen lds
    s_add_u32 m0, s42, 32768
    s_nop 0
    buffer_load_dwordx4 v13, s[16:19], s41 offen lds
    s_add_u32 m0, s42, 1024
    s_nop 0
    buffer_load_dwordx4 v10, s[8:11], s40 offen lds
    s_add_u32 m0, s42, 17408
    s_nop 0
    buffer_load_dwordx4 v14, s[12:15], s41 offen lds
    s_add_u32 m0, s42, 33792
    s_nop 0
    buffer_load_dwordx4 v14, s[16:19], s41 offen lds
    s_add_u32 m0, s42, 2048
    s_nop 0
    buffer_load_dwordx4 v11, s[8:11], s40 offen lds
    s_add_u32 m0, s42, 18432
    s_nop 0
    buffer_load_dwordx4 v15, s[12:15], s41 offen lds
    s_add_u32 m0, s42, 34816
    s_nop 0
    buffer_load_dwordx4 v15, s[16:19], s41 offen lds
    s_add_u32 m0, s42, 3072
    s_nop 0
    buffer_load_dwordx4 v12, s[8:11], s40 offen lds
    s_add_u32 m0, s42, 19456
    s_nop 0
    buffer_load_dwordx4 v16, s[12:15], s41 offen lds
    s_add_u32 m0, s42, 35840
    s_nop 0
    buffer_load_dwordx4 v16, s[16:19], s41 offen lds
    s_mov_b32 s40, 262144
    s_mov_b32 s41, 229376
    s_lshl_b32 s42, s30, 12
    s_add_u32 m0, s42, 49152
    s_nop 0
    buffer_load_dwordx4 v9, s[8:11], s40 offen lds
    s_add_u32 m0, s42, 65536
    s_nop 0
    buffer_load_dwordx4 v13, s[12:15], s41 offen lds
    s_add_u32 m0, s42, 81920
    s_nop 0
    buffer_load_dwordx4 v13, s[16:19], s41 offen lds
    s_add_u32 m0, s42, 50176
    s_nop 0
    buffer_load_dwordx4 v10, s[8:11], s40 offen lds
    s_add_u32 m0, s42, 66560
    s_nop 0
    buffer_load_dwordx4 v14, s[12:15], s41 offen lds
    s_add_u32 m0, s42, 82944
    s_nop 0
    buffer_load_dwordx4 v14, s[16:19], s41 offen lds
    s_add_u32 m0, s42, 51200
    s_nop 0
    buffer_load_dwordx4 v11, s[8:11], s40 offen lds
    s_add_u32 m0, s42, 67584
    s_nop 0
    buffer_load_dwordx4 v15, s[12:15], s41 offen lds
    s_add_u32 m0, s42, 83968
    s_nop 0
    buffer_load_dwordx4 v15, s[16:19], s41 offen lds
    s_add_u32 m0, s42, 52224
    s_nop 0
    buffer_load_dwordx4 v12, s[8:11], s40 offen lds
    s_add_u32 m0, s42, 68608
    s_nop 0
    buffer_load_dwordx4 v16, s[12:15], s41 offen lds
    s_add_u32 m0, s42, 84992
    s_nop 0
    buffer_load_dwordx4 v16, s[16:19], s41 offen lds
    v_lshrrev_b32 v0, 2, v26
    v_and_b32 v24, 1, v27
    v_lshl_or_b32 v24, v24, 2, v0
    v_lshlrev_b32 v24, 1, v24
    v_and_b32 v17, 3, v26
    v_lshrrev_b32 v18, 1, v17
    v_and_b32 v17, 1, v17
    v_lshl_add_u32 v0, v27, 3, v0
    v_lshlrev_b32 v0, 8, v0
    v_lshl_add_u32 v0, v17, 3, v0
    s_lshl_b32 s35, s31, 3
    s_add_u32 s35, s35, 0
    v_add_u32 v19, s35, v18
    v_xor_b32 v19, v19, v24
    v_lshl_add_u32 v1, v19, 4, v0
    s_lshl_b32 s35, s32, 3
    s_add_u32 s35, s35, 0
    v_add_u32 v19, s35, v18
    v_xor_b32 v19, v19, v24
    v_lshl_add_u32 v5, v19, 4, v0
    s_lshl_b32 s35, s31, 3
    s_add_u32 s35, s35, 2
    v_add_u32 v19, s35, v18
    v_xor_b32 v19, v19, v24
    v_lshl_add_u32 v2, v19, 4, v0
    s_lshl_b32 s35, s32, 3
    s_add_u32 s35, s35, 2
    v_add_u32 v19, s35, v18
    v_xor_b32 v19, v19, v24
    v_lshl_add_u32 v6, v19, 4, v0
    s_lshl_b32 s35, s31, 3
    s_add_u32 s35, s35, 4
    v_add_u32 v19, s35, v18
    v_xor_b32 v19, v19, v24
    v_lshl_add_u32 v3, v19, 4, v0
    s_lshl_b32 s35, s32, 3
    s_add_u32 s35, s35, 4
    v_add_u32 v19, s35, v18
    v_xor_b32 v19, v19, v24
    v_lshl_add_u32 v7, v19, 4, v0
    s_lshl_b32 s35, s31, 3
    s_add_u32 s35, s35, 6
    v_add_u32 v19, s35, v18
    v_xor_b32 v19, v19, v24
    v_lshl_add_u32 v4, v19, 4, v0
    s_lshl_b32 s35, s32, 3
    s_add_u32 s35, s35, 6
    v_add_u32 v19, s35, v18
    v_xor_b32 v19, v19, v24
    v_lshl_add_u32 v8, v19, 4, v0
    v_add_u32 v5, 16384, v5
    v_add_u32 v6, 16384, v6
    v_add_u32 v7, 16384, v7
    v_add_u32 v8, 16384, v8
    v_mov_b32 v17, 0
    v_mov_b32 v18, 0
    v_mov_b32 v19, 0
    v_mov_b32 v20, 0
    v_mov_b32 v21, 0
    v_mov_b32 v22, 0
    v_mov_b32 v23, 0
    v_mov_b32 v24, 0
    v_mov_b32 v128, 0
    v_mov_b32 v129, 0
    v_mov_b32 v130, 0
    v_mov_b32 v131, 0
    v_mov_b32 v132, 0
    v_mov_b32 v133, 0
    v_mov_b32 v134, 0
    v_mov_b32 v135, 0
    v_mov_b32 v136, 0
    v_mov_b32 v137, 0
    v_mov_b32 v138, 0
    v_mov_b32 v139, 0
    v_mov_b32 v140, 0
    v_mov_b32 v141, 0
    v_mov_b32 v142, 0
    v_mov_b32 v143, 0
    v_mov_b32 v144, 0
    v_mov_b32 v145, 0
    v_mov_b32 v146, 0
    v_mov_b32 v147, 0
    v_mov_b32 v148, 0
    v_mov_b32 v149, 0
    v_mov_b32 v150, 0
    v_mov_b32 v151, 0
    v_mov_b32 v152, 0
    v_mov_b32 v153, 0
    v_mov_b32 v154, 0
    v_mov_b32 v155, 0
    v_mov_b32 v156, 0
    v_mov_b32 v157, 0
    v_mov_b32 v158, 0
    v_mov_b32 v159, 0
    v_mov_b32 v160, 0
    v_mov_b32 v161, 0
    v_mov_b32 v162, 0
    v_mov_b32 v163, 0
    v_mov_b32 v164, 0
    v_mov_b32 v165, 0
    v_mov_b32 v166, 0
    v_mov_b32 v167, 0
    v_mov_b32 v168, 0
    v_mov_b32 v169, 0
    v_mov_b32 v170, 0
    v_mov_b32 v171, 0
    v_mov_b32 v172, 0
    v_mov_b32 v173, 0
    v_mov_b32 v174, 0
    v_mov_b32 v175, 0
    v_mov_b32 v176, 0
    v_mov_b32 v177, 0
    v_mov_b32 v178, 0
    v_mov_b32 v179, 0
    v_mov_b32 v180, 0
    v_mov_b32 v181, 0
    v_mov_b32 v182, 0
    v_mov_b32 v183, 0
    v_mov_b32 v184, 0
    v_mov_b32 v185, 0
    v_mov_b32 v186, 0
    v_mov_b32 v187, 0
    v_mov_b32 v188, 0
    v_mov_b32 v189, 0
    v_mov_b32 v190, 0
    v_mov_b32 v191, 0
    v_mov_b32 v192, 0
    v_mov_b32 v193, 0
    v_mov_b32 v194, 0
    v_mov_b32 v195, 0
    v_mov_b32 v196, 0
    v_mov_b32 v197, 0
    v_mov_b32 v198, 0
    v_mov_b32 v199, 0
    v_mov_b32 v200, 0
    v_mov_b32 v201, 0
    v_mov_b32 v202, 0
    v_mov_b32 v203, 0
    v_mov_b32 v204, 0
    v_mov_b32 v205, 0
    v_mov_b32 v206, 0
    v_mov_b32 v207, 0
    v_mov_b32 v208, 0
    v_mov_b32 v209, 0
    v_mov_b32 v210, 0
    v_mov_b32 v211, 0
    v_mov_b32 v212, 0
    v_mov_b32 v213, 0
    v_mov_b32 v214, 0
    v_mov_b32 v215, 0
    v_mov_b32 v216, 0
    v_mov_b32 v217, 0
    v_mov_b32 v218, 0
    v_mov_b32 v219, 0
    v_mov_b32 v220, 0
    v_mov_b32 v221, 0
    v_mov_b32 v222, 0
    v_mov_b32 v223, 0
    v_mov_b32 v224, 0
    v_mov_b32 v225, 0
    v_mov_b32 v226, 0
    v_mov_b32 v227, 0
    v_mov_b32 v228, 0
    v_mov_b32 v229, 0
    v_mov_b32 v230, 0
    v_mov_b32 v231, 0
    v_mov_b32 v232, 0
    v_mov_b32 v233, 0
    v_mov_b32 v234, 0
    v_mov_b32 v235, 0
    v_mov_b32 v236, 0
    v_mov_b32 v237, 0
    v_mov_b32 v238, 0
    v_mov_b32 v239, 0
    v_mov_b32 v240, 0
    v_mov_b32 v241, 0
    v_mov_b32 v242, 0
    v_mov_b32 v243, 0
    v_mov_b32 v244, 0
    v_mov_b32 v245, 0
    v_mov_b32 v246, 0
    v_mov_b32 v247, 0
    v_mov_b32 v248, 0
    v_mov_b32 v249, 0
    v_mov_b32 v250, 0
    v_mov_b32 v251, 0
    v_mov_b32 v252, 0
    v_mov_b32 v253, 0
    v_mov_b32 v254, 0
    v_mov_b32 v255, 0
    s_mov_b32 s43, 0x3f803f80
    s_mov_b32 s44, 0x3d372713
    s_waitcnt vmcnt(12)
    s_barrier
    s_mov_b32 s40, 524288
    s_mov_b32 s41, 458752
    s_lshl_b32 s42, s30, 12
    s_add_u32 m0, s42, 98304
    s_nop 0
    buffer_load_dwordx4 v9, s[8:11], s40 offen lds
    s_add_u32 m0, s42, 114688
    s_nop 0
    buffer_load_dwordx4 v13, s[12:15], s41 offen lds
    s_add_u32 m0, s42, 131072
    s_nop 0
    buffer_load_dwordx4 v13, s[16:19], s41 offen lds
    s_add_u32 m0, s42, 99328
    s_nop 0
    buffer_load_dwordx4 v10, s[8:11], s40 offen lds
    s_add_u32 m0, s42, 115712
    s_nop 0
    buffer_load_dwordx4 v14, s[12:15], s41 offen lds
    s_add_u32 m0, s42, 132096
    s_nop 0
    buffer_load_dwordx4 v14, s[16:19], s41 offen lds
    s_add_u32 m0, s42, 100352
    s_nop 0
    buffer_load_dwordx4 v11, s[8:11], s40 offen lds
    s_add_u32 m0, s42, 116736
    s_nop 0
    buffer_load_dwordx4 v15, s[12:15], s41 offen lds
    s_add_u32 m0, s42, 133120
    s_nop 0
    buffer_load_dwordx4 v15, s[16:19], s41 offen lds
    s_add_u32 m0, s42, 101376
    s_nop 0
    buffer_load_dwordx4 v12, s[8:11], s40 offen lds
    s_add_u32 m0, s42, 117760
    s_nop 0
    buffer_load_dwordx4 v16, s[12:15], s41 offen lds
    s_add_u32 m0, s42, 134144
    s_nop 0
    buffer_load_dwordx4 v16, s[16:19], s41 offen lds
    ds_read_b64_tr_b16 v[28:29], v1 offset:0
    ds_read_b64_tr_b16 v[30:31], v1 offset:1024
    ds_read_b64_tr_b16 v[32:33], v2 offset:0
    ds_read_b64_tr_b16 v[34:35], v2 offset:1024
    ds_read_b64_tr_b16 v[36:37], v3 offset:0
    ds_read_b64_tr_b16 v[38:39], v3 offset:1024
    ds_read_b64_tr_b16 v[40:41], v4 offset:0
    ds_read_b64_tr_b16 v[42:43], v4 offset:1024
    ds_read_b64_tr_b16 v[44:45], v5 offset:0
    ds_read_b64_tr_b16 v[46:47], v5 offset:1024
    ds_read_b64_tr_b16 v[48:49], v6 offset:0
    ds_read_b64_tr_b16 v[50:51], v6 offset:1024
    ds_read_b64_tr_b16 v[52:53], v7 offset:0
    ds_read_b64_tr_b16 v[54:55], v7 offset:1024
    ds_read_b64_tr_b16 v[56:57], v8 offset:0
    ds_read_b64_tr_b16 v[58:59], v8 offset:1024
    ds_read_b64_tr_b16 v[60:61], v5 offset:16384
    ds_read_b64_tr_b16 v[62:63], v5 offset:17408
    ds_read_b64_tr_b16 v[64:65], v6 offset:16384
    ds_read_b64_tr_b16 v[66:67], v6 offset:17408
    ds_read_b64_tr_b16 v[68:69], v7 offset:16384
    ds_read_b64_tr_b16 v[70:71], v7 offset:17408
    ds_read_b64_tr_b16 v[72:73], v8 offset:16384
    ds_read_b64_tr_b16 v[74:75], v8 offset:17408
    s_waitcnt lgkmcnt(0)
    ds_read_b64_tr_b16 v[76:77], v1 offset:8192
    ds_read_b64_tr_b16 v[78:79], v1 offset:9216
    ds_read_b64_tr_b16 v[80:81], v2 offset:8192
    ds_read_b64_tr_b16 v[82:83], v2 offset:9216
    ds_read_b64_tr_b16 v[84:85], v3 offset:8192
    ds_read_b64_tr_b16 v[86:87], v3 offset:9216
    ds_read_b64_tr_b16 v[88:89], v4 offset:8192
    ds_read_b64_tr_b16 v[90:91], v4 offset:9216
    ds_read_b64_tr_b16 v[92:93], v5 offset:8192
    ds_read_b64_tr_b16 v[94:95], v5 offset:9216
    ds_read_b64_tr_b16 v[96:97], v6 offset:8192
    ds_read_b64_tr_b16 v[98:99], v6 offset:9216
    ds_read_b64_tr_b16 v[100:101], v7 offset:8192
    ds_read_b64_tr_b16 v[102:103], v7 offset:9216
    ds_read_b64_tr_b16 v[104:105], v8 offset:8192
    ds_read_b64_tr_b16 v[106:107], v8 offset:9216
    ds_read_b64_tr_b16 v[108:109], v5 offset:24576
    ds_read_b64_tr_b16 v[110:111], v5 offset:25600
    ds_read_b64_tr_b16 v[112:113], v6 offset:24576
    ds_read_b64_tr_b16 v[114:115], v6 offset:25600
    ds_read_b64_tr_b16 v[116:117], v7 offset:24576
    ds_read_b64_tr_b16 v[118:119], v7 offset:25600
    ds_read_b64_tr_b16 v[120:121], v8 offset:24576
    ds_read_b64_tr_b16 v[122:123], v8 offset:25600
    v_mfma_f32_16x16x32_bf16 v[128:131], v[28:31], v[44:47], v[128:131]
    v_mfma_f32_16x16x32_bf16 v[132:135], v[28:31], v[48:51], v[132:135]
    v_mfma_f32_16x16x32_bf16 v[136:139], v[28:31], v[52:55], v[136:139]
    v_mfma_f32_16x16x32_bf16 v[140:143], v[28:31], v[56:59], v[140:143]
    v_mfma_f32_16x16x32_bf16 v[144:147], v[28:31], v[60:63], v[144:147]
    v_mfma_f32_16x16x32_bf16 v[148:151], v[28:31], v[64:67], v[148:151]
    v_mfma_f32_16x16x32_bf16 v[152:155], v[28:31], v[68:71], v[152:155]
    v_mfma_f32_16x16x32_bf16 v[156:159], v[28:31], v[72:75], v[156:159]
    v_dot2_f32_bf16 v17, v28, s43, v17
    v_dot2_f32_bf16 v21, v28, v28, v21
    v_dot2_f32_bf16 v17, v29, s43, v17
    v_dot2_f32_bf16 v21, v29, v29, v21
    v_dot2_f32_bf16 v17, v30, s43, v17
    v_dot2_f32_bf16 v21, v30, v30, v21
    v_dot2_f32_bf16 v17, v31, s43, v17
    v_dot2_f32_bf16 v21, v31, v31, v21
    v_mfma_f32_16x16x32_bf16 v[160:163], v[32:35], v[44:47], v[160:163]
    v_mfma_f32_16x16x32_bf16 v[164:167], v[32:35], v[48:51], v[164:167]
    v_mfma_f32_16x16x32_bf16 v[168:171], v[32:35], v[52:55], v[168:171]
    v_mfma_f32_16x16x32_bf16 v[172:175], v[32:35], v[56:59], v[172:175]
    v_mfma_f32_16x16x32_bf16 v[176:179], v[32:35], v[60:63], v[176:179]
    v_mfma_f32_16x16x32_bf16 v[180:183], v[32:35], v[64:67], v[180:183]
    v_mfma_f32_16x16x32_bf16 v[184:187], v[32:35], v[68:71], v[184:187]
    v_mfma_f32_16x16x32_bf16 v[188:191], v[32:35], v[72:75], v[188:191]
    v_dot2_f32_bf16 v18, v32, s43, v18
    v_dot2_f32_bf16 v22, v32, v32, v22
    v_dot2_f32_bf16 v18, v33, s43, v18
    v_dot2_f32_bf16 v22, v33, v33, v22
    v_dot2_f32_bf16 v18, v34, s43, v18
    v_dot2_f32_bf16 v22, v34, v34, v22
    v_dot2_f32_bf16 v18, v35, s43, v18
    v_dot2_f32_bf16 v22, v35, v35, v22
    v_mfma_f32_16x16x32_bf16 v[192:195], v[36:39], v[44:47], v[192:195]
    v_mfma_f32_16x16x32_bf16 v[196:199], v[36:39], v[48:51], v[196:199]
    v_mfma_f32_16x16x32_bf16 v[200:203], v[36:39], v[52:55], v[200:203]
    v_mfma_f32_16x16x32_bf16 v[204:207], v[36:39], v[56:59], v[204:207]
    v_mfma_f32_16x16x32_bf16 v[208:211], v[36:39], v[60:63], v[208:211]
    v_mfma_f32_16x16x32_bf16 v[212:215], v[36:39], v[64:67], v[212:215]
    v_mfma_f32_16x16x32_bf16 v[216:219], v[36:39], v[68:71], v[216:219]
    v_mfma_f32_16x16x32_bf16 v[220:223], v[36:39], v[72:75], v[220:223]
    v_dot2_f32_bf16 v19, v36, s43, v19
    v_dot2_f32_bf16 v23, v36, v36, v23
    v_dot2_f32_bf16 v19, v37, s43, v19
    v_dot2_f32_bf16 v23, v37, v37, v23
    v_dot2_f32_bf16 v19, v38, s43, v19
    v_dot2_f32_bf16 v23, v38, v38, v23
    v_dot2_f32_bf16 v19, v39, s43, v19
    v_dot2_f32_bf16 v23, v39, v39, v23
    v_mfma_f32_16x16x32_bf16 v[224:227], v[40:43], v[44:47], v[224:227]
    v_mfma_f32_16x16x32_bf16 v[228:231], v[40:43], v[48:51], v[228:231]
    v_mfma_f32_16x16x32_bf16 v[232:235], v[40:43], v[52:55], v[232:235]
    v_mfma_f32_16x16x32_bf16 v[236:239], v[40:43], v[56:59], v[236:239]
    v_mfma_f32_16x16x32_bf16 v[240:243], v[40:43], v[60:63], v[240:243]
    v_mfma_f32_16x16x32_bf16 v[244:247], v[40:43], v[64:67], v[244:247]
    v_mfma_f32_16x16x32_bf16 v[248:251], v[40:43], v[68:71], v[248:251]
    v_mfma_f32_16x16x32_bf16 v[252:255], v[40:43], v[72:75], v[252:255]
    v_dot2_f32_bf16 v20, v40, s43, v20
    v_dot2_f32_bf16 v24, v40, v40, v24
    v_dot2_f32_bf16 v20, v41, s43, v20
    v_dot2_f32_bf16 v24, v41, v41, v24
    v_dot2_f32_bf16 v20, v42, s43, v20
    v_dot2_f32_bf16 v24, v42, v42, v24
    v_dot2_f32_bf16 v20, v43, s43, v20
    v_dot2_f32_bf16 v24, v43, v43, v24
    s_waitcnt lgkmcnt(0)
    v_mfma_f32_16x16x32_bf16 v[128:131], v[76:79], v[92:95], v[128:131]
    v_mfma_f32_16x16x32_bf16 v[132:135], v[76:79], v[96:99], v[132:135]
    v_mfma_f32_16x16x32_bf16 v[136:139], v[76:79], v[100:103], v[136:139]
    v_mfma_f32_16x16x32_bf16 v[140:143], v[76:79], v[104:107], v[140:143]
    v_mfma_f32_16x16x32_bf16 v[144:147], v[76:79], v[108:111], v[144:147]
    v_mfma_f32_16x16x32_bf16 v[148:151], v[76:79], v[112:115], v[148:151]
    v_mfma_f32_16x16x32_bf16 v[152:155], v[76:79], v[116:119], v[152:155]
    v_mfma_f32_16x16x32_bf16 v[156:159], v[76:79], v[120:123], v[156:159]
    v_dot2_f32_bf16 v17, v76, s43, v17
    v_dot2_f32_bf16 v21, v76, v76, v21
    v_dot2_f32_bf16 v17, v77, s43, v17
    v_dot2_f32_bf16 v21, v77, v77, v21
    v_dot2_f32_bf16 v17, v78, s43, v17
    v_dot2_f32_bf16 v21, v78, v78, v21
    v_dot2_f32_bf16 v17, v79, s43, v17
    v_dot2_f32_bf16 v21, v79, v79, v21
    v_mfma_f32_16x16x32_bf16 v[160:163], v[80:83], v[92:95], v[160:163]
    v_mfma_f32_16x16x32_bf16 v[164:167], v[80:83], v[96:99], v[164:167]
    v_mfma_f32_16x16x32_bf16 v[168:171], v[80:83], v[100:103], v[168:171]
    v_mfma_f32_16x16x32_bf16 v[172:175], v[80:83], v[104:107], v[172:175]
    v_mfma_f32_16x16x32_bf16 v[176:179], v[80:83], v[108:111], v[176:179]
    v_mfma_f32_16x16x32_bf16 v[180:183], v[80:83], v[112:115], v[180:183]
    v_mfma_f32_16x16x32_bf16 v[184:187], v[80:83], v[116:119], v[184:187]
    v_mfma_f32_16x16x32_bf16 v[188:191], v[80:83], v[120:123], v[188:191]
    v_dot2_f32_bf16 v18, v80, s43, v18
    v_dot2_f32_bf16 v22, v80, v80, v22
    v_dot2_f32_bf16 v18, v81, s43, v18
    v_dot2_f32_bf16 v22, v81, v81, v22
    v_dot2_f32_bf16 v18, v82, s43, v18
    v_dot2_f32_bf16 v22, v82, v82, v22
    v_dot2_f32_bf16 v18, v83, s43, v18
    v_dot2_f32_bf16 v22, v83, v83, v22
    v_mfma_f32_16x16x32_bf16 v[192:195], v[84:87], v[92:95], v[192:195]
    v_mfma_f32_16x16x32_bf16 v[196:199], v[84:87], v[96:99], v[196:199]
    v_mfma_f32_16x16x32_bf16 v[200:203], v[84:87], v[100:103], v[200:203]
    v_mfma_f32_16x16x32_bf16 v[204:207], v[84:87], v[104:107], v[204:207]
    v_mfma_f32_16x16x32_bf16 v[208:211], v[84:87], v[108:111], v[208:211]
    v_mfma_f32_16x16x32_bf16 v[212:215], v[84:87], v[112:115], v[212:215]
    v_mfma_f32_16x16x32_bf16 v[216:219], v[84:87], v[116:119], v[216:219]
    v_mfma_f32_16x16x32_bf16 v[220:223], v[84:87], v[120:123], v[220:223]
    v_dot2_f32_bf16 v19, v84, s43, v19
    v_dot2_f32_bf16 v23, v84, v84, v23
    v_dot2_f32_bf16 v19, v85, s43, v19
    v_dot2_f32_bf16 v23, v85, v85, v23
    v_dot2_f32_bf16 v19, v86, s43, v19
    v_dot2_f32_bf16 v23, v86, v86, v23
    v_dot2_f32_bf16 v19, v87, s43, v19
    v_dot2_f32_bf16 v23, v87, v87, v23
    v_mfma_f32_16x16x32_bf16 v[224:227], v[88:91], v[92:95], v[224:227]
    v_mfma_f32_16x16x32_bf16 v[228:231], v[88:91], v[96:99], v[228:231]
    v_mfma_f32_16x16x32_bf16 v[232:235], v[88:91], v[100:103], v[232:235]
    v_mfma_f32_16x16x32_bf16 v[236:239], v[88:91], v[104:107], v[236:239]
    v_mfma_f32_16x16x32_bf16 v[240:243], v[88:91], v[108:111], v[240:243]
    v_mfma_f32_16x16x32_bf16 v[244:247], v[88:91], v[112:115], v[244:247]
    v_mfma_f32_16x16x32_bf16 v[248:251], v[88:91], v[116:119], v[248:251]
    v_mfma_f32_16x16x32_bf16 v[252:255], v[88:91], v[120:123], v[252:255]
    v_dot2_f32_bf16 v20, v88, s43, v20
    v_dot2_f32_bf16 v24, v88, v88, v24
    v_dot2_f32_bf16 v20, v89, s43, v20
    v_dot2_f32_bf16 v24, v89, v89, v24
    v_dot2_f32_bf16 v20, v90, s43, v20
    v_dot2_f32_bf16 v24, v90, v90, v24
    v_dot2_f32_bf16 v20, v91, s43, v20
    v_dot2_f32_bf16 v24, v91, v91, v24
    v_add_u32 v1, 49152, v1
    v_add_u32 v2, 49152, v2
    v_add_u32 v3, 49152, v3
    v_add_u32 v4, 49152, v4
    v_add_u32 v5, 49152, v5
    v_add_u32 v6, 49152, v6
    v_add_u32 v7, 49152, v7
    v_add_u32 v8, 49152, v8
    s_waitcnt vmcnt(12)
    s_barrier
    s_mov_b32 s40, 786432
    s_mov_b32 s41, 688128
    s_lshl_b32 s42, s30, 12
    s_add_u32 m0, s42, 0
    s_nop 0
    buffer_load_dwordx4 v9, s[8:11], s40 offen lds
    s_add_u32 m0, s42, 16384
    s_nop 0
    buffer_load_dwordx4 v13, s[12:15], s41 offen lds
    s_add_u32 m0, s42, 32768
    s_nop 0
    buffer_load_dwordx4 v13, s[16:19], s41 offen lds
    s_add_u32 m0, s42, 1024
    s_nop 0
    buffer_load_dwordx4 v10, s[8:11], s40 offen lds
    s_add_u32 m0, s42, 17408
    s_nop 0
    buffer_load_dwordx4 v14, s[12:15], s41 offen lds
    s_add_u32 m0, s42, 33792
    s_nop 0
    buffer_load_dwordx4 v14, s[16:19], s41 offen lds
    s_add_u32 m0, s42, 2048
    s_nop 0
    buffer_load_dwordx4 v11, s[8:11], s40 offen lds
    s_add_u32 m0, s42, 18432
    s_nop 0
    buffer_load_dwordx4 v15, s[12:15], s41 offen lds
    s_add_u32 m0, s42, 34816
    s_nop 0
    buffer_load_dwordx4 v15, s[16:19], s41 offen lds
    s_add_u32 m0, s42, 3072
    s_nop 0
    buffer_load_dwordx4 v12, s[8:11], s40 offen lds
    s_add_u32 m0, s42, 19456
    s_nop 0
    buffer_load_dwordx4 v16, s[12:15], s41 offen lds
    s_add_u32 m0, s42, 35840
    s_nop 0
    buffer_load_dwordx4 v16, s[16:19], s41 offen lds
    ds_read_b64_tr_b16 v[28:29], v1 offset:0
    ds_read_b64_tr_b16 v[30:31], v1 offset:1024
    ds_read_b64_tr_b16 v[32:33], v2 offset:0
    ds_read_b64_tr_b16 v[34:35], v2 offset:1024
    ds_read_b64_tr_b16 v[36:37], v3 offset:0
    ds_read_b64_tr_b16 v[38:39], v3 offset:1024
    ds_read_b64_tr_b16 v[40:41], v4 offset:0
    ds_read_b64_tr_b16 v[42:43], v4 offset:1024
    ds_read_b64_tr_b16 v[44:45], v5 offset:0
    ds_read_b64_tr_b16 v[46:47], v5 offset:1024
    ds_read_b64_tr_b16 v[48:49], v6 offset:0
    ds_read_b64_tr_b16 v[50:51], v6 offset:1024
    ds_read_b64_tr_b16 v[52:53], v7 offset:0
    ds_read_b64_tr_b16 v[54:55], v7 offset:1024
    ds_read_b64_tr_b16 v[56:57], v8 offset:0
    ds_read_b64_tr_b16 v[58:59], v8 offset:1024
    ds_read_b64_tr_b16 v[60:61], v5 offset:16384
    ds_read_b64_tr_b16 v[62:63], v5 offset:17408
    ds_read_b64_tr_b16 v[64:65], v6 offset:16384
    ds_read_b64_tr_b16 v[66:67], v6 offset:17408
    ds_read_b64_tr_b16 v[68:69], v7 offset:16384
    ds_read_b64_tr_b16 v[70:71], v7 offset:17408
    ds_read_b64_tr_b16 v[72:73], v8 offset:16384
    ds_read_b64_tr_b16 v[74:75], v8 offset:17408
    s_waitcnt lgkmcnt(0)
    ds_read_b64_tr_b16 v[76:77], v1 offset:8192
    ds_read_b64_tr_b16 v[78:79], v1 offset:9216
    ds_read_b64_tr_b16 v[80:81], v2 offset:8192
    ds_read_b64_tr_b16 v[82:83], v2 offset:9216
    ds_read_b64_tr_b16 v[84:85], v3 offset:8192
    ds_read_b64_tr_b16 v[86:87], v3 offset:9216
    ds_read_b64_tr_b16 v[88:89], v4 offset:8192
    ds_read_b64_tr_b16 v[90:91], v4 offset:9216
    ds_read_b64_tr_b16 v[92:93], v5 offset:8192
    ds_read_b64_tr_b16 v[94:95], v5 offset:9216
    ds_read_b64_tr_b16 v[96:97], v6 offset:8192
    ds_read_b64_tr_b16 v[98:99], v6 offset:9216
    ds_read_b64_tr_b16 v[100:101], v7 offset:8192
    ds_read_b64_tr_b16 v[102:103], v7 offset:9216
    ds_read_b64_tr_b16 v[104:105], v8 offset:8192
    ds_read_b64_tr_b16 v[106:107], v8 offset:9216
    ds_read_b64_tr_b16 v[108:109], v5 offset:24576
    ds_read_b64_tr_b16 v[110:111], v5 offset:25600
    ds_read_b64_tr_b16 v[112:113], v6 offset:24576
    ds_read_b64_tr_b16 v[114:115], v6 offset:25600
    ds_read_b64_tr_b16 v[116:117], v7 offset:24576
    ds_read_b64_tr_b16 v[118:119], v7 offset:25600
    ds_read_b64_tr_b16 v[120:121], v8 offset:24576
    ds_read_b64_tr_b16 v[122:123], v8 offset:25600
    v_mfma_f32_16x16x32_bf16 v[128:131], v[28:31], v[44:47], v[128:131]
    v_mfma_f32_16x16x32_bf16 v[132:135], v[28:31], v[48:51], v[132:135]
    v_mfma_f32_16x16x32_bf16 v[136:139], v[28:31], v[52:55], v[136:139]
    v_mfma_f32_16x16x32_bf16 v[140:143], v[28:31], v[56:59], v[140:143]
    v_mfma_f32_16x16x32_bf16 v[144:147], v[28:31], v[60:63], v[144:147]
    v_mfma_f32_16x16x32_bf16 v[148:151], v[28:31], v[64:67], v[148:151]
    v_mfma_f32_16x16x32_bf16 v[152:155], v[28:31], v[68:71], v[152:155]
    v_mfma_f32_16x16x32_bf16 v[156:159], v[28:31], v[72:75], v[156:159]
    v_dot2_f32_bf16 v17, v28, s43, v17
    v_dot2_f32_bf16 v21, v28, v28, v21
    v_dot2_f32_bf16 v17, v29, s43, v17
    v_dot2_f32_bf16 v21, v29, v29, v21
    v_dot2_f32_bf16 v17, v30, s43, v17
    v_dot2_f32_bf16 v21, v30, v30, v21
    v_dot2_f32_bf16 v17, v31, s43, v17
    v_dot2_f32_bf16 v21, v31, v31, v21
    v_mfma_f32_16x16x32_bf16 v[160:163], v[32:35], v[44:47], v[160:163]
    v_mfma_f32_16x16x32_bf16 v[164:167], v[32:35], v[48:51], v[164:167]
    v_mfma_f32_16x16x32_bf16 v[168:171], v[32:35], v[52:55], v[168:171]
    v_mfma_f32_16x16x32_bf16 v[172:175], v[32:35], v[56:59], v[172:175]
    v_mfma_f32_16x16x32_bf16 v[176:179], v[32:35], v[60:63], v[176:179]
    v_mfma_f32_16x16x32_bf16 v[180:183], v[32:35], v[64:67], v[180:183]
    v_mfma_f32_16x16x32_bf16 v[184:187], v[32:35], v[68:71], v[184:187]
    v_mfma_f32_16x16x32_bf16 v[188:191], v[32:35], v[72:75], v[188:191]
    v_dot2_f32_bf16 v18, v32, s43, v18
    v_dot2_f32_bf16 v22, v32, v32, v22
    v_dot2_f32_bf16 v18, v33, s43, v18
    v_dot2_f32_bf16 v22, v33, v33, v22
    v_dot2_f32_bf16 v18, v34, s43, v18
    v_dot2_f32_bf16 v22, v34, v34, v22
    v_dot2_f32_bf16 v18, v35, s43, v18
    v_dot2_f32_bf16 v22, v35, v35, v22
    v_mfma_f32_16x16x32_bf16 v[192:195], v[36:39], v[44:47], v[192:195]
    v_mfma_f32_16x16x32_bf16 v[196:199], v[36:39], v[48:51], v[196:199]
    v_mfma_f32_16x16x32_bf16 v[200:203], v[36:39], v[52:55], v[200:203]
    v_mfma_f32_16x16x32_bf16 v[204:207], v[36:39], v[56:59], v[204:207]
    v_mfma_f32_16x16x32_bf16 v[208:211], v[36:39], v[60:63], v[208:211]
    v_mfma_f32_16x16x32_bf16 v[212:215], v[36:39], v[64:67], v[212:215]
    v_mfma_f32_16x16x32_bf16 v[216:219], v[36:39], v[68:71], v[216:219]
    v_mfma_f32_16x16x32_bf16 v[220:223], v[36:39], v[72:75], v[220:223]
    v_dot2_f32_bf16 v19, v36, s43, v19
    v_dot2_f32_bf16 v23, v36, v36, v23
    v_dot2_f32_bf16 v19, v37, s43, v19
    v_dot2_f32_bf16 v23, v37, v37, v23
    v_dot2_f32_bf16 v19, v38, s43, v19
    v_dot2_f32_bf16 v23, v38, v38, v23
    v_dot2_f32_bf16 v19, v39, s43, v19
    v_dot2_f32_bf16 v23, v39, v39, v23
    v_mfma_f32_16x16x32_bf16 v[224:227], v[40:43], v[44:47], v[224:227]
    v_mfma_f32_16x16x32_bf16 v[228:231], v[40:43], v[48:51], v[228:231]
    v_mfma_f32_16x16x32_bf16 v[232:235], v[40:43], v[52:55], v[232:235]
    v_mfma_f32_16x16x32_bf16 v[236:239], v[40:43], v[56:59], v[236:239]
    v_mfma_f32_16x16x32_bf16 v[240:243], v[40:43], v[60:63], v[240:243]
    v_mfma_f32_16x16x32_bf16 v[244:247], v[40:43], v[64:67], v[244:247]
    v_mfma_f32_16x16x32_bf16 v[248:251], v[40:43], v[68:71], v[248:251]
    v_mfma_f32_16x16x32_bf16 v[252:255], v[40:43], v[72:75], v[252:255]
    v_dot2_f32_bf16 v20, v40, s43, v20
    v_dot2_f32_bf16 v24, v40, v40, v24
    v_dot2_f32_bf16 v20, v41, s43, v20
    v_dot2_f32_bf16 v24, v41, v41, v24
    v_dot2_f32_bf16 v20, v42, s43, v20
    v_dot2_f32_bf16 v24, v42, v42, v24
    v_dot2_f32_bf16 v20, v43, s43, v20
    v_dot2_f32_bf16 v24, v43, v43, v24
    s_waitcnt lgkmcnt(0)
    v_mfma_f32_16x16x32_bf16 v[128:131], v[76:79], v[92:95], v[128:131]
    v_mfma_f32_16x16x32_bf16 v[132:135], v[76:79], v[96:99], v[132:135]
    v_mfma_f32_16x16x32_bf16 v[136:139], v[76:79], v[100:103], v[136:139]
    v_mfma_f32_16x16x32_bf16 v[140:143], v[76:79], v[104:107], v[140:143]
    v_mfma_f32_16x16x32_bf16 v[144:147], v[76:79], v[108:111], v[144:147]
    v_mfma_f32_16x16x32_bf16 v[148:151], v[76:79], v[112:115], v[148:151]
    v_mfma_f32_16x16x32_bf16 v[152:155], v[76:79], v[116:119], v[152:155]
    v_mfma_f32_16x16x32_bf16 v[156:159], v[76:79], v[120:123], v[156:159]
    v_dot2_f32_bf16 v17, v76, s43, v17
    v_dot2_f32_bf16 v21, v76, v76, v21
    v_dot2_f32_bf16 v17, v77, s43, v17
    v_dot2_f32_bf16 v21, v77, v77, v21
    v_dot2_f32_bf16 v17, v78, s43, v17
    v_dot2_f32_bf16 v21, v78, v78, v21
    v_dot2_f32_bf16 v17, v79, s43, v17
    v_dot2_f32_bf16 v21, v79, v79, v21
    v_mfma_f32_16x16x32_bf16 v[160:163], v[80:83], v[92:95], v[160:163]
    v_mfma_f32_16x16x32_bf16 v[164:167], v[80:83], v[96:99], v[164:167]
    v_mfma_f32_16x16x32_bf16 v[168:171], v[80:83], v[100:103], v[168:171]
    v_mfma_f32_16x16x32_bf16 v[172:175], v[80:83], v[104:107], v[172:175]
    v_mfma_f32_16x16x32_bf16 v[176:179], v[80:83], v[108:111], v[176:179]
    v_mfma_f32_16x16x32_bf16 v[180:183], v[80:83], v[112:115], v[180:183]
    v_mfma_f32_16x16x32_bf16 v[184:187], v[80:83], v[116:119], v[184:187]
    v_mfma_f32_16x16x32_bf16 v[188:191], v[80:83], v[120:123], v[188:191]
    v_dot2_f32_bf16 v18, v80, s43, v18
    v_dot2_f32_bf16 v22, v80, v80, v22
    v_dot2_f32_bf16 v18, v81, s43, v18
    v_dot2_f32_bf16 v22, v81, v81, v22
    v_dot2_f32_bf16 v18, v82, s43, v18
    v_dot2_f32_bf16 v22, v82, v82, v22
    v_dot2_f32_bf16 v18, v83, s43, v18
    v_dot2_f32_bf16 v22, v83, v83, v22
    v_mfma_f32_16x16x32_bf16 v[192:195], v[84:87], v[92:95], v[192:195]
    v_mfma_f32_16x16x32_bf16 v[196:199], v[84:87], v[96:99], v[196:199]
    v_mfma_f32_16x16x32_bf16 v[200:203], v[84:87], v[100:103], v[200:203]
    v_mfma_f32_16x16x32_bf16 v[204:207], v[84:87], v[104:107], v[204:207]
    v_mfma_f32_16x16x32_bf16 v[208:211], v[84:87], v[108:111], v[208:211]
    v_mfma_f32_16x16x32_bf16 v[212:215], v[84:87], v[112:115], v[212:215]
    v_mfma_f32_16x16x32_bf16 v[216:219], v[84:87], v[116:119], v[216:219]
    v_mfma_f32_16x16x32_bf16 v[220:223], v[84:87], v[120:123], v[220:223]
    v_dot2_f32_bf16 v19, v84, s43, v19
    v_dot2_f32_bf16 v23, v84, v84, v23
    v_dot2_f32_bf16 v19, v85, s43, v19
    v_dot2_f32_bf16 v23, v85, v85, v23
    v_dot2_f32_bf16 v19, v86, s43, v19
    v_dot2_f32_bf16 v23, v86, v86, v23
    v_dot2_f32_bf16 v19, v87, s43, v19
    v_dot2_f32_bf16 v23, v87, v87, v23
    v_mfma_f32_16x16x32_bf16 v[224:227], v[88:91], v[92:95], v[224:227]
    v_mfma_f32_16x16x32_bf16 v[228:231], v[88:91], v[96:99], v[228:231]
    v_mfma_f32_16x16x32_bf16 v[232:235], v[88:91], v[100:103], v[232:235]
    v_mfma_f32_16x16x32_bf16 v[236:239], v[88:91], v[104:107], v[236:239]
    v_mfma_f32_16x16x32_bf16 v[240:243], v[88:91], v[108:111], v[240:243]
    v_mfma_f32_16x16x32_bf16 v[244:247], v[88:91], v[112:115], v[244:247]
    v_mfma_f32_16x16x32_bf16 v[248:251], v[88:91], v[116:119], v[248:251]
    v_mfma_f32_16x16x32_bf16 v[252:255], v[88:91], v[120:123], v[252:255]
    v_dot2_f32_bf16 v20, v88, s43, v20
    v_dot2_f32_bf16 v24, v88, v88, v24
    v_dot2_f32_bf16 v20, v89, s43, v20
    v_dot2_f32_bf16 v24, v89, v89, v24
    v_dot2_f32_bf16 v20, v90, s43, v20
    v_dot2_f32_bf16 v24, v90, v90, v24
    v_dot2_f32_bf16 v20, v91, s43, v20
    v_dot2_f32_bf16 v24, v91, v91, v24
    v_add_u32 v1, 49152, v1
    v_add_u32 v2, 49152, v2
    v_add_u32 v3, 49152, v3
    v_add_u32 v4, 49152, v4
    v_add_u32 v5, 49152, v5
    v_add_u32 v6, 49152, v6
    v_add_u32 v7, 49152, v7
    v_add_u32 v8, 49152, v8
    s_waitcnt vmcnt(12)
    s_barrier
    s_mov_b32 s40, 1048576
    s_mov_b32 s41, 917504
    s_lshl_b32 s42, s30, 12
    s_add_u32 m0, s42, 49152
    s_nop 0
    buffer_load_dwordx4 v9, s[8:11], s40 offen lds
    s_add_u32 m0, s42, 65536
    s_nop 0
    buffer_load_dwordx4 v13, s[12:15], s41 offen lds
    s_add_u32 m0, s42, 81920
    s_nop 0
    buffer_load_dwordx4 v13, s[16:19], s41 offen lds
    s_add_u32 m0, s42, 50176
    s_nop 0
    buffer_load_dwordx4 v10, s[8:11], s40 offen lds
    s_add_u32 m0, s42, 66560
    s_nop 0
    buffer_load_dwordx4 v14, s[12:15], s41 offen lds
    s_add_u32 m0, s42, 82944
    s_nop 0
    buffer_load_dwordx4 v14, s[16:19], s41 offen lds
    s_add_u32 m0, s42, 51200
    s_nop 0
    buffer_load_dwordx4 v11, s[8:11], s40 offen lds
    s_add_u32 m0, s42, 67584
    s_nop 0
    buffer_load_dwordx4 v15, s[12:15], s41 offen lds
    s_add_u32 m0, s42, 83968
    s_nop 0
    buffer_load_dwordx4 v15, s[16:19], s41 offen lds
    s_add_u32 m0, s42, 52224
    s_nop 0
    buffer_load_dwordx4 v12, s[8:11], s40 offen lds
    s_add_u32 m0, s42, 68608
    s_nop 0
    buffer_load_dwordx4 v16, s[12:15], s41 offen lds
    s_add_u32 m0, s42, 84992
    s_nop 0
    buffer_load_dwordx4 v16, s[16:19], s41 offen lds
    ds_read_b64_tr_b16 v[28:29], v1 offset:0
    ds_read_b64_tr_b16 v[30:31], v1 offset:1024
    ds_read_b64_tr_b16 v[32:33], v2 offset:0
    ds_read_b64_tr_b16 v[34:35], v2 offset:1024
    ds_read_b64_tr_b16 v[36:37], v3 offset:0
    ds_read_b64_tr_b16 v[38:39], v3 offset:1024
    ds_read_b64_tr_b16 v[40:41], v4 offset:0
    ds_read_b64_tr_b16 v[42:43], v4 offset:1024
    ds_read_b64_tr_b16 v[44:45], v5 offset:0
    ds_read_b64_tr_b16 v[46:47], v5 offset:1024
    ds_read_b64_tr_b16 v[48:49], v6 offset:0
    ds_read_b64_tr_b16 v[50:51], v6 offset:1024
    ds_read_b64_tr_b16 v[52:53], v7 offset:0
    ds_read_b64_tr_b16 v[54:55], v7 offset:1024
    ds_read_b64_tr_b16 v[56:57], v8 offset:0
    ds_read_b64_tr_b16 v[58:59], v8 offset:1024
    ds_read_b64_tr_b16 v[60:61], v5 offset:16384
    ds_read_b64_tr_b16 v[62:63], v5 offset:17408
    ds_read_b64_tr_b16 v[64:65], v6 offset:16384
    ds_read_b64_tr_b16 v[66:67], v6 offset:17408
    ds_read_b64_tr_b16 v[68:69], v7 offset:16384
    ds_read_b64_tr_b16 v[70:71], v7 offset:17408
    ds_read_b64_tr_b16 v[72:73], v8 offset:16384
    ds_read_b64_tr_b16 v[74:75], v8 offset:17408
    s_waitcnt lgkmcnt(0)
    ds_read_b64_tr_b16 v[76:77], v1 offset:8192
    ds_read_b64_tr_b16 v[78:79], v1 offset:9216
    ds_read_b64_tr_b16 v[80:81], v2 offset:8192
    ds_read_b64_tr_b16 v[82:83], v2 offset:9216
    ds_read_b64_tr_b16 v[84:85], v3 offset:8192
    ds_read_b64_tr_b16 v[86:87], v3 offset:9216
    ds_read_b64_tr_b16 v[88:89], v4 offset:8192
    ds_read_b64_tr_b16 v[90:91], v4 offset:9216
    ds_read_b64_tr_b16 v[92:93], v5 offset:8192
    ds_read_b64_tr_b16 v[94:95], v5 offset:9216
    ds_read_b64_tr_b16 v[96:97], v6 offset:8192
    ds_read_b64_tr_b16 v[98:99], v6 offset:9216
    ds_read_b64_tr_b16 v[100:101], v7 offset:8192
    ds_read_b64_tr_b16 v[102:103], v7 offset:9216
    ds_read_b64_tr_b16 v[104:105], v8 offset:8192
    ds_read_b64_tr_b16 v[106:107], v8 offset:9216
    ds_read_b64_tr_b16 v[108:109], v5 offset:24576
    ds_read_b64_tr_b16 v[110:111], v5 offset:25600
    ds_read_b64_tr_b16 v[112:113], v6 offset:24576
    ds_read_b64_tr_b16 v[114:115], v6 offset:25600
    ds_read_b64_tr_b16 v[116:117], v7 offset:24576
    ds_read_b64_tr_b16 v[118:119], v7 offset:25600
    ds_read_b64_tr_b16 v[120:121], v8 offset:24576
    ds_read_b64_tr_b16 v[122:123], v8 offset:25600
    v_mfma_f32_16x16x32_bf16 v[128:131], v[28:31], v[44:47], v[128:131]
    v_mfma_f32_16x16x32_bf16 v[132:135], v[28:31], v[48:51], v[132:135]
    v_mfma_f32_16x16x32_bf16 v[136:139], v[28:31], v[52:55], v[136:139]
    v_mfma_f32_16x16x32_bf16 v[140:143], v[28:31], v[56:59], v[140:143]
    v_mfma_f32_16x16x32_bf16 v[144:147], v[28:31], v[60:63], v[144:147]
    v_mfma_f32_16x16x32_bf16 v[148:151], v[28:31], v[64:67], v[148:151]
    v_mfma_f32_16x16x32_bf16 v[152:155], v[28:31], v[68:71], v[152:155]
    v_mfma_f32_16x16x32_bf16 v[156:159], v[28:31], v[72:75], v[156:159]
    v_dot2_f32_bf16 v17, v28, s43, v17
    v_dot2_f32_bf16 v21, v28, v28, v21
    v_dot2_f32_bf16 v17, v29, s43, v17
    v_dot2_f32_bf16 v21, v29, v29, v21
    v_dot2_f32_bf16 v17, v30, s43, v17
    v_dot2_f32_bf16 v21, v30, v30, v21
    v_dot2_f32_bf16 v17, v31, s43, v17
    v_dot2_f32_bf16 v21, v31, v31, v21
    v_mfma_f32_16x16x32_bf16 v[160:163], v[32:35], v[44:47], v[160:163]
    v_mfma_f32_16x16x32_bf16 v[164:167], v[32:35], v[48:51], v[164:167]
    v_mfma_f32_16x16x32_bf16 v[168:171], v[32:35], v[52:55], v[168:171]
    v_mfma_f32_16x16x32_bf16 v[172:175], v[32:35], v[56:59], v[172:175]
    v_mfma_f32_16x16x32_bf16 v[176:179], v[32:35], v[60:63], v[176:179]
    v_mfma_f32_16x16x32_bf16 v[180:183], v[32:35], v[64:67], v[180:183]
    v_mfma_f32_16x16x32_bf16 v[184:187], v[32:35], v[68:71], v[184:187]
    v_mfma_f32_16x16x32_bf16 v[188:191], v[32:35], v[72:75], v[188:191]
    v_dot2_f32_bf16 v18, v32, s43, v18
    v_dot2_f32_bf16 v22, v32, v32, v22
    v_dot2_f32_bf16 v18, v33, s43, v18
    v_dot2_f32_bf16 v22, v33, v33, v22
    v_dot2_f32_bf16 v18, v34, s43, v18
    v_dot2_f32_bf16 v22, v34, v34, v22
    v_dot2_f32_bf16 v18, v35, s43, v18
    v_dot2_f32_bf16 v22, v35, v35, v22
    v_mfma_f32_16x16x32_bf16 v[192:195], v[36:39], v[44:47], v[192:195]
    v_mfma_f32_16x16x32_bf16 v[196:199], v[36:39], v[48:51], v[196:199]
    v_mfma_f32_16x16x32_bf16 v[200:203], v[36:39], v[52:55], v[200:203]
    v_mfma_f32_16x16x32_bf16 v[204:207], v[36:39], v[56:59], v[204:207]
    v_mfma_f32_16x16x32_bf16 v[208:211], v[36:39], v[60:63], v[208:211]
    v_mfma_f32_16x16x32_bf16 v[212:215], v[36:39], v[64:67], v[212:215]
    v_mfma_f32_16x16x32_bf16 v[216:219], v[36:39], v[68:71], v[216:219]
    v_mfma_f32_16x16x32_bf16 v[220:223], v[36:39], v[72:75], v[220:223]
    v_dot2_f32_bf16 v19, v36, s43, v19
    v_dot2_f32_bf16 v23, v36, v36, v23
    v_dot2_f32_bf16 v19, v37, s43, v19
    v_dot2_f32_bf16 v23, v37, v37, v23
    v_dot2_f32_bf16 v19, v38, s43, v19
    v_dot2_f32_bf16 v23, v38, v38, v23
    v_dot2_f32_bf16 v19, v39, s43, v19
    v_dot2_f32_bf16 v23, v39, v39, v23
    v_mfma_f32_16x16x32_bf16 v[224:227], v[40:43], v[44:47], v[224:227]
    v_mfma_f32_16x16x32_bf16 v[228:231], v[40:43], v[48:51], v[228:231]
    v_mfma_f32_16x16x32_bf16 v[232:235], v[40:43], v[52:55], v[232:235]
    v_mfma_f32_16x16x32_bf16 v[236:239], v[40:43], v[56:59], v[236:239]
    v_mfma_f32_16x16x32_bf16 v[240:243], v[40:43], v[60:63], v[240:243]
    v_mfma_f32_16x16x32_bf16 v[244:247], v[40:43], v[64:67], v[244:247]
    v_mfma_f32_16x16x32_bf16 v[248:251], v[40:43], v[68:71], v[248:251]
    v_mfma_f32_16x16x32_bf16 v[252:255], v[40:43], v[72:75], v[252:255]
    v_dot2_f32_bf16 v20, v40, s43, v20
    v_dot2_f32_bf16 v24, v40, v40, v24
    v_dot2_f32_bf16 v20, v41, s43, v20
    v_dot2_f32_bf16 v24, v41, v41, v24
    v_dot2_f32_bf16 v20, v42, s43, v20
    v_dot2_f32_bf16 v24, v42, v42, v24
    v_dot2_f32_bf16 v20, v43, s43, v20
    v_dot2_f32_bf16 v24, v43, v43, v24
    s_waitcnt lgkmcnt(0)
    v_mfma_f32_16x16x32_bf16 v[128:131], v[76:79], v[92:95], v[128:131]
    v_mfma_f32_16x16x32_bf16 v[132:135], v[76:79], v[96:99], v[132:135]
    v_mfma_f32_16x16x32_bf16 v[136:139], v[76:79], v[100:103], v[136:139]
    v_mfma_f32_16x16x32_bf16 v[140:143], v[76:79], v[104:107], v[140:143]
    v_mfma_f32_16x16x32_bf16 v[144:147], v[76:79], v[108:111], v[144:147]
    v_mfma_f32_16x16x32_bf16 v[148:151], v[76:79], v[112:115], v[148:151]
    v_mfma_f32_16x16x32_bf16 v[152:155], v[76:79], v[116:119], v[152:155]
    v_mfma_f32_16x16x32_bf16 v[156:159], v[76:79], v[120:123], v[156:159]
    v_dot2_f32_bf16 v17, v76, s43, v17
    v_dot2_f32_bf16 v21, v76, v76, v21
    v_dot2_f32_bf16 v17, v77, s43, v17
    v_dot2_f32_bf16 v21, v77, v77, v21
    v_dot2_f32_bf16 v17, v78, s43, v17
    v_dot2_f32_bf16 v21, v78, v78, v21
    v_dot2_f32_bf16 v17, v79, s43, v17
    v_dot2_f32_bf16 v21, v79, v79, v21
    v_mfma_f32_16x16x32_bf16 v[160:163], v[80:83], v[92:95], v[160:163]
    v_mfma_f32_16x16x32_bf16 v[164:167], v[80:83], v[96:99], v[164:167]
    v_mfma_f32_16x16x32_bf16 v[168:171], v[80:83], v[100:103], v[168:171]
    v_mfma_f32_16x16x32_bf16 v[172:175], v[80:83], v[104:107], v[172:175]
    v_mfma_f32_16x16x32_bf16 v[176:179], v[80:83], v[108:111], v[176:179]
    v_mfma_f32_16x16x32_bf16 v[180:183], v[80:83], v[112:115], v[180:183]
    v_mfma_f32_16x16x32_bf16 v[184:187], v[80:83], v[116:119], v[184:187]
    v_mfma_f32_16x16x32_bf16 v[188:191], v[80:83], v[120:123], v[188:191]
    v_dot2_f32_bf16 v18, v80, s43, v18
    v_dot2_f32_bf16 v22, v80, v80, v22
    v_dot2_f32_bf16 v18, v81, s43, v18
    v_dot2_f32_bf16 v22, v81, v81, v22
    v_dot2_f32_bf16 v18, v82, s43, v18
    v_dot2_f32_bf16 v22, v82, v82, v22
    v_dot2_f32_bf16 v18, v83, s43, v18
    v_dot2_f32_bf16 v22, v83, v83, v22
    v_mfma_f32_16x16x32_bf16 v[192:195], v[84:87], v[92:95], v[192:195]
    v_mfma_f32_16x16x32_bf16 v[196:199], v[84:87], v[96:99], v[196:199]
    v_mfma_f32_16x16x32_bf16 v[200:203], v[84:87], v[100:103], v[200:203]
    v_mfma_f32_16x16x32_bf16 v[204:207], v[84:87], v[104:107], v[204:207]
    v_mfma_f32_16x16x32_bf16 v[208:211], v[84:87], v[108:111], v[208:211]
    v_mfma_f32_16x16x32_bf16 v[212:215], v[84:87], v[112:115], v[212:215]
    v_mfma_f32_16x16x32_bf16 v[216:219], v[84:87], v[116:119], v[216:219]
    v_mfma_f32_16x16x32_bf16 v[220:223], v[84:87], v[120:123], v[220:223]
    v_dot2_f32_bf16 v19, v84, s43, v19
    v_dot2_f32_bf16 v23, v84, v84, v23
    v_dot2_f32_bf16 v19, v85, s43, v19
    v_dot2_f32_bf16 v23, v85, v85, v23
    v_dot2_f32_bf16 v19, v86, s43, v19
    v_dot2_f32_bf16 v23, v86, v86, v23
    v_dot2_f32_bf16 v19, v87, s43, v19
    v_dot2_f32_bf16 v23, v87, v87, v23
    v_mfma_f32_16x16x32_bf16 v[224:227], v[88:91], v[92:95], v[224:227]
    v_mfma_f32_16x16x32_bf16 v[228:231], v[88:91], v[96:99], v[228:231]
    v_mfma_f32_16x16x32_bf16 v[232:235], v[88:91], v[100:103], v[232:235]
    v_mfma_f32_16x16x32_bf16 v[236:239], v[88:91], v[104:107], v[236:239]
    v_mfma_f32_16x16x32_bf16 v[240:243], v[88:91], v[108:111], v[240:243]
    v_mfma_f32_16x16x32_bf16 v[244:247], v[88:91], v[112:115], v[244:247]
    v_mfma_f32_16x16x32_bf16 v[248:251], v[88:91], v[116:119], v[248:251]
    v_mfma_f32_16x16x32_bf16 v[252:255], v[88:91], v[120:123], v[252:255]
    v_dot2_f32_bf16 v20, v88, s43, v20
    v_dot2_f32_bf16 v24, v88, v88, v24
    v_dot2_f32_bf16 v20, v89, s43, v20
    v_dot2_f32_bf16 v24, v89, v89, v24
    v_dot2_f32_bf16 v20, v90, s43, v20
    v_dot2_f32_bf16 v24, v90, v90, v24
    v_dot2_f32_bf16 v20, v91, s43, v20
    v_dot2_f32_bf16 v24, v91, v91, v24
    v_add_u32 v1, -98304, v1
    v_add_u32 v2, -98304, v2
    v_add_u32 v3, -98304, v3
    v_add_u32 v4, -98304, v4
    v_add_u32 v5, -98304, v5
    v_add_u32 v6, -98304, v6
    v_add_u32 v7, -98304, v7
    v_add_u32 v8, -98304, v8
    s_waitcnt vmcnt(12)
    s_barrier
    s_mov_b32 s40, 1310720
    s_mov_b32 s41, 1146880
    s_lshl_b32 s42, s30, 12
    s_add_u32 m0, s42, 98304
    s_nop 0
    buffer_load_dwordx4 v9, s[8:11], s40 offen lds
    s_add_u32 m0, s42, 114688
    s_nop 0
    buffer_load_dwordx4 v13, s[12:15], s41 offen lds
    s_add_u32 m0, s42, 131072
    s_nop 0
    buffer_load_dwordx4 v13, s[16:19], s41 offen lds
    s_add_u32 m0, s42, 99328
    s_nop 0
    buffer_load_dwordx4 v10, s[8:11], s40 offen lds
    s_add_u32 m0, s42, 115712
    s_nop 0
    buffer_load_dwordx4 v14, s[12:15], s41 offen lds
    s_add_u32 m0, s42, 132096
    s_nop 0
    buffer_load_dwordx4 v14, s[16:19], s41 offen lds
    s_add_u32 m0, s42, 100352
    s_nop 0
    buffer_load_dwordx4 v11, s[8:11], s40 offen lds
    s_add_u32 m0, s42, 116736
    s_nop 0
    buffer_load_dwordx4 v15, s[12:15], s41 offen lds
    s_add_u32 m0, s42, 133120
    s_nop 0
    buffer_load_dwordx4 v15, s[16:19], s41 offen lds
    s_add_u32 m0, s42, 101376
    s_nop 0
    buffer_load_dwordx4 v12, s[8:11], s40 offen lds
    s_add_u32 m0, s42, 117760
    s_nop 0
    buffer_load_dwordx4 v16, s[12:15], s41 offen lds
    s_add_u32 m0, s42, 134144
    s_nop 0
    buffer_load_dwordx4 v16, s[16:19], s41 offen lds
    ds_read_b64_tr_b16 v[28:29], v1 offset:0
    ds_read_b64_tr_b16 v[30:31], v1 offset:1024
    ds_read_b64_tr_b16 v[32:33], v2 offset:0
    ds_read_b64_tr_b16 v[34:35], v2 offset:1024
    ds_read_b64_tr_b16 v[36:37], v3 offset:0
    ds_read_b64_tr_b16 v[38:39], v3 offset:1024
    ds_read_b64_tr_b16 v[40:41], v4 offset:0
    ds_read_b64_tr_b16 v[42:43], v4 offset:1024
    ds_read_b64_tr_b16 v[44:45], v5 offset:0
    ds_read_b64_tr_b16 v[46:47], v5 offset:1024
    ds_read_b64_tr_b16 v[48:49], v6 offset:0
    ds_read_b64_tr_b16 v[50:51], v6 offset:1024
    ds_read_b64_tr_b16 v[52:53], v7 offset:0
    ds_read_b64_tr_b16 v[54:55], v7 offset:1024
    ds_read_b64_tr_b16 v[56:57], v8 offset:0
    ds_read_b64_tr_b16 v[58:59], v8 offset:1024
    ds_read_b64_tr_b16 v[60:61], v5 offset:16384
    ds_read_b64_tr_b16 v[62:63], v5 offset:17408
    ds_read_b64_tr_b16 v[64:65], v6 offset:16384
    ds_read_b64_tr_b16 v[66:67], v6 offset:17408
    ds_read_b64_tr_b16 v[68:69], v7 offset:16384
    ds_read_b64_tr_b16 v[70:71], v7 offset:17408
    ds_read_b64_tr_b16 v[72:73], v8 offset:16384
    ds_read_b64_tr_b16 v[74:75], v8 offset:17408
    s_waitcnt lgkmcnt(0)
    ds_read_b64_tr_b16 v[76:77], v1 offset:8192
    ds_read_b64_tr_b16 v[78:79], v1 offset:9216
    ds_read_b64_tr_b16 v[80:81], v2 offset:8192
    ds_read_b64_tr_b16 v[82:83], v2 offset:9216
    ds_read_b64_tr_b16 v[84:85], v3 offset:8192
    ds_read_b64_tr_b16 v[86:87], v3 offset:9216
    ds_read_b64_tr_b16 v[88:89], v4 offset:8192
    ds_read_b64_tr_b16 v[90:91], v4 offset:9216
    ds_read_b64_tr_b16 v[92:93], v5 offset:8192
    ds_read_b64_tr_b16 v[94:95], v5 offset:9216
    ds_read_b64_tr_b16 v[96:97], v6 offset:8192
    ds_read_b64_tr_b16 v[98:99], v6 offset:9216
    ds_read_b64_tr_b16 v[100:101], v7 offset:8192
    ds_read_b64_tr_b16 v[102:103], v7 offset:9216
    ds_read_b64_tr_b16 v[104:105], v8 offset:8192
    ds_read_b64_tr_b16 v[106:107], v8 offset:9216
    ds_read_b64_tr_b16 v[108:109], v5 offset:24576
    ds_read_b64_tr_b16 v[110:111], v5 offset:25600
    ds_read_b64_tr_b16 v[112:113], v6 offset:24576
    ds_read_b64_tr_b16 v[114:115], v6 offset:25600
    ds_read_b64_tr_b16 v[116:117], v7 offset:24576
    ds_read_b64_tr_b16 v[118:119], v7 offset:25600
    ds_read_b64_tr_b16 v[120:121], v8 offset:24576
    ds_read_b64_tr_b16 v[122:123], v8 offset:25600
    v_mfma_f32_16x16x32_bf16 v[128:131], v[28:31], v[44:47], v[128:131]
    v_mfma_f32_16x16x32_bf16 v[132:135], v[28:31], v[48:51], v[132:135]
    v_mfma_f32_16x16x32_bf16 v[136:139], v[28:31], v[52:55], v[136:139]
    v_mfma_f32_16x16x32_bf16 v[140:143], v[28:31], v[56:59], v[140:143]
    v_mfma_f32_16x16x32_bf16 v[144:147], v[28:31], v[60:63], v[144:147]
    v_mfma_f32_16x16x32_bf16 v[148:151], v[28:31], v[64:67], v[148:151]
    v_mfma_f32_16x16x32_bf16 v[152:155], v[28:31], v[68:71], v[152:155]
    v_mfma_f32_16x16x32_bf16 v[156:159], v[28:31], v[72:75], v[156:159]
    v_dot2_f32_bf16 v17, v28, s43, v17
    v_dot2_f32_bf16 v21, v28, v28, v21
    v_dot2_f32_bf16 v17, v29, s43, v17
    v_dot2_f32_bf16 v21, v29, v29, v21
    v_dot2_f32_bf16 v17, v30, s43, v17
    v_dot2_f32_bf16 v21, v30, v30, v21
    v_dot2_f32_bf16 v17, v31, s43, v17
    v_dot2_f32_bf16 v21, v31, v31, v21
    v_mfma_f32_16x16x32_bf16 v[160:163], v[32:35], v[44:47], v[160:163]
    v_mfma_f32_16x16x32_bf16 v[164:167], v[32:35], v[48:51], v[164:167]
    v_mfma_f32_16x16x32_bf16 v[168:171], v[32:35], v[52:55], v[168:171]
    v_mfma_f32_16x16x32_bf16 v[172:175], v[32:35], v[56:59], v[172:175]
    v_mfma_f32_16x16x32_bf16 v[176:179], v[32:35], v[60:63], v[176:179]
    v_mfma_f32_16x16x32_bf16 v[180:183], v[32:35], v[64:67], v[180:183]
    v_mfma_f32_16x16x32_bf16 v[184:187], v[32:35], v[68:71], v[184:187]
    v_mfma_f32_16x16x32_bf16 v[188:191], v[32:35], v[72:75], v[188:191]
    v_dot2_f32_bf16 v18, v32, s43, v18
    v_dot2_f32_bf16 v22, v32, v32, v22
    v_dot2_f32_bf16 v18, v33, s43, v18
    v_dot2_f32_bf16 v22, v33, v33, v22
    v_dot2_f32_bf16 v18, v34, s43, v18
    v_dot2_f32_bf16 v22, v34, v34, v22
    v_dot2_f32_bf16 v18, v35, s43, v18
    v_dot2_f32_bf16 v22, v35, v35, v22
    v_mfma_f32_16x16x32_bf16 v[192:195], v[36:39], v[44:47], v[192:195]
    v_mfma_f32_16x16x32_bf16 v[196:199], v[36:39], v[48:51], v[196:199]
    v_mfma_f32_16x16x32_bf16 v[200:203], v[36:39], v[52:55], v[200:203]
    v_mfma_f32_16x16x32_bf16 v[204:207], v[36:39], v[56:59], v[204:207]
    v_mfma_f32_16x16x32_bf16 v[208:211], v[36:39], v[60:63], v[208:211]
    v_mfma_f32_16x16x32_bf16 v[212:215], v[36:39], v[64:67], v[212:215]
    v_mfma_f32_16x16x32_bf16 v[216:219], v[36:39], v[68:71], v[216:219]
    v_mfma_f32_16x16x32_bf16 v[220:223], v[36:39], v[72:75], v[220:223]
    v_dot2_f32_bf16 v19, v36, s43, v19
    v_dot2_f32_bf16 v23, v36, v36, v23
    v_dot2_f32_bf16 v19, v37, s43, v19
    v_dot2_f32_bf16 v23, v37, v37, v23
    v_dot2_f32_bf16 v19, v38, s43, v19
    v_dot2_f32_bf16 v23, v38, v38, v23
    v_dot2_f32_bf16 v19, v39, s43, v19
    v_dot2_f32_bf16 v23, v39, v39, v23
    v_mfma_f32_16x16x32_bf16 v[224:227], v[40:43], v[44:47], v[224:227]
    v_mfma_f32_16x16x32_bf16 v[228:231], v[40:43], v[48:51], v[228:231]
    v_mfma_f32_16x16x32_bf16 v[232:235], v[40:43], v[52:55], v[232:235]
    v_mfma_f32_16x16x32_bf16 v[236:239], v[40:43], v[56:59], v[236:239]
    v_mfma_f32_16x16x32_bf16 v[240:243], v[40:43], v[60:63], v[240:243]
    v_mfma_f32_16x16x32_bf16 v[244:247], v[40:43], v[64:67], v[244:247]
    v_mfma_f32_16x16x32_bf16 v[248:251], v[40:43], v[68:71], v[248:251]
    v_mfma_f32_16x16x32_bf16 v[252:255], v[40:43], v[72:75], v[252:255]
    v_dot2_f32_bf16 v20, v40, s43, v20
    v_dot2_f32_bf16 v24, v40, v40, v24
    v_dot2_f32_bf16 v20, v41, s43, v20
    v_dot2_f32_bf16 v24, v41, v41, v24
    v_dot2_f32_bf16 v20, v42, s43, v20
    v_dot2_f32_bf16 v24, v42, v42, v24
    v_dot2_f32_bf16 v20, v43, s43, v20
    v_dot2_f32_bf16 v24, v43, v43, v24
    s_waitcnt lgkmcnt(0)
    v_mfma_f32_16x16x32_bf16 v[128:131], v[76:79], v[92:95], v[128:131]
    v_mfma_f32_16x16x32_bf16 v[132:135], v[76:79], v[96:99], v[132:135]
    v_mfma_f32_16x16x32_bf16 v[136:139], v[76:79], v[100:103], v[136:139]
    v_mfma_f32_16x16x32_bf16 v[140:143], v[76:79], v[104:107], v[140:143]
    v_mfma_f32_16x16x32_bf16 v[144:147], v[76:79], v[108:111], v[144:147]
    v_mfma_f32_16x16x32_bf16 v[148:151], v[76:79], v[112:115], v[148:151]
    v_mfma_f32_16x16x32_bf16 v[152:155], v[76:79], v[116:119], v[152:155]
    v_mfma_f32_16x16x32_bf16 v[156:159], v[76:79], v[120:123], v[156:159]
    v_dot2_f32_bf16 v17, v76, s43, v17
    v_dot2_f32_bf16 v21, v76, v76, v21
    v_dot2_f32_bf16 v17, v77, s43, v17
    v_dot2_f32_bf16 v21, v77, v77, v21
    v_dot2_f32_bf16 v17, v78, s43, v17
    v_dot2_f32_bf16 v21, v78, v78, v21
    v_dot2_f32_bf16 v17, v79, s43, v17
    v_dot2_f32_bf16 v21, v79, v79, v21
    v_mfma_f32_16x16x32_bf16 v[160:163], v[80:83], v[92:95], v[160:163]
    v_mfma_f32_16x16x32_bf16 v[164:167], v[80:83], v[96:99], v[164:167]
    v_mfma_f32_16x16x32_bf16 v[168:171], v[80:83], v[100:103], v[168:171]
    v_mfma_f32_16x16x32_bf16 v[172:175], v[80:83], v[104:107], v[172:175]
    v_mfma_f32_16x16x32_bf16 v[176:179], v[80:83], v[108:111], v[176:179]
    v_mfma_f32_16x16x32_bf16 v[180:183], v[80:83], v[112:115], v[180:183]
    v_mfma_f32_16x16x32_bf16 v[184:187], v[80:83], v[116:119], v[184:187]
    v_mfma_f32_16x16x32_bf16 v[188:191], v[80:83], v[120:123], v[188:191]
    v_dot2_f32_bf16 v18, v80, s43, v18
    v_dot2_f32_bf16 v22, v80, v80, v22
    v_dot2_f32_bf16 v18, v81, s43, v18
    v_dot2_f32_bf16 v22, v81, v81, v22
    v_dot2_f32_bf16 v18, v82, s43, v18
    v_dot2_f32_bf16 v22, v82, v82, v22
    v_dot2_f32_bf16 v18, v83, s43, v18
    v_dot2_f32_bf16 v22, v83, v83, v22
    v_mfma_f32_16x16x32_bf16 v[192:195], v[84:87], v[92:95], v[192:195]
    v_mfma_f32_16x16x32_bf16 v[196:199], v[84:87], v[96:99], v[196:199]
    v_mfma_f32_16x16x32_bf16 v[200:203], v[84:87], v[100:103], v[200:203]
    v_mfma_f32_16x16x32_bf16 v[204:207], v[84:87], v[104:107], v[204:207]
    v_mfma_f32_16x16x32_bf16 v[208:211], v[84:87], v[108:111], v[208:211]
    v_mfma_f32_16x16x32_bf16 v[212:215], v[84:87], v[112:115], v[212:215]
    v_mfma_f32_16x16x32_bf16 v[216:219], v[84:87], v[116:119], v[216:219]
    v_mfma_f32_16x16x32_bf16 v[220:223], v[84:87], v[120:123], v[220:223]
    v_dot2_f32_bf16 v19, v84, s43, v19
    v_dot2_f32_bf16 v23, v84, v84, v23
    v_dot2_f32_bf16 v19, v85, s43, v19
    v_dot2_f32_bf16 v23, v85, v85, v23
    v_dot2_f32_bf16 v19, v86, s43, v19
    v_dot2_f32_bf16 v23, v86, v86, v23
    v_dot2_f32_bf16 v19, v87, s43, v19
    v_dot2_f32_bf16 v23, v87, v87, v23
    v_mfma_f32_16x16x32_bf16 v[224:227], v[88:91], v[92:95], v[224:227]
    v_mfma_f32_16x16x32_bf16 v[228:231], v[88:91], v[96:99], v[228:231]
    v_mfma_f32_16x16x32_bf16 v[232:235], v[88:91], v[100:103], v[232:235]
    v_mfma_f32_16x16x32_bf16 v[236:239], v[88:91], v[104:107], v[236:239]
    v_mfma_f32_16x16x32_bf16 v[240:243], v[88:91], v[108:111], v[240:243]
    v_mfma_f32_16x16x32_bf16 v[244:247], v[88:91], v[112:115], v[244:247]
    v_mfma_f32_16x16x32_bf16 v[248:251], v[88:91], v[116:119], v[248:251]
    v_mfma_f32_16x16x32_bf16 v[252:255], v[88:91], v[120:123], v[252:255]
    v_dot2_f32_bf16 v20, v88, s43, v20
    v_dot2_f32_bf16 v24, v88, v88, v24
    v_dot2_f32_bf16 v20, v89, s43, v20
    v_dot2_f32_bf16 v24, v89, v89, v24
    v_dot2_f32_bf16 v20, v90, s43, v20
    v_dot2_f32_bf16 v24, v90, v90, v24
    v_dot2_f32_bf16 v20, v91, s43, v20
    v_dot2_f32_bf16 v24, v91, v91, v24
    v_add_u32 v1, 49152, v1
    v_add_u32 v2, 49152, v2
    v_add_u32 v3, 49152, v3
    v_add_u32 v4, 49152, v4
    v_add_u32 v5, 49152, v5
    v_add_u32 v6, 49152, v6
    v_add_u32 v7, 49152, v7
    v_add_u32 v8, 49152, v8
    s_waitcnt vmcnt(12)
    s_barrier
    s_mov_b32 s40, 1572864
    s_mov_b32 s41, 1376256
    s_lshl_b32 s42, s30, 12
    s_add_u32 m0, s42, 0
    s_nop 0
    buffer_load_dwordx4 v9, s[8:11], s40 offen lds
    s_add_u32 m0, s42, 16384
    s_nop 0
    buffer_load_dwordx4 v13, s[12:15], s41 offen lds
    s_add_u32 m0, s42, 32768
    s_nop 0
    buffer_load_dwordx4 v13, s[16:19], s41 offen lds
    s_add_u32 m0, s42, 1024
    s_nop 0
    buffer_load_dwordx4 v10, s[8:11], s40 offen lds
    s_add_u32 m0, s42, 17408
    s_nop 0
    buffer_load_dwordx4 v14, s[12:15], s41 offen lds
    s_add_u32 m0, s42, 33792
    s_nop 0
    buffer_load_dwordx4 v14, s[16:19], s41 offen lds
    s_add_u32 m0, s42, 2048
    s_nop 0
    buffer_load_dwordx4 v11, s[8:11], s40 offen lds
    s_add_u32 m0, s42, 18432
    s_nop 0
    buffer_load_dwordx4 v15, s[12:15], s41 offen lds
    s_add_u32 m0, s42, 34816
    s_nop 0
    buffer_load_dwordx4 v15, s[16:19], s41 offen lds
    s_add_u32 m0, s42, 3072
    s_nop 0
    buffer_load_dwordx4 v12, s[8:11], s40 offen lds
    s_add_u32 m0, s42, 19456
    s_nop 0
    buffer_load_dwordx4 v16, s[12:15], s41 offen lds
    s_add_u32 m0, s42, 35840
    s_nop 0
    buffer_load_dwordx4 v16, s[16:19], s41 offen lds
    ds_read_b64_tr_b16 v[28:29], v1 offset:0
    ds_read_b64_tr_b16 v[30:31], v1 offset:1024
    ds_read_b64_tr_b16 v[32:33], v2 offset:0
    ds_read_b64_tr_b16 v[34:35], v2 offset:1024
    ds_read_b64_tr_b16 v[36:37], v3 offset:0
    ds_read_b64_tr_b16 v[38:39], v3 offset:1024
    ds_read_b64_tr_b16 v[40:41], v4 offset:0
    ds_read_b64_tr_b16 v[42:43], v4 offset:1024
    ds_read_b64_tr_b16 v[44:45], v5 offset:0
    ds_read_b64_tr_b16 v[46:47], v5 offset:1024
    ds_read_b64_tr_b16 v[48:49], v6 offset:0
    ds_read_b64_tr_b16 v[50:51], v6 offset:1024
    ds_read_b64_tr_b16 v[52:53], v7 offset:0
    ds_read_b64_tr_b16 v[54:55], v7 offset:1024
    ds_read_b64_tr_b16 v[56:57], v8 offset:0
    ds_read_b64_tr_b16 v[58:59], v8 offset:1024
    ds_read_b64_tr_b16 v[60:61], v5 offset:16384
    ds_read_b64_tr_b16 v[62:63], v5 offset:17408
    ds_read_b64_tr_b16 v[64:65], v6 offset:16384
    ds_read_b64_tr_b16 v[66:67], v6 offset:17408
    ds_read_b64_tr_b16 v[68:69], v7 offset:16384
    ds_read_b64_tr_b16 v[70:71], v7 offset:17408
    ds_read_b64_tr_b16 v[72:73], v8 offset:16384
    ds_read_b64_tr_b16 v[74:75], v8 offset:17408
    s_waitcnt lgkmcnt(0)
    ds_read_b64_tr_b16 v[76:77], v1 offset:8192
    ds_read_b64_tr_b16 v[78:79], v1 offset:9216
    ds_read_b64_tr_b16 v[80:81], v2 offset:8192
    ds_read_b64_tr_b16 v[82:83], v2 offset:9216
    ds_read_b64_tr_b16 v[84:85], v3 offset:8192
    ds_read_b64_tr_b16 v[86:87], v3 offset:9216
    ds_read_b64_tr_b16 v[88:89], v4 offset:8192
    ds_read_b64_tr_b16 v[90:91], v4 offset:9216
    ds_read_b64_tr_b16 v[92:93], v5 offset:8192
    ds_read_b64_tr_b16 v[94:95], v5 offset:9216
    ds_read_b64_tr_b16 v[96:97], v6 offset:8192
    ds_read_b64_tr_b16 v[98:99], v6 offset:9216
    ds_read_b64_tr_b16 v[100:101], v7 offset:8192
    ds_read_b64_tr_b16 v[102:103], v7 offset:9216
    ds_read_b64_tr_b16 v[104:105], v8 offset:8192
    ds_read_b64_tr_b16 v[106:107], v8 offset:9216
    ds_read_b64_tr_b16 v[108:109], v5 offset:24576
    ds_read_b64_tr_b16 v[110:111], v5 offset:25600
    ds_read_b64_tr_b16 v[112:113], v6 offset:24576
    ds_read_b64_tr_b16 v[114:115], v6 offset:25600
    ds_read_b64_tr_b16 v[116:117], v7 offset:24576
    ds_read_b64_tr_b16 v[118:119], v7 offset:25600
    ds_read_b64_tr_b16 v[120:121], v8 offset:24576
    ds_read_b64_tr_b16 v[122:123], v8 offset:25600
    v_mfma_f32_16x16x32_bf16 v[128:131], v[28:31], v[44:47], v[128:131]
    v_mfma_f32_16x16x32_bf16 v[132:135], v[28:31], v[48:51], v[132:135]
    v_mfma_f32_16x16x32_bf16 v[136:139], v[28:31], v[52:55], v[136:139]
    v_mfma_f32_16x16x32_bf16 v[140:143], v[28:31], v[56:59], v[140:143]
    v_mfma_f32_16x16x32_bf16 v[144:147], v[28:31], v[60:63], v[144:147]
    v_mfma_f32_16x16x32_bf16 v[148:151], v[28:31], v[64:67], v[148:151]
    v_mfma_f32_16x16x32_bf16 v[152:155], v[28:31], v[68:71], v[152:155]
    v_mfma_f32_16x16x32_bf16 v[156:159], v[28:31], v[72:75], v[156:159]
    v_dot2_f32_bf16 v17, v28, s43, v17
    v_dot2_f32_bf16 v21, v28, v28, v21
    v_dot2_f32_bf16 v17, v29, s43, v17
    v_dot2_f32_bf16 v21, v29, v29, v21
    v_dot2_f32_bf16 v17, v30, s43, v17
    v_dot2_f32_bf16 v21, v30, v30, v21
    v_dot2_f32_bf16 v17, v31, s43, v17
    v_dot2_f32_bf16 v21, v31, v31, v21
    v_mfma_f32_16x16x32_bf16 v[160:163], v[32:35], v[44:47], v[160:163]
    v_mfma_f32_16x16x32_bf16 v[164:167], v[32:35], v[48:51], v[164:167]
    v_mfma_f32_16x16x32_bf16 v[168:171], v[32:35], v[52:55], v[168:171]
    v_mfma_f32_16x16x32_bf16 v[172:175], v[32:35], v[56:59], v[172:175]
    v_mfma_f32_16x16x32_bf16 v[176:179], v[32:35], v[60:63], v[176:179]
    v_mfma_f32_16x16x32_bf16 v[180:183], v[32:35], v[64:67], v[180:183]
    v_mfma_f32_16x16x32_bf16 v[184:187], v[32:35], v[68:71], v[184:187]
    v_mfma_f32_16x16x32_bf16 v[188:191], v[32:35], v[72:75], v[188:191]
    v_dot2_f32_bf16 v18, v32, s43, v18
    v_dot2_f32_bf16 v22, v32, v32, v22
    v_dot2_f32_bf16 v18, v33, s43, v18
    v_dot2_f32_bf16 v22, v33, v33, v22
    v_dot2_f32_bf16 v18, v34, s43, v18
    v_dot2_f32_bf16 v22, v34, v34, v22
    v_dot2_f32_bf16 v18, v35, s43, v18
    v_dot2_f32_bf16 v22, v35, v35, v22
    v_mfma_f32_16x16x32_bf16 v[192:195], v[36:39], v[44:47], v[192:195]
    v_mfma_f32_16x16x32_bf16 v[196:199], v[36:39], v[48:51], v[196:199]
    v_mfma_f32_16x16x32_bf16 v[200:203], v[36:39], v[52:55], v[200:203]
    v_mfma_f32_16x16x32_bf16 v[204:207], v[36:39], v[56:59], v[204:207]
    v_mfma_f32_16x16x32_bf16 v[208:211], v[36:39], v[60:63], v[208:211]
    v_mfma_f32_16x16x32_bf16 v[212:215], v[36:39], v[64:67], v[212:215]
    v_mfma_f32_16x16x32_bf16 v[216:219], v[36:39], v[68:71], v[216:219]
    v_mfma_f32_16x16x32_bf16 v[220:223], v[36:39], v[72:75], v[220:223]
    v_dot2_f32_bf16 v19, v36, s43, v19
    v_dot2_f32_bf16 v23, v36, v36, v23
    v_dot2_f32_bf16 v19, v37, s43, v19
    v_dot2_f32_bf16 v23, v37, v37, v23
    v_dot2_f32_bf16 v19, v38, s43, v19
    v_dot2_f32_bf16 v23, v38, v38, v23
    v_dot2_f32_bf16 v19, v39, s43, v19
    v_dot2_f32_bf16 v23, v39, v39, v23
    v_mfma_f32_16x16x32_bf16 v[224:227], v[40:43], v[44:47], v[224:227]
    v_mfma_f32_16x16x32_bf16 v[228:231], v[40:43], v[48:51], v[228:231]
    v_mfma_f32_16x16x32_bf16 v[232:235], v[40:43], v[52:55], v[232:235]
    v_mfma_f32_16x16x32_bf16 v[236:239], v[40:43], v[56:59], v[236:239]
    v_mfma_f32_16x16x32_bf16 v[240:243], v[40:43], v[60:63], v[240:243]
    v_mfma_f32_16x16x32_bf16 v[244:247], v[40:43], v[64:67], v[244:247]
    v_mfma_f32_16x16x32_bf16 v[248:251], v[40:43], v[68:71], v[248:251]
    v_mfma_f32_16x16x32_bf16 v[252:255], v[40:43], v[72:75], v[252:255]
    v_dot2_f32_bf16 v20, v40, s43, v20
    v_dot2_f32_bf16 v24, v40, v40, v24
    v_dot2_f32_bf16 v20, v41, s43, v20
    v_dot2_f32_bf16 v24, v41, v41, v24
    v_dot2_f32_bf16 v20, v42, s43, v20
    v_dot2_f32_bf16 v24, v42, v42, v24
    v_dot2_f32_bf16 v20, v43, s43, v20
    v_dot2_f32_bf16 v24, v43, v43, v24
    s_waitcnt lgkmcnt(0)
    v_mfma_f32_16x16x32_bf16 v[128:131], v[76:79], v[92:95], v[128:131]
    v_mfma_f32_16x16x32_bf16 v[132:135], v[76:79], v[96:99], v[132:135]
    v_mfma_f32_16x16x32_bf16 v[136:139], v[76:79], v[100:103], v[136:139]
    v_mfma_f32_16x16x32_bf16 v[140:143], v[76:79], v[104:107], v[140:143]
    v_mfma_f32_16x16x32_bf16 v[144:147], v[76:79], v[108:111], v[144:147]
    v_mfma_f32_16x16x32_bf16 v[148:151], v[76:79], v[112:115], v[148:151]
    v_mfma_f32_16x16x32_bf16 v[152:155], v[76:79], v[116:119], v[152:155]
    v_mfma_f32_16x16x32_bf16 v[156:159], v[76:79], v[120:123], v[156:159]
    v_dot2_f32_bf16 v17, v76, s43, v17
    v_dot2_f32_bf16 v21, v76, v76, v21
    v_dot2_f32_bf16 v17, v77, s43, v17
    v_dot2_f32_bf16 v21, v77, v77, v21
    v_dot2_f32_bf16 v17, v78, s43, v17
    v_dot2_f32_bf16 v21, v78, v78, v21
    v_dot2_f32_bf16 v17, v79, s43, v17
    v_dot2_f32_bf16 v21, v79, v79, v21
    v_mfma_f32_16x16x32_bf16 v[160:163], v[80:83], v[92:95], v[160:163]
    v_mfma_f32_16x16x32_bf16 v[164:167], v[80:83], v[96:99], v[164:167]
    v_mfma_f32_16x16x32_bf16 v[168:171], v[80:83], v[100:103], v[168:171]
    v_mfma_f32_16x16x32_bf16 v[172:175], v[80:83], v[104:107], v[172:175]
    v_mfma_f32_16x16x32_bf16 v[176:179], v[80:83], v[108:111], v[176:179]
    v_mfma_f32_16x16x32_bf16 v[180:183], v[80:83], v[112:115], v[180:183]
    v_mfma_f32_16x16x32_bf16 v[184:187], v[80:83], v[116:119], v[184:187]
    v_mfma_f32_16x16x32_bf16 v[188:191], v[80:83], v[120:123], v[188:191]
    v_dot2_f32_bf16 v18, v80, s43, v18
    v_dot2_f32_bf16 v22, v80, v80, v22
    v_dot2_f32_bf16 v18, v81, s43, v18
    v_dot2_f32_bf16 v22, v81, v81, v22
    v_dot2_f32_bf16 v18, v82, s43, v18
    v_dot2_f32_bf16 v22, v82, v82, v22
    v_dot2_f32_bf16 v18, v83, s43, v18
    v_dot2_f32_bf16 v22, v83, v83, v22
    v_mfma_f32_16x16x32_bf16 v[192:195], v[84:87], v[92:95], v[192:195]
    v_mfma_f32_16x16x32_bf16 v[196:199], v[84:87], v[96:99], v[196:199]
    v_mfma_f32_16x16x32_bf16 v[200:203], v[84:87], v[100:103], v[200:203]
    v_mfma_f32_16x16x32_bf16 v[204:207], v[84:87], v[104:107], v[204:207]
    v_mfma_f32_16x16x32_bf16 v[208:211], v[84:87], v[108:111], v[208:211]
    v_mfma_f32_16x16x32_bf16 v[212:215], v[84:87], v[112:115], v[212:215]
    v_mfma_f32_16x16x32_bf16 v[216:219], v[84:87], v[116:119], v[216:219]
    v_mfma_f32_16x16x32_bf16 v[220:223], v[84:87], v[120:123], v[220:223]
    v_dot2_f32_bf16 v19, v84, s43, v19
    v_dot2_f32_bf16 v23, v84, v84, v23
    v_dot2_f32_bf16 v19, v85, s43, v19
    v_dot2_f32_bf16 v23, v85, v85, v23
    v_dot2_f32_bf16 v19, v86, s43, v19
    v_dot2_f32_bf16 v23, v86, v86, v23
    v_dot2_f32_bf16 v19, v87, s43, v19
    v_dot2_f32_bf16 v23, v87, v87, v23
    v_mfma_f32_16x16x32_bf16 v[224:227], v[88:91], v[92:95], v[224:227]
    v_mfma_f32_16x16x32_bf16 v[228:231], v[88:91], v[96:99], v[228:231]
    v_mfma_f32_16x16x32_bf16 v[232:235], v[88:91], v[100:103], v[232:235]
    v_mfma_f32_16x16x32_bf16 v[236:239], v[88:91], v[104:107], v[236:239]
    v_mfma_f32_16x16x32_bf16 v[240:243], v[88:91], v[108:111], v[240:243]
    v_mfma_f32_16x16x32_bf16 v[244:247], v[88:91], v[112:115], v[244:247]
    v_mfma_f32_16x16x32_bf16 v[248:251], v[88:91], v[116:119], v[248:251]
    v_mfma_f32_16x16x32_bf16 v[252:255], v[88:91], v[120:123], v[252:255]
    v_dot2_f32_bf16 v20, v88, s43, v20
    v_dot2_f32_bf16 v24, v88, v88, v24
    v_dot2_f32_bf16 v20, v89, s43, v20
    v_dot2_f32_bf16 v24, v89, v89, v24
    v_dot2_f32_bf16 v20, v90, s43, v20
    v_dot2_f32_bf16 v24, v90, v90, v24
    v_dot2_f32_bf16 v20, v91, s43, v20
    v_dot2_f32_bf16 v24, v91, v91, v24
    v_add_u32 v1, 49152, v1
    v_add_u32 v2, 49152, v2
    v_add_u32 v3, 49152, v3
    v_add_u32 v4, 49152, v4
    v_add_u32 v5, 49152, v5
    v_add_u32 v6, 49152, v6
    v_add_u32 v7, 49152, v7
    v_add_u32 v8, 49152, v8
    s_waitcnt vmcnt(12)
    s_barrier
    s_mov_b32 s40, 1835008
    s_mov_b32 s41, 1605632
    s_lshl_b32 s42, s30, 12
    s_add_u32 m0, s42, 49152
    s_nop 0
    buffer_load_dwordx4 v9, s[8:11], s40 offen lds
    s_add_u32 m0, s42, 65536
    s_nop 0
    buffer_load_dwordx4 v13, s[12:15], s41 offen lds
    s_add_u32 m0, s42, 81920
    s_nop 0
    buffer_load_dwordx4 v13, s[16:19], s41 offen lds
    s_add_u32 m0, s42, 50176
    s_nop 0
    buffer_load_dwordx4 v10, s[8:11], s40 offen lds
    s_add_u32 m0, s42, 66560
    s_nop 0
    buffer_load_dwordx4 v14, s[12:15], s41 offen lds
    s_add_u32 m0, s42, 82944
    s_nop 0
    buffer_load_dwordx4 v14, s[16:19], s41 offen lds
    s_add_u32 m0, s42, 51200
    s_nop 0
    buffer_load_dwordx4 v11, s[8:11], s40 offen lds
    s_add_u32 m0, s42, 67584
    s_nop 0
    buffer_load_dwordx4 v15, s[12:15], s41 offen lds
    s_add_u32 m0, s42, 83968
    s_nop 0
    buffer_load_dwordx4 v15, s[16:19], s41 offen lds
    s_add_u32 m0, s42, 52224
    s_nop 0
    buffer_load_dwordx4 v12, s[8:11], s40 offen lds
    s_add_u32 m0, s42, 68608
    s_nop 0
    buffer_load_dwordx4 v16, s[12:15], s41 offen lds
    s_add_u32 m0, s42, 84992
    s_nop 0
    buffer_load_dwordx4 v16, s[16:19], s41 offen lds
    ds_read_b64_tr_b16 v[28:29], v1 offset:0
    ds_read_b64_tr_b16 v[30:31], v1 offset:1024
    ds_read_b64_tr_b16 v[32:33], v2 offset:0
    ds_read_b64_tr_b16 v[34:35], v2 offset:1024
    ds_read_b64_tr_b16 v[36:37], v3 offset:0
    ds_read_b64_tr_b16 v[38:39], v3 offset:1024
    ds_read_b64_tr_b16 v[40:41], v4 offset:0
    ds_read_b64_tr_b16 v[42:43], v4 offset:1024
    ds_read_b64_tr_b16 v[44:45], v5 offset:0
    ds_read_b64_tr_b16 v[46:47], v5 offset:1024
    ds_read_b64_tr_b16 v[48:49], v6 offset:0
    ds_read_b64_tr_b16 v[50:51], v6 offset:1024
    ds_read_b64_tr_b16 v[52:53], v7 offset:0
    ds_read_b64_tr_b16 v[54:55], v7 offset:1024
    ds_read_b64_tr_b16 v[56:57], v8 offset:0
    ds_read_b64_tr_b16 v[58:59], v8 offset:1024
    ds_read_b64_tr_b16 v[60:61], v5 offset:16384
    ds_read_b64_tr_b16 v[62:63], v5 offset:17408
    ds_read_b64_tr_b16 v[64:65], v6 offset:16384
    ds_read_b64_tr_b16 v[66:67], v6 offset:17408
    ds_read_b64_tr_b16 v[68:69], v7 offset:16384
    ds_read_b64_tr_b16 v[70:71], v7 offset:17408
    ds_read_b64_tr_b16 v[72:73], v8 offset:16384
    ds_read_b64_tr_b16 v[74:75], v8 offset:17408
    s_waitcnt lgkmcnt(0)
    ds_read_b64_tr_b16 v[76:77], v1 offset:8192
    ds_read_b64_tr_b16 v[78:79], v1 offset:9216
    ds_read_b64_tr_b16 v[80:81], v2 offset:8192
    ds_read_b64_tr_b16 v[82:83], v2 offset:9216
    ds_read_b64_tr_b16 v[84:85], v3 offset:8192
    ds_read_b64_tr_b16 v[86:87], v3 offset:9216
    ds_read_b64_tr_b16 v[88:89], v4 offset:8192
    ds_read_b64_tr_b16 v[90:91], v4 offset:9216
    ds_read_b64_tr_b16 v[92:93], v5 offset:8192
    ds_read_b64_tr_b16 v[94:95], v5 offset:9216
    ds_read_b64_tr_b16 v[96:97], v6 offset:8192
    ds_read_b64_tr_b16 v[98:99], v6 offset:9216
    ds_read_b64_tr_b16 v[100:101], v7 offset:8192
    ds_read_b64_tr_b16 v[102:103], v7 offset:9216
    ds_read_b64_tr_b16 v[104:105], v8 offset:8192
    ds_read_b64_tr_b16 v[106:107], v8 offset:9216
    ds_read_b64_tr_b16 v[108:109], v5 offset:24576
    ds_read_b64_tr_b16 v[110:111], v5 offset:25600
    ds_read_b64_tr_b16 v[112:113], v6 offset:24576
    ds_read_b64_tr_b16 v[114:115], v6 offset:25600
    ds_read_b64_tr_b16 v[116:117], v7 offset:24576
    ds_read_b64_tr_b16 v[118:119], v7 offset:25600
    ds_read_b64_tr_b16 v[120:121], v8 offset:24576
    ds_read_b64_tr_b16 v[122:123], v8 offset:25600
    v_mfma_f32_16x16x32_bf16 v[128:131], v[28:31], v[44:47], v[128:131]
    v_mfma_f32_16x16x32_bf16 v[132:135], v[28:31], v[48:51], v[132:135]
    v_mfma_f32_16x16x32_bf16 v[136:139], v[28:31], v[52:55], v[136:139]
    v_mfma_f32_16x16x32_bf16 v[140:143], v[28:31], v[56:59], v[140:143]
    v_mfma_f32_16x16x32_bf16 v[144:147], v[28:31], v[60:63], v[144:147]
    v_mfma_f32_16x16x32_bf16 v[148:151], v[28:31], v[64:67], v[148:151]
    v_mfma_f32_16x16x32_bf16 v[152:155], v[28:31], v[68:71], v[152:155]
    v_mfma_f32_16x16x32_bf16 v[156:159], v[28:31], v[72:75], v[156:159]
    v_dot2_f32_bf16 v17, v28, s43, v17
    v_dot2_f32_bf16 v21, v28, v28, v21
    v_dot2_f32_bf16 v17, v29, s43, v17
    v_dot2_f32_bf16 v21, v29, v29, v21
    v_dot2_f32_bf16 v17, v30, s43, v17
    v_dot2_f32_bf16 v21, v30, v30, v21
    v_dot2_f32_bf16 v17, v31, s43, v17
    v_dot2_f32_bf16 v21, v31, v31, v21
    v_mfma_f32_16x16x32_bf16 v[160:163], v[32:35], v[44:47], v[160:163]
    v_mfma_f32_16x16x32_bf16 v[164:167], v[32:35], v[48:51], v[164:167]
    v_mfma_f32_16x16x32_bf16 v[168:171], v[32:35], v[52:55], v[168:171]
    v_mfma_f32_16x16x32_bf16 v[172:175], v[32:35], v[56:59], v[172:175]
    v_mfma_f32_16x16x32_bf16 v[176:179], v[32:35], v[60:63], v[176:179]
    v_mfma_f32_16x16x32_bf16 v[180:183], v[32:35], v[64:67], v[180:183]
    v_mfma_f32_16x16x32_bf16 v[184:187], v[32:35], v[68:71], v[184:187]
    v_mfma_f32_16x16x32_bf16 v[188:191], v[32:35], v[72:75], v[188:191]
    v_dot2_f32_bf16 v18, v32, s43, v18
    v_dot2_f32_bf16 v22, v32, v32, v22
    v_dot2_f32_bf16 v18, v33, s43, v18
    v_dot2_f32_bf16 v22, v33, v33, v22
    v_dot2_f32_bf16 v18, v34, s43, v18
    v_dot2_f32_bf16 v22, v34, v34, v22
    v_dot2_f32_bf16 v18, v35, s43, v18
    v_dot2_f32_bf16 v22, v35, v35, v22
    v_mfma_f32_16x16x32_bf16 v[192:195], v[36:39], v[44:47], v[192:195]
    v_mfma_f32_16x16x32_bf16 v[196:199], v[36:39], v[48:51], v[196:199]
    v_mfma_f32_16x16x32_bf16 v[200:203], v[36:39], v[52:55], v[200:203]
    v_mfma_f32_16x16x32_bf16 v[204:207], v[36:39], v[56:59], v[204:207]
    v_mfma_f32_16x16x32_bf16 v[208:211], v[36:39], v[60:63], v[208:211]
    v_mfma_f32_16x16x32_bf16 v[212:215], v[36:39], v[64:67], v[212:215]
    v_mfma_f32_16x16x32_bf16 v[216:219], v[36:39], v[68:71], v[216:219]
    v_mfma_f32_16x16x32_bf16 v[220:223], v[36:39], v[72:75], v[220:223]
    v_dot2_f32_bf16 v19, v36, s43, v19
    v_dot2_f32_bf16 v23, v36, v36, v23
    v_dot2_f32_bf16 v19, v37, s43, v19
    v_dot2_f32_bf16 v23, v37, v37, v23
    v_dot2_f32_bf16 v19, v38, s43, v19
    v_dot2_f32_bf16 v23, v38, v38, v23
    v_dot2_f32_bf16 v19, v39, s43, v19
    v_dot2_f32_bf16 v23, v39, v39, v23
    v_mfma_f32_16x16x32_bf16 v[224:227], v[40:43], v[44:47], v[224:227]
    v_mfma_f32_16x16x32_bf16 v[228:231], v[40:43], v[48:51], v[228:231]
    v_mfma_f32_16x16x32_bf16 v[232:235], v[40:43], v[52:55], v[232:235]
    v_mfma_f32_16x16x32_bf16 v[236:239], v[40:43], v[56:59], v[236:239]
    v_mfma_f32_16x16x32_bf16 v[240:243], v[40:43], v[60:63], v[240:243]
    v_mfma_f32_16x16x32_bf16 v[244:247], v[40:43], v[64:67], v[244:247]
    v_mfma_f32_16x16x32_bf16 v[248:251], v[40:43], v[68:71], v[248:251]
    v_mfma_f32_16x16x32_bf16 v[252:255], v[40:43], v[72:75], v[252:255]
    v_dot2_f32_bf16 v20, v40, s43, v20
    v_dot2_f32_bf16 v24, v40, v40, v24
    v_dot2_f32_bf16 v20, v41, s43, v20
    v_dot2_f32_bf16 v24, v41, v41, v24
    v_dot2_f32_bf16 v20, v42, s43, v20
    v_dot2_f32_bf16 v24, v42, v42, v24
    v_dot2_f32_bf16 v20, v43, s43, v20
    v_dot2_f32_bf16 v24, v43, v43, v24
    s_waitcnt lgkmcnt(0)
    v_mfma_f32_16x16x32_bf16 v[128:131], v[76:79], v[92:95], v[128:131]
    v_mfma_f32_16x16x32_bf16 v[132:135], v[76:79], v[96:99], v[132:135]
    v_mfma_f32_16x16x32_bf16 v[136:139], v[76:79], v[100:103], v[136:139]
    v_mfma_f32_16x16x32_bf16 v[140:143], v[76:79], v[104:107], v[140:143]
    v_mfma_f32_16x16x32_bf16 v[144:147], v[76:79], v[108:111], v[144:147]
    v_mfma_f32_16x16x32_bf16 v[148:151], v[76:79], v[112:115], v[148:151]
    v_mfma_f32_16x16x32_bf16 v[152:155], v[76:79], v[116:119], v[152:155]
    v_mfma_f32_16x16x32_bf16 v[156:159], v[76:79], v[120:123], v[156:159]
    v_dot2_f32_bf16 v17, v76, s43, v17
    v_dot2_f32_bf16 v21, v76, v76, v21
    v_dot2_f32_bf16 v17, v77, s43, v17
    v_dot2_f32_bf16 v21, v77, v77, v21
    v_dot2_f32_bf16 v17, v78, s43, v17
    v_dot2_f32_bf16 v21, v78, v78, v21
    v_dot2_f32_bf16 v17, v79, s43, v17
    v_dot2_f32_bf16 v21, v79, v79, v21
    v_mfma_f32_16x16x32_bf16 v[160:163], v[80:83], v[92:95], v[160:163]
    v_mfma_f32_16x16x32_bf16 v[164:167], v[80:83], v[96:99], v[164:167]
    v_mfma_f32_16x16x32_bf16 v[168:171], v[80:83], v[100:103], v[168:171]
    v_mfma_f32_16x16x32_bf16 v[172:175], v[80:83], v[104:107], v[172:175]
    v_mfma_f32_16x16x32_bf16 v[176:179], v[80:83], v[108:111], v[176:179]
    v_mfma_f32_16x16x32_bf16 v[180:183], v[80:83], v[112:115], v[180:183]
    v_mfma_f32_16x16x32_bf16 v[184:187], v[80:83], v[116:119], v[184:187]
    v_mfma_f32_16x16x32_bf16 v[188:191], v[80:83], v[120:123], v[188:191]
    v_dot2_f32_bf16 v18, v80, s43, v18
    v_dot2_f32_bf16 v22, v80, v80, v22
    v_dot2_f32_bf16 v18, v81, s43, v18
    v_dot2_f32_bf16 v22, v81, v81, v22
    v_dot2_f32_bf16 v18, v82, s43, v18
    v_dot2_f32_bf16 v22, v82, v82, v22
    v_dot2_f32_bf16 v18, v83, s43, v18
    v_dot2_f32_bf16 v22, v83, v83, v22
    v_mfma_f32_16x16x32_bf16 v[192:195], v[84:87], v[92:95], v[192:195]
    v_mfma_f32_16x16x32_bf16 v[196:199], v[84:87], v[96:99], v[196:199]
    v_mfma_f32_16x16x32_bf16 v[200:203], v[84:87], v[100:103], v[200:203]
    v_mfma_f32_16x16x32_bf16 v[204:207], v[84:87], v[104:107], v[204:207]
    v_mfma_f32_16x16x32_bf16 v[208:211], v[84:87], v[108:111], v[208:211]
    v_mfma_f32_16x16x32_bf16 v[212:215], v[84:87], v[112:115], v[212:215]
    v_mfma_f32_16x16x32_bf16 v[216:219], v[84:87], v[116:119], v[216:219]
    v_mfma_f32_16x16x32_bf16 v[220:223], v[84:87], v[120:123], v[220:223]
    v_dot2_f32_bf16 v19, v84, s43, v19
    v_dot2_f32_bf16 v23, v84, v84, v23
    v_dot2_f32_bf16 v19, v85, s43, v19
    v_dot2_f32_bf16 v23, v85, v85, v23
    v_dot2_f32_bf16 v19, v86, s43, v19
    v_dot2_f32_bf16 v23, v86, v86, v23
    v_dot2_f32_bf16 v19, v87, s43, v19
    v_dot2_f32_bf16 v23, v87, v87, v23
    v_mfma_f32_16x16x32_bf16 v[224:227], v[88:91], v[92:95], v[224:227]
    v_mfma_f32_16x16x32_bf16 v[228:231], v[88:91], v[96:99], v[228:231]
    v_mfma_f32_16x16x32_bf16 v[232:235], v[88:91], v[100:103], v[232:235]
    v_mfma_f32_16x16x32_bf16 v[236:239], v[88:91], v[104:107], v[236:239]
    v_mfma_f32_16x16x32_bf16 v[240:243], v[88:91], v[108:111], v[240:243]
    v_mfma_f32_16x16x32_bf16 v[244:247], v[88:91], v[112:115], v[244:247]
    v_mfma_f32_16x16x32_bf16 v[248:251], v[88:91], v[116:119], v[248:251]
    v_mfma_f32_16x16x32_bf16 v[252:255], v[88:91], v[120:123], v[252:255]
    v_dot2_f32_bf16 v20, v88, s43, v20
    v_dot2_f32_bf16 v24, v88, v88, v24
    v_dot2_f32_bf16 v20, v89, s43, v20
    v_dot2_f32_bf16 v24, v89, v89, v24
    v_dot2_f32_bf16 v20, v90, s43, v20
    v_dot2_f32_bf16 v24, v90, v90, v24
    v_dot2_f32_bf16 v20, v91, s43, v20
    v_dot2_f32_bf16 v24, v91, v91, v24
    v_add_u32 v1, -98304, v1
    v_add_u32 v2, -98304, v2
    v_add_u32 v3, -98304, v3
    v_add_u32 v4, -98304, v4
    v_add_u32 v5, -98304, v5
    v_add_u32 v6, -98304, v6
    v_add_u32 v7, -98304, v7
    v_add_u32 v8, -98304, v8
    s_waitcnt vmcnt(12)
    s_barrier
    ds_read_b64_tr_b16 v[28:29], v1 offset:0
    ds_read_b64_tr_b16 v[30:31], v1 offset:1024
    ds_read_b64_tr_b16 v[32:33], v2 offset:0
    ds_read_b64_tr_b16 v[34:35], v2 offset:1024
    ds_read_b64_tr_b16 v[36:37], v3 offset:0
    ds_read_b64_tr_b16 v[38:39], v3 offset:1024
    ds_read_b64_tr_b16 v[40:41], v4 offset:0
    ds_read_b64_tr_b16 v[42:43], v4 offset:1024
    ds_read_b64_tr_b16 v[44:45], v5 offset:0
    ds_read_b64_tr_b16 v[46:47], v5 offset:1024
    ds_read_b64_tr_b16 v[48:49], v6 offset:0
    ds_read_b64_tr_b16 v[50:51], v6 offset:1024
    ds_read_b64_tr_b16 v[52:53], v7 offset:0
    ds_read_b64_tr_b16 v[54:55], v7 offset:1024
    ds_read_b64_tr_b16 v[56:57], v8 offset:0
    ds_read_b64_tr_b16 v[58:59], v8 offset:1024
    ds_read_b64_tr_b16 v[60:61], v5 offset:16384
    ds_read_b64_tr_b16 v[62:63], v5 offset:17408
    ds_read_b64_tr_b16 v[64:65], v6 offset:16384
    ds_read_b64_tr_b16 v[66:67], v6 offset:17408
    ds_read_b64_tr_b16 v[68:69], v7 offset:16384
    ds_read_b64_tr_b16 v[70:71], v7 offset:17408
    ds_read_b64_tr_b16 v[72:73], v8 offset:16384
    ds_read_b64_tr_b16 v[74:75], v8 offset:17408
    s_waitcnt lgkmcnt(0)
    ds_read_b64_tr_b16 v[76:77], v1 offset:8192
    ds_read_b64_tr_b16 v[78:79], v1 offset:9216
    ds_read_b64_tr_b16 v[80:81], v2 offset:8192
    ds_read_b64_tr_b16 v[82:83], v2 offset:9216
    ds_read_b64_tr_b16 v[84:85], v3 offset:8192
    ds_read_b64_tr_b16 v[86:87], v3 offset:9216
    ds_read_b64_tr_b16 v[88:89], v4 offset:8192
    ds_read_b64_tr_b16 v[90:91], v4 offset:9216
    ds_read_b64_tr_b16 v[92:93], v5 offset:8192
    ds_read_b64_tr_b16 v[94:95], v5 offset:9216
    ds_read_b64_tr_b16 v[96:97], v6 offset:8192
    ds_read_b64_tr_b16 v[98:99], v6 offset:9216
    ds_read_b64_tr_b16 v[100:101], v7 offset:8192
    ds_read_b64_tr_b16 v[102:103], v7 offset:9216
    ds_read_b64_tr_b16 v[104:105], v8 offset:8192
    ds_read_b64_tr_b16 v[106:107], v8 offset:9216
    ds_read_b64_tr_b16 v[108:109], v5 offset:24576
    ds_read_b64_tr_b16 v[110:111], v5 offset:25600
    ds_read_b64_tr_b16 v[112:113], v6 offset:24576
    ds_read_b64_tr_b16 v[114:115], v6 offset:25600
    ds_read_b64_tr_b16 v[116:117], v7 offset:24576
    ds_read_b64_tr_b16 v[118:119], v7 offset:25600
    ds_read_b64_tr_b16 v[120:121], v8 offset:24576
    ds_read_b64_tr_b16 v[122:123], v8 offset:25600
    v_mfma_f32_16x16x32_bf16 v[128:131], v[28:31], v[44:47], v[128:131]
    v_mfma_f32_16x16x32_bf16 v[132:135], v[28:31], v[48:51], v[132:135]
    v_mfma_f32_16x16x32_bf16 v[136:139], v[28:31], v[52:55], v[136:139]
    v_mfma_f32_16x16x32_bf16 v[140:143], v[28:31], v[56:59], v[140:143]
    v_mfma_f32_16x16x32_bf16 v[144:147], v[28:31], v[60:63], v[144:147]
    v_mfma_f32_16x16x32_bf16 v[148:151], v[28:31], v[64:67], v[148:151]
    v_mfma_f32_16x16x32_bf16 v[152:155], v[28:31], v[68:71], v[152:155]
    v_mfma_f32_16x16x32_bf16 v[156:159], v[28:31], v[72:75], v[156:159]
    v_dot2_f32_bf16 v17, v28, s43, v17
    v_dot2_f32_bf16 v21, v28, v28, v21
    v_dot2_f32_bf16 v17, v29, s43, v17
    v_dot2_f32_bf16 v21, v29, v29, v21
    v_dot2_f32_bf16 v17, v30, s43, v17
    v_dot2_f32_bf16 v21, v30, v30, v21
    v_dot2_f32_bf16 v17, v31, s43, v17
    v_dot2_f32_bf16 v21, v31, v31, v21
    v_mfma_f32_16x16x32_bf16 v[160:163], v[32:35], v[44:47], v[160:163]
    v_mfma_f32_16x16x32_bf16 v[164:167], v[32:35], v[48:51], v[164:167]
    v_mfma_f32_16x16x32_bf16 v[168:171], v[32:35], v[52:55], v[168:171]
    v_mfma_f32_16x16x32_bf16 v[172:175], v[32:35], v[56:59], v[172:175]
    v_mfma_f32_16x16x32_bf16 v[176:179], v[32:35], v[60:63], v[176:179]
    v_mfma_f32_16x16x32_bf16 v[180:183], v[32:35], v[64:67], v[180:183]
    v_mfma_f32_16x16x32_bf16 v[184:187], v[32:35], v[68:71], v[184:187]
    v_mfma_f32_16x16x32_bf16 v[188:191], v[32:35], v[72:75], v[188:191]
    v_dot2_f32_bf16 v18, v32, s43, v18
    v_dot2_f32_bf16 v22, v32, v32, v22
    v_dot2_f32_bf16 v18, v33, s43, v18
    v_dot2_f32_bf16 v22, v33, v33, v22
    v_dot2_f32_bf16 v18, v34, s43, v18
    v_dot2_f32_bf16 v22, v34, v34, v22
    v_dot2_f32_bf16 v18, v35, s43, v18
    v_dot2_f32_bf16 v22, v35, v35, v22
    v_mfma_f32_16x16x32_bf16 v[192:195], v[36:39], v[44:47], v[192:195]
    v_mfma_f32_16x16x32_bf16 v[196:199], v[36:39], v[48:51], v[196:199]
    v_mfma_f32_16x16x32_bf16 v[200:203], v[36:39], v[52:55], v[200:203]
    v_mfma_f32_16x16x32_bf16 v[204:207], v[36:39], v[56:59], v[204:207]
    v_mfma_f32_16x16x32_bf16 v[208:211], v[36:39], v[60:63], v[208:211]
    v_mfma_f32_16x16x32_bf16 v[212:215], v[36:39], v[64:67], v[212:215]
    v_mfma_f32_16x16x32_bf16 v[216:219], v[36:39], v[68:71], v[216:219]
    v_mfma_f32_16x16x32_bf16 v[220:223], v[36:39], v[72:75], v[220:223]
    v_dot2_f32_bf16 v19, v36, s43, v19
    v_dot2_f32_bf16 v23, v36, v36, v23
    v_dot2_f32_bf16 v19, v37, s43, v19
    v_dot2_f32_bf16 v23, v37, v37, v23
    v_dot2_f32_bf16 v19, v38, s43, v19
    v_dot2_f32_bf16 v23, v38, v38, v23
    v_dot2_f32_bf16 v19, v39, s43, v19
    v_dot2_f32_bf16 v23, v39, v39, v23
    v_mfma_f32_16x16x32_bf16 v[224:227], v[40:43], v[44:47], v[224:227]
    v_mfma_f32_16x16x32_bf16 v[228:231], v[40:43], v[48:51], v[228:231]
    v_mfma_f32_16x16x32_bf16 v[232:235], v[40:43], v[52:55], v[232:235]
    v_mfma_f32_16x16x32_bf16 v[236:239], v[40:43], v[56:59], v[236:239]
    v_mfma_f32_16x16x32_bf16 v[240:243], v[40:43], v[60:63], v[240:243]
    v_mfma_f32_16x16x32_bf16 v[244:247], v[40:43], v[64:67], v[244:247]
    v_mfma_f32_16x16x32_bf16 v[248:251], v[40:43], v[68:71], v[248:251]
    v_mfma_f32_16x16x32_bf16 v[252:255], v[40:43], v[72:75], v[252:255]
    v_dot2_f32_bf16 v20, v40, s43, v20
    v_dot2_f32_bf16 v24, v40, v40, v24
    v_dot2_f32_bf16 v20, v41, s43, v20
    v_dot2_f32_bf16 v24, v41, v41, v24
    v_dot2_f32_bf16 v20, v42, s43, v20
    v_dot2_f32_bf16 v24, v42, v42, v24
    v_dot2_f32_bf16 v20, v43, s43, v20
    v_dot2_f32_bf16 v24, v43, v43, v24
    s_waitcnt lgkmcnt(0)
    v_mfma_f32_16x16x32_bf16 v[128:131], v[76:79], v[92:95], v[128:131]
    v_mfma_f32_16x16x32_bf16 v[132:135], v[76:79], v[96:99], v[132:135]
    v_mfma_f32_16x16x32_bf16 v[136:139], v[76:79], v[100:103], v[136:139]
    v_mfma_f32_16x16x32_bf16 v[140:143], v[76:79], v[104:107], v[140:143]
    v_mfma_f32_16x16x32_bf16 v[144:147], v[76:79], v[108:111], v[144:147]
    v_mfma_f32_16x16x32_bf16 v[148:151], v[76:79], v[112:115], v[148:151]
    v_mfma_f32_16x16x32_bf16 v[152:155], v[76:79], v[116:119], v[152:155]
    v_mfma_f32_16x16x32_bf16 v[156:159], v[76:79], v[120:123], v[156:159]
    v_dot2_f32_bf16 v17, v76, s43, v17
    v_dot2_f32_bf16 v21, v76, v76, v21
    v_dot2_f32_bf16 v17, v77, s43, v17
    v_dot2_f32_bf16 v21, v77, v77, v21
    v_dot2_f32_bf16 v17, v78, s43, v17
    v_dot2_f32_bf16 v21, v78, v78, v21
    v_dot2_f32_bf16 v17, v79, s43, v17
    v_dot2_f32_bf16 v21, v79, v79, v21
    v_mfma_f32_16x16x32_bf16 v[160:163], v[80:83], v[92:95], v[160:163]
    v_mfma_f32_16x16x32_bf16 v[164:167], v[80:83], v[96:99], v[164:167]
    v_mfma_f32_16x16x32_bf16 v[168:171], v[80:83], v[100:103], v[168:171]
    v_mfma_f32_16x16x32_bf16 v[172:175], v[80:83], v[104:107], v[172:175]
    v_mfma_f32_16x16x32_bf16 v[176:179], v[80:83], v[108:111], v[176:179]
    v_mfma_f32_16x16x32_bf16 v[180:183], v[80:83], v[112:115], v[180:183]
    v_mfma_f32_16x16x32_bf16 v[184:187], v[80:83], v[116:119], v[184:187]
    v_mfma_f32_16x16x32_bf16 v[188:191], v[80:83], v[120:123], v[188:191]
    v_dot2_f32_bf16 v18, v80, s43, v18
    v_dot2_f32_bf16 v22, v80, v80, v22
    v_dot2_f32_bf16 v18, v81, s43, v18
    v_dot2_f32_bf16 v22, v81, v81, v22
    v_dot2_f32_bf16 v18, v82, s43, v18
    v_dot2_f32_bf16 v22, v82, v82, v22
    v_dot2_f32_bf16 v18, v83, s43, v18
    v_dot2_f32_bf16 v22, v83, v83, v22
    v_mfma_f32_16x16x32_bf16 v[192:195], v[84:87], v[92:95], v[192:195]
    v_mfma_f32_16x16x32_bf16 v[196:199], v[84:87], v[96:99], v[196:199]
    v_mfma_f32_16x16x32_bf16 v[200:203], v[84:87], v[100:103], v[200:203]
    v_mfma_f32_16x16x32_bf16 v[204:207], v[84:87], v[104:107], v[204:207]
    v_mfma_f32_16x16x32_bf16 v[208:211], v[84:87], v[108:111], v[208:211]
    v_mfma_f32_16x16x32_bf16 v[212:215], v[84:87], v[112:115], v[212:215]
    v_mfma_f32_16x16x32_bf16 v[216:219], v[84:87], v[116:119], v[216:219]
    v_mfma_f32_16x16x32_bf16 v[220:223], v[84:87], v[120:123], v[220:223]
    v_dot2_f32_bf16 v19, v84, s43, v19
    v_dot2_f32_bf16 v23, v84, v84, v23
    v_dot2_f32_bf16 v19, v85, s43, v19
    v_dot2_f32_bf16 v23, v85, v85, v23
    v_dot2_f32_bf16 v19, v86, s43, v19
    v_dot2_f32_bf16 v23, v86, v86, v23
    v_dot2_f32_bf16 v19, v87, s43, v19
    v_dot2_f32_bf16 v23, v87, v87, v23
    v_mfma_f32_16x16x32_bf16 v[224:227], v[88:91], v[92:95], v[224:227]
    v_mfma_f32_16x16x32_bf16 v[228:231], v[88:91], v[96:99], v[228:231]
    v_mfma_f32_16x16x32_bf16 v[232:235], v[88:91], v[100:103], v[232:235]
    v_mfma_f32_16x16x32_bf16 v[236:239], v[88:91], v[104:107], v[236:239]
    v_mfma_f32_16x16x32_bf16 v[240:243], v[88:91], v[108:111], v[240:243]
    v_mfma_f32_16x16x32_bf16 v[244:247], v[88:91], v[112:115], v[244:247]
    v_mfma_f32_16x16x32_bf16 v[248:251], v[88:91], v[116:119], v[248:251]
    v_mfma_f32_16x16x32_bf16 v[252:255], v[88:91], v[120:123], v[252:255]
    v_dot2_f32_bf16 v20, v88, s43, v20
    v_dot2_f32_bf16 v24, v88, v88, v24
    v_dot2_f32_bf16 v20, v89, s43, v20
    v_dot2_f32_bf16 v24, v89, v89, v24
    v_dot2_f32_bf16 v20, v90, s43, v20
    v_dot2_f32_bf16 v24, v90, v90, v24
    v_dot2_f32_bf16 v20, v91, s43, v20
    v_dot2_f32_bf16 v24, v91, v91, v24
    v_add_u32 v1, 49152, v1
    v_add_u32 v2, 49152, v2
    v_add_u32 v3, 49152, v3
    v_add_u32 v4, 49152, v4
    v_add_u32 v5, 49152, v5
    v_add_u32 v6, 49152, v6
    v_add_u32 v7, 49152, v7
    v_add_u32 v8, 49152, v8
    s_waitcnt vmcnt(0)
    s_barrier
    ds_read_b64_tr_b16 v[28:29], v1 offset:0
    ds_read_b64_tr_b16 v[30:31], v1 offset:1024
    ds_read_b64_tr_b16 v[32:33], v2 offset:0
    ds_read_b64_tr_b16 v[34:35], v2 offset:1024
    ds_read_b64_tr_b16 v[36:37], v3 offset:0
    ds_read_b64_tr_b16 v[38:39], v3 offset:1024
    ds_read_b64_tr_b16 v[40:41], v4 offset:0
    ds_read_b64_tr_b16 v[42:43], v4 offset:1024
    ds_read_b64_tr_b16 v[44:45], v5 offset:0
    ds_read_b64_tr_b16 v[46:47], v5 offset:1024
    ds_read_b64_tr_b16 v[48:49], v6 offset:0
    ds_read_b64_tr_b16 v[50:51], v6 offset:1024
    ds_read_b64_tr_b16 v[52:53], v7 offset:0
    ds_read_b64_tr_b16 v[54:55], v7 offset:1024
    ds_read_b64_tr_b16 v[56:57], v8 offset:0
    ds_read_b64_tr_b16 v[58:59], v8 offset:1024
    ds_read_b64_tr_b16 v[60:61], v5 offset:16384
    ds_read_b64_tr_b16 v[62:63], v5 offset:17408
    ds_read_b64_tr_b16 v[64:65], v6 offset:16384
    ds_read_b64_tr_b16 v[66:67], v6 offset:17408
    ds_read_b64_tr_b16 v[68:69], v7 offset:16384
    ds_read_b64_tr_b16 v[70:71], v7 offset:17408
    ds_read_b64_tr_b16 v[72:73], v8 offset:16384
    ds_read_b64_tr_b16 v[74:75], v8 offset:17408
    s_waitcnt lgkmcnt(0)
    ds_read_b64_tr_b16 v[76:77], v1 offset:8192
    ds_read_b64_tr_b16 v[78:79], v1 offset:9216
    ds_read_b64_tr_b16 v[80:81], v2 offset:8192
    ds_read_b64_tr_b16 v[82:83], v2 offset:9216
    ds_read_b64_tr_b16 v[84:85], v3 offset:8192
    ds_read_b64_tr_b16 v[86:87], v3 offset:9216
    ds_read_b64_tr_b16 v[88:89], v4 offset:8192
    ds_read_b64_tr_b16 v[90:91], v4 offset:9216
    ds_read_b64_tr_b16 v[92:93], v5 offset:8192
    ds_read_b64_tr_b16 v[94:95], v5 offset:9216
    ds_read_b64_tr_b16 v[96:97], v6 offset:8192
    ds_read_b64_tr_b16 v[98:99], v6 offset:9216
    ds_read_b64_tr_b16 v[100:101], v7 offset:8192
    ds_read_b64_tr_b16 v[102:103], v7 offset:9216
    ds_read_b64_tr_b16 v[104:105], v8 offset:8192
    ds_read_b64_tr_b16 v[106:107], v8 offset:9216
    ds_read_b64_tr_b16 v[108:109], v5 offset:24576
    ds_read_b64_tr_b16 v[110:111], v5 offset:25600
    ds_read_b64_tr_b16 v[112:113], v6 offset:24576
    ds_read_b64_tr_b16 v[114:115], v6 offset:25600
    ds_read_b64_tr_b16 v[116:117], v7 offset:24576
    ds_read_b64_tr_b16 v[118:119], v7 offset:25600
    ds_read_b64_tr_b16 v[120:121], v8 offset:24576
    ds_read_b64_tr_b16 v[122:123], v8 offset:25600
    v_mfma_f32_16x16x32_bf16 v[128:131], v[28:31], v[44:47], v[128:131]
    v_mfma_f32_16x16x32_bf16 v[132:135], v[28:31], v[48:51], v[132:135]
    v_mfma_f32_16x16x32_bf16 v[136:139], v[28:31], v[52:55], v[136:139]
    v_mfma_f32_16x16x32_bf16 v[140:143], v[28:31], v[56:59], v[140:143]
    v_mfma_f32_16x16x32_bf16 v[144:147], v[28:31], v[60:63], v[144:147]
    v_mfma_f32_16x16x32_bf16 v[148:151], v[28:31], v[64:67], v[148:151]
    v_mfma_f32_16x16x32_bf16 v[152:155], v[28:31], v[68:71], v[152:155]
    v_mfma_f32_16x16x32_bf16 v[156:159], v[28:31], v[72:75], v[156:159]
    v_dot2_f32_bf16 v17, v28, s43, v17
    v_dot2_f32_bf16 v21, v28, v28, v21
    v_dot2_f32_bf16 v17, v29, s43, v17
    v_dot2_f32_bf16 v21, v29, v29, v21
    v_dot2_f32_bf16 v17, v30, s43, v17
    v_dot2_f32_bf16 v21, v30, v30, v21
    v_dot2_f32_bf16 v17, v31, s43, v17
    v_dot2_f32_bf16 v21, v31, v31, v21
    v_mfma_f32_16x16x32_bf16 v[160:163], v[32:35], v[44:47], v[160:163]
    v_mfma_f32_16x16x32_bf16 v[164:167], v[32:35], v[48:51], v[164:167]
    v_mfma_f32_16x16x32_bf16 v[168:171], v[32:35], v[52:55], v[168:171]
    v_mfma_f32_16x16x32_bf16 v[172:175], v[32:35], v[56:59], v[172:175]
    v_mfma_f32_16x16x32_bf16 v[176:179], v[32:35], v[60:63], v[176:179]
    v_mfma_f32_16x16x32_bf16 v[180:183], v[32:35], v[64:67], v[180:183]
    v_mfma_f32_16x16x32_bf16 v[184:187], v[32:35], v[68:71], v[184:187]
    v_mfma_f32_16x16x32_bf16 v[188:191], v[32:35], v[72:75], v[188:191]
    v_dot2_f32_bf16 v18, v32, s43, v18
    v_dot2_f32_bf16 v22, v32, v32, v22
    v_dot2_f32_bf16 v18, v33, s43, v18
    v_dot2_f32_bf16 v22, v33, v33, v22
    v_dot2_f32_bf16 v18, v34, s43, v18
    v_dot2_f32_bf16 v22, v34, v34, v22
    v_dot2_f32_bf16 v18, v35, s43, v18
    v_dot2_f32_bf16 v22, v35, v35, v22
    v_mfma_f32_16x16x32_bf16 v[192:195], v[36:39], v[44:47], v[192:195]
    v_mfma_f32_16x16x32_bf16 v[196:199], v[36:39], v[48:51], v[196:199]
    v_mfma_f32_16x16x32_bf16 v[200:203], v[36:39], v[52:55], v[200:203]
    v_mfma_f32_16x16x32_bf16 v[204:207], v[36:39], v[56:59], v[204:207]
    v_mfma_f32_16x16x32_bf16 v[208:211], v[36:39], v[60:63], v[208:211]
    v_mfma_f32_16x16x32_bf16 v[212:215], v[36:39], v[64:67], v[212:215]
    v_mfma_f32_16x16x32_bf16 v[216:219], v[36:39], v[68:71], v[216:219]
    v_mfma_f32_16x16x32_bf16 v[220:223], v[36:39], v[72:75], v[220:223]
    v_dot2_f32_bf16 v19, v36, s43, v19
    v_dot2_f32_bf16 v23, v36, v36, v23
    v_dot2_f32_bf16 v19, v37, s43, v19
    v_dot2_f32_bf16 v23, v37, v37, v23
    v_dot2_f32_bf16 v19, v38, s43, v19
    v_dot2_f32_bf16 v23, v38, v38, v23
    v_dot2_f32_bf16 v19, v39, s43, v19
    v_dot2_f32_bf16 v23, v39, v39, v23
    v_mfma_f32_16x16x32_bf16 v[224:227], v[40:43], v[44:47], v[224:227]
    v_mfma_f32_16x16x32_bf16 v[228:231], v[40:43], v[48:51], v[228:231]
    v_mfma_f32_16x16x32_bf16 v[232:235], v[40:43], v[52:55], v[232:235]
    v_mfma_f32_16x16x32_bf16 v[236:239], v[40:43], v[56:59], v[236:239]
    v_mfma_f32_16x16x32_bf16 v[240:243], v[40:43], v[60:63], v[240:243]
    v_mfma_f32_16x16x32_bf16 v[244:247], v[40:43], v[64:67], v[244:247]
    v_mfma_f32_16x16x32_bf16 v[248:251], v[40:43], v[68:71], v[248:251]
    v_mfma_f32_16x16x32_bf16 v[252:255], v[40:43], v[72:75], v[252:255]
    v_dot2_f32_bf16 v20, v40, s43, v20
    v_dot2_f32_bf16 v24, v40, v40, v24
    v_dot2_f32_bf16 v20, v41, s43, v20
    v_dot2_f32_bf16 v24, v41, v41, v24
    v_dot2_f32_bf16 v20, v42, s43, v20
    v_dot2_f32_bf16 v24, v42, v42, v24
    v_dot2_f32_bf16 v20, v43, s43, v20
    v_dot2_f32_bf16 v24, v43, v43, v24
    s_waitcnt lgkmcnt(0)
    v_mfma_f32_16x16x32_bf16 v[128:131], v[76:79], v[92:95], v[128:131]
    v_mfma_f32_16x16x32_bf16 v[132:135], v[76:79], v[96:99], v[132:135]
    v_mfma_f32_16x16x32_bf16 v[136:139], v[76:79], v[100:103], v[136:139]
    v_mfma_f32_16x16x32_bf16 v[140:143], v[76:79], v[104:107], v[140:143]
    v_mfma_f32_16x16x32_bf16 v[144:147], v[76:79], v[108:111], v[144:147]
    v_mfma_f32_16x16x32_bf16 v[148:151], v[76:79], v[112:115], v[148:151]
    v_mfma_f32_16x16x32_bf16 v[152:155], v[76:79], v[116:119], v[152:155]
    v_mfma_f32_16x16x32_bf16 v[156:159], v[76:79], v[120:123], v[156:159]
    v_dot2_f32_bf16 v17, v76, s43, v17
    v_dot2_f32_bf16 v21, v76, v76, v21
    v_dot2_f32_bf16 v17, v77, s43, v17
    v_dot2_f32_bf16 v21, v77, v77, v21
    v_dot2_f32_bf16 v17, v78, s43, v17
    v_dot2_f32_bf16 v21, v78, v78, v21
    v_dot2_f32_bf16 v17, v79, s43, v17
    v_dot2_f32_bf16 v21, v79, v79, v21
    v_mfma_f32_16x16x32_bf16 v[160:163], v[80:83], v[92:95], v[160:163]
    v_mfma_f32_16x16x32_bf16 v[164:167], v[80:83], v[96:99], v[164:167]
    v_mfma_f32_16x16x32_bf16 v[168:171], v[80:83], v[100:103], v[168:171]
    v_mfma_f32_16x16x32_bf16 v[172:175], v[80:83], v[104:107], v[172:175]
    v_mfma_f32_16x16x32_bf16 v[176:179], v[80:83], v[108:111], v[176:179]
    v_mfma_f32_16x16x32_bf16 v[180:183], v[80:83], v[112:115], v[180:183]
    v_mfma_f32_16x16x32_bf16 v[184:187], v[80:83], v[116:119], v[184:187]
    v_mfma_f32_16x16x32_bf16 v[188:191], v[80:83], v[120:123], v[188:191]
    v_dot2_f32_bf16 v18, v80, s43, v18
    v_dot2_f32_bf16 v22, v80, v80, v22
    v_dot2_f32_bf16 v18, v81, s43, v18
    v_dot2_f32_bf16 v22, v81, v81, v22
    v_dot2_f32_bf16 v18, v82, s43, v18
    v_dot2_f32_bf16 v22, v82, v82, v22
    v_dot2_f32_bf16 v18, v83, s43, v18
    v_dot2_f32_bf16 v22, v83, v83, v22
    v_mfma_f32_16x16x32_bf16 v[192:195], v[84:87], v[92:95], v[192:195]
    v_mfma_f32_16x16x32_bf16 v[196:199], v[84:87], v[96:99], v[196:199]
    v_mfma_f32_16x16x32_bf16 v[200:203], v[84:87], v[100:103], v[200:203]
    v_mfma_f32_16x16x32_bf16 v[204:207], v[84:87], v[104:107], v[204:207]
    v_mfma_f32_16x16x32_bf16 v[208:211], v[84:87], v[108:111], v[208:211]
    v_mfma_f32_16x16x32_bf16 v[212:215], v[84:87], v[112:115], v[212:215]
    v_mfma_f32_16x16x32_bf16 v[216:219], v[84:87], v[116:119], v[216:219]
    v_mfma_f32_16x16x32_bf16 v[220:223], v[84:87], v[120:123], v[220:223]
    v_dot2_f32_bf16 v19, v84, s43, v19
    v_dot2_f32_bf16 v23, v84, v84, v23
    v_dot2_f32_bf16 v19, v85, s43, v19
    v_dot2_f32_bf16 v23, v85, v85, v23
    v_dot2_f32_bf16 v19, v86, s43, v19
    v_dot2_f32_bf16 v23, v86, v86, v23
    v_dot2_f32_bf16 v19, v87, s43, v19
    v_dot2_f32_bf16 v23, v87, v87, v23
    v_mfma_f32_16x16x32_bf16 v[224:227], v[88:91], v[92:95], v[224:227]
    v_mfma_f32_16x16x32_bf16 v[228:231], v[88:91], v[96:99], v[228:231]
    v_mfma_f32_16x16x32_bf16 v[232:235], v[88:91], v[100:103], v[232:235]
    v_mfma_f32_16x16x32_bf16 v[236:239], v[88:91], v[104:107], v[236:239]
    v_mfma_f32_16x16x32_bf16 v[240:243], v[88:91], v[108:111], v[240:243]
    v_mfma_f32_16x16x32_bf16 v[244:247], v[88:91], v[112:115], v[244:247]
    v_mfma_f32_16x16x32_bf16 v[248:251], v[88:91], v[116:119], v[248:251]
    v_mfma_f32_16x16x32_bf16 v[252:255], v[88:91], v[120:123], v[252:255]
    v_dot2_f32_bf16 v20, v88, s43, v20
    v_dot2_f32_bf16 v24, v88, v88, v24
    v_dot2_f32_bf16 v20, v89, s43, v20
    v_dot2_f32_bf16 v24, v89, v89, v24
    v_dot2_f32_bf16 v20, v90, s43, v20
    v_dot2_f32_bf16 v24, v90, v90, v24
    v_dot2_f32_bf16 v20, v91, s43, v20
    v_dot2_f32_bf16 v24, v91, v91, v24
    v_add_u32 v1, 49152, v1
    v_add_u32 v2, 49152, v2
    v_add_u32 v3, 49152, v3
    v_add_u32 v4, 49152, v4
    v_add_u32 v5, 49152, v5
    v_add_u32 v6, 49152, v6
    v_add_u32 v7, 49152, v7
    v_add_u32 v8, 49152, v8
    s_barrier
    s_lshl_b32 s35, s30, 12
    v_lshlrev_b32 v0, 5, v26
    v_lshl_add_u32 v0, v27, 3, v0
    v_add_u32 v0, s35, v0
    v_mov_b32 v2, v17
    v_mov_b32 v3, v21
    ds_write_b64 v0, v[2:3] offset:0
    v_mov_b32 v2, v18
    v_mov_b32 v3, v22
    ds_write_b64 v0, v[2:3] offset:512
    v_mov_b32 v2, v19
    v_mov_b32 v3, v23
    ds_write_b64 v0, v[2:3] offset:1024
    v_mov_b32 v2, v20
    v_mov_b32 v3, v24
    ds_write_b64 v0, v[2:3] offset:1536
    v_lshl_add_u32 v1, v25, 5, s35
    s_waitcnt lgkmcnt(0)
    ds_read_b128 v[2:5], v1
    ds_read_b128 v[6:9], v1 offset:16
    s_waitcnt lgkmcnt(0)
    v_add_f32 v2, v2, v4
    v_add_f32 v6, v6, v8
    v_add_f32 v2, v2, v6
    v_add_f32 v3, v3, v5
    v_add_f32 v7, v7, v9
    v_add_f32 v3, v3, v7
    v_mul_f32 v6, 0x3b000000, v2
    v_mul_f32 v7, 0x3b000000, v3
    v_fma_f32 v7, -v6, v6, v7
    v_max_f32 v7, 0, v7
    v_cvt_pk_bf16_f32 v6, v6, v7
    s_nop 0
    v_lshlrev_b32 v4, 16, v6
    v_and_b32 v7, 0xffff0000, v6
    v_add_f32 v7, 0x3727c5ac, v7
    v_cvt_pk_bf16_f32 v7, v7, v7
    s_nop 0
    v_lshlrev_b32 v7, 16, v7
    v_sqrt_f32 v7, v7
    s_nop 0
    v_cvt_pk_bf16_f32 v7, v7, v7
    s_nop 0
    v_lshlrev_b32 v7, 16, v7
    v_rcp_f32 v5, v7
    s_nop 0
    v_lshl_add_u32 v1, v25, 3, s35
    ds_write_b64 v1, v[4:5] offset:2048
    s_lshl_b32 s36, s32, 6
    s_add_u32 s36, s36, s34
    v_add_u32 v2, s36, v26
    v_lshlrev_b32 v2, 2, v2
    s_movk_i32 s39, 0
    buffer_load_dword v28, v2, s[24:27], s39 offen offset:0
    s_movk_i32 s39, 0
    buffer_load_dword v29, v2, s[24:27], s39 offen offset:64
    s_movk_i32 s39, 0
    buffer_load_dword v30, v2, s[24:27], s39 offen offset:128
    s_movk_i32 s39, 0
    buffer_load_dword v31, v2, s[24:27], s39 offen offset:192
    s_movk_i32 s39, 7168
    buffer_load_dword v32, v2, s[24:27], s39 offen offset:0
    s_movk_i32 s39, 7168
    buffer_load_dword v33, v2, s[24:27], s39 offen offset:64
    s_movk_i32 s39, 7168
    buffer_load_dword v34, v2, s[24:27], s39 offen offset:128
    s_movk_i32 s39, 7168
    buffer_load_dword v35, v2, s[24:27], s39 offen offset:192
    v_lshl_add_u32 v1, v27, 5, s35
    s_waitcnt lgkmcnt(0)
    ds_read_b64 v[40:41], v1 offset:2048
    ds_read_b64 v[42:43], v1 offset:2056
    ds_read_b64 v[44:45], v1 offset:2064
    ds_read_b64 v[46:47], v1 offset:2072
    ds_read_b64 v[48:49], v1 offset:2176
    ds_read_b64 v[50:51], v1 offset:2184
    ds_read_b64 v[52:53], v1 offset:2192
    ds_read_b64 v[54:55], v1 offset:2200
    ds_read_b64 v[56:57], v1 offset:2304
    ds_read_b64 v[58:59], v1 offset:2312
    ds_read_b64 v[60:61], v1 offset:2320
    ds_read_b64 v[62:63], v1 offset:2328
    ds_read_b64 v[64:65], v1 offset:2432
    ds_read_b64 v[66:67], v1 offset:2440
    ds_read_b64 v[68:69], v1 offset:2448
    ds_read_b64 v[70:71], v1 offset:2456
    v_lshlrev_b32 v3, 12, v2
    v_lshrrev_b32 v3, 2, v3
    v_lshl_add_u32 v3, v27, 3, v3
    s_lshl_b32 s37, s31, 6
    s_add_u32 s37, s37, s33
    s_lshl_b32 s37, s37, 1
    s_waitcnt vmcnt(0) lgkmcnt(0)
    v_fma_f32 v80, -v40, v28, v128
    v_mul_f32 v80, v80, v41
    v_fma_f32 v81, -v42, v28, v129
    v_mul_f32 v81, v81, v43
    v_fma_f32 v82, -v44, v28, v130
    v_mul_f32 v82, v82, v45
    v_fma_f32 v83, -v46, v28, v131
    v_mul_f32 v83, v83, v47
    v_fma_f32 v84, -v40, v32, v144
    v_mul_f32 v84, v84, v41
    v_fma_f32 v85, -v42, v32, v145
    v_mul_f32 v85, v85, v43
    v_fma_f32 v86, -v44, v32, v146
    v_mul_f32 v86, v86, v45
    v_fma_f32 v87, -v46, v32, v147
    v_mul_f32 v87, v87, v47
    v_cvt_pk_bf16_f32 v80, v80, v80
    v_cvt_pk_bf16_f32 v81, v81, v81
    v_cvt_pk_bf16_f32 v82, v82, v82
    v_cvt_pk_bf16_f32 v83, v83, v83
    v_cvt_pk_bf16_f32 v84, v84, v84
    v_cvt_pk_bf16_f32 v85, v85, v85
    v_cvt_pk_bf16_f32 v86, v86, v86
    v_cvt_pk_bf16_f32 v87, v87, v87
    s_nop 0
    v_lshlrev_b32 v80, 16, v80
    v_lshlrev_b32 v81, 16, v81
    v_lshlrev_b32 v82, 16, v82
    v_lshlrev_b32 v83, 16, v83
    v_lshlrev_b32 v84, 16, v84
    v_lshlrev_b32 v85, 16, v85
    v_lshlrev_b32 v86, 16, v86
    v_lshlrev_b32 v87, 16, v87
    v_mul_f32 v88, v80, v80
    v_fma_f32 v88, v88, s44, 1.0
    v_mul_f32 v88, v88, v80
    v_mul_f32 v88, 0xc0135761, v88
    v_exp_f32 v88, v88
    s_nop 0
    v_add_f32 v88, 1.0, v88
    v_rcp_f32 v88, v88
    s_nop 0
    v_mul_f32 v88, v88, v80
    v_cvt_pk_bf16_f32 v88, v88, v88
    s_nop 0
    v_lshlrev_b32 v88, 16, v88
    v_mul_f32 v88, v88, v84
    v_mul_f32 v89, v81, v81
    v_fma_f32 v89, v89, s44, 1.0
    v_mul_f32 v89, v89, v81
    v_mul_f32 v89, 0xc0135761, v89
    v_exp_f32 v89, v89
    s_nop 0
    v_add_f32 v89, 1.0, v89
    v_rcp_f32 v89, v89
    s_nop 0
    v_mul_f32 v89, v89, v81
    v_cvt_pk_bf16_f32 v89, v89, v89
    s_nop 0
    v_lshlrev_b32 v89, 16, v89
    v_mul_f32 v89, v89, v85
    v_mul_f32 v90, v82, v82
    v_fma_f32 v90, v90, s44, 1.0
    v_mul_f32 v90, v90, v82
    v_mul_f32 v90, 0xc0135761, v90
    v_exp_f32 v90, v90
    s_nop 0
    v_add_f32 v90, 1.0, v90
    v_rcp_f32 v90, v90
    s_nop 0
    v_mul_f32 v90, v90, v82
    v_cvt_pk_bf16_f32 v90, v90, v90
    s_nop 0
    v_lshlrev_b32 v90, 16, v90
    v_mul_f32 v90, v90, v86
    v_mul_f32 v91, v83, v83
    v_fma_f32 v91, v91, s44, 1.0
    v_mul_f32 v91, v91, v83
    v_mul_f32 v91, 0xc0135761, v91
    v_exp_f32 v91, v91
    s_nop 0
    v_add_f32 v91, 1.0, v91
    v_rcp_f32 v91, v91
    s_nop 0
    v_mul_f32 v91, v91, v83
    v_cvt_pk_bf16_f32 v91, v91, v91
    s_nop 0
    v_lshlrev_b32 v91, 16, v91
    v_mul_f32 v91, v91, v87
    v_cvt_pk_bf16_f32 v96, v88, v89
    v_cvt_pk_bf16_f32 v97, v90, v91
    s_add_u32 s38, s37, 0
    s_nop 0
    buffer_store_dwordx2 v[96:97], v3, s[20:23], s38 offen offset:0
    s_nop 0
    v_fma_f32 v80, -v40, v29, v132
    v_mul_f32 v80, v80, v41
    v_fma_f32 v81, -v42, v29, v133
    v_mul_f32 v81, v81, v43
    v_fma_f32 v82, -v44, v29, v134
    v_mul_f32 v82, v82, v45
    v_fma_f32 v83, -v46, v29, v135
    v_mul_f32 v83, v83, v47
    v_fma_f32 v84, -v40, v33, v148
    v_mul_f32 v84, v84, v41
    v_fma_f32 v85, -v42, v33, v149
    v_mul_f32 v85, v85, v43
    v_fma_f32 v86, -v44, v33, v150
    v_mul_f32 v86, v86, v45
    v_fma_f32 v87, -v46, v33, v151
    v_mul_f32 v87, v87, v47
    v_cvt_pk_bf16_f32 v80, v80, v80
    v_cvt_pk_bf16_f32 v81, v81, v81
    v_cvt_pk_bf16_f32 v82, v82, v82
    v_cvt_pk_bf16_f32 v83, v83, v83
    v_cvt_pk_bf16_f32 v84, v84, v84
    v_cvt_pk_bf16_f32 v85, v85, v85
    v_cvt_pk_bf16_f32 v86, v86, v86
    v_cvt_pk_bf16_f32 v87, v87, v87
    s_nop 0
    v_lshlrev_b32 v80, 16, v80
    v_lshlrev_b32 v81, 16, v81
    v_lshlrev_b32 v82, 16, v82
    v_lshlrev_b32 v83, 16, v83
    v_lshlrev_b32 v84, 16, v84
    v_lshlrev_b32 v85, 16, v85
    v_lshlrev_b32 v86, 16, v86
    v_lshlrev_b32 v87, 16, v87
    v_mul_f32 v88, v80, v80
    v_fma_f32 v88, v88, s44, 1.0
    v_mul_f32 v88, v88, v80
    v_mul_f32 v88, 0xc0135761, v88
    v_exp_f32 v88, v88
    s_nop 0
    v_add_f32 v88, 1.0, v88
    v_rcp_f32 v88, v88
    s_nop 0
    v_mul_f32 v88, v88, v80
    v_cvt_pk_bf16_f32 v88, v88, v88
    s_nop 0
    v_lshlrev_b32 v88, 16, v88
    v_mul_f32 v88, v88, v84
    v_mul_f32 v89, v81, v81
    v_fma_f32 v89, v89, s44, 1.0
    v_mul_f32 v89, v89, v81
    v_mul_f32 v89, 0xc0135761, v89
    v_exp_f32 v89, v89
    s_nop 0
    v_add_f32 v89, 1.0, v89
    v_rcp_f32 v89, v89
    s_nop 0
    v_mul_f32 v89, v89, v81
    v_cvt_pk_bf16_f32 v89, v89, v89
    s_nop 0
    v_lshlrev_b32 v89, 16, v89
    v_mul_f32 v89, v89, v85
    v_mul_f32 v90, v82, v82
    v_fma_f32 v90, v90, s44, 1.0
    v_mul_f32 v90, v90, v82
    v_mul_f32 v90, 0xc0135761, v90
    v_exp_f32 v90, v90
    s_nop 0
    v_add_f32 v90, 1.0, v90
    v_rcp_f32 v90, v90
    s_nop 0
    v_mul_f32 v90, v90, v82
    v_cvt_pk_bf16_f32 v90, v90, v90
    s_nop 0
    v_lshlrev_b32 v90, 16, v90
    v_mul_f32 v90, v90, v86
    v_mul_f32 v91, v83, v83
    v_fma_f32 v91, v91, s44, 1.0
    v_mul_f32 v91, v91, v83
    v_mul_f32 v91, 0xc0135761, v91
    v_exp_f32 v91, v91
    s_nop 0
    v_add_f32 v91, 1.0, v91
    v_rcp_f32 v91, v91
    s_nop 0
    v_mul_f32 v91, v91, v83
    v_cvt_pk_bf16_f32 v91, v91, v91
    s_nop 0
    v_lshlrev_b32 v91, 16, v91
    v_mul_f32 v91, v91, v87
    v_cvt_pk_bf16_f32 v96, v88, v89
    v_cvt_pk_bf16_f32 v97, v90, v91
    s_add_u32 s38, s37, 65536
    s_nop 0
    buffer_store_dwordx2 v[96:97], v3, s[20:23], s38 offen offset:0
    s_nop 0
    v_fma_f32 v80, -v40, v30, v136
    v_mul_f32 v80, v80, v41
    v_fma_f32 v81, -v42, v30, v137
    v_mul_f32 v81, v81, v43
    v_fma_f32 v82, -v44, v30, v138
    v_mul_f32 v82, v82, v45
    v_fma_f32 v83, -v46, v30, v139
    v_mul_f32 v83, v83, v47
    v_fma_f32 v84, -v40, v34, v152
    v_mul_f32 v84, v84, v41
    v_fma_f32 v85, -v42, v34, v153
    v_mul_f32 v85, v85, v43
    v_fma_f32 v86, -v44, v34, v154
    v_mul_f32 v86, v86, v45
    v_fma_f32 v87, -v46, v34, v155
    v_mul_f32 v87, v87, v47
    v_cvt_pk_bf16_f32 v80, v80, v80
    v_cvt_pk_bf16_f32 v81, v81, v81
    v_cvt_pk_bf16_f32 v82, v82, v82
    v_cvt_pk_bf16_f32 v83, v83, v83
    v_cvt_pk_bf16_f32 v84, v84, v84
    v_cvt_pk_bf16_f32 v85, v85, v85
    v_cvt_pk_bf16_f32 v86, v86, v86
    v_cvt_pk_bf16_f32 v87, v87, v87
    s_nop 0
    v_lshlrev_b32 v80, 16, v80
    v_lshlrev_b32 v81, 16, v81
    v_lshlrev_b32 v82, 16, v82
    v_lshlrev_b32 v83, 16, v83
    v_lshlrev_b32 v84, 16, v84
    v_lshlrev_b32 v85, 16, v85
    v_lshlrev_b32 v86, 16, v86
    v_lshlrev_b32 v87, 16, v87
    v_mul_f32 v88, v80, v80
    v_fma_f32 v88, v88, s44, 1.0
    v_mul_f32 v88, v88, v80
    v_mul_f32 v88, 0xc0135761, v88
    v_exp_f32 v88, v88
    s_nop 0
    v_add_f32 v88, 1.0, v88
    v_rcp_f32 v88, v88
    s_nop 0
    v_mul_f32 v88, v88, v80
    v_cvt_pk_bf16_f32 v88, v88, v88
    s_nop 0
    v_lshlrev_b32 v88, 16, v88
    v_mul_f32 v88, v88, v84
    v_mul_f32 v89, v81, v81
    v_fma_f32 v89, v89, s44, 1.0
    v_mul_f32 v89, v89, v81
    v_mul_f32 v89, 0xc0135761, v89
    v_exp_f32 v89, v89
    s_nop 0
    v_add_f32 v89, 1.0, v89
    v_rcp_f32 v89, v89
    s_nop 0
    v_mul_f32 v89, v89, v81
    v_cvt_pk_bf16_f32 v89, v89, v89
    s_nop 0
    v_lshlrev_b32 v89, 16, v89
    v_mul_f32 v89, v89, v85
    v_mul_f32 v90, v82, v82
    v_fma_f32 v90, v90, s44, 1.0
    v_mul_f32 v90, v90, v82
    v_mul_f32 v90, 0xc0135761, v90
    v_exp_f32 v90, v90
    s_nop 0
    v_add_f32 v90, 1.0, v90
    v_rcp_f32 v90, v90
    s_nop 0
    v_mul_f32 v90, v90, v82
    v_cvt_pk_bf16_f32 v90, v90, v90
    s_nop 0
    v_lshlrev_b32 v90, 16, v90
    v_mul_f32 v90, v90, v86
    v_mul_f32 v91, v83, v83
    v_fma_f32 v91, v91, s44, 1.0
    v_mul_f32 v91, v91, v83
    v_mul_f32 v91, 0xc0135761, v91
    v_exp_f32 v91, v91
    s_nop 0
    v_add_f32 v91, 1.0, v91
    v_rcp_f32 v91, v91
    s_nop 0
    v_mul_f32 v91, v91, v83
    v_cvt_pk_bf16_f32 v91, v91, v91
    s_nop 0
    v_lshlrev_b32 v91, 16, v91
    v_mul_f32 v91, v91, v87
    v_cvt_pk_bf16_f32 v96, v88, v89
    v_cvt_pk_bf16_f32 v97, v90, v91
    s_add_u32 s38, s37, 131072
    s_nop 0
    buffer_store_dwordx2 v[96:97], v3, s[20:23], s38 offen offset:0
    s_nop 0
    v_fma_f32 v80, -v40, v31, v140
    v_mul_f32 v80, v80, v41
    v_fma_f32 v81, -v42, v31, v141
    v_mul_f32 v81, v81, v43
    v_fma_f32 v82, -v44, v31, v142
    v_mul_f32 v82, v82, v45
    v_fma_f32 v83, -v46, v31, v143
    v_mul_f32 v83, v83, v47
    v_fma_f32 v84, -v40, v35, v156
    v_mul_f32 v84, v84, v41
    v_fma_f32 v85, -v42, v35, v157
    v_mul_f32 v85, v85, v43
    v_fma_f32 v86, -v44, v35, v158
    v_mul_f32 v86, v86, v45
    v_fma_f32 v87, -v46, v35, v159
    v_mul_f32 v87, v87, v47
    v_cvt_pk_bf16_f32 v80, v80, v80
    v_cvt_pk_bf16_f32 v81, v81, v81
    v_cvt_pk_bf16_f32 v82, v82, v82
    v_cvt_pk_bf16_f32 v83, v83, v83
    v_cvt_pk_bf16_f32 v84, v84, v84
    v_cvt_pk_bf16_f32 v85, v85, v85
    v_cvt_pk_bf16_f32 v86, v86, v86
    v_cvt_pk_bf16_f32 v87, v87, v87
    s_nop 0
    v_lshlrev_b32 v80, 16, v80
    v_lshlrev_b32 v81, 16, v81
    v_lshlrev_b32 v82, 16, v82
    v_lshlrev_b32 v83, 16, v83
    v_lshlrev_b32 v84, 16, v84
    v_lshlrev_b32 v85, 16, v85
    v_lshlrev_b32 v86, 16, v86
    v_lshlrev_b32 v87, 16, v87
    v_mul_f32 v88, v80, v80
    v_fma_f32 v88, v88, s44, 1.0
    v_mul_f32 v88, v88, v80
    v_mul_f32 v88, 0xc0135761, v88
    v_exp_f32 v88, v88
    s_nop 0
    v_add_f32 v88, 1.0, v88
    v_rcp_f32 v88, v88
    s_nop 0
    v_mul_f32 v88, v88, v80
    v_cvt_pk_bf16_f32 v88, v88, v88
    s_nop 0
    v_lshlrev_b32 v88, 16, v88
    v_mul_f32 v88, v88, v84
    v_mul_f32 v89, v81, v81
    v_fma_f32 v89, v89, s44, 1.0
    v_mul_f32 v89, v89, v81
    v_mul_f32 v89, 0xc0135761, v89
    v_exp_f32 v89, v89
    s_nop 0
    v_add_f32 v89, 1.0, v89
    v_rcp_f32 v89, v89
    s_nop 0
    v_mul_f32 v89, v89, v81
    v_cvt_pk_bf16_f32 v89, v89, v89
    s_nop 0
    v_lshlrev_b32 v89, 16, v89
    v_mul_f32 v89, v89, v85
    v_mul_f32 v90, v82, v82
    v_fma_f32 v90, v90, s44, 1.0
    v_mul_f32 v90, v90, v82
    v_mul_f32 v90, 0xc0135761, v90
    v_exp_f32 v90, v90
    s_nop 0
    v_add_f32 v90, 1.0, v90
    v_rcp_f32 v90, v90
    s_nop 0
    v_mul_f32 v90, v90, v82
    v_cvt_pk_bf16_f32 v90, v90, v90
    s_nop 0
    v_lshlrev_b32 v90, 16, v90
    v_mul_f32 v90, v90, v86
    v_mul_f32 v91, v83, v83
    v_fma_f32 v91, v91, s44, 1.0
    v_mul_f32 v91, v91, v83
    v_mul_f32 v91, 0xc0135761, v91
    v_exp_f32 v91, v91
    s_nop 0
    v_add_f32 v91, 1.0, v91
    v_rcp_f32 v91, v91
    s_nop 0
    v_mul_f32 v91, v91, v83
    v_cvt_pk_bf16_f32 v91, v91, v91
    s_nop 0
    v_lshlrev_b32 v91, 16, v91
    v_mul_f32 v91, v91, v87
    v_cvt_pk_bf16_f32 v96, v88, v89
    v_cvt_pk_bf16_f32 v97, v90, v91
    s_add_u32 s38, s37, 196608
    s_nop 0
    buffer_store_dwordx2 v[96:97], v3, s[20:23], s38 offen offset:0
    s_nop 0
    v_fma_f32 v80, -v48, v28, v160
    v_mul_f32 v80, v80, v49
    v_fma_f32 v81, -v50, v28, v161
    v_mul_f32 v81, v81, v51
    v_fma_f32 v82, -v52, v28, v162
    v_mul_f32 v82, v82, v53
    v_fma_f32 v83, -v54, v28, v163
    v_mul_f32 v83, v83, v55
    v_fma_f32 v84, -v48, v32, v176
    v_mul_f32 v84, v84, v49
    v_fma_f32 v85, -v50, v32, v177
    v_mul_f32 v85, v85, v51
    v_fma_f32 v86, -v52, v32, v178
    v_mul_f32 v86, v86, v53
    v_fma_f32 v87, -v54, v32, v179
    v_mul_f32 v87, v87, v55
    v_cvt_pk_bf16_f32 v80, v80, v80
    v_cvt_pk_bf16_f32 v81, v81, v81
    v_cvt_pk_bf16_f32 v82, v82, v82
    v_cvt_pk_bf16_f32 v83, v83, v83
    v_cvt_pk_bf16_f32 v84, v84, v84
    v_cvt_pk_bf16_f32 v85, v85, v85
    v_cvt_pk_bf16_f32 v86, v86, v86
    v_cvt_pk_bf16_f32 v87, v87, v87
    s_nop 0
    v_lshlrev_b32 v80, 16, v80
    v_lshlrev_b32 v81, 16, v81
    v_lshlrev_b32 v82, 16, v82
    v_lshlrev_b32 v83, 16, v83
    v_lshlrev_b32 v84, 16, v84
    v_lshlrev_b32 v85, 16, v85
    v_lshlrev_b32 v86, 16, v86
    v_lshlrev_b32 v87, 16, v87
    v_mul_f32 v88, v80, v80
    v_fma_f32 v88, v88, s44, 1.0
    v_mul_f32 v88, v88, v80
    v_mul_f32 v88, 0xc0135761, v88
    v_exp_f32 v88, v88
    s_nop 0
    v_add_f32 v88, 1.0, v88
    v_rcp_f32 v88, v88
    s_nop 0
    v_mul_f32 v88, v88, v80
    v_cvt_pk_bf16_f32 v88, v88, v88
    s_nop 0
    v_lshlrev_b32 v88, 16, v88
    v_mul_f32 v88, v88, v84
    v_mul_f32 v89, v81, v81
    v_fma_f32 v89, v89, s44, 1.0
    v_mul_f32 v89, v89, v81
    v_mul_f32 v89, 0xc0135761, v89
    v_exp_f32 v89, v89
    s_nop 0
    v_add_f32 v89, 1.0, v89
    v_rcp_f32 v89, v89
    s_nop 0
    v_mul_f32 v89, v89, v81
    v_cvt_pk_bf16_f32 v89, v89, v89
    s_nop 0
    v_lshlrev_b32 v89, 16, v89
    v_mul_f32 v89, v89, v85
    v_mul_f32 v90, v82, v82
    v_fma_f32 v90, v90, s44, 1.0
    v_mul_f32 v90, v90, v82
    v_mul_f32 v90, 0xc0135761, v90
    v_exp_f32 v90, v90
    s_nop 0
    v_add_f32 v90, 1.0, v90
    v_rcp_f32 v90, v90
    s_nop 0
    v_mul_f32 v90, v90, v82
    v_cvt_pk_bf16_f32 v90, v90, v90
    s_nop 0
    v_lshlrev_b32 v90, 16, v90
    v_mul_f32 v90, v90, v86
    v_mul_f32 v91, v83, v83
    v_fma_f32 v91, v91, s44, 1.0
    v_mul_f32 v91, v91, v83
    v_mul_f32 v91, 0xc0135761, v91
    v_exp_f32 v91, v91
    s_nop 0
    v_add_f32 v91, 1.0, v91
    v_rcp_f32 v91, v91
    s_nop 0
    v_mul_f32 v91, v91, v83
    v_cvt_pk_bf16_f32 v91, v91, v91
    s_nop 0
    v_lshlrev_b32 v91, 16, v91
    v_mul_f32 v91, v91, v87
    v_cvt_pk_bf16_f32 v96, v88, v89
    v_cvt_pk_bf16_f32 v97, v90, v91
    s_add_u32 s38, s37, 0
    s_nop 0
    buffer_store_dwordx2 v[96:97], v3, s[20:23], s38 offen offset:32
    s_nop 0
    v_fma_f32 v80, -v48, v29, v164
    v_mul_f32 v80, v80, v49
    v_fma_f32 v81, -v50, v29, v165
    v_mul_f32 v81, v81, v51
    v_fma_f32 v82, -v52, v29, v166
    v_mul_f32 v82, v82, v53
    v_fma_f32 v83, -v54, v29, v167
    v_mul_f32 v83, v83, v55
    v_fma_f32 v84, -v48, v33, v180
    v_mul_f32 v84, v84, v49
    v_fma_f32 v85, -v50, v33, v181
    v_mul_f32 v85, v85, v51
    v_fma_f32 v86, -v52, v33, v182
    v_mul_f32 v86, v86, v53
    v_fma_f32 v87, -v54, v33, v183
    v_mul_f32 v87, v87, v55
    v_cvt_pk_bf16_f32 v80, v80, v80
    v_cvt_pk_bf16_f32 v81, v81, v81
    v_cvt_pk_bf16_f32 v82, v82, v82
    v_cvt_pk_bf16_f32 v83, v83, v83
    v_cvt_pk_bf16_f32 v84, v84, v84
    v_cvt_pk_bf16_f32 v85, v85, v85
    v_cvt_pk_bf16_f32 v86, v86, v86
    v_cvt_pk_bf16_f32 v87, v87, v87
    s_nop 0
    v_lshlrev_b32 v80, 16, v80
    v_lshlrev_b32 v81, 16, v81
    v_lshlrev_b32 v82, 16, v82
    v_lshlrev_b32 v83, 16, v83
    v_lshlrev_b32 v84, 16, v84
    v_lshlrev_b32 v85, 16, v85
    v_lshlrev_b32 v86, 16, v86
    v_lshlrev_b32 v87, 16, v87
    v_mul_f32 v88, v80, v80
    v_fma_f32 v88, v88, s44, 1.0
    v_mul_f32 v88, v88, v80
    v_mul_f32 v88, 0xc0135761, v88
    v_exp_f32 v88, v88
    s_nop 0
    v_add_f32 v88, 1.0, v88
    v_rcp_f32 v88, v88
    s_nop 0
    v_mul_f32 v88, v88, v80
    v_cvt_pk_bf16_f32 v88, v88, v88
    s_nop 0
    v_lshlrev_b32 v88, 16, v88
    v_mul_f32 v88, v88, v84
    v_mul_f32 v89, v81, v81
    v_fma_f32 v89, v89, s44, 1.0
    v_mul_f32 v89, v89, v81
    v_mul_f32 v89, 0xc0135761, v89
    v_exp_f32 v89, v89
    s_nop 0
    v_add_f32 v89, 1.0, v89
    v_rcp_f32 v89, v89
    s_nop 0
    v_mul_f32 v89, v89, v81
    v_cvt_pk_bf16_f32 v89, v89, v89
    s_nop 0
    v_lshlrev_b32 v89, 16, v89
    v_mul_f32 v89, v89, v85
    v_mul_f32 v90, v82, v82
    v_fma_f32 v90, v90, s44, 1.0
    v_mul_f32 v90, v90, v82
    v_mul_f32 v90, 0xc0135761, v90
    v_exp_f32 v90, v90
    s_nop 0
    v_add_f32 v90, 1.0, v90
    v_rcp_f32 v90, v90
    s_nop 0
    v_mul_f32 v90, v90, v82
    v_cvt_pk_bf16_f32 v90, v90, v90
    s_nop 0
    v_lshlrev_b32 v90, 16, v90
    v_mul_f32 v90, v90, v86
    v_mul_f32 v91, v83, v83
    v_fma_f32 v91, v91, s44, 1.0
    v_mul_f32 v91, v91, v83
    v_mul_f32 v91, 0xc0135761, v91
    v_exp_f32 v91, v91
    s_nop 0
    v_add_f32 v91, 1.0, v91
    v_rcp_f32 v91, v91
    s_nop 0
    v_mul_f32 v91, v91, v83
    v_cvt_pk_bf16_f32 v91, v91, v91
    s_nop 0
    v_lshlrev_b32 v91, 16, v91
    v_mul_f32 v91, v91, v87
    v_cvt_pk_bf16_f32 v96, v88, v89
    v_cvt_pk_bf16_f32 v97, v90, v91
    s_add_u32 s38, s37, 65536
    s_nop 0
    buffer_store_dwordx2 v[96:97], v3, s[20:23], s38 offen offset:32
    s_nop 0
    v_fma_f32 v80, -v48, v30, v168
    v_mul_f32 v80, v80, v49
    v_fma_f32 v81, -v50, v30, v169
    v_mul_f32 v81, v81, v51
    v_fma_f32 v82, -v52, v30, v170
    v_mul_f32 v82, v82, v53
    v_fma_f32 v83, -v54, v30, v171
    v_mul_f32 v83, v83, v55
    v_fma_f32 v84, -v48, v34, v184
    v_mul_f32 v84, v84, v49
    v_fma_f32 v85, -v50, v34, v185
    v_mul_f32 v85, v85, v51
    v_fma_f32 v86, -v52, v34, v186
    v_mul_f32 v86, v86, v53
    v_fma_f32 v87, -v54, v34, v187
    v_mul_f32 v87, v87, v55
    v_cvt_pk_bf16_f32 v80, v80, v80
    v_cvt_pk_bf16_f32 v81, v81, v81
    v_cvt_pk_bf16_f32 v82, v82, v82
    v_cvt_pk_bf16_f32 v83, v83, v83
    v_cvt_pk_bf16_f32 v84, v84, v84
    v_cvt_pk_bf16_f32 v85, v85, v85
    v_cvt_pk_bf16_f32 v86, v86, v86
    v_cvt_pk_bf16_f32 v87, v87, v87
    s_nop 0
    v_lshlrev_b32 v80, 16, v80
    v_lshlrev_b32 v81, 16, v81
    v_lshlrev_b32 v82, 16, v82
    v_lshlrev_b32 v83, 16, v83
    v_lshlrev_b32 v84, 16, v84
    v_lshlrev_b32 v85, 16, v85
    v_lshlrev_b32 v86, 16, v86
    v_lshlrev_b32 v87, 16, v87
    v_mul_f32 v88, v80, v80
    v_fma_f32 v88, v88, s44, 1.0
    v_mul_f32 v88, v88, v80
    v_mul_f32 v88, 0xc0135761, v88
    v_exp_f32 v88, v88
    s_nop 0
    v_add_f32 v88, 1.0, v88
    v_rcp_f32 v88, v88
    s_nop 0
    v_mul_f32 v88, v88, v80
    v_cvt_pk_bf16_f32 v88, v88, v88
    s_nop 0
    v_lshlrev_b32 v88, 16, v88
    v_mul_f32 v88, v88, v84
    v_mul_f32 v89, v81, v81
    v_fma_f32 v89, v89, s44, 1.0
    v_mul_f32 v89, v89, v81
    v_mul_f32 v89, 0xc0135761, v89
    v_exp_f32 v89, v89
    s_nop 0
    v_add_f32 v89, 1.0, v89
    v_rcp_f32 v89, v89
    s_nop 0
    v_mul_f32 v89, v89, v81
    v_cvt_pk_bf16_f32 v89, v89, v89
    s_nop 0
    v_lshlrev_b32 v89, 16, v89
    v_mul_f32 v89, v89, v85
    v_mul_f32 v90, v82, v82
    v_fma_f32 v90, v90, s44, 1.0
    v_mul_f32 v90, v90, v82
    v_mul_f32 v90, 0xc0135761, v90
    v_exp_f32 v90, v90
    s_nop 0
    v_add_f32 v90, 1.0, v90
    v_rcp_f32 v90, v90
    s_nop 0
    v_mul_f32 v90, v90, v82
    v_cvt_pk_bf16_f32 v90, v90, v90
    s_nop 0
    v_lshlrev_b32 v90, 16, v90
    v_mul_f32 v90, v90, v86
    v_mul_f32 v91, v83, v83
    v_fma_f32 v91, v91, s44, 1.0
    v_mul_f32 v91, v91, v83
    v_mul_f32 v91, 0xc0135761, v91
    v_exp_f32 v91, v91
    s_nop 0
    v_add_f32 v91, 1.0, v91
    v_rcp_f32 v91, v91
    s_nop 0
    v_mul_f32 v91, v91, v83
    v_cvt_pk_bf16_f32 v91, v91, v91
    s_nop 0
    v_lshlrev_b32 v91, 16, v91
    v_mul_f32 v91, v91, v87
    v_cvt_pk_bf16_f32 v96, v88, v89
    v_cvt_pk_bf16_f32 v97, v90, v91
    s_add_u32 s38, s37, 131072
    s_nop 0
    buffer_store_dwordx2 v[96:97], v3, s[20:23], s38 offen offset:32
    s_nop 0
    v_fma_f32 v80, -v48, v31, v172
    v_mul_f32 v80, v80, v49
    v_fma_f32 v81, -v50, v31, v173
    v_mul_f32 v81, v81, v51
    v_fma_f32 v82, -v52, v31, v174
    v_mul_f32 v82, v82, v53
    v_fma_f32 v83, -v54, v31, v175
    v_mul_f32 v83, v83, v55
    v_fma_f32 v84, -v48, v35, v188
    v_mul_f32 v84, v84, v49
    v_fma_f32 v85, -v50, v35, v189
    v_mul_f32 v85, v85, v51
    v_fma_f32 v86, -v52, v35, v190
    v_mul_f32 v86, v86, v53
    v_fma_f32 v87, -v54, v35, v191
    v_mul_f32 v87, v87, v55
    v_cvt_pk_bf16_f32 v80, v80, v80
    v_cvt_pk_bf16_f32 v81, v81, v81
    v_cvt_pk_bf16_f32 v82, v82, v82
    v_cvt_pk_bf16_f32 v83, v83, v83
    v_cvt_pk_bf16_f32 v84, v84, v84
    v_cvt_pk_bf16_f32 v85, v85, v85
    v_cvt_pk_bf16_f32 v86, v86, v86
    v_cvt_pk_bf16_f32 v87, v87, v87
    s_nop 0
    v_lshlrev_b32 v80, 16, v80
    v_lshlrev_b32 v81, 16, v81
    v_lshlrev_b32 v82, 16, v82
    v_lshlrev_b32 v83, 16, v83
    v_lshlrev_b32 v84, 16, v84
    v_lshlrev_b32 v85, 16, v85
    v_lshlrev_b32 v86, 16, v86
    v_lshlrev_b32 v87, 16, v87
    v_mul_f32 v88, v80, v80
    v_fma_f32 v88, v88, s44, 1.0
    v_mul_f32 v88, v88, v80
    v_mul_f32 v88, 0xc0135761, v88
    v_exp_f32 v88, v88
    s_nop 0
    v_add_f32 v88, 1.0, v88
    v_rcp_f32 v88, v88
    s_nop 0
    v_mul_f32 v88, v88, v80
    v_cvt_pk_bf16_f32 v88, v88, v88
    s_nop 0
    v_lshlrev_b32 v88, 16, v88
    v_mul_f32 v88, v88, v84
    v_mul_f32 v89, v81, v81
    v_fma_f32 v89, v89, s44, 1.0
    v_mul_f32 v89, v89, v81
    v_mul_f32 v89, 0xc0135761, v89
    v_exp_f32 v89, v89
    s_nop 0
    v_add_f32 v89, 1.0, v89
    v_rcp_f32 v89, v89
    s_nop 0
    v_mul_f32 v89, v89, v81
    v_cvt_pk_bf16_f32 v89, v89, v89
    s_nop 0
    v_lshlrev_b32 v89, 16, v89
    v_mul_f32 v89, v89, v85
    v_mul_f32 v90, v82, v82
    v_fma_f32 v90, v90, s44, 1.0
    v_mul_f32 v90, v90, v82
    v_mul_f32 v90, 0xc0135761, v90
    v_exp_f32 v90, v90
    s_nop 0
    v_add_f32 v90, 1.0, v90
    v_rcp_f32 v90, v90
    s_nop 0
    v_mul_f32 v90, v90, v82
    v_cvt_pk_bf16_f32 v90, v90, v90
    s_nop 0
    v_lshlrev_b32 v90, 16, v90
    v_mul_f32 v90, v90, v86
    v_mul_f32 v91, v83, v83
    v_fma_f32 v91, v91, s44, 1.0
    v_mul_f32 v91, v91, v83
    v_mul_f32 v91, 0xc0135761, v91
    v_exp_f32 v91, v91
    s_nop 0
    v_add_f32 v91, 1.0, v91
    v_rcp_f32 v91, v91
    s_nop 0
    v_mul_f32 v91, v91, v83
    v_cvt_pk_bf16_f32 v91, v91, v91
    s_nop 0
    v_lshlrev_b32 v91, 16, v91
    v_mul_f32 v91, v91, v87
    v_cvt_pk_bf16_f32 v96, v88, v89
    v_cvt_pk_bf16_f32 v97, v90, v91
    s_add_u32 s38, s37, 196608
    s_nop 0
    buffer_store_dwordx2 v[96:97], v3, s[20:23], s38 offen offset:32
    s_nop 0
    v_fma_f32 v80, -v56, v28, v192
    v_mul_f32 v80, v80, v57
    v_fma_f32 v81, -v58, v28, v193
    v_mul_f32 v81, v81, v59
    v_fma_f32 v82, -v60, v28, v194
    v_mul_f32 v82, v82, v61
    v_fma_f32 v83, -v62, v28, v195
    v_mul_f32 v83, v83, v63
    v_fma_f32 v84, -v56, v32, v208
    v_mul_f32 v84, v84, v57
    v_fma_f32 v85, -v58, v32, v209
    v_mul_f32 v85, v85, v59
    v_fma_f32 v86, -v60, v32, v210
    v_mul_f32 v86, v86, v61
    v_fma_f32 v87, -v62, v32, v211
    v_mul_f32 v87, v87, v63
    v_cvt_pk_bf16_f32 v80, v80, v80
    v_cvt_pk_bf16_f32 v81, v81, v81
    v_cvt_pk_bf16_f32 v82, v82, v82
    v_cvt_pk_bf16_f32 v83, v83, v83
    v_cvt_pk_bf16_f32 v84, v84, v84
    v_cvt_pk_bf16_f32 v85, v85, v85
    v_cvt_pk_bf16_f32 v86, v86, v86
    v_cvt_pk_bf16_f32 v87, v87, v87
    s_nop 0
    v_lshlrev_b32 v80, 16, v80
    v_lshlrev_b32 v81, 16, v81
    v_lshlrev_b32 v82, 16, v82
    v_lshlrev_b32 v83, 16, v83
    v_lshlrev_b32 v84, 16, v84
    v_lshlrev_b32 v85, 16, v85
    v_lshlrev_b32 v86, 16, v86
    v_lshlrev_b32 v87, 16, v87
    v_mul_f32 v88, v80, v80
    v_fma_f32 v88, v88, s44, 1.0
    v_mul_f32 v88, v88, v80
    v_mul_f32 v88, 0xc0135761, v88
    v_exp_f32 v88, v88
    s_nop 0
    v_add_f32 v88, 1.0, v88
    v_rcp_f32 v88, v88
    s_nop 0
    v_mul_f32 v88, v88, v80
    v_cvt_pk_bf16_f32 v88, v88, v88
    s_nop 0
    v_lshlrev_b32 v88, 16, v88
    v_mul_f32 v88, v88, v84
    v_mul_f32 v89, v81, v81
    v_fma_f32 v89, v89, s44, 1.0
    v_mul_f32 v89, v89, v81
    v_mul_f32 v89, 0xc0135761, v89
    v_exp_f32 v89, v89
    s_nop 0
    v_add_f32 v89, 1.0, v89
    v_rcp_f32 v89, v89
    s_nop 0
    v_mul_f32 v89, v89, v81
    v_cvt_pk_bf16_f32 v89, v89, v89
    s_nop 0
    v_lshlrev_b32 v89, 16, v89
    v_mul_f32 v89, v89, v85
    v_mul_f32 v90, v82, v82
    v_fma_f32 v90, v90, s44, 1.0
    v_mul_f32 v90, v90, v82
    v_mul_f32 v90, 0xc0135761, v90
    v_exp_f32 v90, v90
    s_nop 0
    v_add_f32 v90, 1.0, v90
    v_rcp_f32 v90, v90
    s_nop 0
    v_mul_f32 v90, v90, v82
    v_cvt_pk_bf16_f32 v90, v90, v90
    s_nop 0
    v_lshlrev_b32 v90, 16, v90
    v_mul_f32 v90, v90, v86
    v_mul_f32 v91, v83, v83
    v_fma_f32 v91, v91, s44, 1.0
    v_mul_f32 v91, v91, v83
    v_mul_f32 v91, 0xc0135761, v91
    v_exp_f32 v91, v91
    s_nop 0
    v_add_f32 v91, 1.0, v91
    v_rcp_f32 v91, v91
    s_nop 0
    v_mul_f32 v91, v91, v83
    v_cvt_pk_bf16_f32 v91, v91, v91
    s_nop 0
    v_lshlrev_b32 v91, 16, v91
    v_mul_f32 v91, v91, v87
    v_cvt_pk_bf16_f32 v96, v88, v89
    v_cvt_pk_bf16_f32 v97, v90, v91
    s_add_u32 s38, s37, 0
    s_nop 0
    buffer_store_dwordx2 v[96:97], v3, s[20:23], s38 offen offset:64
    s_nop 0
    v_fma_f32 v80, -v56, v29, v196
    v_mul_f32 v80, v80, v57
    v_fma_f32 v81, -v58, v29, v197
    v_mul_f32 v81, v81, v59
    v_fma_f32 v82, -v60, v29, v198
    v_mul_f32 v82, v82, v61
    v_fma_f32 v83, -v62, v29, v199
    v_mul_f32 v83, v83, v63
    v_fma_f32 v84, -v56, v33, v212
    v_mul_f32 v84, v84, v57
    v_fma_f32 v85, -v58, v33, v213
    v_mul_f32 v85, v85, v59
    v_fma_f32 v86, -v60, v33, v214
    v_mul_f32 v86, v86, v61
    v_fma_f32 v87, -v62, v33, v215
    v_mul_f32 v87, v87, v63
    v_cvt_pk_bf16_f32 v80, v80, v80
    v_cvt_pk_bf16_f32 v81, v81, v81
    v_cvt_pk_bf16_f32 v82, v82, v82
    v_cvt_pk_bf16_f32 v83, v83, v83
    v_cvt_pk_bf16_f32 v84, v84, v84
    v_cvt_pk_bf16_f32 v85, v85, v85
    v_cvt_pk_bf16_f32 v86, v86, v86
    v_cvt_pk_bf16_f32 v87, v87, v87
    s_nop 0
    v_lshlrev_b32 v80, 16, v80
    v_lshlrev_b32 v81, 16, v81
    v_lshlrev_b32 v82, 16, v82
    v_lshlrev_b32 v83, 16, v83
    v_lshlrev_b32 v84, 16, v84
    v_lshlrev_b32 v85, 16, v85
    v_lshlrev_b32 v86, 16, v86
    v_lshlrev_b32 v87, 16, v87
    v_mul_f32 v88, v80, v80
    v_fma_f32 v88, v88, s44, 1.0
    v_mul_f32 v88, v88, v80
    v_mul_f32 v88, 0xc0135761, v88
    v_exp_f32 v88, v88
    s_nop 0
    v_add_f32 v88, 1.0, v88
    v_rcp_f32 v88, v88
    s_nop 0
    v_mul_f32 v88, v88, v80
    v_cvt_pk_bf16_f32 v88, v88, v88
    s_nop 0
    v_lshlrev_b32 v88, 16, v88
    v_mul_f32 v88, v88, v84
    v_mul_f32 v89, v81, v81
    v_fma_f32 v89, v89, s44, 1.0
    v_mul_f32 v89, v89, v81
    v_mul_f32 v89, 0xc0135761, v89
    v_exp_f32 v89, v89
    s_nop 0
    v_add_f32 v89, 1.0, v89
    v_rcp_f32 v89, v89
    s_nop 0
    v_mul_f32 v89, v89, v81
    v_cvt_pk_bf16_f32 v89, v89, v89
    s_nop 0
    v_lshlrev_b32 v89, 16, v89
    v_mul_f32 v89, v89, v85
    v_mul_f32 v90, v82, v82
    v_fma_f32 v90, v90, s44, 1.0
    v_mul_f32 v90, v90, v82
    v_mul_f32 v90, 0xc0135761, v90
    v_exp_f32 v90, v90
    s_nop 0
    v_add_f32 v90, 1.0, v90
    v_rcp_f32 v90, v90
    s_nop 0
    v_mul_f32 v90, v90, v82
    v_cvt_pk_bf16_f32 v90, v90, v90
    s_nop 0
    v_lshlrev_b32 v90, 16, v90
    v_mul_f32 v90, v90, v86
    v_mul_f32 v91, v83, v83
    v_fma_f32 v91, v91, s44, 1.0
    v_mul_f32 v91, v91, v83
    v_mul_f32 v91, 0xc0135761, v91
    v_exp_f32 v91, v91
    s_nop 0
    v_add_f32 v91, 1.0, v91
    v_rcp_f32 v91, v91
    s_nop 0
    v_mul_f32 v91, v91, v83
    v_cvt_pk_bf16_f32 v91, v91, v91
    s_nop 0
    v_lshlrev_b32 v91, 16, v91
    v_mul_f32 v91, v91, v87
    v_cvt_pk_bf16_f32 v96, v88, v89
    v_cvt_pk_bf16_f32 v97, v90, v91
    s_add_u32 s38, s37, 65536
    s_nop 0
    buffer_store_dwordx2 v[96:97], v3, s[20:23], s38 offen offset:64
    s_nop 0
    v_fma_f32 v80, -v56, v30, v200
    v_mul_f32 v80, v80, v57
    v_fma_f32 v81, -v58, v30, v201
    v_mul_f32 v81, v81, v59
    v_fma_f32 v82, -v60, v30, v202
    v_mul_f32 v82, v82, v61
    v_fma_f32 v83, -v62, v30, v203
    v_mul_f32 v83, v83, v63
    v_fma_f32 v84, -v56, v34, v216
    v_mul_f32 v84, v84, v57
    v_fma_f32 v85, -v58, v34, v217
    v_mul_f32 v85, v85, v59
    v_fma_f32 v86, -v60, v34, v218
    v_mul_f32 v86, v86, v61
    v_fma_f32 v87, -v62, v34, v219
    v_mul_f32 v87, v87, v63
    v_cvt_pk_bf16_f32 v80, v80, v80
    v_cvt_pk_bf16_f32 v81, v81, v81
    v_cvt_pk_bf16_f32 v82, v82, v82
    v_cvt_pk_bf16_f32 v83, v83, v83
    v_cvt_pk_bf16_f32 v84, v84, v84
    v_cvt_pk_bf16_f32 v85, v85, v85
    v_cvt_pk_bf16_f32 v86, v86, v86
    v_cvt_pk_bf16_f32 v87, v87, v87
    s_nop 0
    v_lshlrev_b32 v80, 16, v80
    v_lshlrev_b32 v81, 16, v81
    v_lshlrev_b32 v82, 16, v82
    v_lshlrev_b32 v83, 16, v83
    v_lshlrev_b32 v84, 16, v84
    v_lshlrev_b32 v85, 16, v85
    v_lshlrev_b32 v86, 16, v86
    v_lshlrev_b32 v87, 16, v87
    v_mul_f32 v88, v80, v80
    v_fma_f32 v88, v88, s44, 1.0
    v_mul_f32 v88, v88, v80
    v_mul_f32 v88, 0xc0135761, v88
    v_exp_f32 v88, v88
    s_nop 0
    v_add_f32 v88, 1.0, v88
    v_rcp_f32 v88, v88
    s_nop 0
    v_mul_f32 v88, v88, v80
    v_cvt_pk_bf16_f32 v88, v88, v88
    s_nop 0
    v_lshlrev_b32 v88, 16, v88
    v_mul_f32 v88, v88, v84
    v_mul_f32 v89, v81, v81
    v_fma_f32 v89, v89, s44, 1.0
    v_mul_f32 v89, v89, v81
    v_mul_f32 v89, 0xc0135761, v89
    v_exp_f32 v89, v89
    s_nop 0
    v_add_f32 v89, 1.0, v89
    v_rcp_f32 v89, v89
    s_nop 0
    v_mul_f32 v89, v89, v81
    v_cvt_pk_bf16_f32 v89, v89, v89
    s_nop 0
    v_lshlrev_b32 v89, 16, v89
    v_mul_f32 v89, v89, v85
    v_mul_f32 v90, v82, v82
    v_fma_f32 v90, v90, s44, 1.0
    v_mul_f32 v90, v90, v82
    v_mul_f32 v90, 0xc0135761, v90
    v_exp_f32 v90, v90
    s_nop 0
    v_add_f32 v90, 1.0, v90
    v_rcp_f32 v90, v90
    s_nop 0
    v_mul_f32 v90, v90, v82
    v_cvt_pk_bf16_f32 v90, v90, v90
    s_nop 0
    v_lshlrev_b32 v90, 16, v90
    v_mul_f32 v90, v90, v86
    v_mul_f32 v91, v83, v83
    v_fma_f32 v91, v91, s44, 1.0
    v_mul_f32 v91, v91, v83
    v_mul_f32 v91, 0xc0135761, v91
    v_exp_f32 v91, v91
    s_nop 0
    v_add_f32 v91, 1.0, v91
    v_rcp_f32 v91, v91
    s_nop 0
    v_mul_f32 v91, v91, v83
    v_cvt_pk_bf16_f32 v91, v91, v91
    s_nop 0
    v_lshlrev_b32 v91, 16, v91
    v_mul_f32 v91, v91, v87
    v_cvt_pk_bf16_f32 v96, v88, v89
    v_cvt_pk_bf16_f32 v97, v90, v91
    s_add_u32 s38, s37, 131072
    s_nop 0
    buffer_store_dwordx2 v[96:97], v3, s[20:23], s38 offen offset:64
    s_nop 0
    v_fma_f32 v80, -v56, v31, v204
    v_mul_f32 v80, v80, v57
    v_fma_f32 v81, -v58, v31, v205
    v_mul_f32 v81, v81, v59
    v_fma_f32 v82, -v60, v31, v206
    v_mul_f32 v82, v82, v61
    v_fma_f32 v83, -v62, v31, v207
    v_mul_f32 v83, v83, v63
    v_fma_f32 v84, -v56, v35, v220
    v_mul_f32 v84, v84, v57
    v_fma_f32 v85, -v58, v35, v221
    v_mul_f32 v85, v85, v59
    v_fma_f32 v86, -v60, v35, v222
    v_mul_f32 v86, v86, v61
    v_fma_f32 v87, -v62, v35, v223
    v_mul_f32 v87, v87, v63
    v_cvt_pk_bf16_f32 v80, v80, v80
    v_cvt_pk_bf16_f32 v81, v81, v81
    v_cvt_pk_bf16_f32 v82, v82, v82
    v_cvt_pk_bf16_f32 v83, v83, v83
    v_cvt_pk_bf16_f32 v84, v84, v84
    v_cvt_pk_bf16_f32 v85, v85, v85
    v_cvt_pk_bf16_f32 v86, v86, v86
    v_cvt_pk_bf16_f32 v87, v87, v87
    s_nop 0
    v_lshlrev_b32 v80, 16, v80
    v_lshlrev_b32 v81, 16, v81
    v_lshlrev_b32 v82, 16, v82
    v_lshlrev_b32 v83, 16, v83
    v_lshlrev_b32 v84, 16, v84
    v_lshlrev_b32 v85, 16, v85
    v_lshlrev_b32 v86, 16, v86
    v_lshlrev_b32 v87, 16, v87
    v_mul_f32 v88, v80, v80
    v_fma_f32 v88, v88, s44, 1.0
    v_mul_f32 v88, v88, v80
    v_mul_f32 v88, 0xc0135761, v88
    v_exp_f32 v88, v88
    s_nop 0
    v_add_f32 v88, 1.0, v88
    v_rcp_f32 v88, v88
    s_nop 0
    v_mul_f32 v88, v88, v80
    v_cvt_pk_bf16_f32 v88, v88, v88
    s_nop 0
    v_lshlrev_b32 v88, 16, v88
    v_mul_f32 v88, v88, v84
    v_mul_f32 v89, v81, v81
    v_fma_f32 v89, v89, s44, 1.0
    v_mul_f32 v89, v89, v81
    v_mul_f32 v89, 0xc0135761, v89
    v_exp_f32 v89, v89
    s_nop 0
    v_add_f32 v89, 1.0, v89
    v_rcp_f32 v89, v89
    s_nop 0
    v_mul_f32 v89, v89, v81
    v_cvt_pk_bf16_f32 v89, v89, v89
    s_nop 0
    v_lshlrev_b32 v89, 16, v89
    v_mul_f32 v89, v89, v85
    v_mul_f32 v90, v82, v82
    v_fma_f32 v90, v90, s44, 1.0
    v_mul_f32 v90, v90, v82
    v_mul_f32 v90, 0xc0135761, v90
    v_exp_f32 v90, v90
    s_nop 0
    v_add_f32 v90, 1.0, v90
    v_rcp_f32 v90, v90
    s_nop 0
    v_mul_f32 v90, v90, v82
    v_cvt_pk_bf16_f32 v90, v90, v90
    s_nop 0
    v_lshlrev_b32 v90, 16, v90
    v_mul_f32 v90, v90, v86
    v_mul_f32 v91, v83, v83
    v_fma_f32 v91, v91, s44, 1.0
    v_mul_f32 v91, v91, v83
    v_mul_f32 v91, 0xc0135761, v91
    v_exp_f32 v91, v91
    s_nop 0
    v_add_f32 v91, 1.0, v91
    v_rcp_f32 v91, v91
    s_nop 0
    v_mul_f32 v91, v91, v83
    v_cvt_pk_bf16_f32 v91, v91, v91
    s_nop 0
    v_lshlrev_b32 v91, 16, v91
    v_mul_f32 v91, v91, v87
    v_cvt_pk_bf16_f32 v96, v88, v89
    v_cvt_pk_bf16_f32 v97, v90, v91
    s_add_u32 s38, s37, 196608
    s_nop 0
    buffer_store_dwordx2 v[96:97], v3, s[20:23], s38 offen offset:64
    s_nop 0
    v_fma_f32 v80, -v64, v28, v224
    v_mul_f32 v80, v80, v65
    v_fma_f32 v81, -v66, v28, v225
    v_mul_f32 v81, v81, v67
    v_fma_f32 v82, -v68, v28, v226
    v_mul_f32 v82, v82, v69
    v_fma_f32 v83, -v70, v28, v227
    v_mul_f32 v83, v83, v71
    v_fma_f32 v84, -v64, v32, v240
    v_mul_f32 v84, v84, v65
    v_fma_f32 v85, -v66, v32, v241
    v_mul_f32 v85, v85, v67
    v_fma_f32 v86, -v68, v32, v242
    v_mul_f32 v86, v86, v69
    v_fma_f32 v87, -v70, v32, v243
    v_mul_f32 v87, v87, v71
    v_cvt_pk_bf16_f32 v80, v80, v80
    v_cvt_pk_bf16_f32 v81, v81, v81
    v_cvt_pk_bf16_f32 v82, v82, v82
    v_cvt_pk_bf16_f32 v83, v83, v83
    v_cvt_pk_bf16_f32 v84, v84, v84
    v_cvt_pk_bf16_f32 v85, v85, v85
    v_cvt_pk_bf16_f32 v86, v86, v86
    v_cvt_pk_bf16_f32 v87, v87, v87
    s_nop 0
    v_lshlrev_b32 v80, 16, v80
    v_lshlrev_b32 v81, 16, v81
    v_lshlrev_b32 v82, 16, v82
    v_lshlrev_b32 v83, 16, v83
    v_lshlrev_b32 v84, 16, v84
    v_lshlrev_b32 v85, 16, v85
    v_lshlrev_b32 v86, 16, v86
    v_lshlrev_b32 v87, 16, v87
    v_mul_f32 v88, v80, v80
    v_fma_f32 v88, v88, s44, 1.0
    v_mul_f32 v88, v88, v80
    v_mul_f32 v88, 0xc0135761, v88
    v_exp_f32 v88, v88
    s_nop 0
    v_add_f32 v88, 1.0, v88
    v_rcp_f32 v88, v88
    s_nop 0
    v_mul_f32 v88, v88, v80
    v_cvt_pk_bf16_f32 v88, v88, v88
    s_nop 0
    v_lshlrev_b32 v88, 16, v88
    v_mul_f32 v88, v88, v84
    v_mul_f32 v89, v81, v81
    v_fma_f32 v89, v89, s44, 1.0
    v_mul_f32 v89, v89, v81
    v_mul_f32 v89, 0xc0135761, v89
    v_exp_f32 v89, v89
    s_nop 0
    v_add_f32 v89, 1.0, v89
    v_rcp_f32 v89, v89
    s_nop 0
    v_mul_f32 v89, v89, v81
    v_cvt_pk_bf16_f32 v89, v89, v89
    s_nop 0
    v_lshlrev_b32 v89, 16, v89
    v_mul_f32 v89, v89, v85
    v_mul_f32 v90, v82, v82
    v_fma_f32 v90, v90, s44, 1.0
    v_mul_f32 v90, v90, v82
    v_mul_f32 v90, 0xc0135761, v90
    v_exp_f32 v90, v90
    s_nop 0
    v_add_f32 v90, 1.0, v90
    v_rcp_f32 v90, v90
    s_nop 0
    v_mul_f32 v90, v90, v82
    v_cvt_pk_bf16_f32 v90, v90, v90
    s_nop 0
    v_lshlrev_b32 v90, 16, v90
    v_mul_f32 v90, v90, v86
    v_mul_f32 v91, v83, v83
    v_fma_f32 v91, v91, s44, 1.0
    v_mul_f32 v91, v91, v83
    v_mul_f32 v91, 0xc0135761, v91
    v_exp_f32 v91, v91
    s_nop 0
    v_add_f32 v91, 1.0, v91
    v_rcp_f32 v91, v91
    s_nop 0
    v_mul_f32 v91, v91, v83
    v_cvt_pk_bf16_f32 v91, v91, v91
    s_nop 0
    v_lshlrev_b32 v91, 16, v91
    v_mul_f32 v91, v91, v87
    v_cvt_pk_bf16_f32 v96, v88, v89
    v_cvt_pk_bf16_f32 v97, v90, v91
    s_add_u32 s38, s37, 0
    s_nop 0
    buffer_store_dwordx2 v[96:97], v3, s[20:23], s38 offen offset:96
    s_nop 0
    v_fma_f32 v80, -v64, v29, v228
    v_mul_f32 v80, v80, v65
    v_fma_f32 v81, -v66, v29, v229
    v_mul_f32 v81, v81, v67
    v_fma_f32 v82, -v68, v29, v230
    v_mul_f32 v82, v82, v69
    v_fma_f32 v83, -v70, v29, v231
    v_mul_f32 v83, v83, v71
    v_fma_f32 v84, -v64, v33, v244
    v_mul_f32 v84, v84, v65
    v_fma_f32 v85, -v66, v33, v245
    v_mul_f32 v85, v85, v67
    v_fma_f32 v86, -v68, v33, v246
    v_mul_f32 v86, v86, v69
    v_fma_f32 v87, -v70, v33, v247
    v_mul_f32 v87, v87, v71
    v_cvt_pk_bf16_f32 v80, v80, v80
    v_cvt_pk_bf16_f32 v81, v81, v81
    v_cvt_pk_bf16_f32 v82, v82, v82
    v_cvt_pk_bf16_f32 v83, v83, v83
    v_cvt_pk_bf16_f32 v84, v84, v84
    v_cvt_pk_bf16_f32 v85, v85, v85
    v_cvt_pk_bf16_f32 v86, v86, v86
    v_cvt_pk_bf16_f32 v87, v87, v87
    s_nop 0
    v_lshlrev_b32 v80, 16, v80
    v_lshlrev_b32 v81, 16, v81
    v_lshlrev_b32 v82, 16, v82
    v_lshlrev_b32 v83, 16, v83
    v_lshlrev_b32 v84, 16, v84
    v_lshlrev_b32 v85, 16, v85
    v_lshlrev_b32 v86, 16, v86
    v_lshlrev_b32 v87, 16, v87
    v_mul_f32 v88, v80, v80
    v_fma_f32 v88, v88, s44, 1.0
    v_mul_f32 v88, v88, v80
    v_mul_f32 v88, 0xc0135761, v88
    v_exp_f32 v88, v88
    s_nop 0
    v_add_f32 v88, 1.0, v88
    v_rcp_f32 v88, v88
    s_nop 0
    v_mul_f32 v88, v88, v80
    v_cvt_pk_bf16_f32 v88, v88, v88
    s_nop 0
    v_lshlrev_b32 v88, 16, v88
    v_mul_f32 v88, v88, v84
    v_mul_f32 v89, v81, v81
    v_fma_f32 v89, v89, s44, 1.0
    v_mul_f32 v89, v89, v81
    v_mul_f32 v89, 0xc0135761, v89
    v_exp_f32 v89, v89
    s_nop 0
    v_add_f32 v89, 1.0, v89
    v_rcp_f32 v89, v89
    s_nop 0
    v_mul_f32 v89, v89, v81
    v_cvt_pk_bf16_f32 v89, v89, v89
    s_nop 0
    v_lshlrev_b32 v89, 16, v89
    v_mul_f32 v89, v89, v85
    v_mul_f32 v90, v82, v82
    v_fma_f32 v90, v90, s44, 1.0
    v_mul_f32 v90, v90, v82
    v_mul_f32 v90, 0xc0135761, v90
    v_exp_f32 v90, v90
    s_nop 0
    v_add_f32 v90, 1.0, v90
    v_rcp_f32 v90, v90
    s_nop 0
    v_mul_f32 v90, v90, v82
    v_cvt_pk_bf16_f32 v90, v90, v90
    s_nop 0
    v_lshlrev_b32 v90, 16, v90
    v_mul_f32 v90, v90, v86
    v_mul_f32 v91, v83, v83
    v_fma_f32 v91, v91, s44, 1.0
    v_mul_f32 v91, v91, v83
    v_mul_f32 v91, 0xc0135761, v91
    v_exp_f32 v91, v91
    s_nop 0
    v_add_f32 v91, 1.0, v91
    v_rcp_f32 v91, v91
    s_nop 0
    v_mul_f32 v91, v91, v83
    v_cvt_pk_bf16_f32 v91, v91, v91
    s_nop 0
    v_lshlrev_b32 v91, 16, v91
    v_mul_f32 v91, v91, v87
    v_cvt_pk_bf16_f32 v96, v88, v89
    v_cvt_pk_bf16_f32 v97, v90, v91
    s_add_u32 s38, s37, 65536
    s_nop 0
    buffer_store_dwordx2 v[96:97], v3, s[20:23], s38 offen offset:96
    s_nop 0
    v_fma_f32 v80, -v64, v30, v232
    v_mul_f32 v80, v80, v65
    v_fma_f32 v81, -v66, v30, v233
    v_mul_f32 v81, v81, v67
    v_fma_f32 v82, -v68, v30, v234
    v_mul_f32 v82, v82, v69
    v_fma_f32 v83, -v70, v30, v235
    v_mul_f32 v83, v83, v71
    v_fma_f32 v84, -v64, v34, v248
    v_mul_f32 v84, v84, v65
    v_fma_f32 v85, -v66, v34, v249
    v_mul_f32 v85, v85, v67
    v_fma_f32 v86, -v68, v34, v250
    v_mul_f32 v86, v86, v69
    v_fma_f32 v87, -v70, v34, v251
    v_mul_f32 v87, v87, v71
    v_cvt_pk_bf16_f32 v80, v80, v80
    v_cvt_pk_bf16_f32 v81, v81, v81
    v_cvt_pk_bf16_f32 v82, v82, v82
    v_cvt_pk_bf16_f32 v83, v83, v83
    v_cvt_pk_bf16_f32 v84, v84, v84
    v_cvt_pk_bf16_f32 v85, v85, v85
    v_cvt_pk_bf16_f32 v86, v86, v86
    v_cvt_pk_bf16_f32 v87, v87, v87
    s_nop 0
    v_lshlrev_b32 v80, 16, v80
    v_lshlrev_b32 v81, 16, v81
    v_lshlrev_b32 v82, 16, v82
    v_lshlrev_b32 v83, 16, v83
    v_lshlrev_b32 v84, 16, v84
    v_lshlrev_b32 v85, 16, v85
    v_lshlrev_b32 v86, 16, v86
    v_lshlrev_b32 v87, 16, v87
    v_mul_f32 v88, v80, v80
    v_fma_f32 v88, v88, s44, 1.0
    v_mul_f32 v88, v88, v80
    v_mul_f32 v88, 0xc0135761, v88
    v_exp_f32 v88, v88
    s_nop 0
    v_add_f32 v88, 1.0, v88
    v_rcp_f32 v88, v88
    s_nop 0
    v_mul_f32 v88, v88, v80
    v_cvt_pk_bf16_f32 v88, v88, v88
    s_nop 0
    v_lshlrev_b32 v88, 16, v88
    v_mul_f32 v88, v88, v84
    v_mul_f32 v89, v81, v81
    v_fma_f32 v89, v89, s44, 1.0
    v_mul_f32 v89, v89, v81
    v_mul_f32 v89, 0xc0135761, v89
    v_exp_f32 v89, v89
    s_nop 0
    v_add_f32 v89, 1.0, v89
    v_rcp_f32 v89, v89
    s_nop 0
    v_mul_f32 v89, v89, v81
    v_cvt_pk_bf16_f32 v89, v89, v89
    s_nop 0
    v_lshlrev_b32 v89, 16, v89
    v_mul_f32 v89, v89, v85
    v_mul_f32 v90, v82, v82
    v_fma_f32 v90, v90, s44, 1.0
    v_mul_f32 v90, v90, v82
    v_mul_f32 v90, 0xc0135761, v90
    v_exp_f32 v90, v90
    s_nop 0
    v_add_f32 v90, 1.0, v90
    v_rcp_f32 v90, v90
    s_nop 0
    v_mul_f32 v90, v90, v82
    v_cvt_pk_bf16_f32 v90, v90, v90
    s_nop 0
    v_lshlrev_b32 v90, 16, v90
    v_mul_f32 v90, v90, v86
    v_mul_f32 v91, v83, v83
    v_fma_f32 v91, v91, s44, 1.0
    v_mul_f32 v91, v91, v83
    v_mul_f32 v91, 0xc0135761, v91
    v_exp_f32 v91, v91
    s_nop 0
    v_add_f32 v91, 1.0, v91
    v_rcp_f32 v91, v91
    s_nop 0
    v_mul_f32 v91, v91, v83
    v_cvt_pk_bf16_f32 v91, v91, v91
    s_nop 0
    v_lshlrev_b32 v91, 16, v91
    v_mul_f32 v91, v91, v87
    v_cvt_pk_bf16_f32 v96, v88, v89
    v_cvt_pk_bf16_f32 v97, v90, v91
    s_add_u32 s38, s37, 131072
    s_nop 0
    buffer_store_dwordx2 v[96:97], v3, s[20:23], s38 offen offset:96
    s_nop 0
    v_fma_f32 v80, -v64, v31, v236
    v_mul_f32 v80, v80, v65
    v_fma_f32 v81, -v66, v31, v237
    v_mul_f32 v81, v81, v67
    v_fma_f32 v82, -v68, v31, v238
    v_mul_f32 v82, v82, v69
    v_fma_f32 v83, -v70, v31, v239
    v_mul_f32 v83, v83, v71
    v_fma_f32 v84, -v64, v35, v252
    v_mul_f32 v84, v84, v65
    v_fma_f32 v85, -v66, v35, v253
    v_mul_f32 v85, v85, v67
    v_fma_f32 v86, -v68, v35, v254
    v_mul_f32 v86, v86, v69
    v_fma_f32 v87, -v70, v35, v255
    v_mul_f32 v87, v87, v71
    v_cvt_pk_bf16_f32 v80, v80, v80
    v_cvt_pk_bf16_f32 v81, v81, v81
    v_cvt_pk_bf16_f32 v82, v82, v82
    v_cvt_pk_bf16_f32 v83, v83, v83
    v_cvt_pk_bf16_f32 v84, v84, v84
    v_cvt_pk_bf16_f32 v85, v85, v85
    v_cvt_pk_bf16_f32 v86, v86, v86
    v_cvt_pk_bf16_f32 v87, v87, v87
    s_nop 0
    v_lshlrev_b32 v80, 16, v80
    v_lshlrev_b32 v81, 16, v81
    v_lshlrev_b32 v82, 16, v82
    v_lshlrev_b32 v83, 16, v83
    v_lshlrev_b32 v84, 16, v84
    v_lshlrev_b32 v85, 16, v85
    v_lshlrev_b32 v86, 16, v86
    v_lshlrev_b32 v87, 16, v87
    v_mul_f32 v88, v80, v80
    v_fma_f32 v88, v88, s44, 1.0
    v_mul_f32 v88, v88, v80
    v_mul_f32 v88, 0xc0135761, v88
    v_exp_f32 v88, v88
    s_nop 0
    v_add_f32 v88, 1.0, v88
    v_rcp_f32 v88, v88
    s_nop 0
    v_mul_f32 v88, v88, v80
    v_cvt_pk_bf16_f32 v88, v88, v88
    s_nop 0
    v_lshlrev_b32 v88, 16, v88
    v_mul_f32 v88, v88, v84
    v_mul_f32 v89, v81, v81
    v_fma_f32 v89, v89, s44, 1.0
    v_mul_f32 v89, v89, v81
    v_mul_f32 v89, 0xc0135761, v89
    v_exp_f32 v89, v89
    s_nop 0
    v_add_f32 v89, 1.0, v89
    v_rcp_f32 v89, v89
    s_nop 0
    v_mul_f32 v89, v89, v81
    v_cvt_pk_bf16_f32 v89, v89, v89
    s_nop 0
    v_lshlrev_b32 v89, 16, v89
    v_mul_f32 v89, v89, v85
    v_mul_f32 v90, v82, v82
    v_fma_f32 v90, v90, s44, 1.0
    v_mul_f32 v90, v90, v82
    v_mul_f32 v90, 0xc0135761, v90
    v_exp_f32 v90, v90
    s_nop 0
    v_add_f32 v90, 1.0, v90
    v_rcp_f32 v90, v90
    s_nop 0
    v_mul_f32 v90, v90, v82
    v_cvt_pk_bf16_f32 v90, v90, v90
    s_nop 0
    v_lshlrev_b32 v90, 16, v90
    v_mul_f32 v90, v90, v86
    v_mul_f32 v91, v83, v83
    v_fma_f32 v91, v91, s44, 1.0
    v_mul_f32 v91, v91, v83
    v_mul_f32 v91, 0xc0135761, v91
    v_exp_f32 v91, v91
    s_nop 0
    v_add_f32 v91, 1.0, v91
    v_rcp_f32 v91, v91
    s_nop 0
    v_mul_f32 v91, v91, v83
    v_cvt_pk_bf16_f32 v91, v91, v91
    s_nop 0
    v_lshlrev_b32 v91, 16, v91
    v_mul_f32 v91, v91, v87
    v_cvt_pk_bf16_f32 v96, v88, v89
    v_cvt_pk_bf16_f32 v97, v90, v91
    s_add_u32 s38, s37, 196608
    s_nop 0
    buffer_store_dwordx2 v[96:97], v3, s[20:23], s38 offen offset:96
    s_nop 0
g1b_exit:
    s_endpgm

.globl g2b_kernel
.p2align 8
.type g2b_kernel,@function
g2b_kernel:
    s_cmp_ge_u32 s2, 256
    s_cbranch_scc1 g2b_exit
    s_load_dwordx2 s[4:5], s[0:1], 120
    s_load_dwordx2 s[6:7], s[0:1], 96
    s_load_dwordx2 s[28:29], s[0:1], 104
    v_readfirstlane_b32 s30, v0
    s_lshr_b32 s30, s30, 6
    s_and_b32 s33, s2, 31
    s_lshl_b32 s33, s33, 6
    s_lshr_b32 s34, s2, 5
    s_lshl_b32 s34, s34, 6
    s_waitcnt lgkmcnt(0)
    s_add_u32 s8, s4, 0x800000
    s_addc_u32 s9, s5, 0
    s_and_b32 s9, s9, 0xffff
    s_mov_b32 s10, 0x700000
    s_mov_b32 s11, 0x00020000
    s_add_u32 s12, s6, 0x0
    s_addc_u32 s13, s7, 0
    s_and_b32 s13, s13, 0xffff
    s_mov_b32 s14, 0x1c0000
    s_mov_b32 s15, 0x00020000
    s_add_u32 s16, s4, 0x600000
    s_addc_u32 s17, s5, 0
    s_and_b32 s17, s17, 0xffff
    s_mov_b32 s18, 0x200000
    s_mov_b32 s19, 0x00020000
    s_add_u32 s20, s28, 0x0
    s_addc_u32 s21, s29, 0
    s_and_b32 s21, s21, 0xffff
    s_mov_b32 s22, 0x200000
    s_mov_b32 s23, 0x00020000
    s_add_u32 s24, s4, 0x1410000
    s_addc_u32 s25, s5, 0
    s_and_b32 s25, s25, 0xffff
    s_mov_b32 s26, 0x4000
    s_mov_b32 s27, 0x00020000
    v_and_b32 v25, 63, v0
    v_and_b32 v26, 15, v25
    v_lshrrev_b32 v27, 4, v25
    v_and_b32 v0, 7, v25
    v_and_b32 v24, 1, v27
    v_lshlrev_b32 v24, 1, v24
    v_xor_b32 v0, v0, v24
    v_lshlrev_b32 v0, 4, v0
    s_lshl_b32 s35, s30, 5
    s_add_u32 s35, s35, 0
    v_lshrrev_b32 v24, 3, v25
    v_add_u32 v24, s35, v24
    v_lshl_add_u32 v9, v24, 12, v0
    s_lshl_b32 s36, s33, 1
    v_add_u32 v9, s36, v9
    v_lshl_add_u32 v13, v24, 10, v0
    s_lshl_b32 s36, s34, 1
    v_add_u32 v13, s36, v13
    v_and_b32 v0, 7, v25
    v_and_b32 v24, 1, v27
    v_lshlrev_b32 v24, 1, v24
    v_xor_b32 v0, v0, v24
    v_xor_b32 v0, 4, v0
    v_lshlrev_b32 v0, 4, v0
    s_lshl_b32 s35, s30, 5
    s_add_u32 s35, s35, 8
    v_lshrrev_b32 v24, 3, v25
    v_add_u32 v24, s35, v24
    v_lshl_add_u32 v10, v24, 12, v0
    s_lshl_b32 s36, s33, 1
    v_add_u32 v10, s36, v10
    v_lshl_add_u32 v14, v24, 10, v0
    s_lshl_b32 s36, s34, 1
    v_add_u32 v14, s36, v14
    v_and_b32 v0, 7, v25
    v_and_b32 v24, 1, v27
    v_lshlrev_b32 v24, 1, v24
    v_xor_b32 v0, v0, v24
    v_lshlrev_b32 v0, 4, v0
    s_lshl_b32 s35, s30, 5
    s_add_u32 s35, s35, 16
    v_lshrrev_b32 v24, 3, v25
    v_add_u32 v24, s35, v24
    v_lshl_add_u32 v11, v24, 12, v0
    s_lshl_b32 s36, s33, 1
    v_add_u32 v11, s36, v11
    v_lshl_add_u32 v15, v24, 10, v0
    s_lshl_b32 s36, s34, 1
    v_add_u32 v15, s36, v15
    v_and_b32 v0, 7, v25
    v_and_b32 v24, 1, v27
    v_lshlrev_b32 v24, 1, v24
    v_xor_b32 v0, v0, v24
    v_xor_b32 v0, 4, v0
    v_lshlrev_b32 v0, 4, v0
    s_lshl_b32 s35, s30, 5
    s_add_u32 s35, s35, 24
    v_lshrrev_b32 v24, 3, v25
    v_add_u32 v24, s35, v24
    v_lshl_add_u32 v12, v24, 12, v0
    s_lshl_b32 s36, s33, 1
    v_add_u32 v12, s36, v12
    v_lshl_add_u32 v16, v24, 10, v0
    s_lshl_b32 s36, s34, 1
    v_add_u32 v16, s36, v16
    s_lshl_b32 s42, s30, 14
    s_mov_b32 s40, 0
    s_mov_b32 s41, 0
    s_add_u32 m0, s42, 0
    s_nop 0
    buffer_load_dwordx4 v9, s[8:11], s40 offen lds
    s_add_u32 m0, s42, 4096
    s_nop 0
    buffer_load_dwordx4 v13, s[12:15], s41 offen lds
    s_add_u32 m0, s42, 1024
    s_nop 0
    buffer_load_dwordx4 v10, s[8:11], s40 offen lds
    s_add_u32 m0, s42, 5120
    s_nop 0
    buffer_load_dwordx4 v14, s[12:15], s41 offen lds
    s_add_u32 m0, s42, 2048
    s_nop 0
    buffer_load_dwordx4 v11, s[8:11], s40 offen lds
    s_add_u32 m0, s42, 6144
    s_nop 0
    buffer_load_dwordx4 v15, s[12:15], s41 offen lds
    s_add_u32 m0, s42, 3072
    s_nop 0
    buffer_load_dwordx4 v12, s[8:11], s40 offen lds
    s_add_u32 m0, s42, 7168
    s_nop 0
    buffer_load_dwordx4 v16, s[12:15], s41 offen lds
    v_lshrrev_b32 v0, 2, v26
    v_lshrrev_b32 v24, 1, v0
    v_and_b32 v17, 1, v27
    v_lshl_or_b32 v24, v17, 1, v24
    v_lshlrev_b32 v24, 1, v24
    v_and_b32 v17, 3, v26
    v_lshrrev_b32 v18, 1, v17
    v_and_b32 v17, 1, v17
    v_lshl_add_u32 v0, v27, 3, v0
    v_lshlrev_b32 v0, 7, v0
    v_lshl_add_u32 v0, v17, 3, v0
    v_add_u32 v0, s42, v0
    v_add_u32 v19, 0, v18
    v_xor_b32 v19, v19, v24
    v_lshl_add_u32 v1, v19, 4, v0
    v_add_u32 v19, 2, v18
    v_xor_b32 v19, v19, v24
    v_lshl_add_u32 v2, v19, 4, v0
    v_add_u32 v19, 4, v18
    v_xor_b32 v19, v19, v24
    v_lshl_add_u32 v3, v19, 4, v0
    v_add_u32 v19, 6, v18
    v_xor_b32 v19, v19, v24
    v_lshl_add_u32 v4, v19, 4, v0
    v_mov_b32 v64, 0
    v_mov_b32 v65, 0
    v_mov_b32 v66, 0
    v_mov_b32 v67, 0
    v_mov_b32 v68, 0
    v_mov_b32 v69, 0
    v_mov_b32 v70, 0
    v_mov_b32 v71, 0
    v_mov_b32 v72, 0
    v_mov_b32 v73, 0
    v_mov_b32 v74, 0
    v_mov_b32 v75, 0
    v_mov_b32 v76, 0
    v_mov_b32 v77, 0
    v_mov_b32 v78, 0
    v_mov_b32 v79, 0
    v_mov_b32 v80, 0
    v_mov_b32 v81, 0
    v_mov_b32 v82, 0
    v_mov_b32 v83, 0
    v_mov_b32 v84, 0
    v_mov_b32 v85, 0
    v_mov_b32 v86, 0
    v_mov_b32 v87, 0
    v_mov_b32 v88, 0
    v_mov_b32 v89, 0
    v_mov_b32 v90, 0
    v_mov_b32 v91, 0
    v_mov_b32 v92, 0
    v_mov_b32 v93, 0
    v_mov_b32 v94, 0
    v_mov_b32 v95, 0
    v_mov_b32 v96, 0
    v_mov_b32 v97, 0
    v_mov_b32 v98, 0
    v_mov_b32 v99, 0
    v_mov_b32 v100, 0
    v_mov_b32 v101, 0
    v_mov_b32 v102, 0
    v_mov_b32 v103, 0
    v_mov_b32 v104, 0
    v_mov_b32 v105, 0
    v_mov_b32 v106, 0
    v_mov_b32 v107, 0
    v_mov_b32 v108, 0
    v_mov_b32 v109, 0
    v_mov_b32 v110, 0
    v_mov_b32 v111, 0
    v_mov_b32 v112, 0
    v_mov_b32 v113, 0
    v_mov_b32 v114, 0
    v_mov_b32 v115, 0
    v_mov_b32 v116, 0
    v_mov_b32 v117, 0
    v_mov_b32 v118, 0
    v_mov_b32 v119, 0
    v_mov_b32 v120, 0
    v_mov_b32 v121, 0
    v_mov_b32 v122, 0
    v_mov_b32 v123, 0
    v_mov_b32 v124, 0
    v_mov_b32 v125, 0
    v_mov_b32 v126, 0
    v_mov_b32 v127, 0
    s_waitcnt vmcnt(0)
    s_mov_b32 s40, 524288
    s_mov_b32 s41, 131072
    s_add_u32 m0, s42, 8192
    s_nop 0
    buffer_load_dwordx4 v9, s[8:11], s40 offen lds
    s_add_u32 m0, s42, 12288
    s_nop 0
    buffer_load_dwordx4 v13, s[12:15], s41 offen lds
    s_add_u32 m0, s42, 9216
    s_nop 0
    buffer_load_dwordx4 v10, s[8:11], s40 offen lds
    s_add_u32 m0, s42, 13312
    s_nop 0
    buffer_load_dwordx4 v14, s[12:15], s41 offen lds
    s_add_u32 m0, s42, 10240
    s_nop 0
    buffer_load_dwordx4 v11, s[8:11], s40 offen lds
    s_add_u32 m0, s42, 14336
    s_nop 0
    buffer_load_dwordx4 v15, s[12:15], s41 offen lds
    s_add_u32 m0, s42, 11264
    s_nop 0
    buffer_load_dwordx4 v12, s[8:11], s40 offen lds
    s_add_u32 m0, s42, 15360
    s_nop 0
    buffer_load_dwordx4 v16, s[12:15], s41 offen lds
    ds_read_b64_tr_b16 v[28:29], v1 offset:0
    ds_read_b64_tr_b16 v[30:31], v1 offset:512
    ds_read_b64_tr_b16 v[32:33], v2 offset:0
    ds_read_b64_tr_b16 v[34:35], v2 offset:512
    ds_read_b64_tr_b16 v[36:37], v3 offset:0
    ds_read_b64_tr_b16 v[38:39], v3 offset:512
    ds_read_b64_tr_b16 v[40:41], v4 offset:0
    ds_read_b64_tr_b16 v[42:43], v4 offset:512
    ds_read_b64_tr_b16 v[44:45], v1 offset:4096
    ds_read_b64_tr_b16 v[46:47], v1 offset:4608
    ds_read_b64_tr_b16 v[48:49], v2 offset:4096
    ds_read_b64_tr_b16 v[50:51], v2 offset:4608
    ds_read_b64_tr_b16 v[52:53], v3 offset:4096
    ds_read_b64_tr_b16 v[54:55], v3 offset:4608
    ds_read_b64_tr_b16 v[56:57], v4 offset:4096
    ds_read_b64_tr_b16 v[58:59], v4 offset:4608
    s_waitcnt lgkmcnt(0)
    v_mfma_f32_16x16x32_bf16 v[64:67], v[28:31], v[44:47], v[64:67]
    v_mfma_f32_16x16x32_bf16 v[68:71], v[28:31], v[48:51], v[68:71]
    v_mfma_f32_16x16x32_bf16 v[72:75], v[28:31], v[52:55], v[72:75]
    v_mfma_f32_16x16x32_bf16 v[76:79], v[28:31], v[56:59], v[76:79]
    v_mfma_f32_16x16x32_bf16 v[80:83], v[32:35], v[44:47], v[80:83]
    v_mfma_f32_16x16x32_bf16 v[84:87], v[32:35], v[48:51], v[84:87]
    v_mfma_f32_16x16x32_bf16 v[88:91], v[32:35], v[52:55], v[88:91]
    v_mfma_f32_16x16x32_bf16 v[92:95], v[32:35], v[56:59], v[92:95]
    v_mfma_f32_16x16x32_bf16 v[96:99], v[36:39], v[44:47], v[96:99]
    v_mfma_f32_16x16x32_bf16 v[100:103], v[36:39], v[48:51], v[100:103]
    v_mfma_f32_16x16x32_bf16 v[104:107], v[36:39], v[52:55], v[104:107]
    v_mfma_f32_16x16x32_bf16 v[108:111], v[36:39], v[56:59], v[108:111]
    v_mfma_f32_16x16x32_bf16 v[112:115], v[40:43], v[44:47], v[112:115]
    v_mfma_f32_16x16x32_bf16 v[116:119], v[40:43], v[48:51], v[116:119]
    v_mfma_f32_16x16x32_bf16 v[120:123], v[40:43], v[52:55], v[120:123]
    v_mfma_f32_16x16x32_bf16 v[124:127], v[40:43], v[56:59], v[124:127]
    s_waitcnt vmcnt(0)
    s_mov_b32 s40, 1048576
    s_mov_b32 s41, 262144
    s_add_u32 m0, s42, 0
    s_nop 0
    buffer_load_dwordx4 v9, s[8:11], s40 offen lds
    s_add_u32 m0, s42, 4096
    s_nop 0
    buffer_load_dwordx4 v13, s[12:15], s41 offen lds
    s_add_u32 m0, s42, 1024
    s_nop 0
    buffer_load_dwordx4 v10, s[8:11], s40 offen lds
    s_add_u32 m0, s42, 5120
    s_nop 0
    buffer_load_dwordx4 v14, s[12:15], s41 offen lds
    s_add_u32 m0, s42, 2048
    s_nop 0
    buffer_load_dwordx4 v11, s[8:11], s40 offen lds
    s_add_u32 m0, s42, 6144
    s_nop 0
    buffer_load_dwordx4 v15, s[12:15], s41 offen lds
    s_add_u32 m0, s42, 3072
    s_nop 0
    buffer_load_dwordx4 v12, s[8:11], s40 offen lds
    s_add_u32 m0, s42, 7168
    s_nop 0
    buffer_load_dwordx4 v16, s[12:15], s41 offen lds
    ds_read_b64_tr_b16 v[28:29], v1 offset:8192
    ds_read_b64_tr_b16 v[30:31], v1 offset:8704
    ds_read_b64_tr_b16 v[32:33], v2 offset:8192
    ds_read_b64_tr_b16 v[34:35], v2 offset:8704
    ds_read_b64_tr_b16 v[36:37], v3 offset:8192
    ds_read_b64_tr_b16 v[38:39], v3 offset:8704
    ds_read_b64_tr_b16 v[40:41], v4 offset:8192
    ds_read_b64_tr_b16 v[42:43], v4 offset:8704
    ds_read_b64_tr_b16 v[44:45], v1 offset:12288
    ds_read_b64_tr_b16 v[46:47], v1 offset:12800
    ds_read_b64_tr_b16 v[48:49], v2 offset:12288
    ds_read_b64_tr_b16 v[50:51], v2 offset:12800
    ds_read_b64_tr_b16 v[52:53], v3 offset:12288
    ds_read_b64_tr_b16 v[54:55], v3 offset:12800
    ds_read_b64_tr_b16 v[56:57], v4 offset:12288
    ds_read_b64_tr_b16 v[58:59], v4 offset:12800
    s_waitcnt lgkmcnt(0)
    v_mfma_f32_16x16x32_bf16 v[64:67], v[28:31], v[44:47], v[64:67]
    v_mfma_f32_16x16x32_bf16 v[68:71], v[28:31], v[48:51], v[68:71]
    v_mfma_f32_16x16x32_bf16 v[72:75], v[28:31], v[52:55], v[72:75]
    v_mfma_f32_16x16x32_bf16 v[76:79], v[28:31], v[56:59], v[76:79]
    v_mfma_f32_16x16x32_bf16 v[80:83], v[32:35], v[44:47], v[80:83]
    v_mfma_f32_16x16x32_bf16 v[84:87], v[32:35], v[48:51], v[84:87]
    v_mfma_f32_16x16x32_bf16 v[88:91], v[32:35], v[52:55], v[88:91]
    v_mfma_f32_16x16x32_bf16 v[92:95], v[32:35], v[56:59], v[92:95]
    v_mfma_f32_16x16x32_bf16 v[96:99], v[36:39], v[44:47], v[96:99]
    v_mfma_f32_16x16x32_bf16 v[100:103], v[36:39], v[48:51], v[100:103]
    v_mfma_f32_16x16x32_bf16 v[104:107], v[36:39], v[52:55], v[104:107]
    v_mfma_f32_16x16x32_bf16 v[108:111], v[36:39], v[56:59], v[108:111]
    v_mfma_f32_16x16x32_bf16 v[112:115], v[40:43], v[44:47], v[112:115]
    v_mfma_f32_16x16x32_bf16 v[116:119], v[40:43], v[48:51], v[116:119]
    v_mfma_f32_16x16x32_bf16 v[120:123], v[40:43], v[52:55], v[120:123]
    v_mfma_f32_16x16x32_bf16 v[124:127], v[40:43], v[56:59], v[124:127]
    s_waitcnt vmcnt(0)
    s_mov_b32 s40, 1572864
    s_mov_b32 s41, 393216
    s_add_u32 m0, s42, 8192
    s_nop 0
    buffer_load_dwordx4 v9, s[8:11], s40 offen lds
    s_add_u32 m0, s42, 12288
    s_nop 0
    buffer_load_dwordx4 v13, s[12:15], s41 offen lds
    s_add_u32 m0, s42, 9216
    s_nop 0
    buffer_load_dwordx4 v10, s[8:11], s40 offen lds
    s_add_u32 m0, s42, 13312
    s_nop 0
    buffer_load_dwordx4 v14, s[12:15], s41 offen lds
    s_add_u32 m0, s42, 10240
    s_nop 0
    buffer_load_dwordx4 v11, s[8:11], s40 offen lds
    s_add_u32 m0, s42, 14336
    s_nop 0
    buffer_load_dwordx4 v15, s[12:15], s41 offen lds
    s_add_u32 m0, s42, 11264
    s_nop 0
    buffer_load_dwordx4 v12, s[8:11], s40 offen lds
    s_add_u32 m0, s42, 15360
    s_nop 0
    buffer_load_dwordx4 v16, s[12:15], s41 offen lds
    ds_read_b64_tr_b16 v[28:29], v1 offset:0
    ds_read_b64_tr_b16 v[30:31], v1 offset:512
    ds_read_b64_tr_b16 v[32:33], v2 offset:0
    ds_read_b64_tr_b16 v[34:35], v2 offset:512
    ds_read_b64_tr_b16 v[36:37], v3 offset:0
    ds_read_b64_tr_b16 v[38:39], v3 offset:512
    ds_read_b64_tr_b16 v[40:41], v4 offset:0
    ds_read_b64_tr_b16 v[42:43], v4 offset:512
    ds_read_b64_tr_b16 v[44:45], v1 offset:4096
    ds_read_b64_tr_b16 v[46:47], v1 offset:4608
    ds_read_b64_tr_b16 v[48:49], v2 offset:4096
    ds_read_b64_tr_b16 v[50:51], v2 offset:4608
    ds_read_b64_tr_b16 v[52:53], v3 offset:4096
    ds_read_b64_tr_b16 v[54:55], v3 offset:4608
    ds_read_b64_tr_b16 v[56:57], v4 offset:4096
    ds_read_b64_tr_b16 v[58:59], v4 offset:4608
    s_waitcnt lgkmcnt(0)
    v_mfma_f32_16x16x32_bf16 v[64:67], v[28:31], v[44:47], v[64:67]
    v_mfma_f32_16x16x32_bf16 v[68:71], v[28:31], v[48:51], v[68:71]
    v_mfma_f32_16x16x32_bf16 v[72:75], v[28:31], v[52:55], v[72:75]
    v_mfma_f32_16x16x32_bf16 v[76:79], v[28:31], v[56:59], v[76:79]
    v_mfma_f32_16x16x32_bf16 v[80:83], v[32:35], v[44:47], v[80:83]
    v_mfma_f32_16x16x32_bf16 v[84:87], v[32:35], v[48:51], v[84:87]
    v_mfma_f32_16x16x32_bf16 v[88:91], v[32:35], v[52:55], v[88:91]
    v_mfma_f32_16x16x32_bf16 v[92:95], v[32:35], v[56:59], v[92:95]
    v_mfma_f32_16x16x32_bf16 v[96:99], v[36:39], v[44:47], v[96:99]
    v_mfma_f32_16x16x32_bf16 v[100:103], v[36:39], v[48:51], v[100:103]
    v_mfma_f32_16x16x32_bf16 v[104:107], v[36:39], v[52:55], v[104:107]
    v_mfma_f32_16x16x32_bf16 v[108:111], v[36:39], v[56:59], v[108:111]
    v_mfma_f32_16x16x32_bf16 v[112:115], v[40:43], v[44:47], v[112:115]
    v_mfma_f32_16x16x32_bf16 v[116:119], v[40:43], v[48:51], v[116:119]
    v_mfma_f32_16x16x32_bf16 v[120:123], v[40:43], v[52:55], v[120:123]
    v_mfma_f32_16x16x32_bf16 v[124:127], v[40:43], v[56:59], v[124:127]
    s_waitcnt vmcnt(0)
    s_mov_b32 s40, 2097152
    s_mov_b32 s41, 524288
    s_add_u32 m0, s42, 0
    s_nop 0
    buffer_load_dwordx4 v9, s[8:11], s40 offen lds
    s_add_u32 m0, s42, 4096
    s_nop 0
    buffer_load_dwordx4 v13, s[12:15], s41 offen lds
    s_add_u32 m0, s42, 1024
    s_nop 0
    buffer_load_dwordx4 v10, s[8:11], s40 offen lds
    s_add_u32 m0, s42, 5120
    s_nop 0
    buffer_load_dwordx4 v14, s[12:15], s41 offen lds
    s_add_u32 m0, s42, 2048
    s_nop 0
    buffer_load_dwordx4 v11, s[8:11], s40 offen lds
    s_add_u32 m0, s42, 6144
    s_nop 0
    buffer_load_dwordx4 v15, s[12:15], s41 offen lds
    s_add_u32 m0, s42, 3072
    s_nop 0
    buffer_load_dwordx4 v12, s[8:11], s40 offen lds
    s_add_u32 m0, s42, 7168
    s_nop 0
    buffer_load_dwordx4 v16, s[12:15], s41 offen lds
    ds_read_b64_tr_b16 v[28:29], v1 offset:8192
    ds_read_b64_tr_b16 v[30:31], v1 offset:8704
    ds_read_b64_tr_b16 v[32:33], v2 offset:8192
    ds_read_b64_tr_b16 v[34:35], v2 offset:8704
    ds_read_b64_tr_b16 v[36:37], v3 offset:8192
    ds_read_b64_tr_b16 v[38:39], v3 offset:8704
    ds_read_b64_tr_b16 v[40:41], v4 offset:8192
    ds_read_b64_tr_b16 v[42:43], v4 offset:8704
    ds_read_b64_tr_b16 v[44:45], v1 offset:12288
    ds_read_b64_tr_b16 v[46:47], v1 offset:12800
    ds_read_b64_tr_b16 v[48:49], v2 offset:12288
    ds_read_b64_tr_b16 v[50:51], v2 offset:12800
    ds_read_b64_tr_b16 v[52:53], v3 offset:12288
    ds_read_b64_tr_b16 v[54:55], v3 offset:12800
    ds_read_b64_tr_b16 v[56:57], v4 offset:12288
    ds_read_b64_tr_b16 v[58:59], v4 offset:12800
    s_waitcnt lgkmcnt(0)
    v_mfma_f32_16x16x32_bf16 v[64:67], v[28:31], v[44:47], v[64:67]
    v_mfma_f32_16x16x32_bf16 v[68:71], v[28:31], v[48:51], v[68:71]
    v_mfma_f32_16x16x32_bf16 v[72:75], v[28:31], v[52:55], v[72:75]
    v_mfma_f32_16x16x32_bf16 v[76:79], v[28:31], v[56:59], v[76:79]
    v_mfma_f32_16x16x32_bf16 v[80:83], v[32:35], v[44:47], v[80:83]
    v_mfma_f32_16x16x32_bf16 v[84:87], v[32:35], v[48:51], v[84:87]
    v_mfma_f32_16x16x32_bf16 v[88:91], v[32:35], v[52:55], v[88:91]
    v_mfma_f32_16x16x32_bf16 v[92:95], v[32:35], v[56:59], v[92:95]
    v_mfma_f32_16x16x32_bf16 v[96:99], v[36:39], v[44:47], v[96:99]
    v_mfma_f32_16x16x32_bf16 v[100:103], v[36:39], v[48:51], v[100:103]
    v_mfma_f32_16x16x32_bf16 v[104:107], v[36:39], v[52:55], v[104:107]
    v_mfma_f32_16x16x32_bf16 v[108:111], v[36:39], v[56:59], v[108:111]
    v_mfma_f32_16x16x32_bf16 v[112:115], v[40:43], v[44:47], v[112:115]
    v_mfma_f32_16x16x32_bf16 v[116:119], v[40:43], v[48:51], v[116:119]
    v_mfma_f32_16x16x32_bf16 v[120:123], v[40:43], v[52:55], v[120:123]
    v_mfma_f32_16x16x32_bf16 v[124:127], v[40:43], v[56:59], v[124:127]
    s_waitcnt vmcnt(0)
    s_mov_b32 s40, 2621440
    s_mov_b32 s41, 655360
    s_add_u32 m0, s42, 8192
    s_nop 0
    buffer_load_dwordx4 v9, s[8:11], s40 offen lds
    s_add_u32 m0, s42, 12288
    s_nop 0
    buffer_load_dwordx4 v13, s[12:15], s41 offen lds
    s_add_u32 m0, s42, 9216
    s_nop 0
    buffer_load_dwordx4 v10, s[8:11], s40 offen lds
    s_add_u32 m0, s42, 13312
    s_nop 0
    buffer_load_dwordx4 v14, s[12:15], s41 offen lds
    s_add_u32 m0, s42, 10240
    s_nop 0
    buffer_load_dwordx4 v11, s[8:11], s40 offen lds
    s_add_u32 m0, s42, 14336
    s_nop 0
    buffer_load_dwordx4 v15, s[12:15], s41 offen lds
    s_add_u32 m0, s42, 11264
    s_nop 0
    buffer_load_dwordx4 v12, s[8:11], s40 offen lds
    s_add_u32 m0, s42, 15360
    s_nop 0
    buffer_load_dwordx4 v16, s[12:15], s41 offen lds
    ds_read_b64_tr_b16 v[28:29], v1 offset:0
    ds_read_b64_tr_b16 v[30:31], v1 offset:512
    ds_read_b64_tr_b16 v[32:33], v2 offset:0
    ds_read_b64_tr_b16 v[34:35], v2 offset:512
    ds_read_b64_tr_b16 v[36:37], v3 offset:0
    ds_read_b64_tr_b16 v[38:39], v3 offset:512
    ds_read_b64_tr_b16 v[40:41], v4 offset:0
    ds_read_b64_tr_b16 v[42:43], v4 offset:512
    ds_read_b64_tr_b16 v[44:45], v1 offset:4096
    ds_read_b64_tr_b16 v[46:47], v1 offset:4608
    ds_read_b64_tr_b16 v[48:49], v2 offset:4096
    ds_read_b64_tr_b16 v[50:51], v2 offset:4608
    ds_read_b64_tr_b16 v[52:53], v3 offset:4096
    ds_read_b64_tr_b16 v[54:55], v3 offset:4608
    ds_read_b64_tr_b16 v[56:57], v4 offset:4096
    ds_read_b64_tr_b16 v[58:59], v4 offset:4608
    s_waitcnt lgkmcnt(0)
    v_mfma_f32_16x16x32_bf16 v[64:67], v[28:31], v[44:47], v[64:67]
    v_mfma_f32_16x16x32_bf16 v[68:71], v[28:31], v[48:51], v[68:71]
    v_mfma_f32_16x16x32_bf16 v[72:75], v[28:31], v[52:55], v[72:75]
    v_mfma_f32_16x16x32_bf16 v[76:79], v[28:31], v[56:59], v[76:79]
    v_mfma_f32_16x16x32_bf16 v[80:83], v[32:35], v[44:47], v[80:83]
    v_mfma_f32_16x16x32_bf16 v[84:87], v[32:35], v[48:51], v[84:87]
    v_mfma_f32_16x16x32_bf16 v[88:91], v[32:35], v[52:55], v[88:91]
    v_mfma_f32_16x16x32_bf16 v[92:95], v[32:35], v[56:59], v[92:95]
    v_mfma_f32_16x16x32_bf16 v[96:99], v[36:39], v[44:47], v[96:99]
    v_mfma_f32_16x16x32_bf16 v[100:103], v[36:39], v[48:51], v[100:103]
    v_mfma_f32_16x16x32_bf16 v[104:107], v[36:39], v[52:55], v[104:107]
    v_mfma_f32_16x16x32_bf16 v[108:111], v[36:39], v[56:59], v[108:111]
    v_mfma_f32_16x16x32_bf16 v[112:115], v[40:43], v[44:47], v[112:115]
    v_mfma_f32_16x16x32_bf16 v[116:119], v[40:43], v[48:51], v[116:119]
    v_mfma_f32_16x16x32_bf16 v[120:123], v[40:43], v[52:55], v[120:123]
    v_mfma_f32_16x16x32_bf16 v[124:127], v[40:43], v[56:59], v[124:127]
    s_waitcnt vmcnt(0)
    s_mov_b32 s40, 3145728
    s_mov_b32 s41, 786432
    s_add_u32 m0, s42, 0
    s_nop 0
    buffer_load_dwordx4 v9, s[8:11], s40 offen lds
    s_add_u32 m0, s42, 4096
    s_nop 0
    buffer_load_dwordx4 v13, s[12:15], s41 offen lds
    s_add_u32 m0, s42, 1024
    s_nop 0
    buffer_load_dwordx4 v10, s[8:11], s40 offen lds
    s_add_u32 m0, s42, 5120
    s_nop 0
    buffer_load_dwordx4 v14, s[12:15], s41 offen lds
    s_add_u32 m0, s42, 2048
    s_nop 0
    buffer_load_dwordx4 v11, s[8:11], s40 offen lds
    s_add_u32 m0, s42, 6144
    s_nop 0
    buffer_load_dwordx4 v15, s[12:15], s41 offen lds
    s_add_u32 m0, s42, 3072
    s_nop 0
    buffer_load_dwordx4 v12, s[8:11], s40 offen lds
    s_add_u32 m0, s42, 7168
    s_nop 0
    buffer_load_dwordx4 v16, s[12:15], s41 offen lds
    ds_read_b64_tr_b16 v[28:29], v1 offset:8192
    ds_read_b64_tr_b16 v[30:31], v1 offset:8704
    ds_read_b64_tr_b16 v[32:33], v2 offset:8192
    ds_read_b64_tr_b16 v[34:35], v2 offset:8704
    ds_read_b64_tr_b16 v[36:37], v3 offset:8192
    ds_read_b64_tr_b16 v[38:39], v3 offset:8704
    ds_read_b64_tr_b16 v[40:41], v4 offset:8192
    ds_read_b64_tr_b16 v[42:43], v4 offset:8704
    ds_read_b64_tr_b16 v[44:45], v1 offset:12288
    ds_read_b64_tr_b16 v[46:47], v1 offset:12800
    ds_read_b64_tr_b16 v[48:49], v2 offset:12288
    ds_read_b64_tr_b16 v[50:51], v2 offset:12800
    ds_read_b64_tr_b16 v[52:53], v3 offset:12288
    ds_read_b64_tr_b16 v[54:55], v3 offset:12800
    ds_read_b64_tr_b16 v[56:57], v4 offset:12288
    ds_read_b64_tr_b16 v[58:59], v4 offset:12800
    s_waitcnt lgkmcnt(0)
    v_mfma_f32_16x16x32_bf16 v[64:67], v[28:31], v[44:47], v[64:67]
    v_mfma_f32_16x16x32_bf16 v[68:71], v[28:31], v[48:51], v[68:71]
    v_mfma_f32_16x16x32_bf16 v[72:75], v[28:31], v[52:55], v[72:75]
    v_mfma_f32_16x16x32_bf16 v[76:79], v[28:31], v[56:59], v[76:79]
    v_mfma_f32_16x16x32_bf16 v[80:83], v[32:35], v[44:47], v[80:83]
    v_mfma_f32_16x16x32_bf16 v[84:87], v[32:35], v[48:51], v[84:87]
    v_mfma_f32_16x16x32_bf16 v[88:91], v[32:35], v[52:55], v[88:91]
    v_mfma_f32_16x16x32_bf16 v[92:95], v[32:35], v[56:59], v[92:95]
    v_mfma_f32_16x16x32_bf16 v[96:99], v[36:39], v[44:47], v[96:99]
    v_mfma_f32_16x16x32_bf16 v[100:103], v[36:39], v[48:51], v[100:103]
    v_mfma_f32_16x16x32_bf16 v[104:107], v[36:39], v[52:55], v[104:107]
    v_mfma_f32_16x16x32_bf16 v[108:111], v[36:39], v[56:59], v[108:111]
    v_mfma_f32_16x16x32_bf16 v[112:115], v[40:43], v[44:47], v[112:115]
    v_mfma_f32_16x16x32_bf16 v[116:119], v[40:43], v[48:51], v[116:119]
    v_mfma_f32_16x16x32_bf16 v[120:123], v[40:43], v[52:55], v[120:123]
    v_mfma_f32_16x16x32_bf16 v[124:127], v[40:43], v[56:59], v[124:127]
    s_waitcnt vmcnt(0)
    s_mov_b32 s40, 3670016
    s_mov_b32 s41, 917504
    s_add_u32 m0, s42, 8192
    s_nop 0
    buffer_load_dwordx4 v9, s[8:11], s40 offen lds
    s_add_u32 m0, s42, 12288
    s_nop 0
    buffer_load_dwordx4 v13, s[12:15], s41 offen lds
    s_add_u32 m0, s42, 9216
    s_nop 0
    buffer_load_dwordx4 v10, s[8:11], s40 offen lds
    s_add_u32 m0, s42, 13312
    s_nop 0
    buffer_load_dwordx4 v14, s[12:15], s41 offen lds
    s_add_u32 m0, s42, 10240
    s_nop 0
    buffer_load_dwordx4 v11, s[8:11], s40 offen lds
    s_add_u32 m0, s42, 14336
    s_nop 0
    buffer_load_dwordx4 v15, s[12:15], s41 offen lds
    s_add_u32 m0, s42, 11264
    s_nop 0
    buffer_load_dwordx4 v12, s[8:11], s40 offen lds
    s_add_u32 m0, s42, 15360
    s_nop 0
    buffer_load_dwordx4 v16, s[12:15], s41 offen lds
    ds_read_b64_tr_b16 v[28:29], v1 offset:0
    ds_read_b64_tr_b16 v[30:31], v1 offset:512
    ds_read_b64_tr_b16 v[32:33], v2 offset:0
    ds_read_b64_tr_b16 v[34:35], v2 offset:512
    ds_read_b64_tr_b16 v[36:37], v3 offset:0
    ds_read_b64_tr_b16 v[38:39], v3 offset:512
    ds_read_b64_tr_b16 v[40:41], v4 offset:0
    ds_read_b64_tr_b16 v[42:43], v4 offset:512
    ds_read_b64_tr_b16 v[44:45], v1 offset:4096
    ds_read_b64_tr_b16 v[46:47], v1 offset:4608
    ds_read_b64_tr_b16 v[48:49], v2 offset:4096
    ds_read_b64_tr_b16 v[50:51], v2 offset:4608
    ds_read_b64_tr_b16 v[52:53], v3 offset:4096
    ds_read_b64_tr_b16 v[54:55], v3 offset:4608
    ds_read_b64_tr_b16 v[56:57], v4 offset:4096
    ds_read_b64_tr_b16 v[58:59], v4 offset:4608
    s_waitcnt lgkmcnt(0)
    v_mfma_f32_16x16x32_bf16 v[64:67], v[28:31], v[44:47], v[64:67]
    v_mfma_f32_16x16x32_bf16 v[68:71], v[28:31], v[48:51], v[68:71]
    v_mfma_f32_16x16x32_bf16 v[72:75], v[28:31], v[52:55], v[72:75]
    v_mfma_f32_16x16x32_bf16 v[76:79], v[28:31], v[56:59], v[76:79]
    v_mfma_f32_16x16x32_bf16 v[80:83], v[32:35], v[44:47], v[80:83]
    v_mfma_f32_16x16x32_bf16 v[84:87], v[32:35], v[48:51], v[84:87]
    v_mfma_f32_16x16x32_bf16 v[88:91], v[32:35], v[52:55], v[88:91]
    v_mfma_f32_16x16x32_bf16 v[92:95], v[32:35], v[56:59], v[92:95]
    v_mfma_f32_16x16x32_bf16 v[96:99], v[36:39], v[44:47], v[96:99]
    v_mfma_f32_16x16x32_bf16 v[100:103], v[36:39], v[48:51], v[100:103]
    v_mfma_f32_16x16x32_bf16 v[104:107], v[36:39], v[52:55], v[104:107]
    v_mfma_f32_16x16x32_bf16 v[108:111], v[36:39], v[56:59], v[108:111]
    v_mfma_f32_16x16x32_bf16 v[112:115], v[40:43], v[44:47], v[112:115]
    v_mfma_f32_16x16x32_bf16 v[116:119], v[40:43], v[48:51], v[116:119]
    v_mfma_f32_16x16x32_bf16 v[120:123], v[40:43], v[52:55], v[120:123]
    v_mfma_f32_16x16x32_bf16 v[124:127], v[40:43], v[56:59], v[124:127]
    s_waitcnt vmcnt(0)
    s_mov_b32 s40, 4194304
    s_mov_b32 s41, 1048576
    s_add_u32 m0, s42, 0
    s_nop 0
    buffer_load_dwordx4 v9, s[8:11], s40 offen lds
    s_add_u32 m0, s42, 4096
    s_nop 0
    buffer_load_dwordx4 v13, s[12:15], s41 offen lds
    s_add_u32 m0, s42, 1024
    s_nop 0
    buffer_load_dwordx4 v10, s[8:11], s40 offen lds
    s_add_u32 m0, s42, 5120
    s_nop 0
    buffer_load_dwordx4 v14, s[12:15], s41 offen lds
    s_add_u32 m0, s42, 2048
    s_nop 0
    buffer_load_dwordx4 v11, s[8:11], s40 offen lds
    s_add_u32 m0, s42, 6144
    s_nop 0
    buffer_load_dwordx4 v15, s[12:15], s41 offen lds
    s_add_u32 m0, s42, 3072
    s_nop 0
    buffer_load_dwordx4 v12, s[8:11], s40 offen lds
    s_add_u32 m0, s42, 7168
    s_nop 0
    buffer_load_dwordx4 v16, s[12:15], s41 offen lds
    ds_read_b64_tr_b16 v[28:29], v1 offset:8192
    ds_read_b64_tr_b16 v[30:31], v1 offset:8704
    ds_read_b64_tr_b16 v[32:33], v2 offset:8192
    ds_read_b64_tr_b16 v[34:35], v2 offset:8704
    ds_read_b64_tr_b16 v[36:37], v3 offset:8192
    ds_read_b64_tr_b16 v[38:39], v3 offset:8704
    ds_read_b64_tr_b16 v[40:41], v4 offset:8192
    ds_read_b64_tr_b16 v[42:43], v4 offset:8704
    ds_read_b64_tr_b16 v[44:45], v1 offset:12288
    ds_read_b64_tr_b16 v[46:47], v1 offset:12800
    ds_read_b64_tr_b16 v[48:49], v2 offset:12288
    ds_read_b64_tr_b16 v[50:51], v2 offset:12800
    ds_read_b64_tr_b16 v[52:53], v3 offset:12288
    ds_read_b64_tr_b16 v[54:55], v3 offset:12800
    ds_read_b64_tr_b16 v[56:57], v4 offset:12288
    ds_read_b64_tr_b16 v[58:59], v4 offset:12800
    s_waitcnt lgkmcnt(0)
    v_mfma_f32_16x16x32_bf16 v[64:67], v[28:31], v[44:47], v[64:67]
    v_mfma_f32_16x16x32_bf16 v[68:71], v[28:31], v[48:51], v[68:71]
    v_mfma_f32_16x16x32_bf16 v[72:75], v[28:31], v[52:55], v[72:75]
    v_mfma_f32_16x16x32_bf16 v[76:79], v[28:31], v[56:59], v[76:79]
    v_mfma_f32_16x16x32_bf16 v[80:83], v[32:35], v[44:47], v[80:83]
    v_mfma_f32_16x16x32_bf16 v[84:87], v[32:35], v[48:51], v[84:87]
    v_mfma_f32_16x16x32_bf16 v[88:91], v[32:35], v[52:55], v[88:91]
    v_mfma_f32_16x16x32_bf16 v[92:95], v[32:35], v[56:59], v[92:95]
    v_mfma_f32_16x16x32_bf16 v[96:99], v[36:39], v[44:47], v[96:99]
    v_mfma_f32_16x16x32_bf16 v[100:103], v[36:39], v[48:51], v[100:103]
    v_mfma_f32_16x16x32_bf16 v[104:107], v[36:39], v[52:55], v[104:107]
    v_mfma_f32_16x16x32_bf16 v[108:111], v[36:39], v[56:59], v[108:111]
    v_mfma_f32_16x16x32_bf16 v[112:115], v[40:43], v[44:47], v[112:115]
    v_mfma_f32_16x16x32_bf16 v[116:119], v[40:43], v[48:51], v[116:119]
    v_mfma_f32_16x16x32_bf16 v[120:123], v[40:43], v[52:55], v[120:123]
    v_mfma_f32_16x16x32_bf16 v[124:127], v[40:43], v[56:59], v[124:127]
    s_waitcnt vmcnt(0)
    s_mov_b32 s40, 4718592
    s_mov_b32 s41, 1179648
    s_add_u32 m0, s42, 8192
    s_nop 0
    buffer_load_dwordx4 v9, s[8:11], s40 offen lds
    s_add_u32 m0, s42, 12288
    s_nop 0
    buffer_load_dwordx4 v13, s[12:15], s41 offen lds
    s_add_u32 m0, s42, 9216
    s_nop 0
    buffer_load_dwordx4 v10, s[8:11], s40 offen lds
    s_add_u32 m0, s42, 13312
    s_nop 0
    buffer_load_dwordx4 v14, s[12:15], s41 offen lds
    s_add_u32 m0, s42, 10240
    s_nop 0
    buffer_load_dwordx4 v11, s[8:11], s40 offen lds
    s_add_u32 m0, s42, 14336
    s_nop 0
    buffer_load_dwordx4 v15, s[12:15], s41 offen lds
    s_add_u32 m0, s42, 11264
    s_nop 0
    buffer_load_dwordx4 v12, s[8:11], s40 offen lds
    s_add_u32 m0, s42, 15360
    s_nop 0
    buffer_load_dwordx4 v16, s[12:15], s41 offen lds
    ds_read_b64_tr_b16 v[28:29], v1 offset:0
    ds_read_b64_tr_b16 v[30:31], v1 offset:512
    ds_read_b64_tr_b16 v[32:33], v2 offset:0
    ds_read_b64_tr_b16 v[34:35], v2 offset:512
    ds_read_b64_tr_b16 v[36:37], v3 offset:0
    ds_read_b64_tr_b16 v[38:39], v3 offset:512
    ds_read_b64_tr_b16 v[40:41], v4 offset:0
    ds_read_b64_tr_b16 v[42:43], v4 offset:512
    ds_read_b64_tr_b16 v[44:45], v1 offset:4096
    ds_read_b64_tr_b16 v[46:47], v1 offset:4608
    ds_read_b64_tr_b16 v[48:49], v2 offset:4096
    ds_read_b64_tr_b16 v[50:51], v2 offset:4608
    ds_read_b64_tr_b16 v[52:53], v3 offset:4096
    ds_read_b64_tr_b16 v[54:55], v3 offset:4608
    ds_read_b64_tr_b16 v[56:57], v4 offset:4096
    ds_read_b64_tr_b16 v[58:59], v4 offset:4608
    s_waitcnt lgkmcnt(0)
    v_mfma_f32_16x16x32_bf16 v[64:67], v[28:31], v[44:47], v[64:67]
    v_mfma_f32_16x16x32_bf16 v[68:71], v[28:31], v[48:51], v[68:71]
    v_mfma_f32_16x16x32_bf16 v[72:75], v[28:31], v[52:55], v[72:75]
    v_mfma_f32_16x16x32_bf16 v[76:79], v[28:31], v[56:59], v[76:79]
    v_mfma_f32_16x16x32_bf16 v[80:83], v[32:35], v[44:47], v[80:83]
    v_mfma_f32_16x16x32_bf16 v[84:87], v[32:35], v[48:51], v[84:87]
    v_mfma_f32_16x16x32_bf16 v[88:91], v[32:35], v[52:55], v[88:91]
    v_mfma_f32_16x16x32_bf16 v[92:95], v[32:35], v[56:59], v[92:95]
    v_mfma_f32_16x16x32_bf16 v[96:99], v[36:39], v[44:47], v[96:99]
    v_mfma_f32_16x16x32_bf16 v[100:103], v[36:39], v[48:51], v[100:103]
    v_mfma_f32_16x16x32_bf16 v[104:107], v[36:39], v[52:55], v[104:107]
    v_mfma_f32_16x16x32_bf16 v[108:111], v[36:39], v[56:59], v[108:111]
    v_mfma_f32_16x16x32_bf16 v[112:115], v[40:43], v[44:47], v[112:115]
    v_mfma_f32_16x16x32_bf16 v[116:119], v[40:43], v[48:51], v[116:119]
    v_mfma_f32_16x16x32_bf16 v[120:123], v[40:43], v[52:55], v[120:123]
    v_mfma_f32_16x16x32_bf16 v[124:127], v[40:43], v[56:59], v[124:127]
    s_waitcnt vmcnt(0)
    s_mov_b32 s40, 5242880
    s_mov_b32 s41, 1310720
    s_add_u32 m0, s42, 0
    s_nop 0
    buffer_load_dwordx4 v9, s[8:11], s40 offen lds
    s_add_u32 m0, s42, 4096
    s_nop 0
    buffer_load_dwordx4 v13, s[12:15], s41 offen lds
    s_add_u32 m0, s42, 1024
    s_nop 0
    buffer_load_dwordx4 v10, s[8:11], s40 offen lds
    s_add_u32 m0, s42, 5120
    s_nop 0
    buffer_load_dwordx4 v14, s[12:15], s41 offen lds
    s_add_u32 m0, s42, 2048
    s_nop 0
    buffer_load_dwordx4 v11, s[8:11], s40 offen lds
    s_add_u32 m0, s42, 6144
    s_nop 0
    buffer_load_dwordx4 v15, s[12:15], s41 offen lds
    s_add_u32 m0, s42, 3072
    s_nop 0
    buffer_load_dwordx4 v12, s[8:11], s40 offen lds
    s_add_u32 m0, s42, 7168
    s_nop 0
    buffer_load_dwordx4 v16, s[12:15], s41 offen lds
    ds_read_b64_tr_b16 v[28:29], v1 offset:8192
    ds_read_b64_tr_b16 v[30:31], v1 offset:8704
    ds_read_b64_tr_b16 v[32:33], v2 offset:8192
    ds_read_b64_tr_b16 v[34:35], v2 offset:8704
    ds_read_b64_tr_b16 v[36:37], v3 offset:8192
    ds_read_b64_tr_b16 v[38:39], v3 offset:8704
    ds_read_b64_tr_b16 v[40:41], v4 offset:8192
    ds_read_b64_tr_b16 v[42:43], v4 offset:8704
    ds_read_b64_tr_b16 v[44:45], v1 offset:12288
    ds_read_b64_tr_b16 v[46:47], v1 offset:12800
    ds_read_b64_tr_b16 v[48:49], v2 offset:12288
    ds_read_b64_tr_b16 v[50:51], v2 offset:12800
    ds_read_b64_tr_b16 v[52:53], v3 offset:12288
    ds_read_b64_tr_b16 v[54:55], v3 offset:12800
    ds_read_b64_tr_b16 v[56:57], v4 offset:12288
    ds_read_b64_tr_b16 v[58:59], v4 offset:12800
    s_waitcnt lgkmcnt(0)
    v_mfma_f32_16x16x32_bf16 v[64:67], v[28:31], v[44:47], v[64:67]
    v_mfma_f32_16x16x32_bf16 v[68:71], v[28:31], v[48:51], v[68:71]
    v_mfma_f32_16x16x32_bf16 v[72:75], v[28:31], v[52:55], v[72:75]
    v_mfma_f32_16x16x32_bf16 v[76:79], v[28:31], v[56:59], v[76:79]
    v_mfma_f32_16x16x32_bf16 v[80:83], v[32:35], v[44:47], v[80:83]
    v_mfma_f32_16x16x32_bf16 v[84:87], v[32:35], v[48:51], v[84:87]
    v_mfma_f32_16x16x32_bf16 v[88:91], v[32:35], v[52:55], v[88:91]
    v_mfma_f32_16x16x32_bf16 v[92:95], v[32:35], v[56:59], v[92:95]
    v_mfma_f32_16x16x32_bf16 v[96:99], v[36:39], v[44:47], v[96:99]
    v_mfma_f32_16x16x32_bf16 v[100:103], v[36:39], v[48:51], v[100:103]
    v_mfma_f32_16x16x32_bf16 v[104:107], v[36:39], v[52:55], v[104:107]
    v_mfma_f32_16x16x32_bf16 v[108:111], v[36:39], v[56:59], v[108:111]
    v_mfma_f32_16x16x32_bf16 v[112:115], v[40:43], v[44:47], v[112:115]
    v_mfma_f32_16x16x32_bf16 v[116:119], v[40:43], v[48:51], v[116:119]
    v_mfma_f32_16x16x32_bf16 v[120:123], v[40:43], v[52:55], v[120:123]
    v_mfma_f32_16x16x32_bf16 v[124:127], v[40:43], v[56:59], v[124:127]
    s_waitcnt vmcnt(0)
    s_mov_b32 s40, 5767168
    s_mov_b32 s41, 1441792
    s_add_u32 m0, s42, 8192
    s_nop 0
    buffer_load_dwordx4 v9, s[8:11], s40 offen lds
    s_add_u32 m0, s42, 12288
    s_nop 0
    buffer_load_dwordx4 v13, s[12:15], s41 offen lds
    s_add_u32 m0, s42, 9216
    s_nop 0
    buffer_load_dwordx4 v10, s[8:11], s40 offen lds
    s_add_u32 m0, s42, 13312
    s_nop 0
    buffer_load_dwordx4 v14, s[12:15], s41 offen lds
    s_add_u32 m0, s42, 10240
    s_nop 0
    buffer_load_dwordx4 v11, s[8:11], s40 offen lds
    s_add_u32 m0, s42, 14336
    s_nop 0
    buffer_load_dwordx4 v15, s[12:15], s41 offen lds
    s_add_u32 m0, s42, 11264
    s_nop 0
    buffer_load_dwordx4 v12, s[8:11], s40 offen lds
    s_add_u32 m0, s42, 15360
    s_nop 0
    buffer_load_dwordx4 v16, s[12:15], s41 offen lds
    ds_read_b64_tr_b16 v[28:29], v1 offset:0
    ds_read_b64_tr_b16 v[30:31], v1 offset:512
    ds_read_b64_tr_b16 v[32:33], v2 offset:0
    ds_read_b64_tr_b16 v[34:35], v2 offset:512
    ds_read_b64_tr_b16 v[36:37], v3 offset:0
    ds_read_b64_tr_b16 v[38:39], v3 offset:512
    ds_read_b64_tr_b16 v[40:41], v4 offset:0
    ds_read_b64_tr_b16 v[42:43], v4 offset:512
    ds_read_b64_tr_b16 v[44:45], v1 offset:4096
    ds_read_b64_tr_b16 v[46:47], v1 offset:4608
    ds_read_b64_tr_b16 v[48:49], v2 offset:4096
    ds_read_b64_tr_b16 v[50:51], v2 offset:4608
    ds_read_b64_tr_b16 v[52:53], v3 offset:4096
    ds_read_b64_tr_b16 v[54:55], v3 offset:4608
    ds_read_b64_tr_b16 v[56:57], v4 offset:4096
    ds_read_b64_tr_b16 v[58:59], v4 offset:4608
    s_waitcnt lgkmcnt(0)
    v_mfma_f32_16x16x32_bf16 v[64:67], v[28:31], v[44:47], v[64:67]
    v_mfma_f32_16x16x32_bf16 v[68:71], v[28:31], v[48:51], v[68:71]
    v_mfma_f32_16x16x32_bf16 v[72:75], v[28:31], v[52:55], v[72:75]
    v_mfma_f32_16x16x32_bf16 v[76:79], v[28:31], v[56:59], v[76:79]
    v_mfma_f32_16x16x32_bf16 v[80:83], v[32:35], v[44:47], v[80:83]
    v_mfma_f32_16x16x32_bf16 v[84:87], v[32:35], v[48:51], v[84:87]
    v_mfma_f32_16x16x32_bf16 v[88:91], v[32:35], v[52:55], v[88:91]
    v_mfma_f32_16x16x32_bf16 v[92:95], v[32:35], v[56:59], v[92:95]
    v_mfma_f32_16x16x32_bf16 v[96:99], v[36:39], v[44:47], v[96:99]
    v_mfma_f32_16x16x32_bf16 v[100:103], v[36:39], v[48:51], v[100:103]
    v_mfma_f32_16x16x32_bf16 v[104:107], v[36:39], v[52:55], v[104:107]
    v_mfma_f32_16x16x32_bf16 v[108:111], v[36:39], v[56:59], v[108:111]
    v_mfma_f32_16x16x32_bf16 v[112:115], v[40:43], v[44:47], v[112:115]
    v_mfma_f32_16x16x32_bf16 v[116:119], v[40:43], v[48:51], v[116:119]
    v_mfma_f32_16x16x32_bf16 v[120:123], v[40:43], v[52:55], v[120:123]
    v_mfma_f32_16x16x32_bf16 v[124:127], v[40:43], v[56:59], v[124:127]
    s_waitcnt vmcnt(0)
    s_mov_b32 s40, 6291456
    s_mov_b32 s41, 1572864
    s_add_u32 m0, s42, 0
    s_nop 0
    buffer_load_dwordx4 v9, s[8:11], s40 offen lds
    s_add_u32 m0, s42, 4096
    s_nop 0
    buffer_load_dwordx4 v13, s[12:15], s41 offen lds
    s_add_u32 m0, s42, 1024
    s_nop 0
    buffer_load_dwordx4 v10, s[8:11], s40 offen lds
    s_add_u32 m0, s42, 5120
    s_nop 0
    buffer_load_dwordx4 v14, s[12:15], s41 offen lds
    s_add_u32 m0, s42, 2048
    s_nop 0
    buffer_load_dwordx4 v11, s[8:11], s40 offen lds
    s_add_u32 m0, s42, 6144
    s_nop 0
    buffer_load_dwordx4 v15, s[12:15], s41 offen lds
    s_add_u32 m0, s42, 3072
    s_nop 0
    buffer_load_dwordx4 v12, s[8:11], s40 offen lds
    s_add_u32 m0, s42, 7168
    s_nop 0
    buffer_load_dwordx4 v16, s[12:15], s41 offen lds
    ds_read_b64_tr_b16 v[28:29], v1 offset:8192
    ds_read_b64_tr_b16 v[30:31], v1 offset:8704
    ds_read_b64_tr_b16 v[32:33], v2 offset:8192
    ds_read_b64_tr_b16 v[34:35], v2 offset:8704
    ds_read_b64_tr_b16 v[36:37], v3 offset:8192
    ds_read_b64_tr_b16 v[38:39], v3 offset:8704
    ds_read_b64_tr_b16 v[40:41], v4 offset:8192
    ds_read_b64_tr_b16 v[42:43], v4 offset:8704
    ds_read_b64_tr_b16 v[44:45], v1 offset:12288
    ds_read_b64_tr_b16 v[46:47], v1 offset:12800
    ds_read_b64_tr_b16 v[48:49], v2 offset:12288
    ds_read_b64_tr_b16 v[50:51], v2 offset:12800
    ds_read_b64_tr_b16 v[52:53], v3 offset:12288
    ds_read_b64_tr_b16 v[54:55], v3 offset:12800
    ds_read_b64_tr_b16 v[56:57], v4 offset:12288
    ds_read_b64_tr_b16 v[58:59], v4 offset:12800
    s_waitcnt lgkmcnt(0)
    v_mfma_f32_16x16x32_bf16 v[64:67], v[28:31], v[44:47], v[64:67]
    v_mfma_f32_16x16x32_bf16 v[68:71], v[28:31], v[48:51], v[68:71]
    v_mfma_f32_16x16x32_bf16 v[72:75], v[28:31], v[52:55], v[72:75]
    v_mfma_f32_16x16x32_bf16 v[76:79], v[28:31], v[56:59], v[76:79]
    v_mfma_f32_16x16x32_bf16 v[80:83], v[32:35], v[44:47], v[80:83]
    v_mfma_f32_16x16x32_bf16 v[84:87], v[32:35], v[48:51], v[84:87]
    v_mfma_f32_16x16x32_bf16 v[88:91], v[32:35], v[52:55], v[88:91]
    v_mfma_f32_16x16x32_bf16 v[92:95], v[32:35], v[56:59], v[92:95]
    v_mfma_f32_16x16x32_bf16 v[96:99], v[36:39], v[44:47], v[96:99]
    v_mfma_f32_16x16x32_bf16 v[100:103], v[36:39], v[48:51], v[100:103]
    v_mfma_f32_16x16x32_bf16 v[104:107], v[36:39], v[52:55], v[104:107]
    v_mfma_f32_16x16x32_bf16 v[108:111], v[36:39], v[56:59], v[108:111]
    v_mfma_f32_16x16x32_bf16 v[112:115], v[40:43], v[44:47], v[112:115]
    v_mfma_f32_16x16x32_bf16 v[116:119], v[40:43], v[48:51], v[116:119]
    v_mfma_f32_16x16x32_bf16 v[120:123], v[40:43], v[52:55], v[120:123]
    v_mfma_f32_16x16x32_bf16 v[124:127], v[40:43], v[56:59], v[124:127]
    s_waitcnt vmcnt(0)
    s_mov_b32 s40, 6815744
    s_mov_b32 s41, 1703936
    s_add_u32 m0, s42, 8192
    s_nop 0
    buffer_load_dwordx4 v9, s[8:11], s40 offen lds
    s_add_u32 m0, s42, 12288
    s_nop 0
    buffer_load_dwordx4 v13, s[12:15], s41 offen lds
    s_add_u32 m0, s42, 9216
    s_nop 0
    buffer_load_dwordx4 v10, s[8:11], s40 offen lds
    s_add_u32 m0, s42, 13312
    s_nop 0
    buffer_load_dwordx4 v14, s[12:15], s41 offen lds
    s_add_u32 m0, s42, 10240
    s_nop 0
    buffer_load_dwordx4 v11, s[8:11], s40 offen lds
    s_add_u32 m0, s42, 14336
    s_nop 0
    buffer_load_dwordx4 v15, s[12:15], s41 offen lds
    s_add_u32 m0, s42, 11264
    s_nop 0
    buffer_load_dwordx4 v12, s[8:11], s40 offen lds
    s_add_u32 m0, s42, 15360
    s_nop 0
    buffer_load_dwordx4 v16, s[12:15], s41 offen lds
    ds_read_b64_tr_b16 v[28:29], v1 offset:0
    ds_read_b64_tr_b16 v[30:31], v1 offset:512
    ds_read_b64_tr_b16 v[32:33], v2 offset:0
    ds_read_b64_tr_b16 v[34:35], v2 offset:512
    ds_read_b64_tr_b16 v[36:37], v3 offset:0
    ds_read_b64_tr_b16 v[38:39], v3 offset:512
    ds_read_b64_tr_b16 v[40:41], v4 offset:0
    ds_read_b64_tr_b16 v[42:43], v4 offset:512
    ds_read_b64_tr_b16 v[44:45], v1 offset:4096
    ds_read_b64_tr_b16 v[46:47], v1 offset:4608
    ds_read_b64_tr_b16 v[48:49], v2 offset:4096
    ds_read_b64_tr_b16 v[50:51], v2 offset:4608
    ds_read_b64_tr_b16 v[52:53], v3 offset:4096
    ds_read_b64_tr_b16 v[54:55], v3 offset:4608
    ds_read_b64_tr_b16 v[56:57], v4 offset:4096
    ds_read_b64_tr_b16 v[58:59], v4 offset:4608
    s_waitcnt lgkmcnt(0)
    v_mfma_f32_16x16x32_bf16 v[64:67], v[28:31], v[44:47], v[64:67]
    v_mfma_f32_16x16x32_bf16 v[68:71], v[28:31], v[48:51], v[68:71]
    v_mfma_f32_16x16x32_bf16 v[72:75], v[28:31], v[52:55], v[72:75]
    v_mfma_f32_16x16x32_bf16 v[76:79], v[28:31], v[56:59], v[76:79]
    v_mfma_f32_16x16x32_bf16 v[80:83], v[32:35], v[44:47], v[80:83]
    v_mfma_f32_16x16x32_bf16 v[84:87], v[32:35], v[48:51], v[84:87]
    v_mfma_f32_16x16x32_bf16 v[88:91], v[32:35], v[52:55], v[88:91]
    v_mfma_f32_16x16x32_bf16 v[92:95], v[32:35], v[56:59], v[92:95]
    v_mfma_f32_16x16x32_bf16 v[96:99], v[36:39], v[44:47], v[96:99]
    v_mfma_f32_16x16x32_bf16 v[100:103], v[36:39], v[48:51], v[100:103]
    v_mfma_f32_16x16x32_bf16 v[104:107], v[36:39], v[52:55], v[104:107]
    v_mfma_f32_16x16x32_bf16 v[108:111], v[36:39], v[56:59], v[108:111]
    v_mfma_f32_16x16x32_bf16 v[112:115], v[40:43], v[44:47], v[112:115]
    v_mfma_f32_16x16x32_bf16 v[116:119], v[40:43], v[48:51], v[116:119]
    v_mfma_f32_16x16x32_bf16 v[120:123], v[40:43], v[52:55], v[120:123]
    v_mfma_f32_16x16x32_bf16 v[124:127], v[40:43], v[56:59], v[124:127]
    s_waitcnt vmcnt(0)
    ds_read_b64_tr_b16 v[28:29], v1 offset:8192
    ds_read_b64_tr_b16 v[30:31], v1 offset:8704
    ds_read_b64_tr_b16 v[32:33], v2 offset:8192
    ds_read_b64_tr_b16 v[34:35], v2 offset:8704
    ds_read_b64_tr_b16 v[36:37], v3 offset:8192
    ds_read_b64_tr_b16 v[38:39], v3 offset:8704
    ds_read_b64_tr_b16 v[40:41], v4 offset:8192
    ds_read_b64_tr_b16 v[42:43], v4 offset:8704
    ds_read_b64_tr_b16 v[44:45], v1 offset:12288
    ds_read_b64_tr_b16 v[46:47], v1 offset:12800
    ds_read_b64_tr_b16 v[48:49], v2 offset:12288
    ds_read_b64_tr_b16 v[50:51], v2 offset:12800
    ds_read_b64_tr_b16 v[52:53], v3 offset:12288
    ds_read_b64_tr_b16 v[54:55], v3 offset:12800
    ds_read_b64_tr_b16 v[56:57], v4 offset:12288
    ds_read_b64_tr_b16 v[58:59], v4 offset:12800
    s_waitcnt lgkmcnt(0)
    v_mfma_f32_16x16x32_bf16 v[64:67], v[28:31], v[44:47], v[64:67]
    v_mfma_f32_16x16x32_bf16 v[68:71], v[28:31], v[48:51], v[68:71]
    v_mfma_f32_16x16x32_bf16 v[72:75], v[28:31], v[52:55], v[72:75]
    v_mfma_f32_16x16x32_bf16 v[76:79], v[28:31], v[56:59], v[76:79]
    v_mfma_f32_16x16x32_bf16 v[80:83], v[32:35], v[44:47], v[80:83]
    v_mfma_f32_16x16x32_bf16 v[84:87], v[32:35], v[48:51], v[84:87]
    v_mfma_f32_16x16x32_bf16 v[88:91], v[32:35], v[52:55], v[88:91]
    v_mfma_f32_16x16x32_bf16 v[92:95], v[32:35], v[56:59], v[92:95]
    v_mfma_f32_16x16x32_bf16 v[96:99], v[36:39], v[44:47], v[96:99]
    v_mfma_f32_16x16x32_bf16 v[100:103], v[36:39], v[48:51], v[100:103]
    v_mfma_f32_16x16x32_bf16 v[104:107], v[36:39], v[52:55], v[104:107]
    v_mfma_f32_16x16x32_bf16 v[108:111], v[36:39], v[56:59], v[108:111]
    v_mfma_f32_16x16x32_bf16 v[112:115], v[40:43], v[44:47], v[112:115]
    v_mfma_f32_16x16x32_bf16 v[116:119], v[40:43], v[48:51], v[116:119]
    v_mfma_f32_16x16x32_bf16 v[120:123], v[40:43], v[52:55], v[120:123]
    v_mfma_f32_16x16x32_bf16 v[124:127], v[40:43], v[56:59], v[124:127]
    s_waitcnt lgkmcnt(0)
    s_nop 7
    v_lshl_add_u32 v1, v25, 4, s42
    ds_write_b128 v1, v[64:67] offset:0
    ds_write_b128 v1, v[68:71] offset:1024
    ds_write_b128 v1, v[72:75] offset:2048
    ds_write_b128 v1, v[76:79] offset:3072
    ds_write_b128 v1, v[80:83] offset:4096
    ds_write_b128 v1, v[84:87] offset:5120
    ds_write_b128 v1, v[88:91] offset:6144
    ds_write_b128 v1, v[92:95] offset:7168
    ds_write_b128 v1, v[96:99] offset:8192
    ds_write_b128 v1, v[100:103] offset:9216
    ds_write_b128 v1, v[104:107] offset:10240
    ds_write_b128 v1, v[108:111] offset:11264
    ds_write_b128 v1, v[112:115] offset:12288
    ds_write_b128 v1, v[116:119] offset:13312
    ds_write_b128 v1, v[120:123] offset:14336
    ds_write_b128 v1, v[124:127] offset:15360
    v_lshlrev_b32 v2, 12, v26
    v_lshl_add_u32 v2, v27, 3, v2
    s_lshl_b32 s37, s34, 12
    s_lshl_b32 s35, s30, 4
    s_add_u32 s35, s35, s33
    s_lshl_b32 s35, s35, 1
    s_add_u32 s37, s37, s35
    s_add_u32 s44, s37, 0
    buffer_load_dwordx2 v[28:29], v2, s[16:19], s44 offen
    s_add_u32 s45, s37, 65536
    buffer_load_dwordx2 v[30:31], v2, s[16:19], s45 offen
    s_add_u32 s46, s37, 131072
    buffer_load_dwordx2 v[32:33], v2, s[16:19], s46 offen
    s_add_u32 s47, s37, 196608
    buffer_load_dwordx2 v[34:35], v2, s[16:19], s47 offen
    s_waitcnt lgkmcnt(0)
    s_barrier
    s_lshl_b32 s35, s30, 12
    v_lshl_add_u32 v1, v25, 4, s35
    ds_read_b128 v[64:67], v1 offset:0
    ds_read_b128 v[68:71], v1 offset:1024
    ds_read_b128 v[72:75], v1 offset:2048
    ds_read_b128 v[76:79], v1 offset:3072
    ds_read_b128 v[80:83], v1 offset:16384
    ds_read_b128 v[84:87], v1 offset:17408
    ds_read_b128 v[88:91], v1 offset:18432
    ds_read_b128 v[92:95], v1 offset:19456
    ds_read_b128 v[96:99], v1 offset:32768
    ds_read_b128 v[100:103], v1 offset:33792
    ds_read_b128 v[104:107], v1 offset:34816
    ds_read_b128 v[108:111], v1 offset:35840
    ds_read_b128 v[112:115], v1 offset:49152
    ds_read_b128 v[116:119], v1 offset:50176
    ds_read_b128 v[120:123], v1 offset:51200
    ds_read_b128 v[124:127], v1 offset:52224
    s_waitcnt vmcnt(0) lgkmcnt(0)
    v_add_f32 v64, v64, v80
    v_add_f32 v65, v65, v81
    v_add_f32 v66, v66, v82
    v_add_f32 v67, v67, v83
    v_add_f32 v68, v68, v84
    v_add_f32 v69, v69, v85
    v_add_f32 v70, v70, v86
    v_add_f32 v71, v71, v87
    v_add_f32 v72, v72, v88
    v_add_f32 v73, v73, v89
    v_add_f32 v74, v74, v90
    v_add_f32 v75, v75, v91
    v_add_f32 v76, v76, v92
    v_add_f32 v77, v77, v93
    v_add_f32 v78, v78, v94
    v_add_f32 v79, v79, v95
    v_add_f32 v64, v64, v96
    v_add_f32 v65, v65, v97
    v_add_f32 v66, v66, v98
    v_add_f32 v67, v67, v99
    v_add_f32 v68, v68, v100
    v_add_f32 v69, v69, v101
    v_add_f32 v70, v70, v102
    v_add_f32 v71, v71, v103
    v_add_f32 v72, v72, v104
    v_add_f32 v73, v73, v105
    v_add_f32 v74, v74, v106
    v_add_f32 v75, v75, v107
    v_add_f32 v76, v76, v108
    v_add_f32 v77, v77, v109
    v_add_f32 v78, v78, v110
    v_add_f32 v79, v79, v111
    v_add_f32 v64, v64, v112
    v_add_f32 v65, v65, v113
    v_add_f32 v66, v66, v114
    v_add_f32 v67, v67, v115
    v_add_f32 v68, v68, v116
    v_add_f32 v69, v69, v117
    v_add_f32 v70, v70, v118
    v_add_f32 v71, v71, v119
    v_add_f32 v72, v72, v120
    v_add_f32 v73, v73, v121
    v_add_f32 v74, v74, v122
    v_add_f32 v75, v75, v123
    v_add_f32 v76, v76, v124
    v_add_f32 v77, v77, v125
    v_add_f32 v78, v78, v126
    v_add_f32 v79, v79, v127
    v_mov_b32 v40, 0
    v_mov_b32 v41, 0
    v_mov_b32 v42, 0
    v_mov_b32 v43, 0
    v_mov_b32 v44, 0
    v_mov_b32 v45, 0
    v_mov_b32 v46, 0
    v_mov_b32 v47, 0
    v_cvt_pk_bf16_f32 v50, v64, v65
    v_cvt_pk_bf16_f32 v51, v66, v67
    s_nop 0
    v_lshlrev_b32 v52, 16, v50
    v_lshlrev_b32 v53, 16, v28
    v_add_f32 v52, v52, v53
    v_and_b32 v53, 0xffff0000, v50
    v_and_b32 v54, 0xffff0000, v28
    v_add_f32 v53, v53, v54
    v_cvt_pk_bf16_f32 v56, v52, v53
    s_nop 0
    v_lshlrev_b32 v52, 16, v51
    v_lshlrev_b32 v53, 16, v29
    v_add_f32 v52, v52, v53
    v_and_b32 v53, 0xffff0000, v51
    v_and_b32 v54, 0xffff0000, v29
    v_add_f32 v53, v53, v54
    v_cvt_pk_bf16_f32 v57, v52, v53
    s_nop 0
    v_lshlrev_b32 v3, 12, v27
    v_lshl_add_u32 v3, v26, 1, v3
    s_lshl_b32 s35, s30, 4
    s_add_u32 s35, s35, s33
    s_lshl_b32 s35, s35, 10
    s_lshl_b32 s36, s34, 1
    s_add_u32 s35, s35, s36
    s_add_u32 s35, s35, 0
    s_nop 3
    buffer_store_short v56, v3, s[20:23], s35 offen offset:0
    buffer_store_short_d16_hi v56, v3, s[20:23], s35 offen offset:1024
    buffer_store_short v57, v3, s[20:23], s35 offen offset:2048
    buffer_store_short_d16_hi v57, v3, s[20:23], s35 offen offset:3072
    s_nop 0
    v_cvt_pk_bf16_f32 v50, v68, v69
    v_cvt_pk_bf16_f32 v51, v70, v71
    s_nop 0
    v_lshlrev_b32 v52, 16, v50
    v_lshlrev_b32 v53, 16, v30
    v_add_f32 v52, v52, v53
    v_and_b32 v53, 0xffff0000, v50
    v_and_b32 v54, 0xffff0000, v30
    v_add_f32 v53, v53, v54
    v_cvt_pk_bf16_f32 v56, v52, v53
    s_nop 0
    v_lshlrev_b32 v52, 16, v51
    v_lshlrev_b32 v53, 16, v31
    v_add_f32 v52, v52, v53
    v_and_b32 v53, 0xffff0000, v51
    v_and_b32 v54, 0xffff0000, v31
    v_add_f32 v53, v53, v54
    v_cvt_pk_bf16_f32 v57, v52, v53
    s_nop 0
    v_lshlrev_b32 v3, 12, v27
    v_lshl_add_u32 v3, v26, 1, v3
    s_lshl_b32 s35, s30, 4
    s_add_u32 s35, s35, s33
    s_lshl_b32 s35, s35, 10
    s_lshl_b32 s36, s34, 1
    s_add_u32 s35, s35, s36
    s_add_u32 s35, s35, 32
    s_nop 3
    buffer_store_short v56, v3, s[20:23], s35 offen offset:0
    buffer_store_short_d16_hi v56, v3, s[20:23], s35 offen offset:1024
    buffer_store_short v57, v3, s[20:23], s35 offen offset:2048
    buffer_store_short_d16_hi v57, v3, s[20:23], s35 offen offset:3072
    s_nop 0
    v_cvt_pk_bf16_f32 v50, v72, v73
    v_cvt_pk_bf16_f32 v51, v74, v75
    s_nop 0
    v_lshlrev_b32 v52, 16, v50
    v_lshlrev_b32 v53, 16, v32
    v_add_f32 v52, v52, v53
    v_and_b32 v53, 0xffff0000, v50
    v_and_b32 v54, 0xffff0000, v32
    v_add_f32 v53, v53, v54
    v_cvt_pk_bf16_f32 v56, v52, v53
    s_nop 0
    v_lshlrev_b32 v52, 16, v51
    v_lshlrev_b32 v53, 16, v33
    v_add_f32 v52, v52, v53
    v_and_b32 v53, 0xffff0000, v51
    v_and_b32 v54, 0xffff0000, v33
    v_add_f32 v53, v53, v54
    v_cvt_pk_bf16_f32 v57, v52, v53
    s_nop 0
    v_lshlrev_b32 v3, 12, v27
    v_lshl_add_u32 v3, v26, 1, v3
    s_lshl_b32 s35, s30, 4
    s_add_u32 s35, s35, s33
    s_lshl_b32 s35, s35, 10
    s_lshl_b32 s36, s34, 1
    s_add_u32 s35, s35, s36
    s_add_u32 s35, s35, 64
    s_nop 3
    buffer_store_short v56, v3, s[20:23], s35 offen offset:0
    buffer_store_short_d16_hi v56, v3, s[20:23], s35 offen offset:1024
    buffer_store_short v57, v3, s[20:23], s35 offen offset:2048
    buffer_store_short_d16_hi v57, v3, s[20:23], s35 offen offset:3072
    s_nop 0
    v_cvt_pk_bf16_f32 v50, v76, v77
    v_cvt_pk_bf16_f32 v51, v78, v79
    s_nop 0
    v_lshlrev_b32 v52, 16, v50
    v_lshlrev_b32 v53, 16, v34
    v_add_f32 v52, v52, v53
    v_and_b32 v53, 0xffff0000, v50
    v_and_b32 v54, 0xffff0000, v34
    v_add_f32 v53, v53, v54
    v_cvt_pk_bf16_f32 v56, v52, v53
    s_nop 0
    v_lshlrev_b32 v52, 16, v51
    v_lshlrev_b32 v53, 16, v35
    v_add_f32 v52, v52, v53
    v_and_b32 v53, 0xffff0000, v51
    v_and_b32 v54, 0xffff0000, v35
    v_add_f32 v53, v53, v54
    v_cvt_pk_bf16_f32 v57, v52, v53
    s_nop 0
    v_lshlrev_b32 v3, 12, v27
    v_lshl_add_u32 v3, v26, 1, v3
    s_lshl_b32 s35, s30, 4
    s_add_u32 s35, s35, s33
    s_lshl_b32 s35, s35, 10
    s_lshl_b32 s36, s34, 1
    s_add_u32 s35, s35, s36
    s_add_u32 s35, s35, 96
    s_nop 3
    buffer_store_short v56, v3, s[20:23], s35 offen offset:0
    buffer_store_short_d16_hi v56, v3, s[20:23], s35 offen offset:1024
    buffer_store_short v57, v3, s[20:23], s35 offen offset:2048
    buffer_store_short_d16_hi v57, v3, s[20:23], s35 offen offset:3072
    s_nop 0
g2b_exit:
    s_endpgm

.section .rodata,"a"
.p2align 6
.amdhsa_kernel prep_kernel
  .amdhsa_next_free_vgpr 128
  .amdhsa_next_free_sgpr 96
  .amdhsa_accum_offset 128
  .amdhsa_group_segment_fixed_size 0
  .amdhsa_kernarg_size 128
  .amdhsa_user_sgpr_count 2
  .amdhsa_user_sgpr_kernarg_segment_ptr 1
  .amdhsa_system_sgpr_workgroup_id_x 1
.end_amdhsa_kernel

.p2align 6
.amdhsa_kernel conv1_kernel
  .amdhsa_next_free_vgpr 256
  .amdhsa_next_free_sgpr 96
  .amdhsa_accum_offset 256
  .amdhsa_group_segment_fixed_size 0
  .amdhsa_kernarg_size 128
  .amdhsa_user_sgpr_count 2
  .amdhsa_user_sgpr_kernarg_segment_ptr 1
  .amdhsa_system_sgpr_workgroup_id_x 1
.end_amdhsa_kernel

.p2align 6
.amdhsa_kernel g1a_kernel
  .amdhsa_next_free_vgpr 256
  .amdhsa_next_free_sgpr 96
  .amdhsa_accum_offset 256
  .amdhsa_group_segment_fixed_size 0
  .amdhsa_kernarg_size 128
  .amdhsa_user_sgpr_count 2
  .amdhsa_user_sgpr_kernarg_segment_ptr 1
  .amdhsa_system_sgpr_workgroup_id_x 1
.end_amdhsa_kernel

.p2align 6
.amdhsa_kernel g2a_kernel
  .amdhsa_next_free_vgpr 128
  .amdhsa_next_free_sgpr 96
  .amdhsa_accum_offset 128
  .amdhsa_group_segment_fixed_size 0
  .amdhsa_kernarg_size 128
  .amdhsa_user_sgpr_count 2
  .amdhsa_user_sgpr_kernarg_segment_ptr 1
  .amdhsa_system_sgpr_workgroup_id_x 1
.end_amdhsa_kernel

.p2align 6
.amdhsa_kernel conv2_kernel
  .amdhsa_next_free_vgpr 256
  .amdhsa_next_free_sgpr 96
  .amdhsa_accum_offset 256
  .amdhsa_group_segment_fixed_size 0
  .amdhsa_kernarg_size 128
  .amdhsa_user_sgpr_count 2
  .amdhsa_user_sgpr_kernarg_segment_ptr 1
  .amdhsa_system_sgpr_workgroup_id_x 1
.end_amdhsa_kernel

.p2align 6
.amdhsa_kernel g1b_kernel
  .amdhsa_next_free_vgpr 256
  .amdhsa_next_free_sgpr 96
  .amdhsa_accum_offset 256
  .amdhsa_group_segment_fixed_size 0
  .amdhsa_kernarg_size 128
  .amdhsa_user_sgpr_count 2
  .amdhsa_user_sgpr_kernarg_segment_ptr 1
  .amdhsa_system_sgpr_workgroup_id_x 1
.end_amdhsa_kernel

.p2align 6
.amdhsa_kernel g2b_kernel
  .amdhsa_next_free_vgpr 128
  .amdhsa_next_free_sgpr 96
  .amdhsa_accum_offset 128
  .amdhsa_group_segment_fixed_size 0
  .amdhsa_kernarg_size 128
  .amdhsa_user_sgpr_count 2
  .amdhsa_user_sgpr_kernarg_segment_ptr 1
  .amdhsa_system_sgpr_workgroup_id_x 1
.end_amdhsa_kernel
```
